```python
import torch

def _softmax(x, axis=-1):
    return torch.softmax(x, dim=axis)
def _gelu(x):
    return torch.nn.functional.gelu(x, approximate="tanh")
def _silu(x):
    return torch.nn.functional.silu(x)
def _sigmoid(x):
    return torch.sigmoid(x)
def _layernorm(x, axis=-1, eps=1e-5):
    m = x.mean(dim=axis, keepdim=True)
    v = x.var(dim=axis, keepdim=True, unbiased=False)
    return (x - m) / torch.sqrt(v + eps)
def _scatter_add(tgt, idx, src, axis=0):
    return tgt.clone().index_add_(axis, idx, src)
def _segment_sum(src, seg, n):
    out = torch.zeros((n,) + src.shape[1:], dtype=src.dtype)
    return out.index_add_(0, seg, src)
def _pad(x, pw):
    flat = tuple(v for pair in reversed(pw) for v in pair)
    return torch.nn.functional.pad(x, flat)

kernel_name = 'interleave_layers__sliding_local_dilated__swiglu_ffn__prompt'

def setup_inputs():

    _w = (lambda a: (lambda t: t.to(torch.bfloat16) if t.is_floating_point() else t)(torch.as_tensor(a)))
    def _A_setup():
        B, S, D = 1, 2048, 448
        return {
            "x": _w((lambda *s: torch.randn(*s, dtype=torch.bfloat16) * 0.05)(B, S, D)),
            "wqkv": _w((lambda *s: torch.randn(*s, dtype=torch.bfloat16) * 0.05)(D, 3 * D)),
            "wo": _w((lambda *s: torch.randn(*s, dtype=torch.bfloat16) * 0.05)(D, D)),
        }
    _A_in = _A_setup()

    def _B_setup():
        B, S, D, F = 1, 2048, 448, 1792
        return {
            "x": _w((lambda *s: torch.randn(*s, dtype=torch.bfloat16) * 0.05)(B, S, D)),
            "w_gate": _w((lambda *s: torch.randn(*s, dtype=torch.bfloat16) * 0.05)(D, F)),
            "w_up": _w((lambda *s: torch.randn(*s, dtype=torch.bfloat16) * 0.05)(D, F)),
            "w_down": _w((lambda *s: torch.randn(*s, dtype=torch.bfloat16) * 0.05)(F, D)),
        }
    _B_in = _B_setup()

    return {
        "A_x": _A_in["x"],
        "A_wqkv": _A_in["wqkv"],
        "A_wo": _A_in["wo"],
        "B_x": _B_in["x"],
        "B_w_gate": _B_in["w_gate"],
        "B_w_up": _B_in["w_up"],
        "B_w_down": _B_in["w_down"],
    }

def reference(A_x, A_wqkv, A_wo, B_x, B_w_gate, B_w_up, B_w_down):
    def _A_ref(x, wqkv, wo):
        B, S, D = x.shape
        H = 16; Dh = D // H
        W, dil = 8, 2
        qkv = (lambda x, *d: x.permute(*d))((x @ wqkv).reshape(B, S, 3, H, Dh), 2, 0, 3, 1, 4)
        q, k, v = qkv[0], qkv[1], qkv[2]
        scale = Dh ** -0.5
        pos = torch.arange(S)
        off = torch.arange(W) * dil
        idx = pos[:, None] - off[None, :]
        mask = idx >= 0
        idx_c = torch.where(mask, idx, 0).reshape(-1)
        kg = k[:, :, idx_c, :].reshape(B, H, S, W, Dh)
        vg = v[:, :, idx_c, :].reshape(B, H, S, W, Dh)
        logits = torch.einsum("bhsd,bhswd->bhsw", q, kg) * scale
        logits = torch.where(mask[None, None, :, :], logits, -1e9)
        attn = _softmax(logits, axis=-1)
        o = torch.einsum("bhsw,bhswd->bhsd", attn, vg)
        return (lambda x, *d: x.permute(*d))(o, 0, 2, 1, 3).reshape(B, S, D) @ wo

    def _B_ref(x, w_gate, w_up, w_down):
        g = _silu(x @ w_gate)
        u = x @ w_up
        return (g * u) @ w_down

    x = A_x
    x = x + _A_ref(_layernorm(x, axis=-1), A_wqkv, A_wo)
    x = x + _B_ref(_layernorm(x, axis=-1), B_w_gate, B_w_up, B_w_down)
    x = x + _A_ref(_layernorm(x, axis=-1), A_wqkv, A_wo)
    x = x + _B_ref(_layernorm(x, axis=-1), B_w_gate, B_w_up, B_w_down)
    return x
```

```asm
; @launch grid=(256,1,1) block=(256,1,1) lds=163840
.amdgcn_target "amdgcn-amd-amdhsa--gfx950"
.text
.globl interleave_layers__sliding_local_dilated__swiglu_ffn__prompt_kernel
.p2align 8
.type interleave_layers__sliding_local_dilated__swiglu_ffn__prompt_kernel,@function
interleave_layers__sliding_local_dilated__swiglu_ffn__prompt_kernel:
    s_load_dwordx16 s[68:83], s[0:1], 0
    s_load_dwordx4 s[96:99], s[0:1], 64
    s_memrealtime s[54:55]
    s_cmp_ge_u32 s2, 256
    s_cbranch_scc1 Lend_1
    v_lshrrev_b32 v30, 6, v0
    v_and_b32 v31, 63, v0
    s_getpc_b64 s[12:13]
Lpc_3:
    v_readfirstlane_b32 s24, v30
    v_lshlrev_b32 v1, 4, v31
    s_and_b32 s13, s13, 0xffff
    s_mov_b32 s14, Lfast_end-Lpc_3
    s_mov_b32 s15, 0x00020000
    v_lshl_add_u32 v29, v30, 15, v1
    s_lshr_b32 s61, s2, 3
    s_lshl_b32 s60, s61, 10
    buffer_load_dwordx4 v[12:15], v29, s[12:15], s60 offen
    s_sub_u32 s62, s2, 16
    s_and_b32 s64, s2, 7
    s_mul_i32 s64, s64, 14
    s_add_u32 s64, s64, s61
    s_sub_u32 s64, s64, 2
    s_and_b32 s63, s64, 3
    s_and_b32 s64, s64, 0x7c
    s_add_u32 s65, s64, s24
    s_mul_i32 s65, s65, 10752
    s_mul_i32 s66, s63, 224
    s_add_u32 s32, s65, s66
    v_lshrrev_b32 v26, 4, v31
    v_and_b32 v25, 0xf0, v1
    s_movk_i32 s65, 2688
    v_min_u32 v25, 0xd0, v25
    v_mad_u32_u24 v176, v26, s65, v25
    s_mov_b32 s90, 1204224
    s_mov_b32 s91, 0x00020000
    s_lshl_b32 s22, s24, 10
    s_mov_b32 m0, s22
    s_and_b32 s25, s61, 15
    s_and_b32 s59, s2, 7
    s_lshl_b32 s59, s59, 1
    s_lshr_b32 s65, s2, 7
    s_add_u32 s59, s59, s65
    s_cmp_lt_u32 s62, 112
    s_waitcnt lgkmcnt(0)
    s_mov_b32 s84, s68
    s_cbranch_scc0 LuN_4
    s_mov_b32 s88, s70
    s_and_b32 s89, s71, 0xffff
    buffer_load_dwordx4 v176, s[88:91], s32 offen lds
    s_add_u32 m0, s22, 3200
    s_nop 0
    buffer_load_dwordx4 v176, s[88:91], s32 offen offset:896 lds
    s_add_u32 m0, s22, 6400
    s_nop 0
    buffer_load_dwordx4 v176, s[88:91], s32 offen offset:1792 lds
    s_lshl_b32 s65, s63, 2
    s_add_u32 s65, s65, s24
    s_mul_i32 s66, s65, 86016
    s_lshl_b32 s63, s64, 8
    s_add_u32 s66, s66, s63
    s_add_u32 s68, s66, s63
    s_add_u32 s89, s66, 57344
    s_mul_i32 s66, s65, 10752
    s_lshl_b32 s63, s64, 5
    s_add_u32 s66, s66, s63
    s_add_u32 s70, s66, 0x390000
    s_lshl_b32 s66, s65, 10
    s_lshl_b32 s63, s64, 3
    s_add_u32 s66, s66, s63
    s_add_u32 s71, s66, 0x720000
LuJ_5:
    s_lshr_b32 s63, s59, 3
    s_lshl_b32 s64, s24, 4
    s_add_u32 s64, s64, s25
    s_and_b32 s67, s59, 7
    s_lshl_b32 s62, s67, 6
    s_add_u32 s62, s62, s64
    s_lshl_b32 s62, s62, 2
    s_add_u32 s62, s62, s63
    s_mul_i32 s62, s62, 896
    v_lshrrev_b32 v29, 5, v31
    v_mul_u32_u24 v25, 1280, v29
    v_add_u32 v25, v25, v1
    s_mov_b32 s20, 0x0fffffff
    s_mov_b32 s21, s20
    v_cndmask_b32_e64 v25, 2.0, v25, s[20:21]
    s_mov_b32 s87, 0x00020000
    s_mov_b32 s86, 1835008
    s_and_b32 s85, s69, 0xffff
    buffer_load_dwordx4 v[208:211], v25, s[84:87], s62 offen
    buffer_load_dwordx4 v[212:215], v25, s[84:87], s62 offen offset:448
    s_sub_u32 s65, s59, 1
    s_and_b32 s65, s65, 7
    s_lshl_b32 s65, s65, 8
    s_add_u32 s48, s65, s63
    s_and_b32 s64, s64, 7
    s_lshl_b32 s64, s64, 1
    s_add_u32 s64, s64, s48
    s_add_u32 s64, s64, 240
    s_mul_i32 s64, s64, 896
    v_min_u32 v27, 6, v31
    v_lshlrev_b32 v27, 7, v27
    v_lshrrev_b32 v28, 3, v31
    buffer_load_dword v9, v27, s[84:87], s64 offen
    s_mov_b32 s19, 0x00020000
    s_mov_b32 s95, 0x00020000
    s_mov_b32 s7, 0x00020000
    s_mov_b32 s11, 0x00020000
    s_mov_b32 s4, s98
    s_and_b32 s5, s99, 0xffff
    s_mov_b32 s6, 0x10000000
    s_mov_b32 s92, s96
    s_and_b32 s93, s97, 0xffff
    s_movk_i32 s94, 256
    s_mov_b32 s8, s82
    s_and_b32 s9, s83, 0xffff
    s_mov_b32 s10, 1835008
    s_and_b32 s60, s24, 1
    s_lshr_b32 s61, s24, 1
    s_mov_b32 s96, 0x10000000
    s_mov_b32 s97, 14336
    s_mov_b32 s36, 896
    s_mov_b32 s37, 32
    s_lshl_b32 s65, s61, 11
    s_lshl_b32 s66, s60, 6
    s_add_u32 s38, s65, s66
    s_mov_b32 s40, 0x10000000
    s_mov_b32 s27, 0x10000000
    s_mov_b64 s[16:17], s[80:81]
    s_mov_b32 s18, 1605632
    s_sub_u32 s62, s2, 128
    s_cmp_lt_u32 s62, 112
    s_cbranch_scc0 Lu4_7
    s_cmp_lt_u32 s24, 2
    s_cselect_b64 s[16:17], s[76:77], s[78:79]
    s_lshr_b32 s62, s62, 2
    s_and_b32 s63, s2, 3
    s_mul_i32 s64, s63, 14
    s_add_u32 s64, s64, s60
    s_mul_i32 s64, s64, 28672
    s_lshl_b32 s65, s62, 7
    s_add_u32 s96, s64, s65
    s_mov_b32 s97, 57344
    s_movk_i32 s36, 3584
    s_movk_i32 s37, 2048
    s_lshl_b32 s38, s24, 5
    s_lshl_b32 s64, s62, 2
    s_add_u32 s64, s64, s24
    s_mul_i32 s65, s64, 9363
    s_lshr_b32 s65, s65, 16
    s_add_u32 s65, s65, s64
    s_and_b32 s66, s65, 1
    s_mul_i32 s66, s66, 768
    s_lshl_b32 s65, s65, 10
    s_sub_u32 s65, s65, s66
    s_lshr_b32 s66, s63, 1
    s_lshl_b32 s66, s66, 9
    s_add_u32 s65, s65, s66
    s_and_b32 s66, s63, 1
    s_lshl_b32 s66, s66, 10
    s_add_u32 s65, s65, s66
    s_add_u32 s27, s65, 0x1d0000
    s_lshl_b32 s64, s64, 2
    s_add_u32 s64, s64, s63
    s_mul_i32 s64, s64, 7168
    s_add_u32 s40, s64, 0x400000
LuD_8:
    s_and_b32 s17, s17, 0xffff
    v_and_b32 v27, 0x70, v1
    v_mad_u32_u24 v177, v28, s36, v27
    v_lshlrev_b32 v2, 2, v31
    v_add_u32 v0, 0x1000, v1
    v_lshlrev_b32 v26, 4, v26
    v_xor_b32 v27, v27, v26
    s_movk_i32 s62, 1792
    v_mad_u32_u24 v221, v28, s62, v27
    v_xor_b32 v222, 64, v221
    s_add_u32 s69, s40, 3072
    s_cmp_eq_u32 s71, 0x10000000
    s_cselect_b32 s68, s40, s68
    s_lshl_b32 s62, s67, 2
    s_add_u32 s62, s62, s24
    s_lshl_b32 s62, s62, 6
    s_lshr_b32 s63, s59, 3
    s_add_u32 s62, s62, s63
    s_mul_i32 s74, s62, 896
    s_add_u32 s75, s74, 14336
    s_add_u32 s76, s74, 28672
    s_add_u32 s77, s74, 43008
    s_lshl_b32 s78, s24, 12
    s_lshl_b32 s62, s48, 2
    s_add_u32 s62, s62, s24
    s_add_u32 s62, s62, 960
    s_mul_i32 s83, s62, 224
    v_bfe_u32 v27, v31, 2, 2
    v_lshl_add_u32 v28, v29, 2, v27
    v_bfe_u32 v27, v31, 4, 1
    v_and_b32 v26, 3, v31
    v_lshlrev_b32 v26, 3, v26
    v_mad_u32_u24 v180, v27, s37, v26
    v_lshl_add_u32 v180, v28, 7, v180
    v_add_u32 v180, s38, v180
    v_lshl_add_u32 v178, v27, 5, v26
    v_lshl_add_u32 v178, v28, 8, v178
    s_mul_i32 s62, s24, 56
    v_add_u32 v178, s62, v178
    v_cndmask_b32_e64 v181, 0, -1, s[20:21]
    v_lshlrev_b32 v7, 6, v29
    v_sub_u32 v7, v1, v7
    v_cndmask_b32_e64 v7, 2.0, v7, s[20:21]
    v_mul_u32_u24 v188, 3456, v29
    v_add_u32 v188, v188, v2
    v_and_b32 v28, 0x7c, v2
    v_add_u32 v28, 7168, v28
    v_min_u32 v6, 1, v31
    v_lshlrev_b32 v6, 28, v6
    s_getreg_b32 s3, hwreg(HW_REG_XCC_ID)
    s_and_b32 s3, s3, 15
    s_mov_b32 s23, 0x3f803f80
    s_mov_b32 s30, 40000
    s_lshl_b32 s22, s24, 10
    s_cmp_lg_u32 s71, 0x10000000
    s_cbranch_scc1 LnoU_9
    s_add_u32 m0, s22, 0
    s_nop 0
    buffer_load_dwordx4 v177, s[16:19], s96 offen lds
    s_add_u32 s96, s96, s97
    s_add_u32 m0, s22, 4096
    s_nop 0
    buffer_load_dwordx4 v177, s[16:19], s96 offen lds
    s_add_u32 s96, s96, s97
    s_add_u32 m0, s22, 8192
    s_nop 0
    buffer_load_dwordx4 v177, s[16:19], s96 offen lds
    s_add_u32 s96, s96, s97
    s_add_u32 m0, s22, 12288
    s_nop 0
    buffer_load_dwordx4 v177, s[16:19], s96 offen lds
    s_add_u32 s96, s96, s97
    s_add_u32 m0, s22, 16384
    s_nop 0
    buffer_load_dwordx4 v177, s[16:19], s96 offen lds
    s_add_u32 s96, s96, s97
    s_add_u32 m0, s22, 20480
    s_nop 0
    buffer_load_dwordx4 v177, s[16:19], s96 offen lds
    s_add_u32 s96, s96, s97
    s_add_u32 m0, s22, 24576
    s_nop 0
    buffer_load_dwordx4 v177, s[16:19], s96 offen lds
    s_add_u32 s96, s96, s97
LnoU_9:
    s_lshl_b32 s26, s59, 21
    s_add_u32 s26, s26, 0x800000
    s_mul_i32 s55, s24, 7168
    s_mul_i32 s38, s25, 86016
    s_mul_i32 s36, s24, 14336
    s_add_u32 s36, s36, s26
    s_add_u32 s36, s36, 0x20000
    v_and_b32 v10, 7, v31
    v_lshlrev_b32 v10, 2, v10
    v_and_b32 v11, 15, v31
    v_min_u32 v11, 13, v11
    v_lshlrev_b32 v11, 2, v11
    v_and_b32 v30, 31, v31
    v_lshlrev_b32 v3, 3, v30
    v_min_u32 v4, 55, v31
    v_lshlrev_b32 v4, 7, v4
    s_mov_b32 s53, 0x05040100
    s_lshl_b32 s37, s24, 12
    s_add_u32 s37, s37, s26
    s_lshl_b32 s61, s25, 2
    s_add_u32 s29, s61, s24
    s_mov_b32 s40, s72
    s_and_b32 s41, s73, 0xffff
    s_mov_b32 s42, 401408
    s_mov_b32 s43, 0x00020000
    s_add_u32 s61, s59, 1
    s_and_b32 s61, s61, 7
    s_and_b32 s62, s59, 8
    s_or_b32 s61, s61, s62
    s_lshl_b32 s28, s61, 21
    s_add_u32 s28, s28, 0x800000
    s_and_b32 s61, s59, 7
    s_or_b32 s61, s61, s24
    s_cmp_eq_u32 s61, 0
    s_cselect_b32 s31, 0, -1
    s_mul_i32 s39, s25, 200704
    s_add_u32 s39, s39, s55
    s_add_u32 s39, s39, 0x400000
    s_mul_i32 s61, s29, 7168
    s_add_u32 s61, s61, 0x20000
    s_add_u32 s57, s61, s26
    s_add_u32 s66, s26, 0xc000
    s_lshr_b32 s61, s24, 1
    s_lshl_b32 s61, s61, 7
    s_lshr_b32 s62, s25, 2
    s_lshl_b32 s62, s62, 5
    s_add_u32 s61, s61, s62
    s_and_b32 s62, s24, 1
    s_lshl_b32 s62, s62, 4
    s_add_u32 s61, s61, s62
    s_and_b32 s62, s25, 3
    s_lshl_b32 s62, s62, 2
    s_add_u32 s61, s61, s62
    s_add_u32 s54, s61, s66
    s_and_b32 s61, s25, 1
    s_lshl_b32 s61, s61, 7
    s_lshl_b32 s62, s24, 5
    s_add_u32 s61, s61, s62
    s_add_u32 s56, s61, s66
    s_lshl_b32 s61, s24, 6
    s_add_u32 s101, s61, s66
    s_xor_b32 s61, s24, 1
    s_mul_i32 s61, s61, 12288
    s_add_u32 s32, s61, 57344
    s_xor_b32 s61, s24, 2
    s_mul_i32 s61, s61, 12288
    s_add_u32 s33, s61, 61440
    s_xor_b32 s61, s24, 3
    s_mul_i32 s61, s61, 12288
    s_add_u32 s34, s61, 65536
    s_mul_i32 s61, s24, 12288
    s_add_u32 s35, s61, 57344
    s_and_b32 s61, s25, 14
    s_and_b32 s62, s24, 1
    s_or_b32 s61, s61, s62
    s_xor_b32 s62, s61, 1
    s_and_b32 s63, s25, 1
    s_lshl_b32 s63, s63, 1
    s_lshr_b32 s64, s24, 1
    s_or_b32 s63, s63, s64
    s_xor_b32 s64, s63, 1
    s_lshl_b32 s67, s63, 6
    s_add_u32 s66, s66, s67
    s_lshl_b32 s67, s61, 2
    s_add_u32 s100, s66, s67
    s_cmp_ge_u32 s25, 14
    s_cselect_b32 s65, 0x10000000, 0
    s_mul_i32 s66, s61, 114688
    s_mul_i32 s67, s24, 28672
    s_add_u32 s66, s66, s67
    s_add_u32 s66, s66, s65
    s_add_u32 s48, s66, 0x200000
    s_mul_i32 s66, s62, 114688
    s_mul_i32 s67, s24, 28672
    s_add_u32 s66, s66, s67
    s_add_u32 s66, s66, s65
    s_add_u32 s58, s66, 0x200000
    s_add_u32 s65, s65, s26
    s_mul_i32 s67, s24, 114688
    s_add_u32 s67, s67, 0x20000
    s_add_u32 s67, s67, s65
    s_mul_i32 s66, s63, 7168
    s_add_u32 m0, s78, 36864
    s_nop 0
    buffer_load_dwordx4 v221, s[84:87], s74 offen lds
    s_add_u32 s46, s66, s67
    s_mul_i32 s66, s64, 7168
    s_add_u32 s47, s66, s67
    s_lshl_b32 s67, s61, 11
    s_add_u32 s50, s67, s28
    s_lshl_b32 s66, s63, 12
    s_lshl_b32 s67, s61, 8
    s_add_u32 s66, s66, s67
    s_add_u32 s49, s66, s65
    s_lshl_b32 s67, s61, 6
    s_add_u32 s51, s67, s28
    s_add_u32 m0, s78, 53120
    s_nop 0
    buffer_load_dwordx4 v221, s[84:87], s74 offen offset:128 lds
    s_add_u32 s50, s50, 0x10000
    s_add_u32 s51, s51, 0x17000
    s_cmp_eq_u32 s63, 3
    s_cselect_b32 s50, s50, 0x10000000
    s_cselect_b32 s51, s51, 0x10000000
    s_and_b32 s66, s59, 7
    s_lshl_b32 s66, s66, 8
    s_lshl_b32 s67, s63, 6
    s_add_u32 s66, s66, s67
    s_lshr_b32 s67, s59, 3
    s_add_u32 s66, s66, s67
    s_mul_i32 s66, s66, 896
    s_lshl_b32 s67, s61, 6
    s_add_u32 m0, s78, 37888
    s_nop 0
    buffer_load_dwordx4 v222, s[84:87], s75 offen lds
    s_add_u32 s52, s66, s67
    s_min_u32 s67, s61, 13
    s_lshr_b32 s67, s67, 1
    s_cmp_ge_u32 s67, 3
    s_cselect_b32 s66, 12, 9
    s_lshl_b32 s67, s67, 2
    s_add_u32 s66, s66, s67
    s_add_u32 s66, s66, s63
    s_lshl_b32 s81, s66, 12
    s_and_b32 s67, s61, 1
    s_lshl_b32 s82, s67, 6
    s_cmp_eq_u32 s24, 0
    s_cselect_b32 s79, 16, -1
    s_cselect_b32 s80, 0, 0x10000000
    s_add_u32 m0, s78, 54144
    s_nop 0
    buffer_load_dwordx4 v222, s[84:87], s75 offen offset:128 lds
    v_lshlrev_b32 v232, 4, v3
    v_and_b32 v30, 0x70, v3
    v_lshrrev_b32 v29, 5, v31
    v_lshl_add_u32 v30, v29, 3, v30
    v_add_u32 v232, v30, v232
    s_add_u32 s62, s78, 36864
    v_add_u32 v224, s62, v232
    v_xor_b32 v225, 16, v224
    v_xor_b32 v226, 32, v224
    v_xor_b32 v227, 48, v224
    v_xor_b32 v228, 64, v224
    s_cmp_eq_u32 s71, 0x10000000
    s_cbranch_scc1 LnoA_10
    s_waitcnt vmcnt(7)
    s_barrier
    ds_read_b64_tr_b16 v[144:145], v178 offset:0
    ds_read_b64_tr_b16 v[146:147], v178 offset:2048
    ds_read_b64_tr_b16 v[148:149], v178 offset:4096
    ds_read_b64_tr_b16 v[150:151], v178 offset:6144
    ds_read_b64_tr_b16 v[152:153], v178 offset:8192
    ds_read_b64_tr_b16 v[154:155], v178 offset:10240
    s_waitcnt lgkmcnt(0)
    v_and_b32 v144, v181, v144
    v_and_b32 v145, v181, v145
    v_and_b32 v146, v181, v146
    v_and_b32 v147, v181, v147
    buffer_store_dwordx4 v[144:147], v7, s[4:7], s68 offen offset:1024 sc1
    v_and_b32 v148, v181, v148
    v_and_b32 v149, v181, v149
    v_and_b32 v150, v181, v150
    v_and_b32 v151, v181, v151
    buffer_store_dwordx4 v[148:151], v7, s[4:7], s68 offen sc1
    v_and_b32 v152, v181, v152
    v_and_b32 v153, v181, v153
    v_and_b32 v154, v181, v154
    v_and_b32 v155, v181, v155
    buffer_store_dwordx4 v[152:155], v7, s[4:7], s89 offen sc1
    v_dot2_f32_bf16 v172, v144, s23, 0
    v_dot2_f32_bf16 v173, v148, s23, 0
    v_dot2_f32_bf16 v174, v152, s23, 0
    v_dot2_f32_bf16 v172, v145, s23, v172
    v_dot2_f32_bf16 v173, v149, s23, v173
    v_dot2_f32_bf16 v174, v153, s23, v174
    v_dot2_f32_bf16 v172, v146, s23, v172
    v_dot2_f32_bf16 v173, v150, s23, v173
    v_dot2_f32_bf16 v174, v154, s23, v174
    v_dot2_f32_bf16 v172, v147, s23, v172
    v_dot2_f32_bf16 v173, v151, s23, v173
    v_dot2_f32_bf16 v174, v155, s23, v174
    s_nop 2
    v_mov_b32 v176, v174
    v_permlane32_swap_b32 v172, v173
    s_nop 0
    v_permlane32_swap_b32 v174, v176
    v_add_f32 v172, v172, v173
    v_add_f32 v174, v174, v176
    buffer_store_dword v172, v188, s[4:7], s70 offen sc1
    buffer_store_dword v174, v28, s[4:7], s70 offen sc1
    s_mov_b32 s68, 0x10000000
LnoA_10:
    buffer_load_dword v25, off, s[92:95], 0 sc1
    s_add_u32 m0, s78, 38912
    s_nop 0
    buffer_load_dwordx4 v221, s[84:87], s76 offen lds
    v_xor_b32 v229, 80, v224
    v_xor_b32 v230, 96, v224
    v_xor_b32 v231, 112, v224
    v_xor_b32 v232, s82, v232
    v_add_u32 v232, s81, v232
    v_xor_b32 v233, 16, v232
    v_xor_b32 v234, 32, v232
    v_xor_b32 v235, 48, v232
    v_mov_b32 v252, -1
    v_mov_b32 v253, -1
    v_mov_b32 v254, -1
    s_add_u32 m0, s78, 55168
    s_nop 0
    buffer_load_dwordx4 v221, s[84:87], s76 offen offset:128 lds
    v_mov_b32 v255, -1
    v_lshrrev_b32 v30, 4, v1
    v_and_b32 v30, 32, v30
    v_add_u32 v30, v30, v10
    v_mov_b32 v23, 0x10000000
    s_mov_b32 s20, 0xff000000
    s_mov_b32 s21, 0xff000000
    v_cndmask_b32_e64 v22, v23, v1, s[20:21]
    v_cndmask_b32_e64 v23, v23, v30, s[20:21]
    s_lshl_b32 s64, s59, 2
    s_add_u32 s64, s64, s24
    s_add_u32 m0, s78, 39936
    s_nop 0
    buffer_load_dwordx4 v222, s[84:87], s77 offen lds
    s_lshl_b32 s64, s64, 11
    s_add_u32 s64, s64, 0x740000
    s_lshl_b32 s63, s25, 7
    s_add_u32 s63, s63, s64
    s_sub_u32 s65, s59, 1
    s_and_b32 s65, s65, 7
    s_and_b32 s62, s59, 8
    s_or_b32 s65, s65, s62
    s_lshl_b32 s65, s65, 13
    s_add_u32 s65, s65, 0x741e00
    v_and_b32 v218, 15, v31
    s_add_u32 m0, s78, 56192
    s_nop 0
    buffer_load_dwordx4 v222, s[84:87], s77 offen offset:128 lds
    v_min_u32 v218, 1, v218
    v_lshlrev_b32 v218, 29, v218
    v_or_b32 v218, v218, v31
    v_lshrrev_b32 v218, 1, v218
    s_lshl_b32 s66, s25, 10
    s_add_u32 s66, s66, s80
    s_add_u32 s66, s66, 0x720000
    s_lshl_b32 s67, s2, 7
    s_add_u32 s67, s67, s80
    s_add_u32 s67, s67, 0x730000
    v_min_u32 v26, 216, v3
    s_add_u32 m0, s78, 69376
    s_nop 0
    buffer_load_dwordx4 v221, s[84:87], s74 offen offset:256 lds
    v_lshlrev_b32 v26, 2, v26
    s_add_u32 m0, s78, 97920
    s_nop 0
    buffer_load_dwordx4 v221, s[84:87], s74 offen offset:384 lds
    s_waitcnt vmcnt(13)
    v_dot2_f32_bf16 v216, v208, s23, 0
    v_dot2_f32_bf16 v217, v208, v208, 0
    v_dot2_f32_bf16 v216, v209, s23, v216
    v_dot2_f32_bf16 v217, v209, v209, v217
    v_dot2_f32_bf16 v216, v210, s23, v216
    v_dot2_f32_bf16 v217, v210, v210, v217
    v_dot2_f32_bf16 v216, v211, s23, v216
    v_dot2_f32_bf16 v217, v211, v211, v217
    s_waitcnt vmcnt(12)
    v_dot2_f32_bf16 v216, v212, s23, v216
    v_dot2_f32_bf16 v217, v212, v212, v217
    v_dot2_f32_bf16 v216, v213, s23, v216
    v_dot2_f32_bf16 v217, v213, v213, v217
    v_dot2_f32_bf16 v216, v214, s23, v216
    v_dot2_f32_bf16 v217, v214, v214, v217
    v_dot2_f32_bf16 v216, v215, s23, v216
    v_dot2_f32_bf16 v217, v215, v215, v217
    s_nop 2
    v_permlane16_swap_b32 v216, v217
    v_add_f32 v216, v216, v217
    s_nop 1
    v_add_f32_dpp v216, v216, v216 row_ror:8 row_mask:0xf bank_mask:0xf
    s_nop 1
    v_add_f32_dpp v216, v216, v216 row_ror:4 row_mask:0xf bank_mask:0xf
    s_nop 1
    v_add_f32_dpp v216, v216, v216 row_ror:2 row_mask:0xf bank_mask:0xf
    s_nop 1
    v_add_f32_dpp v216, v216, v216 row_ror:1 row_mask:0xf bank_mask:0xf
    s_waitcnt vmcnt(6)
    v_cmp_eq_u32 vcc, 0, v25
    s_cbranch_vccnz Lfs_11
Lc_12:
    v_or_b32 v25, s3, v25
    buffer_store_dword v25, v6, s[4:7], s71 offen sc1
    v_mov_b32 v217, v25
    buffer_store_dwordx2 v[216:217], v218, s[4:7], s63 offen sc1
    v_readfirstlane_b32 s3, v25
    s_lshl_b32 s22, s24, 10
    s_cmp_eq_u32 s71, 0x10000000
    s_cbranch_scc1 LnoB_13
    s_add_u32 m0, s22, 12288
    s_nop 0
    buffer_load_dwordx4 v177, s[16:19], s96 offen lds
    s_add_u32 s96, s96, s97
    s_add_u32 m0, s22, 16384
    s_nop 0
    buffer_load_dwordx4 v177, s[16:19], s96 offen lds
    s_add_u32 s96, s96, s97
    s_add_u32 m0, s22, 20480
    s_nop 0
    buffer_load_dwordx4 v177, s[16:19], s96 offen lds
    s_add_u32 s96, s96, s97
    s_add_u32 m0, s22, 24576
    s_nop 0
    buffer_load_dwordx4 v177, s[16:19], s96 offen lds
    s_add_u32 s96, s96, s97
LnoC_14:
    s_add_u32 m0, s78, 70400
    s_nop 0
    buffer_load_dwordx4 v222, s[84:87], s75 offen offset:256 lds
    s_add_u32 m0, s78, 98944
    s_nop 0
    buffer_load_dwordx4 v222, s[84:87], s75 offen offset:384 lds
    s_add_u32 m0, s78, 71424
    s_nop 0
    buffer_load_dwordx4 v221, s[84:87], s76 offen offset:256 lds
    s_waitcnt vmcnt(12)
    ds_read_b64 v[32:33], v224 offset:0
    ds_read_b64 v[34:35], v225 offset:0
    ds_read_b64 v[36:37], v226 offset:0
    ds_read_b64 v[38:39], v227 offset:0
    ds_read_b64 v[40:41], v228 offset:0
    ds_read_b64 v[42:43], v229 offset:0
    ds_read_b64 v[44:45], v230 offset:0
    ds_read_b64 v[46:47], v231 offset:0
    s_add_u32 m0, s78, 99968
    s_nop 0
    buffer_load_dwordx4 v221, s[84:87], s76 offen offset:384 lds
    s_waitcnt vmcnt(12)
    ds_read_b64 v[48:49], v224 offset:16384
    ds_read_b64 v[50:51], v225 offset:16384
    ds_read_b64 v[52:53], v226 offset:16384
    ds_read_b64 v[54:55], v227 offset:16384
    ds_read_b64 v[56:57], v228 offset:16384
    ds_read_b64 v[58:59], v229 offset:16384
    ds_read_b64 v[60:61], v230 offset:16384
    ds_read_b64 v[62:63], v231 offset:16384
    s_add_u32 m0, s78, 72448
    s_nop 0
    buffer_load_dwordx4 v222, s[84:87], s77 offen offset:256 lds
    s_add_u32 m0, s78, 100992
    s_nop 0
    buffer_load_dwordx4 v222, s[84:87], s77 offen offset:384 lds
    s_add_u32 m0, s78, 114176
    s_nop 0
    buffer_load_dwordx4 v221, s[84:87], s74 offen offset:512 lds
    s_add_u32 m0, s78, 115200
    s_nop 0
    buffer_load_dwordx4 v222, s[84:87], s75 offen offset:512 lds
    s_waitcnt vmcnt(8)
    s_barrier
    ds_read_b64_tr_b16 v[144:145], v180 offset:0
    ds_read_b64_tr_b16 v[146:147], v180 offset:1024
    ds_read_b64_tr_b16 v[148:149], v180 offset:4096
    ds_read_b64_tr_b16 v[150:151], v180 offset:5120
    ds_read_b64_tr_b16 v[152:153], v180 offset:8192
    ds_read_b64_tr_b16 v[154:155], v180 offset:9216
    ds_read_b64_tr_b16 v[156:157], v180 offset:12288
    ds_read_b64_tr_b16 v[158:159], v180 offset:13312
    ds_read_b64_tr_b16 v[160:161], v180 offset:16384
    ds_read_b64_tr_b16 v[162:163], v180 offset:17408
    ds_read_b64_tr_b16 v[164:165], v180 offset:20480
    ds_read_b64_tr_b16 v[166:167], v180 offset:21504
    ds_read_b64_tr_b16 v[168:169], v180 offset:24576
    ds_read_b64_tr_b16 v[170:171], v180 offset:25600
    s_add_u32 m0, s78, 116224
    s_nop 0
    buffer_load_dwordx4 v221, s[84:87], s76 offen offset:512 lds
    s_waitcnt lgkmcnt(12)
    buffer_store_dwordx4 v[144:147], v1, s[4:7], s68 offen sc1
    v_dot2_f32_bf16 v174, v144, s23, 0
    v_dot2_f32_bf16 v175, v145, s23, 0
    v_dot2_f32_bf16 v174, v146, s23, v174
    v_dot2_f32_bf16 v175, v147, s23, v175
    s_add_u32 m0, s78, 117248
    s_nop 0
    buffer_load_dwordx4 v222, s[84:87], s77 offen offset:512 lds
    s_waitcnt lgkmcnt(10)
    buffer_store_dwordx4 v[148:151], v1, s[4:7], s68 offen offset:1024 sc1
    v_dot2_f32_bf16 v174, v148, s23, v174
    v_dot2_f32_bf16 v175, v149, s23, v175
    v_dot2_f32_bf16 v174, v150, s23, v174
    v_dot2_f32_bf16 v175, v151, s23, v175
    buffer_load_dword v8, v26, s[4:7], s66 offen sc1
    s_add_u32 m0, s78, 130432
    s_nop 0
    buffer_load_dwordx4 v221, s[84:87], s74 offen offset:640 lds
    s_waitcnt lgkmcnt(8)
    buffer_store_dwordx4 v[152:155], v1, s[4:7], s68 offen offset:2048 sc1
    v_dot2_f32_bf16 v174, v152, s23, v174
    v_dot2_f32_bf16 v175, v153, s23, v175
    v_dot2_f32_bf16 v174, v154, s23, v174
    v_dot2_f32_bf16 v175, v155, s23, v175
    s_waitcnt vmcnt(10)
    ds_read_b64 v[64:65], v224 offset:32768
    ds_read_b64 v[66:67], v225 offset:32768
    ds_read_b64 v[68:69], v226 offset:32768
    ds_read_b64 v[70:71], v227 offset:32768
    ds_read_b64 v[72:73], v228 offset:32768
    ds_read_b64 v[74:75], v229 offset:32768
    ds_read_b64 v[76:77], v230 offset:32768
    ds_read_b64 v[78:79], v231 offset:32768
    s_add_u32 m0, s78, 131456
    s_nop 0
    buffer_load_dwordx4 v222, s[84:87], s75 offen offset:640 lds
    s_waitcnt lgkmcnt(14)
    buffer_store_dwordx4 v[156:159], v1, s[4:7], s69 offen sc1
    v_dot2_f32_bf16 v174, v156, s23, v174
    v_dot2_f32_bf16 v175, v157, s23, v175
    v_dot2_f32_bf16 v174, v158, s23, v174
    v_dot2_f32_bf16 v175, v159, s23, v175
    s_waitcnt vmcnt(11)
    ds_read_b64 v[80:81], v224 offset:61440
    ds_read_b64 v[82:83], v225 offset:61440
    ds_read_b64 v[84:85], v226 offset:61440
    ds_read_b64 v[86:87], v227 offset:61440
    ds_read_b64 v[88:89], v228 offset:61440
    ds_read_b64 v[90:91], v229 offset:61440
    ds_read_b64 v[92:93], v230 offset:61440
    ds_read_b64 v[94:95], v231 offset:61440
    s_mul_i32 s72, s24, 3072
    s_add_u32 s73, s72, s38
    v_add_u32 v224, 77824, v224
    v_add_u32 v225, 77824, v225
    v_add_u32 v226, 77824, v226
    v_add_u32 v227, 77824, v227
    v_add_u32 v228, 77824, v228
    v_add_u32 v229, 77824, v229
    v_add_u32 v230, 77824, v230
    v_add_u32 v231, 77824, v231
    s_waitcnt vmcnt(4)
    v_xor_b32 v8, s3, v8
    v_cmp_le_u32 vcc, s79, v8
    s_cbranch_vccnz Lfs_15
Lc_16:
    s_waitcnt lgkmcnt(15)
    s_barrier
    s_add_u32 m0, s72, 0
    s_add_u32 s88, s73, 0
    buffer_load_dwordx4 v7, s[4:7], s88 offen lds
    buffer_load_dwordx4 v7, s[4:7], s88 offen offset:1024 lds
    buffer_load_dwordx4 v7, s[4:7], s88 offen offset:2048 lds
    ds_read_b64 v[12:13], v232
    ds_read_b64 v[14:15], v233
    ds_read_b64 v[16:17], v234
    ds_read_b64 v[18:19], v235
    s_add_u32 m0, s72, 12288
    s_add_u32 s88, s73, 12288
    buffer_load_dwordx4 v7, s[4:7], s88 offen lds
    buffer_store_dwordx4 v[160:163], v1, s[4:7], s69 offen offset:1024 sc1
    v_dot2_f32_bf16 v174, v160, s23, v174
    v_dot2_f32_bf16 v175, v161, s23, v175
    v_dot2_f32_bf16 v174, v162, s23, v174
    v_dot2_f32_bf16 v175, v163, s23, v175
    buffer_load_dwordx4 v7, s[4:7], s88 offen offset:1024 lds
    buffer_store_dwordx4 v[164:167], v1, s[4:7], s69 offen offset:2048 sc1
    v_dot2_f32_bf16 v174, v164, s23, v174
    v_dot2_f32_bf16 v175, v165, s23, v175
    v_dot2_f32_bf16 v174, v166, s23, v174
    v_dot2_f32_bf16 v175, v167, s23, v175
    buffer_load_dwordx4 v7, s[4:7], s88 offen offset:2048 lds
    buffer_store_dwordx4 v[168:171], v1, s[4:7], s69 offen offset:3072 sc1
    v_dot2_f32_bf16 v174, v168, s23, v174
    v_dot2_f32_bf16 v175, v169, s23, v175
    v_dot2_f32_bf16 v174, v170, s23, v174
    v_dot2_f32_bf16 v175, v171, s23, v175
    buffer_store_dwordx4 v[252:255], v22, s[4:7], s50 offen sc1
    buffer_store_dwordx4 v[252:255], v22, s[4:7], s50 offen offset:1024 sc1
    buffer_store_dword v252, v23, s[4:7], s51 offen sc1
    v_add_f32 v175, v174, v175
    v_mov_b32 v176, v175
    s_nop 1
    v_permlane32_swap_b32 v175, v176
    v_add_f32 v176, v175, v176
    v_cvt_pk_bf16_f32 v172, v176, v176
    v_and_b32 v172, 0xffff0000, v172
    v_sub_f32 v172, v176, v172
    v_cvt_pk_bf16_f32 v172, v176, v172
    v_lshlrev_b32 v27, 1, v3
    v_lshrrev_b32 v173, 8, v27
    v_mul_u32_u24 v173, 248, v173
    v_sub_u32 v27, v27, v173
    v_mov_b32 v173, v172
    buffer_store_dwordx2 v[172:173], v27, s[4:7], s27 offen sc1
    s_waitcnt lgkmcnt(0)
    s_barrier
    v_mov_b32 v20, 0
    v_mov_b32 v21, 0
    v_mov_b32 v22, 0
    v_mov_b32 v23, 0
    s_add_u32 s22, s72, 90112
    v_add_u32 v27, s22, v1
    ds_write_b128 v27, v[20:23] offset:0
    ds_write_b128 v27, v[20:23] offset:1024
    ds_write_b128 v27, v[20:23] offset:2048
    s_add_u32 m0, s78, 132480
    s_nop 0
    buffer_load_dwordx4 v221, s[84:87], s76 offen offset:640 lds
    s_add_u32 m0, s78, 133504
    s_nop 0
    buffer_load_dwordx4 v222, s[84:87], s77 offen offset:640 lds
    s_add_u32 m0, s78, 146688
    s_nop 0
    buffer_load_dwordx4 v221, s[84:87], s74 offen offset:768 lds
    s_add_u32 m0, s78, 147712
    s_nop 0
    buffer_load_dwordx4 v222, s[84:87], s75 offen offset:768 lds
    s_add_u32 m0, s78, 148736
    s_nop 0
    buffer_load_dwordx4 v221, s[84:87], s76 offen offset:768 lds
    s_add_u32 m0, s78, 149760
    s_nop 0
    buffer_load_dwordx4 v222, s[84:87], s77 offen offset:768 lds
    s_min_u32 s89, s24, 2
    s_mul_i32 s90, s25, 3
    s_add_u32 s90, s90, s89
    s_mul_i32 s90, s90, 3584
    s_add_u32 s90, s90, 0x390000
    s_lshl_b32 s89, s89, 10
    v_lshrrev_b32 v25, 9, v1
    v_mul_u32_u24 v25, 1664, v25
    v_add_u32 v25, v25, v2
    v_and_b32 v8, 0xf0, v3
    v_and_b32 v9, 16, v1
    v_lshl_add_u32 v8, v8, 3, v9
    v_and_b32 v9, 0x190, v8
    v_bfe_u32 v27, v1, 9, 1
    v_lshl_add_u32 v8, v27, 3, v8
    v_bfe_u32 v27, v1, 7, 1
    v_lshl_add_u32 v9, v27, 3, v9
    s_lshl_b32 s92, s55, 1
    v_add_u32 v31, s92, v1
    v_add_u32 v29, 57344, v1
    s_waitcnt vmcnt(16)
    s_waitcnt lgkmcnt(0)
    s_barrier
    ds_read_b128 a[224:227], v1 offset:0
    ds_read_b128 a[228:231], v1 offset:1024
    ds_read_b128 a[232:235], v1 offset:2048
    ds_read_b128 a[236:239], v1 offset:3072
    ds_read_b128 a[240:243], v1 offset:4096
    ds_read_b128 a[244:247], v1 offset:5120
    ds_read_b128 a[248:251], v1 offset:6144
    s_waitcnt lgkmcnt(3)
    v_mfma_f32_32x32x16_bf16 v[144:159], a[224:227], v[32:35], 0
    ds_read_b128 a[252:255], v1 offset:7168
    s_add_u32 m0, s72, 24576
    s_add_u32 s88, s73, 24576
    buffer_load_dwordx4 v7, s[4:7], s88 offen lds
    buffer_load_dwordx4 v7, s[4:7], s88 offen offset:1024 lds
    buffer_load_dwordx4 v7, s[4:7], s88 offen offset:2048 lds
    s_lshl_b32 s60, s24, 11
    s_add_u32 m0, s60, 102400
    s_nop 0
    buffer_load_dwordx4 v222, s[84:87], s83 offen lds
    s_lshl_b32 s60, s24, 11
    s_add_u32 m0, s60, 103296
    s_nop 0
    buffer_load_dwordx4 v222, s[84:87], s83 offen offset:128 lds
    v_mfma_f32_32x32x16_bf16 v[160:175], a[228:231], v[32:35], 0
    ds_read_b128 a[224:227], v1 offset:8192
    s_add_u32 m0, s72, 36864
    s_add_u32 s88, s73, 36864
    buffer_load_dwordx4 v7, s[4:7], s88 offen lds
    v_mfma_f32_32x32x16_bf16 v[144:159], a[232:235], v[36:39], v[144:159]
    ds_read_b128 a[228:231], v1 offset:9216
    buffer_load_dwordx4 v7, s[4:7], s88 offen offset:1024 lds
    s_lshl_b32 s96, s25, 12
    v_mfma_f32_32x32x16_bf16 v[160:175], a[236:239], v[36:39], v[160:175]
    ds_read_b128 a[232:235], v1 offset:10240
    buffer_load_dwordx4 v7, s[4:7], s88 offen offset:2048 lds
    s_waitcnt lgkmcnt(3)
    v_mfma_f32_32x32x16_bf16 v[144:159], a[240:243], v[40:43], v[144:159]
    ds_read_b128 a[236:239], v1 offset:11264
    s_add_u32 s96, s96, s89
    s_add_u32 s96, s96, s26
    s_add_u32 s96, s96, 0x120000
    v_lshrrev_b32 v191, 2, v2
    v_not_b32 v191, v191
    v_mfma_f32_32x32x16_bf16 v[160:175], a[244:247], v[40:43], v[160:175]
    s_waitcnt vmcnt(19)
    s_barrier
    ds_read_b128 a[240:243], v1 offset:12288
    v_mov_b32 v190, 0xff000000
    v_lshrrev_b32 v191, v191, v190
    v_bfe_u32 v190, v1, 9, 1
    v_mfma_f32_32x32x16_bf16 v[144:159], a[248:251], v[44:47], v[144:159]
    ds_read_b128 a[244:247], v1 offset:13312
    v_lshlrev_b32 v190, 2, v190
    v_lshrrev_b32 v191, v190, v191
    v_not_b32 v191, v191
    v_bfe_i32 v176, v191, 0, 1
    v_bfe_i32 v177, v191, 1, 1
    v_mfma_f32_32x32x16_bf16 v[160:175], a[252:255], v[44:47], v[160:175]
    ds_read_b128 a[248:251], v1 offset:14336
    v_bfe_i32 v178, v191, 2, 1
    v_bfe_i32 v179, v191, 3, 1
    v_bfe_i32 v180, v191, 8, 1
    v_bfe_i32 v181, v191, 9, 1
    s_waitcnt lgkmcnt(3)
    v_mfma_f32_32x32x16_bf16 v[144:159], a[224:227], v[48:51], v[144:159]
    ds_read_b128 a[252:255], v1 offset:15360
    v_bfe_i32 v182, v191, 10, 1
    v_bfe_i32 v183, v191, 11, 1
    v_bfe_i32 v184, v191, 16, 1
    v_bfe_i32 v185, v191, 17, 1
    v_bfe_i32 v186, v191, 18, 1
    v_mfma_f32_32x32x16_bf16 v[160:175], a[228:231], v[48:51], v[160:175]
    ds_read_b128 a[224:227], v1 offset:16384
    v_bfe_i32 v187, v191, 19, 1
    v_bfe_i32 v188, v191, 24, 1
    v_bfe_i32 v189, v191, 25, 1
    v_bfe_i32 v190, v191, 26, 1
    v_bfe_i32 v191, v191, 27, 1
    v_mfma_f32_32x32x16_bf16 v[144:159], a[232:235], v[52:55], v[144:159]
    ds_read_b128 a[228:231], v1 offset:17408
    v_mfma_f32_32x32x16_bf16 v[160:175], a[236:239], v[52:55], v[160:175]
    ds_read_b128 a[232:235], v1 offset:18432
    s_waitcnt lgkmcnt(3)
    v_mfma_f32_32x32x16_bf16 v[144:159], a[240:243], v[56:59], v[144:159]
    ds_read_b128 a[236:239], v1 offset:19456
    v_mfma_f32_32x32x16_bf16 v[160:175], a[244:247], v[56:59], v[160:175]
    ds_read_b128 a[240:243], v1 offset:20480
    s_add_u32 m0, s72, 49152
    s_add_u32 s88, s73, 49152
    buffer_load_dwordx4 v7, s[4:7], s88 offen lds
    v_mfma_f32_32x32x16_bf16 v[144:159], a[248:251], v[60:63], v[144:159]
    ds_read_b128 a[244:247], v1 offset:21504
    buffer_load_dwordx4 v7, s[4:7], s88 offen offset:1024 lds
    v_mfma_f32_32x32x16_bf16 v[160:175], a[252:255], v[60:63], v[160:175]
    ds_read_b128 a[248:251], v1 offset:22528
    buffer_load_dwordx4 v7, s[4:7], s88 offen offset:2048 lds
    s_waitcnt lgkmcnt(3)
    v_mfma_f32_32x32x16_bf16 v[144:159], a[224:227], v[64:67], v[144:159]
    ds_read_b128 a[252:255], v1 offset:23552
    s_add_u32 m0, s72, 61440
    s_add_u32 s88, s73, 61440
    buffer_load_dwordx4 v7, s[4:7], s88 offen lds
    v_mfma_f32_32x32x16_bf16 v[160:175], a[228:231], v[64:67], v[160:175]
    s_waitcnt vmcnt(4)
    s_barrier
    ds_read_b128 a[224:227], v1 offset:24576
    buffer_load_dwordx4 v7, s[4:7], s88 offen offset:1024 lds
    v_mfma_f32_32x32x16_bf16 v[144:159], a[232:235], v[68:71], v[144:159]
    ds_read_b128 a[228:231], v1 offset:25600
    v_mfma_f32_32x32x16_bf16 v[160:175], a[236:239], v[68:71], v[160:175]
    ds_read_b128 a[232:235], v1 offset:26624
    buffer_load_dwordx4 v7, s[4:7], s88 offen offset:2048 lds
    s_barrier
    v_mov_b32 v27, s3
    buffer_store_dword v27, v6, s[4:7], s67 offen sc1
    s_cmp_lt_u32 s25, 8
    s_cbranch_scc1 LnoR_17
    ds_read_b64 v[12:13], v232
    ds_read_b64 v[14:15], v233
    ds_read_b64 v[16:17], v234
    ds_read_b64 v[18:19], v235
LnoR_17:
    s_waitcnt lgkmcnt(3)
    v_mfma_f32_32x32x16_bf16 v[144:159], a[240:243], v[72:75], v[144:159]
    ds_read_b128 a[236:239], v1 offset:27648
    s_add_u32 m0, s72, 73728
    s_add_u32 s88, s73, 73728
    buffer_load_dwordx4 v7, s[4:7], s88 offen lds
    v_mfma_f32_32x32x16_bf16 v[160:175], a[244:247], v[72:75], v[160:175]
    ds_read_b128 a[240:243], v1 offset:28672
    buffer_load_dwordx4 v7, s[4:7], s88 offen offset:1024 lds
    v_mfma_f32_32x32x16_bf16 v[144:159], a[248:251], v[76:79], v[144:159]
    ds_read_b128 a[244:247], v1 offset:29696
    buffer_load_dwordx4 v7, s[4:7], s88 offen offset:2048 lds
    buffer_load_dword v192, v25, s[4:7], s90 offen
    v_mfma_f32_32x32x16_bf16 v[160:175], a[252:255], v[76:79], v[160:175]
    ds_read_b128 a[248:251], v1 offset:30720
    buffer_load_dword v193, v25, s[4:7], s90 offen offset:128
    buffer_load_dword v194, v25, s[4:7], s90 offen offset:256
    buffer_load_dword v195, v25, s[4:7], s90 offen offset:384
    s_waitcnt lgkmcnt(3)
    v_mfma_f32_32x32x16_bf16 v[144:159], a[224:227], v[80:83], v[144:159]
    ds_read_b128 a[252:255], v1 offset:31744
    buffer_load_dword v196, v25, s[4:7], s90 offen offset:512
    buffer_load_dword v197, v25, s[4:7], s90 offen offset:640
    ds_read_b64 v[96:97], v224 offset:0
    v_mfma_f32_32x32x16_bf16 v[160:175], a[228:231], v[80:83], v[160:175]
    ds_read_b128 a[224:227], v1 offset:32768
    buffer_load_dword v198, v25, s[4:7], s90 offen offset:768
    buffer_load_dword v199, v25, s[4:7], s90 offen offset:896
    buffer_load_dword v200, v25, s[4:7], s90 offen offset:1024
    v_mfma_f32_32x32x16_bf16 v[144:159], a[232:235], v[84:87], v[144:159]
    ds_read_b128 a[228:231], v1 offset:33792
    buffer_load_dword v201, v25, s[4:7], s90 offen offset:1152
    buffer_load_dword v202, v25, s[4:7], s90 offen offset:1280
    ds_read_b64 v[98:99], v225 offset:0
    v_mfma_f32_32x32x16_bf16 v[160:175], a[236:239], v[84:87], v[160:175]
    ds_read_b128 a[232:235], v1 offset:34816
    buffer_load_dword v203, v25, s[4:7], s90 offen offset:1408
    buffer_load_dword v204, v25, s[4:7], s90 offen offset:1536
    ds_read_b64 v[100:101], v226 offset:0
    ds_read_b64 v[102:103], v227 offset:0
    ds_read_b64 v[104:105], v228 offset:0
    ds_read_b64 v[106:107], v229 offset:0
    ds_read_b64 v[108:109], v230 offset:0
    ds_read_b64 v[110:111], v231 offset:0
    s_waitcnt lgkmcnt(11)
    v_mfma_f32_32x32x16_bf16 v[144:159], a[240:243], v[88:91], v[144:159]
    ds_read_b128 a[236:239], v1 offset:35840
    buffer_load_dword v205, v25, s[4:7], s90 offen offset:1664
    ds_read_b64 v[112:113], v224 offset:16384
    ds_read_b64 v[114:115], v225 offset:16384
    v_mfma_f32_32x32x16_bf16 v[160:175], a[244:247], v[88:91], v[160:175]
    ds_read_b128 a[240:243], v1 offset:36864
    ds_read_b64 v[116:117], v226 offset:16384
    ds_read_b64 v[118:119], v227 offset:16384
    ds_read_b64 v[120:121], v228 offset:16384
    ds_read_b64 v[122:123], v229 offset:16384
    ds_read_b64 v[124:125], v230 offset:16384
    v_mfma_f32_32x32x16_bf16 v[144:159], a[248:251], v[92:95], v[144:159]
    ds_read_b128 a[244:247], v1 offset:37888
    buffer_load_dwordx2 v[216:217], v8, s[4:7], s64 offen sc1
    buffer_load_dwordx2 v[208:209], v9, s[4:7], s65 offen sc1
    ds_read_b64 v[126:127], v231 offset:16384
    v_mfma_f32_32x32x16_bf16 v[160:175], a[252:255], v[92:95], v[160:175]
    ds_read_b128 a[248:251], v1 offset:38912
    ds_read_b64 v[128:129], v224 offset:32768
    ds_read_b64 v[130:131], v225 offset:32768
    ds_read_b64 v[132:133], v226 offset:32768
    s_waitcnt lgkmcnt(14)
    v_mfma_f32_32x32x16_bf16 v[144:159], a[224:227], v[96:99], v[144:159]
    ds_read_b128 a[252:255], v1 offset:39936
    ds_read_b64 v[134:135], v227 offset:32768
    ds_read_b64 v[136:137], v228 offset:32768
    ds_read_b64 v[138:139], v229 offset:32768
    ds_read_b64 v[140:141], v230 offset:32768
    ds_read_b64 v[142:143], v231 offset:32768
    v_mfma_f32_32x32x16_bf16 v[160:175], a[228:231], v[96:99], v[160:175]
    ds_read_b128 a[224:227], v1 offset:40960
    s_sub_u32 s62, s60, s78
    s_add_u32 s62, s62, 4294951936
    v_add_u32 v224, s62, v224
    v_add_u32 v225, s62, v225
    v_add_u32 v226, s62, v226
    v_mfma_f32_32x32x16_bf16 v[144:159], a[232:235], v[100:103], v[144:159]
    ds_read_b128 a[228:231], v1 offset:41984
    v_add_u32 v227, s62, v227
    v_add_u32 v228, s62, v228
    v_add_u32 v229, s62, v229
    v_add_u32 v230, s62, v230
    v_add_u32 v231, s62, v231
    v_mfma_f32_32x32x16_bf16 v[160:175], a[236:239], v[100:103], v[160:175]
    ds_read_b128 a[232:235], v1 offset:43008
    ds_read_b64 v[232:233], v228 offset:0
    ds_read_b64 v[234:235], v229 offset:0
    ds_read_b64 v[236:237], v230 offset:0
    s_waitcnt lgkmcnt(11)
    v_mfma_f32_32x32x16_bf16 v[144:159], a[240:243], v[104:107], v[144:159]
    ds_read_b128 a[236:239], v1 offset:44032
    ds_read_b64 v[238:239], v231 offset:0
    ds_read_b64 v[240:241], v224 offset:1024
    ds_read_b64 v[242:243], v225 offset:1024
    ds_read_b64 v[244:245], v226 offset:1024
    ds_read_b64 v[246:247], v227 offset:1024
    v_mfma_f32_32x32x16_bf16 v[160:175], a[244:247], v[104:107], v[160:175]
    ds_read_b128 a[240:243], v1 offset:45056
    ds_read_b64 v[248:249], v228 offset:1024
    ds_read_b64 v[250:251], v229 offset:1024
    ds_read_b64 v[228:229], v226 offset:0
    ds_read_b64 v[230:231], v227 offset:0
    ds_read_b64 v[226:227], v225 offset:0
    v_mfma_f32_32x32x16_bf16 v[144:159], a[248:251], v[108:111], v[144:159]
    ds_read_b128 a[244:247], v1 offset:46080
    ds_read_b64 v[224:225], v224 offset:0
    v_and_b32 v221, 0x70, v1
    v_and_b32 v222, 64, v2
    v_xor_b32 v221, v221, v222
    v_lshrrev_b32 v222, 7, v1
    v_mfma_f32_32x32x16_bf16 v[160:175], a[252:255], v[108:111], v[160:175]
    ds_read_b128 a[248:251], v1 offset:47104
    v_mul_u32_u24 v222, 896, v222
    v_add_u32 v221, v221, v222
    v_add_u32 v222, 6144, v221
    s_waitcnt lgkmcnt(14)
    v_mfma_f32_32x32x16_bf16 v[144:159], a[224:227], v[112:115], v[144:159]
    ds_read_b128 a[252:255], v1 offset:48128
    s_lshr_b32 s61, s25, 1
    s_lshl_b32 s61, s61, 7
    s_mul_i32 s22, s24, 100352
    s_add_u32 s61, s61, s22
    s_cmp_ge_u32 s25, 14
    s_cselect_b32 s61, 0x10000000, s61
    s_lshl_b32 s59, s55, 1
    v_mfma_f32_32x32x16_bf16 v[160:175], a[228:231], v[112:115], v[160:175]
    s_waitcnt lgkmcnt(2)
    s_waitcnt vmcnt(23)
    s_barrier
    ds_read_b128 a[224:227], v1 offset:49152
    v_mfma_f32_32x32x16_bf16 v[144:159], a[232:235], v[116:119], v[144:159]
    ds_read_b128 a[228:231], v1 offset:50176
    s_add_u32 m0, s59, 0x1a000
    s_nop 0
    buffer_load_dwordx4 v221, s[40:43], s61 offen lds
    buffer_load_dwordx4 v222, s[40:43], s61 offen offset:1024 lds
    s_add_u32 m0, s59, 0x1a800
    s_add_u32 s61, s61, 14336
    buffer_load_dwordx4 v221, s[40:43], s61 offen lds
    v_mfma_f32_32x32x16_bf16 v[160:175], a[236:239], v[116:119], v[160:175]
    ds_read_b128 a[232:235], v1 offset:51200
    buffer_load_dwordx4 v222, s[40:43], s61 offen offset:1024 lds
    s_waitcnt lgkmcnt(3)
    v_mfma_f32_32x32x16_bf16 v[144:159], a[240:243], v[120:123], v[144:159]
    ds_read_b128 a[236:239], v1 offset:52224
    s_add_u32 m0, s59, 0x1b000
    s_add_u32 s61, s61, 14336
    buffer_load_dwordx4 v221, s[40:43], s61 offen lds
    v_mfma_f32_32x32x16_bf16 v[160:175], a[244:247], v[120:123], v[160:175]
    ds_read_b128 a[240:243], v1 offset:53248
    s_waitcnt vmcnt(19)
    v_add_f32 v192, v192, v193
    s_waitcnt vmcnt(12)
    v_add_f32 v199, v199, v200
    v_add_f32 v194, v194, v195
    s_waitcnt vmcnt(10)
    v_add_f32 v201, v201, v202
    v_add_f32 v196, v196, v197
    v_mfma_f32_32x32x16_bf16 v[144:159], a[248:251], v[124:127], v[144:159]
    ds_read_b128 a[244:247], v1 offset:54272
    buffer_load_dwordx4 v222, s[40:43], s61 offen offset:1024 lds
    s_waitcnt vmcnt(9)
    v_add_f32 v203, v203, v204
    v_mfma_f32_32x32x16_bf16 v[160:175], a[252:255], v[124:127], v[160:175]
    ds_read_b128 a[248:251], v1 offset:55296
    s_add_u32 m0, s59, 0x1b800
    s_add_u32 s61, s61, 14336
    buffer_load_dwordx4 v221, s[40:43], s61 offen lds
    s_waitcnt lgkmcnt(3)
    v_mfma_f32_32x32x16_bf16 v[144:159], a[224:227], v[128:131], v[144:159]
    ds_read_b128 a[252:255], v1 offset:56320
    buffer_load_dwordx4 v222, s[40:43], s61 offen offset:1024 lds
    v_add_f32 v192, v192, v194
    v_mfma_f32_32x32x16_bf16 v[160:175], a[228:231], v[128:131], v[160:175]
    ds_read_b128 a[224:227], v31 offset:0
    s_add_u32 m0, s59, 0x1c000
    s_add_u32 s61, s61, 14336
    buffer_load_dwordx4 v221, s[40:43], s61 offen lds
    s_mul_i32 s20, s25, 7
    s_andn2_b32 s20, s20, 3
    s_add_u32 s20, s20, 128
    v_lshrrev_b32 v25, 2, v11
    v_min_u32 v20, 11, v25
    v_add_u32 v20, s20, v20
    v_min_u32 v20, 0xef, v20
    s_lshr_b32 s20, s25, 1
    s_add_u32 s20, s20, 16
    v_mul_u32_u24 v25, 7, v25
    v_add_u32 v25, s20, v25
    s_mov_b32 s20, 0xffff
    s_mov_b32 s21, 0
    v_cndmask_b32_e64 v25, v25, v20, s[20:21]
    v_min_u32 v20, 24, v10
    s_sub_u32 s20, s65, 0x740000
    s_lshr_b32 s21, s20, 14
    s_bfe_u32 s20, s20, 0x1000d
    s_lshl_b32 s20, s20, 7
    s_add_u32 s20, s20, s21
    s_add_u32 s20, s20, 8
    v_lshl_add_u32 v20, v20, 2, s20
    s_mov_b32 s20, 0
    s_mov_b32 s21, -1
    v_cndmask_b32_e64 v25, v25, v20, s[20:21]
    v_lshlrev_b32 v25, 7, v25
    s_add_u32 s91, s80, 0x730000
    s_lshr_b32 s22, s24, 1
    s_lshl_b32 s87, s22, 10
    s_sub_u32 s20, s22, 1
    s_sub_u32 s21, 0, s22
    s_and_b32 s22, s24, 1
    s_lshl3_add_u32 s87, s22, s87
    s_sub_u32 s18, 0, s22
    s_mov_b32 s19, s18
    s_andn2_b64 s[16:17], s[20:21], s[18:19]
    s_and_b64 s[18:19], s[20:21], s[18:19]
    s_add_u32 s87, s87, 104448
    s_lshl_b32 s86, s24, 12
    s_add_u32 s84, s86, 90112
    s_sub_u32 s86, s86, 4096
    s_and_b32 s86, s86, 0x3000
    s_add_u32 s86, s86, 90112
    s_lshl_b32 s93, s24, 7
    s_add_u32 s85, s93, 102016
    s_add_u32 s93, s93, 89216
    s_mov_b32 s94, 0xff000000
    s_mov_b32 s95, 0xff000000
    s_and_b32 s70, s31, 0xff
    s_mov_b32 s71, s70
    s_waitcnt vmcnt(10)
    v_xor_b32 v217, s3, v217
    v_cmp_le_u32 vcc, 16, v217
    s_cbranch_vccnz Lfs_19
Lc_20:
    v_cmp_ne_u32 vcc, 0, v217
    s_nop 1
    s_mov_b32 s45, vcc_lo
    v_mfma_f32_32x32x16_bf16 v[144:159], a[232:235], v[132:135], v[144:159]
    ds_read_b128 a[228:231], v31 offset:2048
    buffer_load_dwordx4 v222, s[40:43], s61 offen offset:1024 lds
    v_add_f32 v199, v199, v201
    v_mfma_f32_32x32x16_bf16 v[160:175], a[236:239], v[132:135], v[160:175]
    ds_read_b128 a[232:235], v31 offset:4096
    s_add_u32 m0, s59, 0x1c800
    s_add_u32 s61, s61, 14336
    buffer_load_dwordx4 v221, s[40:43], s61 offen lds
    s_waitcnt lgkmcnt(3)
    s_waitcnt vmcnt(11)
    v_xor_b32 v209, s3, v209
    v_cmp_le_u32 vcc, 16, v209
    s_cbranch_vccnz Lfs_21
Lc_22:
    v_mfma_f32_32x32x16_bf16 v[144:159], a[240:243], v[136:139], v[144:159]
    ds_read_b128 a[236:239], v31 offset:6144
    buffer_load_dwordx4 v222, s[40:43], s61 offen offset:1024 lds
    v_add_f32 v196, v196, v198
    v_mfma_f32_32x32x16_bf16 v[160:175], a[244:247], v[136:139], v[160:175]
    ds_read_b128 a[240:243], v31 offset:8192
    s_add_u32 m0, s59, 0x1d000
    s_add_u32 s61, s61, 14336
    buffer_load_dwordx4 v221, s[40:43], s61 offen lds
    v_mfma_f32_32x32x16_bf16 v[144:159], a[248:251], v[140:143], v[144:159]
    ds_read_b128 a[244:247], v31 offset:10240
    buffer_load_dwordx4 v222, s[40:43], s61 offen offset:1024 lds
    v_add_f32 v203, v203, v205
    v_mfma_f32_32x32x16_bf16 v[160:175], a[252:255], v[140:143], v[160:175]
    ds_read_b128 a[248:251], v31 offset:12288
    v_add_f32 v192, v192, v196
    v_add_f32 v199, v199, v203
    v_cvt_pk_bf16_f32 v193, v192, v192
    v_and_b32 v193, 0xffff0000, v193
    v_sub_f32 v193, v192, v193
    v_cvt_pk_bf16_f32 v204, v192, v193
    v_mov_b32 v205, v204
    v_cvt_pk_bf16_f32 v200, v199, v199
    v_and_b32 v200, 0xffff0000, v200
    v_sub_f32 v200, v199, v200
    v_cvt_pk_bf16_f32 v206, v199, v200
    v_mov_b32 v207, v206
    v_add_u32 v192, s89, v29
    ds_write_b128 v192, v[204:207] offset:28672
    buffer_store_dwordx4 v[204:207], v1, s[4:7], s96 offen sc1
    s_waitcnt lgkmcnt(4)
    s_waitcnt lgkmcnt(0)
    s_barrier
    v_mfma_f32_32x32x16_bf16 v[192:207], a[224:227], v[224:227], 0
    ds_read_b128 a[252:255], v29 offset:29696
    v_mov_b32 v217, v216
    s_nop 0
    s_nop 0
    v_permlane32_swap_b32 v216, v217
    v_mul_f32 v216, 0xbb124925, v216
    v_mov_b32 v218, 0x3727c5ac
    v_mfma_f32_32x32x16_bf16 v[192:207], a[228:231], v[228:231], v[192:207]
    ds_read_b128 a[224:227], v29 offset:29696
    v_fmac_f32 v218, 0x3b124925, v217
    v_fma_f32 v219, -v216, v216, v218
    v_max_f32 v219, 0x3727c5ac, v219
    v_cvt_pk_bf16_f32 v20, v216, v216
    s_nop 0
    v_mfma_f32_32x32x16_bf16 v[192:207], a[232:235], v[232:235], v[192:207]
    ds_read_b128 a[228:231], v29 offset:28672
    v_rsq_f32 v24, v219
    v_and_b32 v220, 0xffff0000, v20
    v_sub_f32 v220, v216, v220
    v_cvt_pk_bf16_f32 v21, v220, v220
    v_mfma_f32_32x32x16_bf16 v[192:207], a[236:239], v[236:239], v[192:207]
    v_add_u32 v31, s55, v29
    ds_read_b128 a[232:235], v31 offset:0
    v_mov_b32 v22, v20
    v_mov_b32 v23, v21
    v_mul_f32 v26, 0x3e8b97f6, v24
    s_waitcnt lgkmcnt(3)
    v_mfma_f32_32x32x16_bf16 v[192:207], a[240:243], v[240:243], v[192:207]
    ds_read_b128 a[236:239], v31 offset:1024
    buffer_load_dword v8, v25, s[4:7], s91 offen sc1
    v_lshrrev_b32 v9, 1, v3
    v_add_u32 v9, s93, v9
    v_mov_b32_dpp v210, v208 row_ror:8 row_mask:0xf bank_mask:0xf
    v_mfma_f32_32x32x16_bf16 v[192:207], a[244:247], v[244:247], v[192:207]
    ds_read_b128 a[240:243], v31 offset:2048
    ds_write_b32 v9, v24
    v_add_u32 v28, s84, v1
    v_add_u32 v30, s85, v1
    v_mfma_f32_32x32x16_bf16 v[192:207], a[248:251], v[248:251], v[192:207]
    ds_read_b128 a[244:247], v31 offset:3072
    s_mov_b32 s20, 0xff00ff00
    s_mov_b32 s21, 0xff00ff00
    v_cndmask_b32_e64 v209, v210, v208, s[20:21]
    v_cndmask_b32_e64 v208, v208, v210, s[20:21]
    v_mul_f32 v208, 0xbb124925, v208
    v_mov_b32 v210, 0x3727c5ac
    v_fmac_f32 v210, 0x3b124925, v209
    v_fma_f32 v211, -v208, v208, v210
    v_max_f32 v211, 0x3727c5ac, v211
    v_cvt_pk_bf16_f32 v252, v208, v208
    v_rsq_f32 v213, v211
    v_and_b32 v212, 0xffff0000, v252
    v_sub_f32 v212, v208, v212
    v_cvt_pk_bf16_f32 v253, v212, v212
    v_cndmask_b32_e64 v254, 0, v252, s[18:19]
    v_cndmask_b32_e64 v255, 0, v253, s[18:19]
    v_cndmask_b32_e64 v252, 0, v252, s[16:17]
    v_cndmask_b32_e64 v253, 0, v253, s[16:17]
    v_mfma_f32_32x32x16_bf16 v[144:159], a[252:255], v[20:23], v[144:159]
    ds_read_b128 a[248:251], v31 offset:4096
    v_add_u32 v214, 89184, v10
    ds_write_b32 v214, v213
    s_waitcnt lgkmcnt(5)
    v_mfma_f32_32x32x16_bf16 v[192:207], a[224:227], v[252:255], v[192:207]
    ds_read_b128 a[252:255], v31 offset:5120
    buffer_load_dword v5, v4, s[4:7], s57 offen
    v_min_u32 v27, 768, v4
    s_mul_i32 s22, s29, 896
    s_add_u32 s22, s22, s26
    buffer_load_dword v5, v27, s[4:7], s22 offen
    v_mfma_f32_32x32x16_bf16 v[160:175], a[228:231], v[20:23], v[160:175]
    ds_read_b128 a[224:227], v31 offset:6144
    v_cvt_pk_bf16_f32 v144, v144, v145
    v_cvt_pk_bf16_f32 v145, v146, v147
    v_cvt_pk_bf16_f32 v146, v148, v149
    v_cvt_pk_bf16_f32 v147, v150, v151
    v_cvt_pk_bf16_f32 v148, v152, v153
    v_mfma_f32_32x32x16_bf16 v[208:223], v[224:227], a[232:235], 0
    ds_read_b128 a[228:231], v29 offset:30720
    v_cvt_pk_bf16_f32 v149, v154, v155
    v_cvt_pk_bf16_f32 v150, v156, v157
    v_cvt_pk_bf16_f32 v151, v158, v159
    v_add_u32 v224, s86, v1
    v_lshrrev_b32 v226, 5, v1
    v_mfma_f32_32x32x16_bf16 v[208:223], v[228:231], a[236:239], v[208:223]
    ds_read_b128 a[232:235], v29 offset:0
    s_mov_b64 exec, s[94:95]
    ds_write_b128 v28, v[144:147]
    ds_write_b128 v28, v[148:151] offset:1024
    s_mov_b64 exec, -1
    s_waitcnt lgkmcnt(5)
    v_mfma_f32_32x32x16_bf16 v[208:223], v[232:235], a[240:243], v[208:223]
    ds_read_b128 a[236:239], v29 offset:1024
    v_cvt_pk_bf16_f32 v192, v192, v193
    v_cvt_pk_bf16_f32 v193, v194, v195
    v_cvt_pk_bf16_f32 v194, v196, v197
    v_cvt_pk_bf16_f32 v195, v198, v199
    v_cvt_pk_bf16_f32 v196, v200, v201
    v_and_b32 v226, 16, v226
    v_sub_u32 v9, v9, v226
    v_mfma_f32_32x32x16_bf16 v[208:223], v[236:239], a[244:247], v[208:223]
    ds_read_b128 a[240:243], v29 offset:2048
    v_cvt_pk_bf16_f32 v197, v202, v203
    v_cvt_pk_bf16_f32 v198, v204, v205
    v_cvt_pk_bf16_f32 v199, v206, v207
    v_cvt_pk_bf16_f32 v160, v160, v161
    v_cvt_pk_bf16_f32 v161, v162, v163
    v_mfma_f32_32x32x16_bf16 v[208:223], v[240:243], a[248:251], v[208:223]
    ds_read_b128 a[244:247], v29 offset:3072
    s_mov_b64 exec, s[94:95]
    ds_write_b128 v30, v[192:195]
    ds_write_b128 v30, v[196:199] offset:1024
    s_mov_b64 exec, -1
    v_mfma_f32_32x32x16_bf16 v[208:223], v[244:247], a[252:255], v[208:223]
    ds_read_b128 a[248:251], v29 offset:4096
    v_cvt_pk_bf16_f32 v162, v164, v165
    v_cvt_pk_bf16_f32 v163, v166, v167
    v_cvt_pk_bf16_f32 v164, v168, v169
    v_cvt_pk_bf16_f32 v165, v170, v171
    s_waitcnt lgkmcnt(5)
    v_mfma_f32_32x32x16_bf16 v[208:223], v[248:251], a[224:227], v[208:223]
    ds_read_b128 a[252:255], v29 offset:5120
    s_waitcnt vmcnt(2)
    v_xor_b32 v8, s3, v8
    v_cmp_le_u32 vcc, s79, v8
    s_cbranch_vccnz Lfs_23
Lc_24:
    s_waitcnt lgkmcnt(2)
    s_barrier
    ds_read_b128 v[152:155], v224
    ds_read_b128 v[156:159], v224 offset:1024
    v_mfma_f32_32x32x16_bf16 v[208:223], v[252:255], a[228:231], v[208:223]
    v_mov_b32 v248, -1
    v_lshlrev_b32 v249, 1, v1
    v_cvt_pk_bf16_f32 v166, v172, v173
    v_cvt_pk_bf16_f32 v167, v174, v175
    v_bfi_b32 v228, 31, v226, v9
    v_subrev_u32 v229, 4, v9
    v_mfma_f32_32x32x16_bf16 v[192:207], v[32:35], a[232:235], 0
    v_bfi_b32 v229, 31, v226, v229
    v_subrev_u32 v230, 8, v9
    v_bfi_b32 v230, 31, v226, v230
    v_subrev_u32 v231, 12, v9
    v_bfi_b32 v231, 31, v226, v231
    v_cndmask_b32_e64 v232, 0, v176, s[70:71]
    v_mfma_f32_32x32x16_bf16 v[192:207], v[36:39], a[236:239], v[192:207]
    v_cvt_pk_bf16_f32 v246, v220, v221
    v_cvt_pk_bf16_f32 v247, v222, v223
    v_cndmask_b32_e64 v233, 0, v177, s[70:71]
    v_cndmask_b32_e64 v234, 0, v178, s[70:71]
    v_cndmask_b32_e64 v235, 0, v179, s[70:71]
    s_waitcnt lgkmcnt(2)
    v_mfma_f32_32x32x16_bf16 v[192:207], v[40:43], a[240:243], v[192:207]
    ds_read_b32 v228, v228 offset:0
    ds_read_b32 v229, v229 offset:4
    ds_read_b32 v230, v230 offset:8
    ds_read_b32 v231, v231 offset:12
    v_perm_b32 v236, v177, v176, s53
    v_perm_b32 v237, v179, v178, s53
    v_mfma_f32_32x32x16_bf16 v[192:207], v[44:47], a[244:247], v[192:207]
    ds_read_b128 a[224:227], v29 offset:6144
    v_perm_b32 v238, v181, v180, s53
    v_perm_b32 v239, v183, v182, s53
    v_perm_b32 v240, v185, v184, s53
    v_perm_b32 v241, v187, v186, s53
    v_perm_b32 v242, v189, v188, s53
    v_mfma_f32_32x32x16_bf16 v[192:207], v[48:51], a[248:251], v[192:207]
    ds_read_b128 a[228:231], v29 offset:7168
    v_perm_b32 v243, v191, v190, s53
    v_cndmask_b32_e64 v244, 0, v236, s[70:71]
    v_cndmask_b32_e64 v245, 0, v237, s[70:71]
    v_add_u32 v225, s87, v1
    s_lshl2_add_u32 s93, s25, s101
    v_mfma_f32_32x32x16_bf16 v[192:207], v[52:55], a[252:255], v[192:207]
    ds_read_b128 a[232:235], v29 offset:8192
    s_waitcnt lgkmcnt(8)
    v_mfma_f32_32x32x16_bf16 v[208:223], v[152:155], v[160:163], 0
    ds_read_b128 a[236:239], v29 offset:9216
    v_mfma_f32_32x32x16_bf16 v[32:47], v[144:147], v[160:163], v[176:191]
    ds_read_b128 a[240:243], v29 offset:10240
    s_waitcnt lgkmcnt(9)
    v_mfma_f32_32x32x16_bf16 v[208:223], v[156:159], v[164:167], v[208:223]
    ds_read_b128 a[244:247], v29 offset:11264
    v_mfma_f32_32x32x16_bf16 v[32:47], v[148:151], v[164:167], v[32:47]
    ds_read_b128 a[248:251], v29 offset:12288
    s_waitcnt lgkmcnt(3)
    v_mfma_f32_32x32x16_bf16 v[192:207], v[56:59], a[224:227], v[192:207]
    ds_read_b128 a[252:255], v29 offset:13312
    s_nop 5
    v_add_f32 v208, v208, v212
    v_add_f32 v209, v209, v213
    v_add_f32 v210, v210, v214
    v_add_f32 v211, v211, v215
    v_add_f32 v216, v216, v220
    v_mfma_f32_32x32x16_bf16 v[192:207], v[60:63], a[228:231], v[192:207]
    ds_read_b128 a[224:227], v29 offset:14336
    v_add_f32 v217, v217, v221
    v_add_f32 v218, v218, v222
    v_add_f32 v219, v219, v223
    v_add_f32 v208, v208, v216
    v_add_f32 v209, v209, v217
    v_mfma_f32_32x32x16_bf16 v[192:207], v[64:67], a[232:235], v[192:207]
    ds_read_b128 a[228:231], v29 offset:15360
    buffer_store_dword v248, v249, s[4:7], s57 offen offset:2048
    v_add_f32 v210, v210, v218
    v_add_f32 v211, v211, v219
    v_mfma_f32_32x32x16_bf16 v[192:207], v[68:71], a[236:239], v[192:207]
    ds_read_b128 a[232:235], v29 offset:16384
    v_max3_f32 v32, v32, v36, v40
    v_max3_f32 v33, v33, v37, v41
    v_max3_f32 v34, v34, v38, v42
    v_max3_f32 v35, v35, v39, v43
    s_waitcnt lgkmcnt(3)
    v_mfma_f32_32x32x16_bf16 v[192:207], v[72:75], a[240:243], v[192:207]
    ds_read_b128 a[236:239], v29 offset:17408
    v_bfi_b32 v208, v232, v208, -1
    v_bfi_b32 v209, v233, v209, -1
    v_bfi_b32 v210, v234, v210, -1
    v_bfi_b32 v211, v235, v211, -1
    v_max3_f32 v208, v208, v32, v44
    v_mfma_f32_32x32x16_bf16 v[192:207], v[76:79], a[244:247], v[192:207]
    ds_read_b128 a[240:243], v29 offset:18432
    v_max3_f32 v209, v209, v33, v45
    v_max3_f32 v210, v210, v34, v46
    v_max3_f32 v211, v211, v35, v47
    v_mul_f32 v208, v208, v228
    v_mul_f32 v209, v209, v229
    v_mfma_f32_32x32x16_bf16 v[192:207], v[80:83], a[248:251], v[192:207]
    ds_read_b128 a[244:247], v29 offset:19456
    v_mul_f32 v210, v210, v230
    v_mul_f32 v211, v211, v231
    v_max_f32 v212, v208, v209
    v_max3_f32 v212, v212, v210, v211
    v_mov_b32 v213, v212
    v_mfma_f32_32x32x16_bf16 v[192:207], v[84:87], a[252:255], v[192:207]
    ds_read_b128 a[248:251], v29 offset:20480
    v_permlane32_swap_b32 v212, v213
    v_max_f32 v212, v212, v213
    v_mul_f32 v212, v212, v26
    v_fma_f32 v208, v208, v26, -v212
    s_waitcnt lgkmcnt(3)
    v_mfma_f32_32x32x16_bf16 v[192:207], v[88:91], a[224:227], v[192:207]
    ds_read_b128 a[252:255], v29 offset:21504
    v_fma_f32 v209, v209, v26, -v212
    v_fma_f32 v210, v210, v26, -v212
    v_fma_f32 v211, v211, v26, -v212
    v_exp_f32_e64 v208, v208 clamp
    v_mfma_f32_32x32x16_bf16 v[192:207], v[92:95], a[228:231], v[192:207]
    ds_read_b128 a[224:227], v29 offset:22528
    v_exp_f32_e64 v209, v209 clamp
    v_exp_f32_e64 v210, v210 clamp
    v_mfma_f32_32x32x16_bf16 v[192:207], v[96:99], a[232:235], v[192:207]
    ds_read_b128 a[228:231], v29 offset:23552
    s_add_u32 s22, s57, 4096
    buffer_store_dword v248, v249, s[4:7], s22 offen offset:1024
    v_mfma_f32_32x32x16_bf16 v[192:207], v[100:103], a[236:239], v[192:207]
    ds_read_b128 a[232:235], v29 offset:24576
    v_exp_f32_e64 v211, v211 clamp
    v_add_f32 v212, v208, v209
    v_add_f32 v213, v210, v211
    s_waitcnt lgkmcnt(3)
    v_mfma_f32_32x32x16_bf16 v[192:207], v[104:107], a[240:243], v[192:207]
    ds_read_b128 a[236:239], v29 offset:25600
    v_add_f32 v212, v212, v213
    v_mov_b32 v213, v212
    v_mul_f32 v208, v208, v228
    v_mul_f32 v209, v209, v229
    v_permlane32_swap_b32 v212, v213
    v_mfma_f32_32x32x16_bf16 v[192:207], v[108:111], a[244:247], v[192:207]
    ds_read_b128 a[240:243], v29 offset:26624
    s_add_u32 s22, s49, 0x0
    buffer_store_dword v248, v2, s[4:7], s22 offen
    s_add_u32 s22, s49, 0x4000
    buffer_store_dword v248, v2, s[4:7], s22 offen
    s_add_u32 s22, s49, 0x8000
    buffer_store_dword v248, v2, s[4:7], s22 offen
    v_mfma_f32_32x32x16_bf16 v[192:207], v[112:115], a[248:251], v[192:207]
    ds_read_b128 a[244:247], v29 offset:27648
    v_add_f32 v212, v212, v213
    v_rcp_f32 v212, v212
    v_mul_f32 v210, v210, v230
    v_mul_f32 v211, v211, v231
    v_mfma_f32_32x32x16_bf16 v[192:207], v[116:119], a[252:255], v[192:207]
    ds_read_b128 a[248:251], v29 offset:30720
    v_mul_f32 v208, v208, v212
    v_mul_f32 v209, v209, v212
    v_mul_f32 v210, v210, v212
    v_mul_f32 v211, v211, v212
    s_waitcnt lgkmcnt(3)
    v_mfma_f32_32x32x16_bf16 v[192:207], v[120:123], a[224:227], v[192:207]
    v_cvt_pk_bf16_f32 v212, v208, v209
    v_cvt_pk_bf16_f32 v213, v210, v211
    v_bfi_b32 v52, v236, 0, v212
    v_bfi_b32 v53, v237, 0, v213
    v_bfi_b32 v54, v238, 0, v212
    v_bfi_b32 v55, v239, 0, v213
    v_mfma_f32_32x32x16_bf16 v[192:207], v[124:127], a[228:231], v[192:207]
    s_add_u32 m0, s55, 0x0
    s_add_u32 s62, s39, 0x0
    buffer_load_dwordx4 v1, s[4:7], s62 offen lds
    v_mfma_f32_32x32x16_bf16 v[192:207], v[128:131], a[232:235], v[192:207]
    v_bfi_b32 v56, v240, 0, v212
    v_bfi_b32 v57, v241, 0, v213
    v_bfi_b32 v58, v242, 0, v212
    v_bfi_b32 v59, v243, 0, v213
    v_and_b32 v60, v244, v212
    v_and_b32 v61, v245, v213
    v_mfma_f32_32x32x16_bf16 v[192:207], v[132:135], a[236:239], v[192:207]
    buffer_load_dwordx4 v1, s[4:7], s62 offen offset:1024 lds
    v_and_b32 v62, v244, v212
    s_waitcnt lgkmcnt(0)
    v_mfma_f32_32x32x16_bf16 v[192:207], v[136:139], a[240:243], v[192:207]
    v_and_b32 v63, v245, v213
    v_mfma_f32_32x32x16_bf16 v[192:207], v[140:143], a[244:247], v[192:207]
    buffer_load_dwordx4 v1, s[4:7], s62 offen offset:2048 lds
    v_mfma_f32_32x32x16_bf16 v[192:207], v[20:23], a[248:251], v[192:207]
    buffer_load_dwordx4 v1, s[4:7], s62 offen offset:3072 lds
    s_add_u32 m0, s55, 0x1000
    s_nop 0
    buffer_load_dwordx4 v0, s[4:7], s62 offen lds
    s_nop 7
    v_cvt_pk_bf16_f32 v70, v204, v205
    v_cvt_pk_bf16_f32 v71, v206, v207
    ds_write_b64 v28, v[70:71] offset:3080
    ds_write_b64 v225, v[246:247]
    v_cvt_pk_bf16_f32 v64, v192, v193
    v_cvt_pk_bf16_f32 v65, v194, v195
    v_cvt_pk_bf16_f32 v66, v196, v197
    v_cvt_pk_bf16_f32 v67, v198, v199
    v_cvt_pk_bf16_f32 v68, v200, v201
    v_cvt_pk_bf16_f32 v69, v202, v203
    v_mfma_f32_32x32x16_bf16 v[176:191], v[64:67], v[52:55], 0
    s_waitcnt lgkmcnt(0)
    s_barrier
    ds_read_b128 v[168:171], v224 offset:2048
    ds_read_b128 v[172:175], v224 offset:3072
    v_mfma_f32_32x32x16_bf16 v[176:191], v[68:71], v[56:59], v[176:191]
    buffer_load_dwordx4 v0, s[4:7], s62 offen offset:1024 lds
    buffer_load_dwordx4 v0, s[4:7], s62 offen offset:2048 lds
    s_andn2_b32 s3, s3, 15
    s_cmp_lg_u32 s45, 0
    v_or_b32_e64 v27, s3, 0
    s_waitcnt vmcnt(7)
    s_cbranch_scc1 Lef_25
    buffer_store_dword v27, v6, s[4:7], s93 offen
Lef_25:
    s_waitcnt lgkmcnt(1)
    v_mfma_f32_32x32x16_bf16 v[176:191], v[168:171], v[60:63], v[176:191]
    s_waitcnt lgkmcnt(0)
    v_mfma_f32_32x32x16_bf16 v[176:191], v[172:175], v[60:63], v[176:191]
    s_andn2_b32 s3, s3, 15
    s_cmp_lg_u32 s45, 0
    s_cbranch_scc1 Lslow_entry
    s_nop 8
    v_cvt_pk_bf16_f32 v176, v176, v177
    v_cvt_pk_bf16_f32 v177, v178, v179
    v_cvt_pk_bf16_f32 v178, v180, v181
    v_cvt_pk_bf16_f32 v179, v182, v183
    buffer_store_dwordx4 v[176:179], v1, s[4:7], s57 offen offset:2048
    v_cvt_pk_bf16_f32 v180, v184, v185
    v_cvt_pk_bf16_f32 v181, v186, v187
    v_cvt_pk_bf16_f32 v182, v188, v189
    v_cvt_pk_bf16_f32 v183, v190, v191
    buffer_store_dwordx4 v[180:183], v1, s[4:7], s57 offen offset:3072
LstS2_0f:
    s_add_u32 m0, s55, 0x7000
    s_add_u32 s63, s39, 0x7000
    buffer_load_dwordx4 v1, s[4:7], s63 offen lds
    buffer_load_dwordx4 v1, s[4:7], s63 offen offset:1024 lds
    buffer_load_dwordx4 v1, s[4:7], s63 offen offset:2048 lds
    buffer_load_dwordx4 v1, s[4:7], s63 offen offset:3072 lds
    s_add_u32 m0, s55, 0x8000
    s_nop 0
    buffer_load_dwordx4 v0, s[4:7], s63 offen lds
    buffer_load_dwordx4 v0, s[4:7], s63 offen offset:1024 lds
    buffer_load_dwordx4 v0, s[4:7], s63 offen offset:2048 lds
    s_cmp_ge_u32 s25, 14
    s_cbranch_scc1 Lidle_26
    s_and_b32 s86, s24, 1
    s_lshl_b32 s87, s86, 5
    s_andn2_b32 s85, s100, 63
    s_add_u32 s85, s85, s87
    buffer_load_dword v8, v10, s[4:7], s85 offen sc1
    s_add_u32 s66, s3, 0
    s_lshl_b32 s87, s86, 1
    s_sub_u32 s87, s87, s24
    s_mul_i32 s87, s87, 114688
    s_add_u32 s84, s87, s46
    s_mul_i32 s87, s86, 28736
    s_add_u32 s87, s87, 106496
    v_and_b32 v146, 0x58, v3
    v_and_b32 v147, 0x60, v3
    v_lshl_add_u32 v146, v147, 2, v146
    v_bfe_u32 v147, v3, 7, 1
    v_lshl_add_u32 v146, v147, 5, v146
    v_xor_b32 v146, s87, v146
    v_xor_b32 v147, 64, v146
    v_and_b32 v145, 0x200, v1
    v_add_u32 v144, v145, v146
    v_add_u32 v145, v145, v147
    s_lshl_b32 s87, s24, 12
    s_add_u32 s87, s87, 90112
    v_add_u32 v31, s87, v1
    v_xor_b32 v28, 0x1000, v31
    v_lshlrev_b32 v176, 16, v12
    v_and_b32 v177, 0xffff0000, v12
    v_lshlrev_b32 v178, 16, v13
    v_and_b32 v179, 0xffff0000, v13
    v_lshlrev_b32 v180, 16, v14
    v_and_b32 v181, 0xffff0000, v14
    v_lshlrev_b32 v182, 16, v15
    v_and_b32 v183, 0xffff0000, v15
    v_lshlrev_b32 v184, 16, v16
    v_and_b32 v185, 0xffff0000, v16
    v_lshlrev_b32 v186, 16, v17
    v_and_b32 v187, 0xffff0000, v17
    v_lshlrev_b32 v188, 16, v18
    v_and_b32 v189, 0xffff0000, v18
    v_lshlrev_b32 v190, 16, v19
    v_and_b32 v191, 0xffff0000, v19
    s_add_u32 s92, s57, 0x1400
    s_add_u32 s93, s49, 0x0
    v_or_b32_e64 v162, s3, 0
    s_barrier
    ds_read_b64_tr_b16 v[96:97], v145 offset:0
    ds_read_b64_tr_b16 v[98:99], v145 offset:1024
    ds_read_b64_tr_b16 v[100:101], v144 offset:0
    ds_read_b64_tr_b16 v[102:103], v144 offset:1024
    ds_read_b64_tr_b16 v[104:105], v145 offset:2048
    ds_read_b64_tr_b16 v[106:107], v147 offset:3072
    ds_read_b64_tr_b16 v[108:109], v144 offset:2048
    ds_read_b64_tr_b16 v[110:111], v146 offset:3072
    ds_read_b64_tr_b16 v[112:113], v145 offset:3584
    ds_read_b64_tr_b16 v[114:115], v145 offset:4608
    ds_read_b64_tr_b16 v[116:117], v144 offset:3584
    ds_read_b64_tr_b16 v[118:119], v144 offset:4608
    ds_read_b64_tr_b16 v[120:121], v145 offset:5632
    ds_read_b64_tr_b16 v[122:123], v147 offset:6656
    ds_read_b64_tr_b16 v[124:125], v144 offset:5632
    ds_read_b64_tr_b16 v[126:127], v146 offset:6656
    ds_read_b64_tr_b16 v[128:129], v145 offset:7168
    ds_read_b64_tr_b16 v[130:131], v145 offset:8192
    ds_read_b64_tr_b16 v[132:133], v144 offset:7168
    ds_read_b64_tr_b16 v[134:135], v144 offset:8192
    ds_read_b64_tr_b16 v[136:137], v145 offset:9216
    ds_read_b64_tr_b16 v[138:139], v147 offset:10240
    ds_read_b64_tr_b16 v[140:141], v144 offset:9216
    ds_read_b64_tr_b16 v[142:143], v146 offset:10240
    ds_read_b64_tr_b16 v[224:225], v145 offset:10752
    ds_read_b64_tr_b16 v[226:227], v145 offset:11776
    ds_read_b64_tr_b16 v[228:229], v144 offset:10752
    ds_read_b64_tr_b16 v[230:231], v144 offset:11776
    ds_read_b64_tr_b16 v[232:233], v145 offset:12800
    ds_read_b64_tr_b16 v[234:235], v147 offset:13824
    ds_read_b64_tr_b16 v[236:237], v144 offset:12800
    ds_read_b64_tr_b16 v[238:239], v146 offset:13824
    ds_read_b64_tr_b16 v[240:241], v145 offset:14336
    ds_read_b64_tr_b16 v[242:243], v145 offset:15360
    ds_read_b64_tr_b16 v[244:245], v145 offset:16384
    ds_read_b64_tr_b16 v[246:247], v147 offset:17408
    ds_read_b64_tr_b16 v[248:249], v145 offset:17920
    ds_read_b64_tr_b16 v[250:251], v145 offset:18944
    ds_read_b64_tr_b16 v[252:253], v145 offset:19968
    ds_read_b64_tr_b16 v[254:255], v147 offset:20992
    ds_read_b64_tr_b16 a[224:225], v145 offset:21504
    ds_read_b64_tr_b16 a[226:227], v145 offset:22528
    ds_read_b64_tr_b16 a[228:229], v145 offset:23552
    ds_read_b64_tr_b16 a[230:231], v147 offset:24576
    ds_read_b64_tr_b16 a[232:233], v145 offset:25088
    ds_read_b64_tr_b16 a[234:235], v145 offset:26112
    ds_read_b64_tr_b16 a[236:237], v145 offset:27136
    ds_read_b64_tr_b16 a[238:239], v147 offset:28160
    ds_read_b64_tr_b16 a[240:241], v144 offset:14336
    ds_read_b64_tr_b16 a[242:243], v144 offset:15360
    ds_read_b64_tr_b16 a[244:245], v144 offset:16384
    ds_read_b64_tr_b16 a[246:247], v146 offset:17408
    ds_read_b64_tr_b16 a[248:249], v144 offset:17920
    ds_read_b64_tr_b16 a[250:251], v144 offset:18944
    ds_read_b64_tr_b16 a[252:253], v144 offset:19968
    ds_read_b64_tr_b16 a[254:255], v146 offset:20992
    ds_read_b64_tr_b16 v[208:209], v144 offset:21504
    ds_read_b64_tr_b16 v[210:211], v144 offset:22528
    ds_read_b64_tr_b16 v[212:213], v144 offset:23552
    ds_read_b64_tr_b16 v[214:215], v146 offset:24576
    ds_read_b64_tr_b16 v[216:217], v144 offset:25088
    ds_read_b64_tr_b16 v[218:219], v144 offset:26112
    ds_read_b64_tr_b16 v[220:221], v144 offset:27136
    ds_read_b64_tr_b16 v[222:223], v146 offset:28160
    buffer_load_dword v9, v10, s[4:7], s85 offen sc1
Lp_27:
    s_waitcnt vmcnt(1)
    v_subrev_u32 v8, s66, v8
    v_cmp_le_u32 vcc, 16, v8
    s_cbranch_vccz Lo_28
    buffer_load_dword v8, v10, s[4:7], s85 offen sc1
    s_waitcnt vmcnt(1)
    v_subrev_u32 v9, s66, v9
    v_cmp_le_u32 vcc, 16, v9
    s_cbranch_vccz Lo_28
    buffer_load_dword v9, v10, s[4:7], s85 offen sc1
    s_sub_u32 s30, s30, 1
    s_cbranch_scc0 Lp_27
    s_mov_b32 s30, 0
Lo_28:
    buffer_load_dwordx4 v[32:35], v1, s[4:7], s84 offen offset:2048 sc1
    buffer_load_dwordx4 v[36:39], v1, s[4:7], s84 offen offset:3072 sc1
    s_add_u32 s65, s84, 0x6000
    buffer_load_dwordx4 v[40:43], v0, s[4:7], s65 offen offset:2048 sc1
    buffer_load_dwordx4 v[44:47], v0, s[4:7], s65 offen offset:3072 sc1
    s_add_u32 s65, s84, 0xe000
    buffer_load_dwordx4 v[48:51], v1, s[4:7], s65 offen offset:2048 sc1
    buffer_load_dwordx4 v[52:55], v1, s[4:7], s65 offen offset:3072 sc1
    s_add_u32 s65, s84, 0x14000
    buffer_load_dwordx4 v[56:59], v0, s[4:7], s65 offen offset:2048 sc1
    buffer_load_dwordx4 v[60:63], v0, s[4:7], s65 offen offset:3072 sc1
    s_waitcnt vmcnt(7)
    v_cmp_u_f32 vcc, v32, v32
    s_cbranch_vccnz Lfc_29
Lc_30:
    s_waitcnt lgkmcnt(15)
    v_mfma_f32_32x32x16_bf16 v[192:207], v[96:99], v[32:35], 0
    s_add_u32 s65, s84, 0x1c000
    buffer_load_dwordx4 v[64:67], v1, s[4:7], s65 offen offset:2048 sc1
    s_waitcnt vmcnt(7)
    v_cmp_u_f32 vcc, v36, v36
    v_mfma_f32_32x32x16_bf16 v[176:191], v[100:103], v[32:35], v[176:191]
    buffer_load_dwordx4 v[68:71], v1, s[4:7], s65 offen offset:3072 sc1
    s_cbranch_vccnz Lfc_32
Lc_33:
    v_mfma_f32_32x32x16_bf16 v[192:207], v[104:107], v[36:39], v[192:207]
    s_add_u32 s65, s84, 0x22000
    buffer_load_dwordx4 v[72:75], v0, s[4:7], s65 offen offset:2048 sc1
    s_waitcnt vmcnt(7)
    v_cmp_u_f32 vcc, v40, v44
    v_mfma_f32_32x32x16_bf16 v[176:191], v[108:111], v[36:39], v[176:191]
    buffer_load_dwordx4 v[76:79], v0, s[4:7], s65 offen offset:3072 sc1
    s_cbranch_vccnz Lfc_35
Lc_36:
    v_mfma_f32_32x32x16_bf16 v[192:207], v[112:115], v[40:43], v[192:207]
    s_add_u32 s65, s84, 0x2a000
    buffer_load_dwordx4 v[80:83], v1, s[4:7], s65 offen offset:2048 sc1
    v_mfma_f32_32x32x16_bf16 v[176:191], v[116:119], v[40:43], v[176:191]
    buffer_load_dwordx4 v[84:87], v1, s[4:7], s65 offen offset:3072 sc1
    v_mfma_f32_32x32x16_bf16 v[192:207], v[120:123], v[44:47], v[192:207]
    s_add_u32 s65, s84, 0x30000
    buffer_load_dwordx4 v[88:91], v0, s[4:7], s65 offen offset:2048 sc1
    s_waitcnt vmcnt(9)
    v_cmp_u_f32 vcc, v48, v52
    v_mfma_f32_32x32x16_bf16 v[176:191], v[124:127], v[44:47], v[176:191]
    buffer_load_dwordx4 v[92:95], v0, s[4:7], s65 offen offset:3072 sc1
    s_cbranch_vccnz Lfc_38
Lc_39:
    v_mfma_f32_32x32x16_bf16 v[192:207], v[128:131], v[48:51], v[192:207]
    v_mfma_f32_32x32x16_bf16 v[176:191], v[132:135], v[48:51], v[176:191]
    v_mfma_f32_32x32x16_bf16 v[192:207], v[136:139], v[52:55], v[192:207]
    s_lshl_b32 s22, s24, 12
    s_add_u32 s22, s22, LstS3_0f-Lpc_3
    v_lshlrev_b32 v27, 2, v1
    buffer_load_dword v8, v27, s[12:15], s22 offen
    s_waitcnt vmcnt(9)
    v_cmp_u_f32 vcc, v56, v60
    s_add_u32 m0, s55, 0xe000
    s_add_u32 s67, s39, 0xe000
    buffer_load_dwordx4 v1, s[4:7], s67 offen lds
    v_mfma_f32_32x32x16_bf16 v[176:191], v[140:143], v[52:55], v[176:191]
    s_cbranch_vccnz Lfc_41
Lc_42:
    v_mfma_f32_32x32x16_bf16 v[192:207], v[224:227], v[56:59], v[192:207]
    buffer_load_dwordx4 v1, s[4:7], s67 offen offset:1024 lds
    v_mfma_f32_32x32x16_bf16 v[176:191], v[228:231], v[56:59], v[176:191]
    buffer_load_dwordx4 v1, s[4:7], s67 offen offset:2048 lds
    v_mfma_f32_32x32x16_bf16 v[192:207], v[232:235], v[60:63], v[192:207]
    s_waitcnt vmcnt(10)
    v_cmp_u_f32 vcc, v64, v68
    s_waitcnt lgkmcnt(0)
    s_barrier
    v_mfma_f32_32x32x16_bf16 v[176:191], v[236:239], v[60:63], v[176:191]
    s_cbranch_vccnz Lfc_44
Lc_45:
    buffer_load_dwordx4 v1, s[4:7], s67 offen offset:3072 lds
    s_add_u32 m0, s55, 0xf000
    v_mfma_f32_32x32x16_bf16 v[192:207], v[240:243], v[64:67], v[192:207]
    s_waitcnt vmcnt(9)
    v_cmp_u_f32 vcc, v72, v76
    v_mfma_f32_32x32x16_bf16 v[192:207], v[244:247], v[68:71], v[192:207]
    s_cbranch_vccnz Lfc_47
Lc_48:
    buffer_load_dwordx4 v0, s[4:7], s67 offen lds
    v_mfma_f32_32x32x16_bf16 v[192:207], v[248:251], v[72:75], v[192:207]
    s_waitcnt vmcnt(8)
    v_cmp_u_f32 vcc, v80, v84
    v_mfma_f32_32x32x16_bf16 v[192:207], v[252:255], v[76:79], v[192:207]
    s_cbranch_vccnz Lfc_50
Lc_51:
    buffer_load_dwordx4 v0, s[4:7], s67 offen offset:1024 lds
    v_mfma_f32_32x32x16_bf16 v[192:207], a[224:227], v[80:83], v[192:207]
    s_waitcnt vmcnt(7)
    v_cmp_u_f32 vcc, v88, v92
    buffer_load_dwordx4 v0, s[4:7], s67 offen offset:2048 lds
    v_mfma_f32_32x32x16_bf16 v[192:207], a[228:231], v[84:87], v[192:207]
    s_cbranch_vccnz Lfc_53
Lc_54:
    v_mfma_f32_32x32x16_bf16 v[192:207], a[232:235], v[88:91], v[192:207]
    v_mfma_f32_32x32x16_bf16 v[192:207], a[236:239], v[92:95], v[192:207]
    v_mfma_f32_32x32x16_bf16 v[176:191], a[240:243], v[64:67], v[176:191]
    v_mfma_f32_32x32x16_bf16 v[176:191], a[244:247], v[68:71], v[176:191]
    s_nop 9
    ds_write_b128 v28, v[192:195] offset:0
    v_mfma_f32_32x32x16_bf16 v[176:191], a[248:251], v[72:75], v[176:191]
    ds_write_b128 v28, v[196:199] offset:1024
    v_mfma_f32_32x32x16_bf16 v[176:191], a[252:255], v[76:79], v[176:191]
    ds_write_b128 v28, v[200:203] offset:2048
    v_mfma_f32_32x32x16_bf16 v[176:191], v[208:211], v[80:83], v[176:191]
    ds_write_b128 v28, v[204:207] offset:3072
    v_mfma_f32_32x32x16_bf16 v[176:191], v[212:215], v[84:87], v[176:191]
    v_mfma_f32_32x32x16_bf16 v[176:191], v[216:219], v[88:91], v[176:191]
    v_mfma_f32_32x32x16_bf16 v[176:191], v[220:223], v[92:95], v[176:191]
    s_waitcnt lgkmcnt(0)
    s_barrier
    ds_read_b128 v[192:195], v31 offset:0
    ds_read_b128 v[196:199], v31 offset:1024
    ds_read_b128 v[200:203], v31 offset:2048
    ds_read_b128 v[204:207], v31 offset:3072
    buffer_store_dword v162, v6, s[4:7], s100 offen offset:256
    s_waitcnt lgkmcnt(3)
    s_nop 3
    v_pk_add_f32 v[176:177], v[176:177], v[192:193]
    v_pk_add_f32 v[178:179], v[178:179], v[194:195]
    v_cvt_pk_bf16_f32 v12, v176, v177
    v_cvt_pk_bf16_f32 v13, v178, v179
    s_waitcnt lgkmcnt(2)
    v_pk_add_f32 v[180:181], v[180:181], v[196:197]
    v_pk_add_f32 v[182:183], v[182:183], v[198:199]
    v_cvt_pk_bf16_f32 v14, v180, v181
    v_cvt_pk_bf16_f32 v15, v182, v183
    buffer_store_dwordx4 v[12:15], v1, s[4:7], s92 offen
    s_waitcnt lgkmcnt(1)
    v_pk_add_f32 v[184:185], v[184:185], v[200:201]
    v_pk_add_f32 v[186:187], v[186:187], v[202:203]
    v_cvt_pk_bf16_f32 v16, v184, v185
    v_cvt_pk_bf16_f32 v17, v186, v187
    s_waitcnt lgkmcnt(0)
    v_pk_add_f32 v[188:189], v[188:189], v[204:205]
    v_pk_add_f32 v[190:191], v[190:191], v[206:207]
    v_cvt_pk_bf16_f32 v18, v188, v189
    v_cvt_pk_bf16_f32 v19, v190, v191
    buffer_store_dwordx4 v[16:19], v1, s[4:7], s92 offen offset:1024
    v_dot2_f32_bf16 v160, v12, s23, 0
    v_dot2_f32_bf16 v161, v12, v12, 0
    v_dot2_f32_bf16 v160, v13, s23, v160
    v_dot2_f32_bf16 v161, v13, v13, v161
    v_dot2_f32_bf16 v160, v14, s23, v160
    v_dot2_f32_bf16 v161, v14, v14, v161
    v_dot2_f32_bf16 v160, v15, s23, v160
    v_dot2_f32_bf16 v161, v15, v15, v161
    v_dot2_f32_bf16 v160, v16, s23, v160
    v_dot2_f32_bf16 v161, v16, v16, v161
    v_dot2_f32_bf16 v160, v17, s23, v160
    v_dot2_f32_bf16 v161, v17, v17, v161
    v_dot2_f32_bf16 v160, v18, s23, v160
    v_dot2_f32_bf16 v161, v18, v18, v161
    v_dot2_f32_bf16 v160, v19, s23, v160
    v_dot2_f32_bf16 v161, v19, v19, v161
    s_nop 2
    v_permlane32_swap_b32 v160, v161
    v_add_f32 v160, v160, v161
    buffer_store_dword v160, v2, s[4:7], s93 offen
LstS3_0f:
    s_waitcnt vmcnt(4)
    s_waitcnt lgkmcnt(0)
    s_barrier
    s_lshl_b32 s22, s24, 12
    s_add_u32 s22, s22, LstS4_0f-Lpc_3
    v_lshlrev_b32 v27, 2, v1
    buffer_load_dword v9, v27, s[12:15], s22 offen
    buffer_load_dword v8, v11, s[4:7], s101 offen offset:256 sc1
    s_add_u32 s70, s3, 0
    s_add_u32 s93, s37, 0x0
    v_lshrrev_b32 v30, 1, v1
    v_xor_b32 v30, v30, v1
    v_and_b32 v30, 64, v30
    v_mul_u32_u24 v30, 3, v30
    v_and_b32 v29, 0x100, v1
    v_mul_u32_u24 v5, 111, v29
    v_add_u32 v5, v5, v1
    v_mad_u32_u24 v4, v29, 27, v1
    v_xor_b32 v4, v4, v30
    v_mad_u32_u24 v31, v29, 3, v1
    v_xor_b32 v28, v31, v30
    v_add_u32 v29, 57344, v28
    v_add_u32 v30, 106496, v28
    ds_read_b128 a[224:227], v28 offset:0
    ds_read_b128 a[228:231], v28 offset:28672
    ds_read_b128 a[232:235], v29 offset:0
    ds_read_b128 a[236:239], v28 offset:256
    ds_read_b128 a[240:243], v28 offset:28928
    ds_read_b128 a[244:247], v29 offset:256
    ds_read_b128 a[248:251], v28 offset:2048
    buffer_load_dword v9, v11, s[4:7], s101 offen offset:256 sc1
Lp_57:
    s_waitcnt vmcnt(1)
    v_subrev_u32 v8, s70, v8
    v_cmp_le_u32 vcc, 16, v8
    s_cbranch_vccz Lo_58
    buffer_load_dword v8, v11, s[4:7], s101 offen offset:256 sc1
    s_waitcnt vmcnt(1)
    v_subrev_u32 v9, s70, v9
    v_cmp_le_u32 vcc, 16, v9
    s_cbranch_vccz Lo_58
    buffer_load_dword v9, v11, s[4:7], s101 offen offset:256 sc1
    s_sub_u32 s30, s30, 1
    s_cbranch_scc0 Lp_57
    s_mov_b32 s30, 0
Lo_58:
    s_add_u32 s69, s36, 0x1000
    buffer_load_dwordx4 v[32:35], v31, s[4:7], s69 offen offset:1024 sc1
    buffer_load_dwordx4 v[36:39], v31, s[4:7], s69 offen offset:1280 sc1
    s_add_u32 s69, s36, 0x3000
    buffer_load_dwordx4 v[40:43], v31, s[4:7], s69 offen sc1
    buffer_load_dwordx4 v[44:47], v31, s[4:7], s69 offen offset:256 sc1
    s_add_u32 s69, s36, 0xf000
    buffer_load_dwordx4 v[48:51], v31, s[4:7], s69 offen offset:1024 sc1
    buffer_load_dwordx4 v[52:55], v31, s[4:7], s69 offen offset:1280 sc1
    s_add_u32 s69, s36, 0x11000
    buffer_load_dwordx4 v[56:59], v31, s[4:7], s69 offen sc1
    buffer_load_dwordx4 v[60:63], v31, s[4:7], s69 offen offset:256 sc1
    s_add_u32 s69, s36, 0x1d000
    buffer_load_dwordx4 v[64:67], v31, s[4:7], s69 offen offset:1024 sc1
    buffer_load_dwordx4 v[68:71], v31, s[4:7], s69 offen offset:1280 sc1
    s_add_u32 s69, s36, 0x1f000
    buffer_load_dwordx4 v[72:75], v31, s[4:7], s69 offen sc1
    buffer_load_dwordx4 v[76:79], v31, s[4:7], s69 offen offset:256 sc1
    s_add_u32 s96, s38, s55
    s_waitcnt lgkmcnt(3)
    s_waitcnt vmcnt(10)
    v_cmp_u_f32 vcc, v32, v36
    s_cbranch_vccnz Lfc_59
Lc_60:
    v_mfma_f32_16x16x32_bf16 v[148:151], a[224:227], v[36:39], 0
    ds_read_b128 a[252:255], v28 offset:30720
    v_mfma_f32_16x16x32_bf16 v[144:147], a[224:227], v[32:35], 0
    s_add_u32 s69, s36, 0x2b000
    buffer_load_dwordx4 v[80:83], v31, s[4:7], s69 offen offset:1024 sc1
    v_mfma_f32_16x16x32_bf16 v[160:163], a[228:231], v[32:35], 0
    ds_read_b128 a[224:227], v29 offset:2048
    v_mfma_f32_16x16x32_bf16 v[164:167], a[228:231], v[36:39], 0
    v_mfma_f32_16x16x32_bf16 v[180:183], a[232:235], v[36:39], 0
    ds_read_b128 a[228:231], v28 offset:2304
    buffer_load_dwordx4 v[84:87], v31, s[4:7], s69 offen offset:1280 sc1
    v_mfma_f32_16x16x32_bf16 v[176:179], a[232:235], v[32:35], 0
    v_mfma_f32_16x16x32_bf16 v[152:155], a[236:239], v[32:35], 0
    ds_read_b128 a[232:235], v28 offset:30976
    s_waitcnt lgkmcnt(3)
    v_mfma_f32_16x16x32_bf16 v[156:159], a[236:239], v[36:39], 0
    v_mfma_f32_16x16x32_bf16 v[172:175], a[240:243], v[36:39], 0
    ds_read_b128 a[236:239], v29 offset:2304
    s_waitcnt vmcnt(10)
    v_cmp_u_f32 vcc, v40, v44
    v_mfma_f32_16x16x32_bf16 v[168:171], a[240:243], v[32:35], 0
    s_add_u32 s69, s36, 0x2d000
    buffer_load_dwordx4 v[88:91], v31, s[4:7], s69 offen sc1
    v_mfma_f32_16x16x32_bf16 v[184:187], a[244:247], v[32:35], 0
    ds_read_b128 a[240:243], v28 offset:4096
    s_cbranch_vccnz Lfc_62
Lc_63:
    v_mfma_f32_16x16x32_bf16 v[188:191], a[244:247], v[36:39], 0
    v_mfma_f32_16x16x32_bf16 v[148:151], a[248:251], v[44:47], v[148:151]
    ds_read_b128 a[244:247], v28 offset:32768
    buffer_load_dwordx4 v[92:95], v31, s[4:7], s69 offen offset:256 sc1
    v_mfma_f32_16x16x32_bf16 v[144:147], a[248:251], v[40:43], v[144:147]
    v_mfma_f32_16x16x32_bf16 v[160:163], a[252:255], v[40:43], v[160:163]
    ds_read_b128 a[248:251], v29 offset:4096
    s_waitcnt lgkmcnt(3)
    v_mfma_f32_16x16x32_bf16 v[164:167], a[252:255], v[44:47], v[164:167]
    v_mfma_f32_16x16x32_bf16 v[180:183], a[224:227], v[44:47], v[180:183]
    ds_read_b128 a[252:255], v28 offset:4352
    v_mfma_f32_16x16x32_bf16 v[176:179], a[224:227], v[40:43], v[176:179]
    s_add_u32 s69, s36, 0x39000
    buffer_load_dwordx4 v[96:99], v31, s[4:7], s69 offen offset:1024 sc1
    v_mfma_f32_16x16x32_bf16 v[152:155], a[228:231], v[40:43], v[152:155]
    ds_read_b128 a[224:227], v28 offset:33024
    v_mfma_f32_16x16x32_bf16 v[156:159], a[228:231], v[44:47], v[156:159]
    v_mfma_f32_16x16x32_bf16 v[172:175], a[232:235], v[44:47], v[172:175]
    ds_read_b128 a[228:231], v29 offset:4352
    s_waitcnt vmcnt(11)
    v_cmp_u_f32 vcc, v48, v52
    v_mfma_f32_16x16x32_bf16 v[168:171], a[232:235], v[40:43], v[168:171]
    buffer_load_dwordx4 v[100:103], v31, s[4:7], s69 offen offset:1280 sc1
    v_mfma_f32_16x16x32_bf16 v[184:187], a[236:239], v[40:43], v[184:187]
    ds_read_b128 a[232:235], v28 offset:6144
    s_waitcnt lgkmcnt(3)
    s_cbranch_vccnz Lfc_65
Lc_66:
    v_mfma_f32_16x16x32_bf16 v[188:191], a[236:239], v[44:47], v[188:191]
    v_mfma_f32_16x16x32_bf16 v[148:151], a[240:243], v[52:55], v[148:151]
    ds_read_b128 a[236:239], v28 offset:34816
    v_mfma_f32_16x16x32_bf16 v[144:147], a[240:243], v[48:51], v[144:147]
    s_add_u32 s69, s36, 0x3b000
    buffer_load_dwordx4 v[104:107], v31, s[4:7], s69 offen sc1
    v_mfma_f32_16x16x32_bf16 v[160:163], a[244:247], v[48:51], v[160:163]
    ds_read_b128 a[240:243], v29 offset:6144
    v_mfma_f32_16x16x32_bf16 v[164:167], a[244:247], v[52:55], v[164:167]
    v_mfma_f32_16x16x32_bf16 v[180:183], a[248:251], v[52:55], v[180:183]
    ds_read_b128 a[244:247], v28 offset:6400
    buffer_load_dwordx4 v[108:111], v31, s[4:7], s69 offen offset:256 sc1
    v_mfma_f32_16x16x32_bf16 v[176:179], a[248:251], v[48:51], v[176:179]
    v_mfma_f32_16x16x32_bf16 v[152:155], a[252:255], v[48:51], v[152:155]
    ds_read_b128 a[248:251], v28 offset:35072
    s_waitcnt lgkmcnt(3)
    v_mfma_f32_16x16x32_bf16 v[156:159], a[252:255], v[52:55], v[156:159]
    v_mfma_f32_16x16x32_bf16 v[172:175], a[224:227], v[52:55], v[172:175]
    ds_read_b128 a[252:255], v29 offset:6400
    s_waitcnt vmcnt(12)
    v_cmp_u_f32 vcc, v56, v60
    v_mfma_f32_16x16x32_bf16 v[168:171], a[224:227], v[48:51], v[168:171]
    s_add_u32 s69, s36, 0x47000
    buffer_load_dwordx4 v[112:115], v31, s[4:7], s69 offen offset:1024 sc1
    v_mfma_f32_16x16x32_bf16 v[184:187], a[228:231], v[48:51], v[184:187]
    ds_read_b128 a[224:227], v28 offset:8192
    s_cbranch_vccnz Lfc_68
Lc_69:
    v_mfma_f32_16x16x32_bf16 v[188:191], a[228:231], v[52:55], v[188:191]
    v_mfma_f32_16x16x32_bf16 v[148:151], a[232:235], v[60:63], v[148:151]
    ds_read_b128 a[228:231], v28 offset:36864
    v_mfma_f32_16x16x32_bf16 v[144:147], a[232:235], v[56:59], v[144:147]
    v_mfma_f32_16x16x32_bf16 v[160:163], a[236:239], v[56:59], v[160:163]
    ds_read_b128 a[232:235], v29 offset:8192
    s_waitcnt lgkmcnt(3)
    v_mfma_f32_16x16x32_bf16 v[164:167], a[236:239], v[60:63], v[164:167]
    buffer_load_dwordx4 v[116:119], v31, s[4:7], s69 offen offset:1280 sc1
    v_mfma_f32_16x16x32_bf16 v[180:183], a[240:243], v[60:63], v[180:183]
    ds_read_b128 a[236:239], v28 offset:8448
    v_mfma_f32_16x16x32_bf16 v[176:179], a[240:243], v[56:59], v[176:179]
    v_mfma_f32_16x16x32_bf16 v[152:155], a[244:247], v[56:59], v[152:155]
    ds_read_b128 a[240:243], v28 offset:37120
    s_add_u32 m0, s55, 0x1a000
    s_add_u32 s71, s39, 0x15000
    buffer_load_dwordx4 v1, s[4:7], s71 offen lds
    v_mfma_f32_16x16x32_bf16 v[156:159], a[244:247], v[60:63], v[156:159]
    v_mfma_f32_16x16x32_bf16 v[172:175], a[248:251], v[60:63], v[172:175]
    ds_read_b128 a[244:247], v29 offset:8448
    s_waitcnt vmcnt(13)
    v_cmp_u_f32 vcc, v64, v68
    v_mfma_f32_16x16x32_bf16 v[168:171], a[248:251], v[56:59], v[168:171]
    v_mfma_f32_16x16x32_bf16 v[184:187], a[252:255], v[56:59], v[184:187]
    ds_read_b128 a[248:251], v28 offset:10240
    s_waitcnt lgkmcnt(3)
    s_cbranch_vccnz Lfc_71
Lc_72:
    buffer_load_dwordx4 v1, s[4:7], s71 offen offset:1024 lds
    v_mfma_f32_16x16x32_bf16 v[188:191], a[252:255], v[60:63], v[188:191]
    v_mfma_f32_16x16x32_bf16 v[148:151], a[224:227], v[68:71], v[148:151]
    ds_read_b128 a[252:255], v28 offset:38912
    v_mfma_f32_16x16x32_bf16 v[144:147], a[224:227], v[64:67], v[144:147]
    v_mfma_f32_16x16x32_bf16 v[160:163], a[228:231], v[64:67], v[160:163]
    ds_read_b128 a[224:227], v29 offset:10240
    buffer_load_dwordx4 v1, s[4:7], s71 offen offset:2048 lds
    v_mfma_f32_16x16x32_bf16 v[164:167], a[228:231], v[68:71], v[164:167]
    v_mfma_f32_16x16x32_bf16 v[180:183], a[232:235], v[68:71], v[180:183]
    ds_read_b128 a[228:231], v28 offset:10496
    v_mfma_f32_16x16x32_bf16 v[176:179], a[232:235], v[64:67], v[176:179]
    v_mfma_f32_16x16x32_bf16 v[152:155], a[236:239], v[64:67], v[152:155]
    ds_read_b128 a[232:235], v28 offset:39168
    s_waitcnt lgkmcnt(3)
    buffer_load_dwordx4 v1, s[4:7], s71 offen offset:3072 lds
    s_add_u32 m0, s55, 0x1b000
    v_mfma_f32_16x16x32_bf16 v[156:159], a[236:239], v[68:71], v[156:159]
    v_mfma_f32_16x16x32_bf16 v[172:175], a[240:243], v[68:71], v[172:175]
    ds_read_b128 a[236:239], v29 offset:10496
    s_waitcnt vmcnt(14)
    v_cmp_u_f32 vcc, v72, v76
    v_mfma_f32_16x16x32_bf16 v[168:171], a[240:243], v[64:67], v[168:171]
    v_mfma_f32_16x16x32_bf16 v[184:187], a[244:247], v[64:67], v[184:187]
    ds_read_b128 a[240:243], v28 offset:12288
    s_cbranch_vccnz Lfc_74
Lc_75:
    buffer_load_dwordx4 v0, s[4:7], s71 offen lds
    v_mfma_f32_16x16x32_bf16 v[188:191], a[244:247], v[68:71], v[188:191]
    v_mfma_f32_16x16x32_bf16 v[148:151], a[248:251], v[76:79], v[148:151]
    ds_read_b128 a[244:247], v28 offset:40960
    v_mfma_f32_16x16x32_bf16 v[144:147], a[248:251], v[72:75], v[144:147]
    v_mfma_f32_16x16x32_bf16 v[160:163], a[252:255], v[72:75], v[160:163]
    ds_read_b128 a[248:251], v29 offset:12288
    s_waitcnt lgkmcnt(3)
    v_mfma_f32_16x16x32_bf16 v[164:167], a[252:255], v[76:79], v[164:167]
    v_mfma_f32_16x16x32_bf16 v[180:183], a[224:227], v[76:79], v[180:183]
    ds_read_b128 a[252:255], v28 offset:12544
    buffer_load_dwordx4 v0, s[4:7], s71 offen offset:1024 lds
    v_mfma_f32_16x16x32_bf16 v[176:179], a[224:227], v[72:75], v[176:179]
    v_mfma_f32_16x16x32_bf16 v[152:155], a[228:231], v[72:75], v[152:155]
    ds_read_b128 a[224:227], v28 offset:41216
    v_mfma_f32_16x16x32_bf16 v[156:159], a[228:231], v[76:79], v[156:159]
    v_mfma_f32_16x16x32_bf16 v[172:175], a[232:235], v[76:79], v[172:175]
    ds_read_b128 a[228:231], v29 offset:12544
    s_waitcnt vmcnt(14)
    v_cmp_u_f32 vcc, v80, v84
    buffer_load_dwordx4 v0, s[4:7], s71 offen offset:2048 lds
    v_mfma_f32_16x16x32_bf16 v[168:171], a[232:235], v[72:75], v[168:171]
    v_mfma_f32_16x16x32_bf16 v[184:187], a[236:239], v[72:75], v[184:187]
    ds_read_b128 a[232:235], v28 offset:14336
    s_waitcnt lgkmcnt(3)
    s_cbranch_vccnz Lfc_77
Lc_78:
    v_mfma_f32_16x16x32_bf16 v[188:191], a[236:239], v[76:79], v[188:191]
    v_mfma_f32_16x16x32_bf16 v[148:151], a[240:243], v[84:87], v[148:151]
    ds_read_b128 a[236:239], v28 offset:43008
    v_mfma_f32_16x16x32_bf16 v[144:147], a[240:243], v[80:83], v[144:147]
    s_lshl_b32 s94, s24, 11
    s_add_u32 m0, s94, 86016
    s_lshl_b32 s95, s25, 13
    s_add_u32 s94, s94, s95
    s_add_u32 s94, s94, 0x1d0000
    buffer_load_dwordx4 v1, s[4:7], s94 offen lds
    v_mfma_f32_16x16x32_bf16 v[160:163], a[244:247], v[80:83], v[160:163]
    ds_read_b128 a[240:243], v29 offset:14336
    v_mfma_f32_16x16x32_bf16 v[164:167], a[244:247], v[84:87], v[164:167]
    v_mfma_f32_16x16x32_bf16 v[180:183], a[248:251], v[84:87], v[180:183]
    ds_read_b128 a[244:247], v28 offset:14592
    buffer_load_dwordx4 v1, s[4:7], s94 offen offset:1024 lds
    v_mfma_f32_16x16x32_bf16 v[176:179], a[248:251], v[80:83], v[176:179]
    v_mfma_f32_16x16x32_bf16 v[152:155], a[252:255], v[80:83], v[152:155]
    ds_read_b128 a[248:251], v28 offset:43264
    s_waitcnt lgkmcnt(3)
    v_mfma_f32_16x16x32_bf16 v[156:159], a[252:255], v[84:87], v[156:159]
    v_mfma_f32_16x16x32_bf16 v[172:175], a[224:227], v[84:87], v[172:175]
    ds_read_b128 a[252:255], v29 offset:14592
    s_waitcnt vmcnt(15)
    v_cmp_u_f32 vcc, v88, v92
    v_mfma_f32_16x16x32_bf16 v[168:171], a[224:227], v[80:83], v[168:171]
    s_add_u32 s69, s36, 0x49000
    buffer_load_dwordx4 v[120:123], v31, s[4:7], s69 offen sc1
    v_mfma_f32_16x16x32_bf16 v[184:187], a[228:231], v[80:83], v[184:187]
    ds_read_b128 a[224:227], v28 offset:16384
    s_cbranch_vccnz Lfc_80
Lc_81:
    v_mfma_f32_16x16x32_bf16 v[188:191], a[228:231], v[84:87], v[188:191]
    v_mfma_f32_16x16x32_bf16 v[148:151], a[232:235], v[92:95], v[148:151]
    ds_read_b128 a[228:231], v28 offset:45056
    buffer_load_dwordx4 v[124:127], v31, s[4:7], s69 offen offset:256 sc1
    v_mfma_f32_16x16x32_bf16 v[144:147], a[232:235], v[88:91], v[144:147]
    v_mfma_f32_16x16x32_bf16 v[160:163], a[236:239], v[88:91], v[160:163]
    ds_read_b128 a[232:235], v29 offset:16384
    s_waitcnt lgkmcnt(3)
    v_mfma_f32_16x16x32_bf16 v[164:167], a[236:239], v[92:95], v[164:167]
    v_mfma_f32_16x16x32_bf16 v[180:183], a[240:243], v[92:95], v[180:183]
    ds_read_b128 a[236:239], v28 offset:16640
    v_mfma_f32_16x16x32_bf16 v[176:179], a[240:243], v[88:91], v[176:179]
    s_add_u32 s69, s36, 0x55000
    buffer_load_dwordx4 v[128:131], v31, s[4:7], s69 offen offset:1024 sc1
    v_mfma_f32_16x16x32_bf16 v[152:155], a[244:247], v[88:91], v[152:155]
    ds_read_b128 a[240:243], v28 offset:45312
    v_mfma_f32_16x16x32_bf16 v[156:159], a[244:247], v[92:95], v[156:159]
    v_mfma_f32_16x16x32_bf16 v[172:175], a[248:251], v[92:95], v[172:175]
    ds_read_b128 a[244:247], v29 offset:16640
    s_waitcnt vmcnt(16)
    v_cmp_u_f32 vcc, v96, v100
    v_mfma_f32_16x16x32_bf16 v[168:171], a[248:251], v[88:91], v[168:171]
    buffer_load_dword v208, v2, s[4:7], s93 offen sc1
    v_mfma_f32_16x16x32_bf16 v[184:187], a[252:255], v[88:91], v[184:187]
    ds_read_b128 a[248:251], v28 offset:18432
    s_waitcnt lgkmcnt(3)
    s_cbranch_vccnz Lfc_83
Lc_84:
    v_mfma_f32_16x16x32_bf16 v[188:191], a[252:255], v[92:95], v[188:191]
    buffer_load_dwordx4 v[132:135], v31, s[4:7], s69 offen offset:1280 sc1
    v_mfma_f32_16x16x32_bf16 v[148:151], a[224:227], v[100:103], v[148:151]
    ds_read_b128 a[252:255], v28 offset:47104
    v_mfma_f32_16x16x32_bf16 v[144:147], a[224:227], v[96:99], v[144:147]
    v_mfma_f32_16x16x32_bf16 v[160:163], a[228:231], v[96:99], v[160:163]
    ds_read_b128 a[224:227], v29 offset:18432
    buffer_load_dword v209, v2, s[4:7], s93 offen offset:256 sc1
    v_mfma_f32_16x16x32_bf16 v[164:167], a[228:231], v[100:103], v[164:167]
    v_mfma_f32_16x16x32_bf16 v[180:183], a[232:235], v[100:103], v[180:183]
    ds_read_b128 a[228:231], v28 offset:18688
    buffer_load_dword v210, v2, s[4:7], s93 offen offset:512 sc1
    v_mfma_f32_16x16x32_bf16 v[176:179], a[232:235], v[96:99], v[176:179]
    v_mfma_f32_16x16x32_bf16 v[152:155], a[236:239], v[96:99], v[152:155]
    ds_read_b128 a[232:235], v28 offset:47360
    s_waitcnt lgkmcnt(3)
    v_mfma_f32_16x16x32_bf16 v[156:159], a[236:239], v[100:103], v[156:159]
    buffer_load_dword v211, v2, s[4:7], s93 offen offset:768 sc1
    v_mfma_f32_16x16x32_bf16 v[172:175], a[240:243], v[100:103], v[172:175]
    ds_read_b128 a[236:239], v29 offset:18688
    s_waitcnt vmcnt(19)
    v_cmp_u_f32 vcc, v104, v108
    v_mfma_f32_16x16x32_bf16 v[168:171], a[240:243], v[96:99], v[168:171]
    buffer_load_dword v212, v2, s[4:7], s93 offen offset:1024 sc1
    v_mfma_f32_16x16x32_bf16 v[184:187], a[244:247], v[96:99], v[184:187]
    ds_read_b128 a[240:243], v28 offset:20480
    s_cbranch_vccnz Lfc_86
Lc_87:
    v_mfma_f32_16x16x32_bf16 v[188:191], a[244:247], v[100:103], v[188:191]
    buffer_load_dword v213, v2, s[4:7], s93 offen offset:1280 sc1
    v_mfma_f32_16x16x32_bf16 v[148:151], a[248:251], v[108:111], v[148:151]
    ds_read_b128 a[244:247], v28 offset:49152
    v_mfma_f32_16x16x32_bf16 v[144:147], a[248:251], v[104:107], v[144:147]
    s_add_u32 s69, s36, 0x57000
    buffer_load_dwordx4 v[136:139], v31, s[4:7], s69 offen sc1
    v_mfma_f32_16x16x32_bf16 v[160:163], a[252:255], v[104:107], v[160:163]
    ds_read_b128 a[248:251], v29 offset:20480
    s_waitcnt lgkmcnt(3)
    v_mfma_f32_16x16x32_bf16 v[164:167], a[252:255], v[108:111], v[164:167]
    v_mfma_f32_16x16x32_bf16 v[180:183], a[224:227], v[108:111], v[180:183]
    ds_read_b128 a[252:255], v28 offset:20736
    buffer_load_dword v214, v2, s[4:7], s93 offen offset:1536 sc1
    v_mfma_f32_16x16x32_bf16 v[176:179], a[224:227], v[104:107], v[176:179]
    v_mfma_f32_16x16x32_bf16 v[152:155], a[228:231], v[104:107], v[152:155]
    ds_read_b128 a[224:227], v28 offset:49408
    buffer_load_dword v215, v2, s[4:7], s93 offen offset:1792 sc1
    v_mfma_f32_16x16x32_bf16 v[156:159], a[228:231], v[108:111], v[156:159]
    v_mfma_f32_16x16x32_bf16 v[172:175], a[232:235], v[108:111], v[172:175]
    ds_read_b128 a[228:231], v29 offset:20736
    s_waitcnt vmcnt(22)
    v_cmp_u_f32 vcc, v112, v116
    v_mfma_f32_16x16x32_bf16 v[168:171], a[232:235], v[104:107], v[168:171]
    buffer_load_dword v216, v2, s[4:7], s93 offen offset:2048 sc1
    v_mfma_f32_16x16x32_bf16 v[184:187], a[236:239], v[104:107], v[184:187]
    ds_read_b128 a[232:235], v28 offset:22528
    s_waitcnt lgkmcnt(3)
    s_cbranch_vccnz Lfc_89
Lc_90:
    v_mfma_f32_16x16x32_bf16 v[188:191], a[236:239], v[108:111], v[188:191]
    buffer_load_dwordx4 v[140:143], v31, s[4:7], s69 offen offset:256 sc1
    v_mfma_f32_16x16x32_bf16 v[148:151], a[240:243], v[116:119], v[148:151]
    ds_read_b128 a[236:239], v28 offset:51200
    v_mfma_f32_16x16x32_bf16 v[144:147], a[240:243], v[112:115], v[144:147]
    v_mfma_f32_16x16x32_bf16 v[160:163], a[244:247], v[112:115], v[160:163]
    ds_read_b128 a[240:243], v29 offset:22528
    buffer_load_dword v217, v2, s[4:7], s93 offen offset:2304 sc1
    v_mfma_f32_16x16x32_bf16 v[164:167], a[244:247], v[116:119], v[164:167]
    v_mfma_f32_16x16x32_bf16 v[180:183], a[248:251], v[116:119], v[180:183]
    ds_read_b128 a[244:247], v28 offset:22784
    buffer_load_dword v218, v2, s[4:7], s93 offen offset:2560 sc1
    v_mfma_f32_16x16x32_bf16 v[176:179], a[248:251], v[112:115], v[176:179]
    v_mfma_f32_16x16x32_bf16 v[152:155], a[252:255], v[112:115], v[152:155]
    ds_read_b128 a[248:251], v28 offset:51456
    s_waitcnt lgkmcnt(3)
    v_mfma_f32_16x16x32_bf16 v[156:159], a[252:255], v[116:119], v[156:159]
    buffer_load_dword v219, v2, s[4:7], s93 offen offset:2816 sc1
    v_mfma_f32_16x16x32_bf16 v[172:175], a[224:227], v[116:119], v[172:175]
    ds_read_b128 a[252:255], v29 offset:22784
    s_waitcnt vmcnt(16)
    v_cmp_u_f32 vcc, v120, v124
    v_mfma_f32_16x16x32_bf16 v[168:171], a[224:227], v[112:115], v[168:171]
    buffer_load_dword v220, v2, s[4:7], s93 offen offset:3072 sc1
    v_mfma_f32_16x16x32_bf16 v[184:187], a[228:231], v[112:115], v[184:187]
    ds_read_b128 a[224:227], v28 offset:24576
    s_cbranch_vccnz Lfc_92
Lc_93:
    v_mfma_f32_16x16x32_bf16 v[188:191], a[228:231], v[116:119], v[188:191]
    s_add_u32 m0, s55, 0x21000
    s_add_u32 s72, s39, 0x1c000
    buffer_load_dwordx4 v1, s[4:7], s72 offen lds
    v_mfma_f32_16x16x32_bf16 v[148:151], a[232:235], v[124:127], v[148:151]
    ds_read_b128 a[228:231], v28 offset:53248
    buffer_load_dword v221, v2, s[4:7], s93 offen offset:3328 sc1
    v_mfma_f32_16x16x32_bf16 v[144:147], a[232:235], v[120:123], v[144:147]
    buffer_load_dwordx4 a[0:3], v4, s[4:7], s48 offen
    v_mfma_f32_16x16x32_bf16 v[160:163], a[236:239], v[120:123], v[160:163]
    ds_read_b128 a[232:235], v29 offset:24576
    s_waitcnt lgkmcnt(3)
    v_mfma_f32_16x16x32_bf16 v[164:167], a[236:239], v[124:127], v[164:167]
    v_mfma_f32_16x16x32_bf16 v[180:183], a[240:243], v[124:127], v[180:183]
    ds_read_b128 a[236:239], v28 offset:24832
    buffer_load_dwordx4 v1, s[4:7], s72 offen offset:1024 lds
    v_mfma_f32_16x16x32_bf16 v[176:179], a[240:243], v[120:123], v[176:179]
    v_mfma_f32_16x16x32_bf16 v[152:155], a[244:247], v[120:123], v[152:155]
    ds_read_b128 a[240:243], v28 offset:53504
    buffer_load_dwordx4 a[28:31], v4, s[4:7], s48 offen offset:256
    v_mfma_f32_16x16x32_bf16 v[156:159], a[244:247], v[124:127], v[156:159]
    v_mfma_f32_16x16x32_bf16 v[172:175], a[248:251], v[124:127], v[172:175]
    ds_read_b128 a[244:247], v29 offset:24832
    s_waitcnt vmcnt(19)
    v_cmp_u_f32 vcc, v128, v132
    v_mfma_f32_16x16x32_bf16 v[168:171], a[248:251], v[120:123], v[168:171]
    v_mfma_f32_16x16x32_bf16 v[184:187], a[252:255], v[120:123], v[184:187]
    ds_read_b128 a[248:251], v28 offset:26624
    s_waitcnt lgkmcnt(3)
    s_cbranch_vccnz Lfc_95
Lc_96:
    buffer_load_dwordx4 v1, s[4:7], s72 offen offset:2048 lds
    v_mfma_f32_16x16x32_bf16 v[188:191], a[252:255], v[124:127], v[188:191]
    v_mfma_f32_16x16x32_bf16 v[148:151], a[224:227], v[132:135], v[148:151]
    ds_read_b128 a[252:255], v28 offset:55296
    buffer_load_dwordx4 a[112:115], v4, s[4:7], s58 offen
    v_mfma_f32_16x16x32_bf16 v[144:147], a[224:227], v[128:131], v[144:147]
    v_mfma_f32_16x16x32_bf16 v[160:163], a[228:231], v[128:131], v[160:163]
    ds_read_b128 a[224:227], v29 offset:26624
    buffer_load_dwordx4 v1, s[4:7], s72 offen offset:3072 lds
    s_add_u32 m0, s55, 0x22000
    v_mfma_f32_16x16x32_bf16 v[164:167], a[228:231], v[132:135], v[164:167]
    v_mfma_f32_16x16x32_bf16 v[180:183], a[232:235], v[132:135], v[180:183]
    ds_read_b128 a[228:231], v28 offset:26880
    v_mfma_f32_16x16x32_bf16 v[176:179], a[232:235], v[128:131], v[176:179]
    v_mfma_f32_16x16x32_bf16 v[152:155], a[236:239], v[128:131], v[152:155]
    ds_read_b128 a[232:235], v28 offset:55552
    s_waitcnt lgkmcnt(3)
    buffer_load_dwordx4 v0, s[4:7], s72 offen lds
    v_mfma_f32_16x16x32_bf16 v[156:159], a[236:239], v[132:135], v[156:159]
    buffer_load_dwordx4 a[140:143], v4, s[4:7], s58 offen offset:256
    v_mfma_f32_16x16x32_bf16 v[172:175], a[240:243], v[132:135], v[172:175]
    ds_read_b128 a[236:239], v29 offset:26880
    s_waitcnt vmcnt(14)
    v_cmp_u_f32 vcc, v136, v140
    v_mfma_f32_16x16x32_bf16 v[168:171], a[240:243], v[128:131], v[168:171]
    v_mfma_f32_16x16x32_bf16 v[184:187], a[244:247], v[128:131], v[184:187]
    s_barrier
    ds_read_b128 a[240:243], v30 offset:0
    v_mfma_f32_16x16x32_bf16 v[188:191], a[244:247], v[132:135], v[188:191]
    s_cbranch_vccnz Lfc_98
Lc_99:
    buffer_load_dwordx4 v0, s[4:7], s72 offen offset:1024 lds
    v_mfma_f32_16x16x32_bf16 v[148:151], a[248:251], v[140:143], v[148:151]
    ds_read_b128 a[244:247], v30 offset:256
    v_mfma_f32_16x16x32_bf16 v[144:147], a[248:251], v[136:139], v[144:147]
    s_add_u32 s68, s48, 0x3000
    buffer_load_dwordx4 a[56:59], v4, s[4:7], s68 offen offset:2048
    v_mfma_f32_16x16x32_bf16 v[160:163], a[252:255], v[136:139], v[160:163]
    ds_read_b128 a[248:251], v30 offset:2048
    s_waitcnt lgkmcnt(3)
    buffer_load_dwordx4 v0, s[4:7], s72 offen offset:2048 lds
    v_add_f32 v208, v208, v209
    v_mfma_f32_16x16x32_bf16 v[164:167], a[252:255], v[140:143], v[164:167]
    v_add_f32 v210, v210, v211
    v_add_f32 v212, v212, v213
    v_add_f32 v214, v214, v215
    v_mfma_f32_16x16x32_bf16 v[180:183], a[224:227], v[140:143], v[180:183]
    ds_read_b128 a[252:255], v30 offset:2304
    s_waitcnt vmcnt(16)
    v_add_f32 v216, v216, v217
    s_waitcnt vmcnt(14)
    v_add_f32 v218, v218, v219
    v_mfma_f32_16x16x32_bf16 v[176:179], a[224:227], v[136:139], v[176:179]
    s_waitcnt vmcnt(11)
    v_add_f32 v220, v220, v221
    v_add_f32 v208, v208, v210
    v_add_f32 v212, v212, v214
    v_mfma_f32_16x16x32_bf16 v[152:155], a[228:231], v[136:139], v[152:155]
    ds_read_b128 a[224:227], v30 offset:4096
    buffer_load_dwordx4 a[84:87], v4, s[4:7], s68 offen offset:2304
    v_mfma_f32_16x16x32_bf16 v[156:159], a[228:231], v[140:143], v[156:159]
    v_add_f32 v216, v216, v218
    v_add_f32 v208, v208, v212
    v_add_f32 v216, v216, v220
    v_mfma_f32_16x16x32_bf16 v[172:175], a[232:235], v[140:143], v[172:175]
    ds_read_b128 a[228:231], v30 offset:4352
    v_add_f32 v208, v208, v216
    v_mfma_f32_16x16x32_bf16 v[168:171], a[232:235], v[136:139], v[168:171]
    v_mfma_f32_16x16x32_bf16 v[184:187], a[236:239], v[136:139], v[184:187]
    ds_read_b128 a[232:235], v29 offset:28672
    s_waitcnt lgkmcnt(3)
    v_mfma_f32_16x16x32_bf16 v[188:191], a[236:239], v[140:143], v[188:191]
    v_cmp_u_f32 vcc, v208, v208
    s_cbranch_vccnz Lnn_101
Lc_102:
    v_mfma_f32_16x16x32_bf16 v[192:195], a[240:243], v[32:35], 0
    s_add_u32 s68, s58, 0x3000
    buffer_load_dwordx4 a[168:171], v4, s[4:7], s68 offen offset:2048
    v_mfma_f32_16x16x32_bf16 v[196:199], a[240:243], v[36:39], 0
    v_mov_b32 v209, v208
    s_nop 0
    s_barrier
    v_mfma_f32_16x16x32_bf16 v[204:207], a[244:247], v[36:39], 0
    ds_read_b128 a[236:239], v29 offset:28928
    v_permlane32_swap_b32 v208, v209
    v_mfma_f32_16x16x32_bf16 v[200:203], a[244:247], v[32:35], 0
    v_mul_f32 v208, 0xbb124925, v208
    v_mov_b32 v210, 0x3727c5ac
    v_fmac_f32 v210, 0x3b124925, v209
    v_mfma_f32_16x16x32_bf16 v[192:195], a[248:251], v[40:43], v[192:195]
    v_fma_f32 v25, -v208, v208, v210
    v_max_f32 v25, 0x3727c5ac, v25
    v_cvt_pk_bf16_f32 v20, v208, v208
    v_mfma_f32_16x16x32_bf16 v[196:199], a[248:251], v[44:47], v[196:199]
    v_rsq_f32 v24, v25
    v_and_b32 v212, 0xffff0000, v20
    v_mfma_f32_16x16x32_bf16 v[204:207], a[252:255], v[44:47], v[204:207]
    ds_read_b128 a[240:243], v29 offset:30720
    s_waitcnt lgkmcnt(2)
    v_sub_f32 v212, v208, v212
    v_mfma_f32_16x16x32_bf16 v[200:203], a[252:255], v[40:43], v[200:203]
    buffer_load_dwordx4 a[196:199], v4, s[4:7], s68 offen offset:2304
    v_cvt_pk_bf16_f32 v21, v212, v212
    v_mfma_f32_16x16x32_bf16 v[192:195], a[224:227], v[48:51], v[192:195]
    v_mov_b32 v22, v20
    v_mov_b32 v23, v21
    v_mul_f32 v26, 0xbfb8aa3b, v24
    v_mfma_f32_16x16x32_bf16 v[196:199], a[224:227], v[52:55], v[196:199]
    v_permlane16_swap_b32 v20, v22
    v_mfma_f32_16x16x32_bf16 v[204:207], a[228:231], v[52:55], v[204:207]
    ds_read_b128 a[244:247], v30 offset:6144
    v_permlane16_swap_b32 v21, v23
    v_mfma_f32_16x16x32_bf16 v[200:203], a[228:231], v[48:51], v[200:203]
    v_mov_b32 v27, v26
    v_mov_b32 v24, v25
    v_mfma_f32_16x16x16_bf16 v[144:147], a[232:233], v[20:21], v[144:147]
    ds_read_b128 a[248:251], v30 offset:6400
    buffer_load_dwordx4 a[4:7], v4, s[4:7], s48 offen offset:1024
    v_mfma_f32_16x16x16_bf16 v[148:151], a[232:233], v[22:23], v[148:151]
    v_permlane16_swap_b32 v26, v27
    v_mfma_f32_16x16x16_bf16 v[152:155], a[234:235], v[20:21], v[152:155]
    ds_read_b128 a[252:255], v30 offset:8192
    s_waitcnt lgkmcnt(3)
    v_mfma_f32_16x16x16_bf16 v[156:159], a[234:235], v[22:23], v[156:159]
    v_permlane16_swap_b32 v25, v24
    v_mfma_f32_16x16x16_bf16 v[160:163], a[236:237], v[20:21], v[160:163]
    ds_read_b128 a[224:227], v30 offset:8448
    v_mfma_f32_16x16x16_bf16 v[164:167], a[236:237], v[22:23], v[164:167]
    v_mfma_f32_16x16x16_bf16 v[168:171], a[238:239], v[20:21], v[168:171]
    ds_read_b128 a[228:231], v30 offset:10240
    buffer_load_dwordx4 a[32:35], v4, s[4:7], s48 offen offset:1280
    v_mfma_f32_16x16x16_bf16 v[172:175], a[238:239], v[22:23], v[172:175]
    v_mfma_f32_16x16x16_bf16 v[176:179], a[240:241], v[20:21], v[176:179]
    ds_read_b128 a[232:235], v30 offset:10496
    v_mfma_f32_16x16x16_bf16 v[180:183], a[240:241], v[22:23], v[180:183]
    v_pk_mul_f32 v[224:225], v[144:145], v[26:27] op_sel:[0,0] op_sel_hi:[1,0]
    v_pk_mul_f32 v[226:227], v[146:147], v[26:27] op_sel:[0,0] op_sel_hi:[1,0]
    v_pk_mul_f32 v[228:229], v[148:149], v[26:27] op_sel:[0,1] op_sel_hi:[1,1]
    v_pk_mul_f32 v[230:231], v[150:151], v[26:27] op_sel:[0,1] op_sel_hi:[1,1]
    v_pk_mul_f32 v[144:145], v[144:145], v[152:153]
    v_pk_mul_f32 v[146:147], v[146:147], v[154:155]
    v_pk_mul_f32 v[148:149], v[148:149], v[156:157]
    v_pk_mul_f32 v[150:151], v[150:151], v[158:159]
    v_mfma_f32_16x16x16_bf16 v[184:187], a[242:243], v[20:21], v[184:187]
    ds_read_b128 a[236:239], v30 offset:12288
    s_waitcnt lgkmcnt(3)
    v_mfma_f32_16x16x16_bf16 v[188:191], a[242:243], v[22:23], v[188:191]
    v_exp_f32 v224, v224
    v_mfma_f32_16x16x32_bf16 v[192:195], a[244:247], v[56:59], v[192:195]
    ds_read_b128 a[240:243], v30 offset:12544
    buffer_load_dwordx4 a[116:119], v4, s[4:7], s58 offen offset:1024
    v_mfma_f32_16x16x32_bf16 v[196:199], a[244:247], v[60:63], v[196:199]
    v_exp_f32 v225, v225
    v_mfma_f32_16x16x32_bf16 v[204:207], a[248:251], v[60:63], v[204:207]
    ds_read_b128 a[244:247], v30 offset:14336
    v_exp_f32 v226, v226
    v_mfma_f32_16x16x32_bf16 v[200:203], a[248:251], v[56:59], v[200:203]
    v_exp_f32 v227, v227
    v_mfma_f32_16x16x32_bf16 v[192:195], a[252:255], v[64:67], v[192:195]
    ds_read_b128 a[248:251], v30 offset:14592
    v_exp_f32 v228, v228
    v_mfma_f32_16x16x32_bf16 v[196:199], a[252:255], v[68:71], v[196:199]
    v_exp_f32 v229, v229
    v_mfma_f32_16x16x32_bf16 v[204:207], a[224:227], v[68:71], v[204:207]
    ds_read_b128 a[252:255], v30 offset:16384
    s_waitcnt lgkmcnt(3)
    v_mfma_f32_16x16x32_bf16 v[200:203], a[224:227], v[64:67], v[200:203]
    buffer_load_dwordx4 a[144:147], v4, s[4:7], s58 offen offset:1280
    v_mfma_f32_16x16x32_bf16 v[192:195], a[228:231], v[72:75], v[192:195]
    ds_read_b128 a[224:227], v30 offset:16640
    v_mfma_f32_16x16x32_bf16 v[196:199], a[228:231], v[76:79], v[196:199]
    v_exp_f32 v230, v230
    v_exp_f32 v231, v231
    v_pk_fma_f32 v[224:225], v[224:225], v[24:25], v[24:25] op_sel:[0,1,1] op_sel_hi:[1,1,1]
    v_pk_fma_f32 v[226:227], v[226:227], v[24:25], v[24:25] op_sel:[0,1,1] op_sel_hi:[1,1,1]
    v_pk_fma_f32 v[228:229], v[228:229], v[24:25], v[24:25] op_sel:[0,0,0] op_sel_hi:[1,0,0]
    v_pk_fma_f32 v[230:231], v[230:231], v[24:25], v[24:25] op_sel:[0,0,0] op_sel_hi:[1,0,0]
    v_mfma_f32_16x16x32_bf16 v[204:207], a[232:235], v[76:79], v[204:207]
    ds_read_b128 a[228:231], v30 offset:18432
    v_rcp_f32 v224, v224
    v_mfma_f32_16x16x32_bf16 v[200:203], a[232:235], v[72:75], v[200:203]
    v_rcp_f32 v225, v225
    v_mfma_f32_16x16x32_bf16 v[192:195], a[236:239], v[80:83], v[192:195]
    ds_read_b128 a[232:235], v30 offset:18688
    v_rcp_f32 v226, v226
    v_mfma_f32_16x16x32_bf16 v[196:199], a[236:239], v[84:87], v[196:199]
    s_add_u32 s68, s48, 0x3000
    buffer_load_dwordx4 a[60:63], v4, s[4:7], s68 offen offset:3072
    v_mfma_f32_16x16x32_bf16 v[204:207], a[240:243], v[84:87], v[204:207]
    ds_read_b128 a[236:239], v30 offset:20480
    s_waitcnt lgkmcnt(3)
    v_mfma_f32_16x16x32_bf16 v[200:203], a[240:243], v[80:83], v[200:203]
    v_rcp_f32 v227, v227
    v_mfma_f32_16x16x32_bf16 v[192:195], a[244:247], v[88:91], v[192:195]
    ds_read_b128 a[240:243], v30 offset:20736
    buffer_load_dwordx4 a[88:91], v4, s[4:7], s68 offen offset:3328
    v_mfma_f32_16x16x32_bf16 v[196:199], a[244:247], v[92:95], v[196:199]
    v_rcp_f32 v228, v228
    v_mfma_f32_16x16x32_bf16 v[204:207], a[248:251], v[92:95], v[204:207]
    ds_read_b128 a[244:247], v30 offset:22528
    v_rcp_f32 v229, v229
    v_mfma_f32_16x16x32_bf16 v[200:203], a[248:251], v[88:91], v[200:203]
    v_rcp_f32 v230, v230
    v_rcp_f32 v231, v231
    v_pk_mul_f32 v[144:145], v[144:145], v[224:225]
    v_pk_mul_f32 v[146:147], v[146:147], v[226:227]
    v_pk_mul_f32 v[148:149], v[148:149], v[228:229]
    v_pk_mul_f32 v[150:151], v[150:151], v[230:231]
    v_mfma_f32_16x16x32_bf16 v[192:195], a[252:255], v[96:99], v[192:195]
    ds_read_b128 a[248:251], v30 offset:22784
    s_add_u32 m0, s55, 0xe000
    s_add_u32 s73, s39, 0x23000
    buffer_load_dwordx4 v1, s[4:7], s73 offen lds
    v_mfma_f32_16x16x32_bf16 v[196:199], a[252:255], v[100:103], v[196:199]
    v_cvt_pk_bf16_f32 v232, v144, v145
    v_cvt_pk_bf16_f32 v234, v148, v149
    v_cvt_pk_bf16_f32 v233, v146, v147
    v_mfma_f32_16x16x32_bf16 v[204:207], a[224:227], v[100:103], v[204:207]
    ds_read_b128 a[252:255], v30 offset:24576
    s_waitcnt lgkmcnt(3)
    v_cvt_pk_bf16_f32 v235, v150, v151
    v_mfma_f32_16x16x32_bf16 v[200:203], a[224:227], v[96:99], v[200:203]
    v_permlane16_swap_b32 v232, v234
    v_mfma_f32_16x16x32_bf16 v[192:195], a[228:231], v[104:107], v[192:195]
    ds_read_b128 a[224:227], v30 offset:24832
    buffer_load_dwordx4 v1, s[4:7], s73 offen offset:1024 lds
    v_permlane16_swap_b32 v233, v235
    v_mfma_f32_16x16x32_bf16 v[196:199], a[228:231], v[108:111], v[196:199]
    s_add_u32 s68, s58, 0x3000
    buffer_load_dwordx4 a[172:175], v4, s[4:7], s68 offen offset:3072
    v_mfma_f32_16x16x32_bf16 v[204:207], a[232:235], v[108:111], v[204:207]
    ds_read_b128 a[228:231], v30 offset:26624
    buffer_store_dwordx4 v[232:235], v1, s[4:7], s57 offen
    v_mfma_f32_16x16x32_bf16 v[200:203], a[232:235], v[104:107], v[200:203]
    v_pk_mul_f32 v[224:225], v[160:161], v[26:27] op_sel:[0,0] op_sel_hi:[1,0]
    v_pk_mul_f32 v[226:227], v[162:163], v[26:27] op_sel:[0,0] op_sel_hi:[1,0]
    v_pk_mul_f32 v[228:229], v[164:165], v[26:27] op_sel:[0,1] op_sel_hi:[1,1]
    v_pk_mul_f32 v[230:231], v[166:167], v[26:27] op_sel:[0,1] op_sel_hi:[1,1]
    v_pk_mul_f32 v[160:161], v[160:161], v[168:169]
    v_pk_mul_f32 v[162:163], v[162:163], v[170:171]
    v_pk_mul_f32 v[164:165], v[164:165], v[172:173]
    v_pk_mul_f32 v[166:167], v[166:167], v[174:175]
    v_mfma_f32_16x16x32_bf16 v[192:195], a[236:239], v[112:115], v[192:195]
    ds_read_b128 a[232:235], v30 offset:26880
    v_exp_f32 v224, v224
    v_mfma_f32_16x16x32_bf16 v[196:199], a[236:239], v[116:119], v[196:199]
    v_exp_f32 v225, v225
    v_mfma_f32_16x16x32_bf16 v[204:207], a[240:243], v[116:119], v[204:207]
    ds_read_b128 a[236:239], v29 offset:30976
    s_waitcnt lgkmcnt(3)
    buffer_load_dwordx4 v1, s[4:7], s73 offen offset:2048 lds
    v_mfma_f32_16x16x32_bf16 v[200:203], a[240:243], v[112:115], v[200:203]
    buffer_load_dwordx4 a[200:203], v4, s[4:7], s68 offen offset:3328
    v_mfma_f32_16x16x32_bf16 v[192:195], a[244:247], v[120:123], v[192:195]
    v_exp_f32 v226, v226
    v_mfma_f32_16x16x32_bf16 v[196:199], a[244:247], v[124:127], v[196:199]
    v_exp_f32 v227, v227
    v_mfma_f32_16x16x32_bf16 v[204:207], a[248:251], v[124:127], v[204:207]
    s_waitcnt vmcnt(15)
    s_barrier
    ds_read_b128 a[240:243], v30 offset:28672
    v_mfma_f32_16x16x32_bf16 v[200:203], a[248:251], v[120:123], v[200:203]
    buffer_load_dwordx4 v1, s[4:7], s73 offen offset:3072 lds
    s_add_u32 m0, s55, 0xf000
    v_exp_f32 v228, v228
    v_mfma_f32_16x16x32_bf16 v[192:195], a[252:255], v[128:131], v[192:195]
    ds_read_b128 a[244:247], v30 offset:28928
    buffer_load_dwordx4 a[8:11], v4, s[4:7], s48 offen offset:2048
    v_mfma_f32_16x16x32_bf16 v[196:199], a[252:255], v[132:135], v[196:199]
    v_exp_f32 v229, v229
    v_mfma_f32_16x16x32_bf16 v[204:207], a[224:227], v[132:135], v[204:207]
    ds_read_b128 a[248:251], v30 offset:30720
    s_waitcnt lgkmcnt(3)
    buffer_load_dwordx4 v0, s[4:7], s73 offen lds
    v_mfma_f32_16x16x32_bf16 v[200:203], a[224:227], v[128:131], v[200:203]
    v_exp_f32 v230, v230
    v_exp_f32 v231, v231
    v_pk_fma_f32 v[224:225], v[224:225], v[24:25], v[24:25] op_sel:[0,1,1] op_sel_hi:[1,1,1]
    v_pk_fma_f32 v[226:227], v[226:227], v[24:25], v[24:25] op_sel:[0,1,1] op_sel_hi:[1,1,1]
    v_pk_fma_f32 v[228:229], v[228:229], v[24:25], v[24:25] op_sel:[0,0,0] op_sel_hi:[1,0,0]
    v_pk_fma_f32 v[230:231], v[230:231], v[24:25], v[24:25] op_sel:[0,0,0] op_sel_hi:[1,0,0]
    v_mfma_f32_16x16x32_bf16 v[192:195], a[228:231], v[136:139], v[192:195]
    ds_read_b128 a[252:255], v30 offset:30976
    v_rcp_f32 v224, v224
    v_mfma_f32_16x16x32_bf16 v[196:199], a[228:231], v[140:143], v[196:199]
    v_rcp_f32 v225, v225
    v_mfma_f32_16x16x32_bf16 v[204:207], a[232:235], v[140:143], v[204:207]
    ds_read_b128 a[224:227], v30 offset:32768
    buffer_load_dwordx4 v0, s[4:7], s73 offen offset:1024 lds
    buffer_load_dwordx4 a[36:39], v4, s[4:7], s48 offen offset:2304
    v_mfma_f32_16x16x32_bf16 v[200:203], a[232:235], v[136:139], v[200:203]
    v_rcp_f32 v226, v226
    v_mfma_f32_16x16x16_bf16 v[192:195], a[236:237], v[20:21], v[192:195]
    ds_read_b128 a[228:231], v30 offset:33024
    v_rcp_f32 v227, v227
    v_mfma_f32_16x16x16_bf16 v[196:199], a[236:237], v[22:23], v[196:199]
    v_rcp_f32 v228, v228
    v_mfma_f32_16x16x16_bf16 v[200:203], a[238:239], v[20:21], v[200:203]
    ds_read_b128 a[232:235], v30 offset:34816
    s_waitcnt lgkmcnt(3)
    buffer_load_dwordx4 v0, s[4:7], s73 offen offset:2048 lds
    v_mfma_f32_16x16x16_bf16 v[204:207], a[238:239], v[22:23], v[204:207]
    v_rcp_f32 v229, v229
    v_mfma_f32_16x16x32_bf16 v[208:211], a[240:243], v[32:35], 0
    ds_read_b128 a[236:239], v30 offset:35072
    buffer_load_dwordx4 a[120:123], v4, s[4:7], s58 offen offset:2048
    v_mfma_f32_16x16x32_bf16 v[212:215], a[240:243], v[36:39], 0
    v_rcp_f32 v230, v230
    v_rcp_f32 v231, v231
    v_pk_mul_f32 v[160:161], v[160:161], v[224:225]
    v_pk_mul_f32 v[162:163], v[162:163], v[226:227]
    v_pk_mul_f32 v[164:165], v[164:165], v[228:229]
    v_pk_mul_f32 v[166:167], v[166:167], v[230:231]
    v_mfma_f32_16x16x32_bf16 v[220:223], a[244:247], v[36:39], 0
    ds_read_b128 a[240:243], v30 offset:36864
    v_cvt_pk_bf16_f32 v236, v160, v161
    v_cvt_pk_bf16_f32 v238, v164, v165
    v_mfma_f32_16x16x32_bf16 v[216:219], a[244:247], v[32:35], 0
    v_cvt_pk_bf16_f32 v237, v162, v163
    v_cvt_pk_bf16_f32 v239, v166, v167
    s_add_u32 s84, s46, 0x0
    v_mfma_f32_16x16x32_bf16 v[208:211], a[248:251], v[40:43], v[208:211]
    ds_read_b128 a[244:247], v30 offset:37120
    v_permlane16_swap_b32 v236, v238
    v_mfma_f32_16x16x32_bf16 v[212:215], a[248:251], v[44:47], v[212:215]
    v_permlane16_swap_b32 v237, v239
    buffer_store_dwordx4 v[236:239], v1, s[4:7], s57 offen offset:1024
    v_mfma_f32_16x16x32_bf16 v[220:223], a[252:255], v[44:47], v[220:223]
    ds_read_b128 a[248:251], v30 offset:38912
    s_waitcnt lgkmcnt(3)
    s_add_u32 s85, s47, 0x0
    v_mfma_f32_16x16x32_bf16 v[216:219], a[252:255], v[40:43], v[216:219]
    buffer_load_dwordx4 a[148:151], v4, s[4:7], s58 offen offset:2304
    s_add_u32 s86, s46, 0x1000
    v_mfma_f32_16x16x32_bf16 v[208:211], a[224:227], v[48:51], v[208:211]
    ds_read_b128 a[252:255], v30 offset:39168
    s_add_u32 s87, s47, 0x1000
    s_add_u32 s88, s46, 0xe000
    v_mfma_f32_16x16x32_bf16 v[212:215], a[224:227], v[52:55], v[212:215]
    v_pk_mul_f32 v[224:225], v[176:177], v[26:27] op_sel:[0,0] op_sel_hi:[1,0]
    v_pk_mul_f32 v[226:227], v[178:179], v[26:27] op_sel:[0,0] op_sel_hi:[1,0]
    v_pk_mul_f32 v[228:229], v[180:181], v[26:27] op_sel:[0,1] op_sel_hi:[1,1]
    v_pk_mul_f32 v[230:231], v[182:183], v[26:27] op_sel:[0,1] op_sel_hi:[1,1]
    v_pk_mul_f32 v[176:177], v[176:177], v[184:185]
    v_pk_mul_f32 v[178:179], v[178:179], v[186:187]
    v_pk_mul_f32 v[180:181], v[180:181], v[188:189]
    v_pk_mul_f32 v[182:183], v[182:183], v[190:191]
    v_mfma_f32_16x16x32_bf16 v[220:223], a[228:231], v[52:55], v[220:223]
    ds_read_b128 a[224:227], v30 offset:40960
    v_exp_f32 v224, v224
    v_mfma_f32_16x16x32_bf16 v[216:219], a[228:231], v[48:51], v[216:219]
    v_exp_f32 v225, v225
    s_add_u32 s89, s47, 0xe000
    v_mfma_f32_16x16x32_bf16 v[208:211], a[232:235], v[56:59], v[208:211]
    ds_read_b128 a[228:231], v30 offset:41216
    v_exp_f32 v226, v226
    v_mfma_f32_16x16x32_bf16 v[212:215], a[232:235], v[60:63], v[212:215]
    s_add_u32 s68, s48, 0x4000
    buffer_load_dwordx4 a[64:67], v4, s[4:7], s68 offen
    v_mfma_f32_16x16x32_bf16 v[220:223], a[236:239], v[60:63], v[220:223]
    ds_read_b128 a[232:235], v30 offset:43008
    s_waitcnt lgkmcnt(3)
    s_add_u32 s90, s46, 0xf000
    v_mfma_f32_16x16x32_bf16 v[216:219], a[236:239], v[56:59], v[216:219]
    v_exp_f32 v227, v227
    s_add_u32 s91, s47, 0xf000
    v_mfma_f32_16x16x32_bf16 v[208:211], a[240:243], v[64:67], v[208:211]
    ds_read_b128 a[236:239], v30 offset:43264
    v_exp_f32 v228, v228
    v_mfma_f32_16x16x32_bf16 v[212:215], a[240:243], v[68:71], v[212:215]
    v_exp_f32 v229, v229
    v_mfma_f32_16x16x32_bf16 v[220:223], a[244:247], v[68:71], v[220:223]
    ds_read_b128 a[240:243], v30 offset:45056
    buffer_load_dwordx4 a[92:95], v4, s[4:7], s68 offen offset:256
    v_mfma_f32_16x16x32_bf16 v[216:219], a[244:247], v[64:67], v[216:219]
    v_exp_f32 v230, v230
    v_exp_f32 v231, v231
    v_pk_fma_f32 v[224:225], v[224:225], v[24:25], v[24:25] op_sel:[0,1,1] op_sel_hi:[1,1,1]
    v_pk_fma_f32 v[226:227], v[226:227], v[24:25], v[24:25] op_sel:[0,1,1] op_sel_hi:[1,1,1]
    v_pk_fma_f32 v[228:229], v[228:229], v[24:25], v[24:25] op_sel:[0,0,0] op_sel_hi:[1,0,0]
    v_pk_fma_f32 v[230:231], v[230:231], v[24:25], v[24:25] op_sel:[0,0,0] op_sel_hi:[1,0,0]
    v_mfma_f32_16x16x32_bf16 v[208:211], a[248:251], v[72:75], v[208:211]
    ds_read_b128 a[244:247], v30 offset:45312
    v_rcp_f32 v224, v224
    v_mfma_f32_16x16x32_bf16 v[212:215], a[248:251], v[76:79], v[212:215]
    v_rcp_f32 v225, v225
    v_mfma_f32_16x16x32_bf16 v[220:223], a[252:255], v[76:79], v[220:223]
    ds_read_b128 a[248:251], v30 offset:47104
    s_waitcnt lgkmcnt(3)
    v_mfma_f32_16x16x32_bf16 v[216:219], a[252:255], v[72:75], v[216:219]
    v_rcp_f32 v226, v226
    v_mfma_f32_16x16x32_bf16 v[208:211], a[224:227], v[80:83], v[208:211]
    ds_read_b128 a[252:255], v30 offset:47360
    v_rcp_f32 v227, v227
    v_mfma_f32_16x16x32_bf16 v[212:215], a[224:227], v[84:87], v[212:215]
    s_add_u32 s68, s58, 0x4000
    buffer_load_dwordx4 a[176:179], v4, s[4:7], s68 offen
    v_mfma_f32_16x16x32_bf16 v[220:223], a[228:231], v[84:87], v[220:223]
    ds_read_b128 a[224:227], v30 offset:49152
    v_rcp_f32 v228, v228
    v_mfma_f32_16x16x32_bf16 v[216:219], a[228:231], v[80:83], v[216:219]
    v_rcp_f32 v229, v229
    v_mfma_f32_16x16x32_bf16 v[208:211], a[232:235], v[88:91], v[208:211]
    ds_read_b128 a[228:231], v30 offset:49408
    v_mfma_f32_16x16x32_bf16 v[212:215], a[232:235], v[92:95], v[212:215]
    v_rcp_f32 v230, v230
    v_rcp_f32 v231, v231
    v_pk_mul_f32 v[176:177], v[176:177], v[224:225]
    v_pk_mul_f32 v[178:179], v[178:179], v[226:227]
    v_pk_mul_f32 v[180:181], v[180:181], v[228:229]
    v_pk_mul_f32 v[182:183], v[182:183], v[230:231]
    v_mfma_f32_16x16x32_bf16 v[220:223], a[236:239], v[92:95], v[220:223]
    ds_read_b128 a[232:235], v30 offset:51200
    s_waitcnt lgkmcnt(3)
    v_cvt_pk_bf16_f32 v232, v176, v177
    v_mfma_f32_16x16x32_bf16 v[216:219], a[236:239], v[88:91], v[216:219]
    buffer_load_dwordx4 a[204:207], v4, s[4:7], s68 offen offset:256
    v_cvt_pk_bf16_f32 v234, v180, v181
    v_mfma_f32_16x16x32_bf16 v[208:211], a[240:243], v[96:99], v[208:211]
    ds_read_b128 a[236:239], v30 offset:51456
    s_add_u32 m0, s55, 0x0
    s_add_u32 s74, s39, 0x2a000
    buffer_load_dwordx4 v1, s[4:7], s74 offen lds
    v_mfma_f32_16x16x32_bf16 v[212:215], a[240:243], v[100:103], v[212:215]
    v_cvt_pk_bf16_f32 v233, v178, v179
    v_cvt_pk_bf16_f32 v235, v182, v183
    v_mfma_f32_16x16x32_bf16 v[220:223], a[244:247], v[100:103], v[220:223]
    ds_read_b128 a[240:243], v30 offset:53248
    v_permlane16_swap_b32 v232, v234
    v_mfma_f32_16x16x32_bf16 v[216:219], a[244:247], v[96:99], v[216:219]
    v_permlane16_swap_b32 v233, v235
    buffer_store_dwordx4 v[232:235], v1, s[4:7], s57 offen offset:2048
    v_mfma_f32_16x16x32_bf16 v[208:211], a[248:251], v[104:107], v[208:211]
    ds_read_b128 a[244:247], v30 offset:53504
    buffer_load_dwordx4 v1, s[4:7], s74 offen offset:1024 lds
    buffer_load_dwordx4 a[124:127], v4, s[4:7], s58 offen offset:3072
    v_mfma_f32_16x16x32_bf16 v[212:215], a[248:251], v[108:111], v[212:215]
    v_pk_mul_f32 v[224:225], v[192:193], v[26:27] op_sel:[0,0] op_sel_hi:[1,0]
    v_pk_mul_f32 v[226:227], v[194:195], v[26:27] op_sel:[0,0] op_sel_hi:[1,0]
    v_pk_mul_f32 v[228:229], v[196:197], v[26:27] op_sel:[0,1] op_sel_hi:[1,1]
    v_pk_mul_f32 v[230:231], v[198:199], v[26:27] op_sel:[0,1] op_sel_hi:[1,1]
    v_pk_mul_f32 v[192:193], v[192:193], v[200:201]
    v_pk_mul_f32 v[194:195], v[194:195], v[202:203]
    v_pk_mul_f32 v[196:197], v[196:197], v[204:205]
    v_pk_mul_f32 v[198:199], v[198:199], v[206:207]
    v_mfma_f32_16x16x32_bf16 v[220:223], a[252:255], v[108:111], v[220:223]
    ds_read_b128 a[248:251], v30 offset:55296
    s_waitcnt lgkmcnt(3)
    v_mfma_f32_16x16x32_bf16 v[216:219], a[252:255], v[104:107], v[216:219]
    v_exp_f32 v224, v224
    v_mfma_f32_16x16x32_bf16 v[208:211], a[224:227], v[112:115], v[208:211]
    ds_read_b128 a[252:255], v30 offset:55552
    v_exp_f32 v225, v225
    v_mfma_f32_16x16x32_bf16 v[212:215], a[224:227], v[116:119], v[212:215]
    v_exp_f32 v226, v226
    v_mfma_f32_16x16x32_bf16 v[220:223], a[228:231], v[116:119], v[220:223]
    ds_read_b128 a[224:227], v29 offset:32768
    buffer_load_dwordx4 v1, s[4:7], s74 offen offset:2048 lds
    buffer_load_dwordx4 a[152:155], v4, s[4:7], s58 offen offset:3328
    v_mfma_f32_16x16x32_bf16 v[216:219], a[228:231], v[112:115], v[216:219]
    v_exp_f32 v227, v227
    v_mfma_f32_16x16x32_bf16 v[208:211], a[232:235], v[120:123], v[208:211]
    v_exp_f32 v228, v228
    v_mfma_f32_16x16x32_bf16 v[212:215], a[232:235], v[124:127], v[212:215]
    v_exp_f32 v229, v229
    v_mfma_f32_16x16x32_bf16 v[220:223], a[236:239], v[124:127], v[220:223]
    s_waitcnt vmcnt(13)
    s_barrier
    ds_read_b128 a[228:231], v29 offset:0
    v_mfma_f32_16x16x32_bf16 v[216:219], a[236:239], v[120:123], v[216:219]
    s_waitcnt lgkmcnt(2)
    v_or_b32_e64 v9, s3, 1
    s_waitcnt vmcnt(11)
    buffer_store_dword v9, v6, s[4:7], s54 offen offset:512
    buffer_load_dwordx4 v1, s[4:7], s74 offen offset:3072 lds
    s_add_u32 m0, s55, 0x1000
    v_mfma_f32_16x16x32_bf16 v[208:211], a[240:243], v[128:131], v[208:211]
    ds_read_b128 a[232:235], v29 offset:256
    v_mfma_f32_16x16x32_bf16 v[212:215], a[240:243], v[132:135], v[212:215]
    s_add_u32 s68, s58, 0x4000
    buffer_load_dwordx4 a[180:183], v4, s[4:7], s68 offen offset:1024
    v_mfma_f32_16x16x32_bf16 v[220:223], a[244:247], v[132:135], v[220:223]
    ds_read_b128 a[236:239], v29 offset:2048
    buffer_load_dwordx4 v0, s[4:7], s74 offen lds
    v_mfma_f32_16x16x32_bf16 v[216:219], a[244:247], v[128:131], v[216:219]
    v_exp_f32 v230, v230
    v_exp_f32 v231, v231
    v_pk_fma_f32 v[224:225], v[224:225], v[24:25], v[24:25] op_sel:[0,1,1] op_sel_hi:[1,1,1]
    v_pk_fma_f32 v[226:227], v[226:227], v[24:25], v[24:25] op_sel:[0,1,1] op_sel_hi:[1,1,1]
    v_pk_fma_f32 v[228:229], v[228:229], v[24:25], v[24:25] op_sel:[0,0,0] op_sel_hi:[1,0,0]
    v_pk_fma_f32 v[230:231], v[230:231], v[24:25], v[24:25] op_sel:[0,0,0] op_sel_hi:[1,0,0]
    v_mfma_f32_16x16x32_bf16 v[208:211], a[248:251], v[136:139], v[208:211]
    ds_read_b128 a[240:243], v29 offset:2304
    v_rcp_f32 v224, v224
    v_mfma_f32_16x16x32_bf16 v[212:215], a[248:251], v[140:143], v[212:215]
    v_rcp_f32 v225, v225
    v_mfma_f32_16x16x32_bf16 v[220:223], a[252:255], v[140:143], v[220:223]
    ds_read_b128 a[244:247], v29 offset:4096
    s_waitcnt lgkmcnt(3)
    buffer_load_dwordx4 v0, s[4:7], s74 offen offset:1024 lds
    v_mfma_f32_16x16x32_bf16 v[216:219], a[252:255], v[136:139], v[216:219]
    buffer_load_dwordx4 a[208:211], v4, s[4:7], s68 offen offset:1280
    v_mfma_f32_16x16x16_bf16 v[208:211], a[224:225], v[20:21], v[208:211]
    ds_read_b128 a[248:251], v29 offset:4352
    v_rcp_f32 v226, v226
    v_mfma_f32_16x16x16_bf16 v[212:215], a[224:225], v[22:23], v[212:215]
    v_rcp_f32 v227, v227
    v_mfma_f32_16x16x16_bf16 v[216:219], a[226:227], v[20:21], v[216:219]
    ds_read_b128 a[252:255], v29 offset:6144
    buffer_load_dwordx4 v0, s[4:7], s74 offen offset:2048 lds
    buffer_load_dwordx4 a[12:15], v4, s[4:7], s48 offen offset:3072
    v_mfma_f32_16x16x16_bf16 v[220:223], a[226:227], v[22:23], v[220:223]
    v_rcp_f32 v228, v228
    v_mfma_f32_16x16x32_bf16 v[144:147], a[228:231], v[32:35], 0
    ds_read_b128 a[224:227], v29 offset:6400
    v_rcp_f32 v229, v229
    v_mfma_f32_16x16x32_bf16 v[148:151], a[228:231], v[36:39], 0
    v_rcp_f32 v230, v230
    v_rcp_f32 v231, v231
    v_pk_mul_f32 v[192:193], v[192:193], v[224:225]
    v_pk_mul_f32 v[194:195], v[194:195], v[226:227]
    v_pk_mul_f32 v[196:197], v[196:197], v[228:229]
    v_pk_mul_f32 v[198:199], v[198:199], v[230:231]
    v_mfma_f32_16x16x32_bf16 v[156:159], a[232:235], v[36:39], 0
    ds_read_b128 a[228:231], v29 offset:8192
    s_waitcnt lgkmcnt(3)
    v_cvt_pk_bf16_f32 v236, v192, v193
    v_mfma_f32_16x16x32_bf16 v[152:155], a[232:235], v[32:35], 0
    v_cvt_pk_bf16_f32 v238, v196, v197
    v_cvt_pk_bf16_f32 v237, v194, v195
    v_cvt_pk_bf16_f32 v239, v198, v199
    v_mfma_f32_16x16x32_bf16 v[144:147], a[236:239], v[40:43], v[144:147]
    ds_read_b128 a[232:235], v29 offset:8448
    buffer_load_dwordx4 a[40:43], v4, s[4:7], s48 offen offset:3328
    v_mfma_f32_16x16x32_bf16 v[148:151], a[236:239], v[44:47], v[148:151]
    v_permlane16_swap_b32 v236, v238
    v_mfma_f32_16x16x32_bf16 v[156:159], a[240:243], v[44:47], v[156:159]
    ds_read_b128 a[236:239], v29 offset:10240
    v_permlane16_swap_b32 v237, v239
    v_mfma_f32_16x16x32_bf16 v[152:155], a[240:243], v[40:43], v[152:155]
    buffer_store_dwordx4 v[236:239], v1, s[4:7], s57 offen offset:3072
    v_permlane16_swap_b32 v12, v14
    v_mfma_f32_16x16x32_bf16 v[144:147], a[244:247], v[48:51], v[144:147]
    ds_read_b128 a[240:243], v29 offset:10496
    v_permlane16_swap_b32 v13, v15
    v_mfma_f32_16x16x32_bf16 v[148:151], a[244:247], v[52:55], v[148:151]
    v_permlane16_swap_b32 v16, v18
    v_mfma_f32_16x16x32_bf16 v[156:159], a[248:251], v[52:55], v[156:159]
    ds_read_b128 a[244:247], v29 offset:12288
    s_waitcnt lgkmcnt(3)
    v_mfma_f32_16x16x32_bf16 v[152:155], a[248:251], v[48:51], v[152:155]
    s_add_u32 s68, s48, 0x4000
    buffer_load_dwordx4 a[68:71], v4, s[4:7], s68 offen offset:1024
    v_mfma_f32_16x16x32_bf16 v[144:147], a[252:255], v[56:59], v[144:147]
    ds_read_b128 a[248:251], v29 offset:12544
    v_permlane16_swap_b32 v17, v19
    v_mfma_f32_16x16x32_bf16 v[148:151], a[252:255], v[60:63], v[148:151]
    v_lshlrev_b32 v176, 16, v12
    v_and_b32 v177, 0xffff0000, v12
    v_lshlrev_b32 v178, 16, v13
    v_mfma_f32_16x16x32_bf16 v[156:159], a[224:227], v[60:63], v[156:159]
    ds_read_b128 a[252:255], v29 offset:14336
    v_and_b32 v179, 0xffff0000, v13
    v_lshlrev_b32 v180, 16, v14
    v_mfma_f32_16x16x32_bf16 v[152:155], a[224:227], v[56:59], v[152:155]
    v_and_b32 v181, 0xffff0000, v14
    v_lshlrev_b32 v182, 16, v15
    v_and_b32 v183, 0xffff0000, v15
    v_mfma_f32_16x16x32_bf16 v[144:147], a[228:231], v[64:67], v[144:147]
    ds_read_b128 a[224:227], v29 offset:14592
    buffer_load_dwordx4 a[96:99], v4, s[4:7], s68 offen offset:1280
    v_mfma_f32_16x16x32_bf16 v[148:151], a[228:231], v[68:71], v[148:151]
    v_lshlrev_b32 v184, 16, v16
    v_and_b32 v185, 0xffff0000, v16
    v_lshlrev_b32 v186, 16, v17
    v_mfma_f32_16x16x32_bf16 v[156:159], a[232:235], v[68:71], v[156:159]
    ds_read_b128 a[228:231], v29 offset:16384
    s_waitcnt lgkmcnt(3)
    v_and_b32 v187, 0xffff0000, v17
    v_mfma_f32_16x16x32_bf16 v[152:155], a[232:235], v[64:67], v[152:155]
    v_lshlrev_b32 v188, 16, v18
    v_and_b32 v189, 0xffff0000, v18
    v_lshlrev_b32 v190, 16, v19
    v_mfma_f32_16x16x32_bf16 v[144:147], a[236:239], v[72:75], v[144:147]
    ds_read_b128 a[232:235], v29 offset:16640
    v_and_b32 v191, 0xffff0000, v19
    v_mfma_f32_16x16x32_bf16 v[148:151], a[236:239], v[76:79], v[148:151]
    v_pk_mul_f32 v[224:225], v[208:209], v[26:27] op_sel:[0,0] op_sel_hi:[1,0]
    v_pk_mul_f32 v[226:227], v[210:211], v[26:27] op_sel:[0,0] op_sel_hi:[1,0]
    v_pk_mul_f32 v[228:229], v[212:213], v[26:27] op_sel:[0,1] op_sel_hi:[1,1]
    v_pk_mul_f32 v[230:231], v[214:215], v[26:27] op_sel:[0,1] op_sel_hi:[1,1]
    v_pk_mul_f32 v[208:209], v[208:209], v[216:217]
    v_pk_mul_f32 v[210:211], v[210:211], v[218:219]
    v_pk_mul_f32 v[212:213], v[212:213], v[220:221]
    v_pk_mul_f32 v[214:215], v[214:215], v[222:223]
    v_mfma_f32_16x16x32_bf16 v[156:159], a[240:243], v[76:79], v[156:159]
    ds_read_b128 a[236:239], v29 offset:18432
    v_exp_f32 v224, v224
    v_mfma_f32_16x16x32_bf16 v[152:155], a[240:243], v[72:75], v[152:155]
    s_add_u32 s68, s58, 0x1000
    buffer_load_dwordx4 a[128:131], v4, s[4:7], s68 offen
    v_mfma_f32_16x16x32_bf16 v[144:147], a[244:247], v[80:83], v[144:147]
    ds_read_b128 a[240:243], v29 offset:18688
    v_exp_f32 v225, v225
    v_mfma_f32_16x16x32_bf16 v[148:151], a[244:247], v[84:87], v[148:151]
    v_exp_f32 v226, v226
    v_mfma_f32_16x16x32_bf16 v[156:159], a[248:251], v[84:87], v[156:159]
    ds_read_b128 a[244:247], v29 offset:20480
    s_waitcnt lgkmcnt(3)
    v_mfma_f32_16x16x32_bf16 v[152:155], a[248:251], v[80:83], v[152:155]
    v_exp_f32 v227, v227
    v_mfma_f32_16x16x32_bf16 v[144:147], a[252:255], v[88:91], v[144:147]
    ds_read_b128 a[248:251], v29 offset:20736
    buffer_load_dwordx4 a[156:159], v4, s[4:7], s68 offen offset:256
    v_mfma_f32_16x16x32_bf16 v[148:151], a[252:255], v[92:95], v[148:151]
    v_exp_f32 v228, v228
    v_mfma_f32_16x16x32_bf16 v[156:159], a[224:227], v[92:95], v[156:159]
    ds_read_b128 a[252:255], v29 offset:22528
    v_exp_f32 v229, v229
    v_mfma_f32_16x16x32_bf16 v[152:155], a[224:227], v[88:91], v[152:155]
    v_exp_f32 v230, v230
    v_exp_f32 v231, v231
    v_pk_fma_f32 v[224:225], v[224:225], v[24:25], v[24:25] op_sel:[0,1,1] op_sel_hi:[1,1,1]
    v_pk_fma_f32 v[226:227], v[226:227], v[24:25], v[24:25] op_sel:[0,1,1] op_sel_hi:[1,1,1]
    v_pk_fma_f32 v[228:229], v[228:229], v[24:25], v[24:25] op_sel:[0,0,0] op_sel_hi:[1,0,0]
    v_pk_fma_f32 v[230:231], v[230:231], v[24:25], v[24:25] op_sel:[0,0,0] op_sel_hi:[1,0,0]
    v_mfma_f32_16x16x32_bf16 v[144:147], a[228:231], v[96:99], v[144:147]
    ds_read_b128 a[224:227], v29 offset:22784
    v_rcp_f32 v224, v224
    v_mfma_f32_16x16x32_bf16 v[148:151], a[228:231], v[100:103], v[148:151]
    v_rcp_f32 v225, v225
    v_mfma_f32_16x16x32_bf16 v[156:159], a[232:235], v[100:103], v[156:159]
    ds_read_b128 a[228:231], v29 offset:24576
    s_waitcnt lgkmcnt(3)
    v_mfma_f32_16x16x32_bf16 v[152:155], a[232:235], v[96:99], v[152:155]
    s_add_u32 s68, s58, 0x4000
    buffer_load_dwordx4 a[184:187], v4, s[4:7], s68 offen offset:2048
    v_mfma_f32_16x16x32_bf16 v[144:147], a[236:239], v[104:107], v[144:147]
    ds_read_b128 a[232:235], v29 offset:24832
    v_rcp_f32 v226, v226
    v_mfma_f32_16x16x32_bf16 v[148:151], a[236:239], v[108:111], v[148:151]
    v_rcp_f32 v227, v227
    v_mfma_f32_16x16x32_bf16 v[156:159], a[240:243], v[108:111], v[156:159]
    ds_read_b128 a[236:239], v29 offset:26624
    buffer_load_dword v8, v10, s[4:7], s56 offen offset:512 sc1
    v_mfma_f32_16x16x32_bf16 v[152:155], a[240:243], v[104:107], v[152:155]
    s_add_u32 s44, s3, 1
    v_rcp_f32 v228, v228
    v_mfma_f32_16x16x32_bf16 v[144:147], a[244:247], v[112:115], v[144:147]
    ds_read_b128 a[240:243], v29 offset:26880
    buffer_load_dwordx4 a[212:215], v4, s[4:7], s68 offen offset:2304
    v_mfma_f32_16x16x32_bf16 v[148:151], a[244:247], v[116:119], v[148:151]
    v_rcp_f32 v229, v229
    v_mfma_f32_16x16x32_bf16 v[156:159], a[248:251], v[116:119], v[156:159]
    ds_read_b128 a[244:247], v29 offset:33024
    s_waitcnt lgkmcnt(3)
    v_mfma_f32_16x16x32_bf16 v[152:155], a[248:251], v[112:115], v[152:155]
    v_rcp_f32 v230, v230
    v_rcp_f32 v231, v231
    v_pk_mul_f32 v[208:209], v[208:209], v[224:225]
    v_pk_mul_f32 v[210:211], v[210:211], v[226:227]
    v_pk_mul_f32 v[212:213], v[212:213], v[228:229]
    v_pk_mul_f32 v[214:215], v[214:215], v[230:231]
    v_mfma_f32_16x16x32_bf16 v[144:147], a[252:255], v[120:123], v[144:147]
    v_cvt_pk_bf16_f32 v232, v208, v209
    v_cvt_pk_bf16_f32 v234, v212, v213
    v_cvt_pk_bf16_f32 v233, v210, v211
    v_mfma_f32_16x16x32_bf16 v[148:151], a[252:255], v[124:127], v[148:151]
    v_cvt_pk_bf16_f32 v235, v214, v215
    v_permlane16_swap_b32 v232, v234
    v_mfma_f32_16x16x32_bf16 v[156:159], a[224:227], v[124:127], v[156:159]
    s_waitcnt vmcnt(10)
    s_barrier
    ds_read_b128 a[248:251], v28 offset:0
    v_mfma_f32_16x16x32_bf16 v[152:155], a[224:227], v[120:123], v[152:155]
    s_add_u32 s68, s48, 0x1000
    buffer_load_dwordx4 a[16:19], v4, s[4:7], s68 offen
    v_mfma_f32_16x16x32_bf16 v[144:147], a[228:231], v[128:131], v[144:147]
    ds_read_b128 a[252:255], v28 offset:256
    v_permlane16_swap_b32 v233, v235
    v_mfma_f32_16x16x32_bf16 v[148:151], a[228:231], v[132:135], v[148:151]
    buffer_store_dwordx4 v[232:235], v0, s[4:7], s57 offen
    v_mfma_f32_16x16x32_bf16 v[156:159], a[232:235], v[132:135], v[156:159]
    ds_read_b128 a[224:227], v28 offset:2048
    s_waitcnt lgkmcnt(3)
    v_mfma_f32_16x16x32_bf16 v[152:155], a[232:235], v[128:131], v[152:155]
    v_mfma_f32_16x16x32_bf16 v[144:147], a[236:239], v[136:139], v[144:147]
    ds_read_b128 a[228:231], v28 offset:2304
    buffer_load_dwordx4 a[44:47], v4, s[4:7], s68 offen offset:256
    v_mfma_f32_16x16x32_bf16 v[148:151], a[236:239], v[140:143], v[148:151]
    v_mfma_f32_16x16x32_bf16 v[156:159], a[240:243], v[140:143], v[156:159]
    ds_read_b128 a[232:235], v28 offset:4096
    v_mfma_f32_16x16x32_bf16 v[152:155], a[240:243], v[136:139], v[152:155]
    v_mfma_f32_16x16x16_bf16 v[144:147], a[244:245], v[20:21], v[144:147]
    ds_read_b128 a[236:239], v28 offset:4352
    v_mfma_f32_16x16x16_bf16 v[148:151], a[244:245], v[22:23], v[148:151]
    v_mfma_f32_16x16x16_bf16 v[152:155], a[246:247], v[20:21], v[152:155]
    ds_read_b128 a[240:243], v28 offset:6144
    s_waitcnt lgkmcnt(3)
    v_mfma_f32_16x16x16_bf16 v[156:159], a[246:247], v[22:23], v[156:159]
    s_add_u32 s68, s48, 0x4000
    buffer_load_dwordx4 a[72:75], v4, s[4:7], s68 offen offset:2048
    v_mfma_f32_16x16x32_bf16 v[160:163], a[248:251], v[32:35], 0
    ds_read_b128 a[244:247], v28 offset:6400
    v_mfma_f32_16x16x32_bf16 v[164:167], a[248:251], v[36:39], 0
    s_waitcnt vmcnt(5)
    v_subrev_u32 v8, s44, v8
    v_cmp_le_u32 vcc, 16, v8
    s_cbranch_vccnz Lfs_105
Lc_106:
    v_mfma_f32_16x16x32_bf16 v[172:175], a[252:255], v[36:39], 0
    ds_read_b128 a[248:251], v28 offset:8192
    buffer_load_dwordx4 v[240:243], v5, s[4:7], s84 offen sc1
    v_mfma_f32_16x16x32_bf16 v[168:171], a[252:255], v[32:35], 0
    buffer_load_dwordx4 v[244:247], v5, s[4:7], s84 offen offset:256 sc1
    buffer_load_dwordx4 v[248:251], v5, s[4:7], s88 offen sc1
    buffer_load_dwordx4 v[252:255], v5, s[4:7], s88 offen offset:256 sc1
    s_barrier
    v_mfma_f32_16x16x32_bf16 v[160:163], a[224:227], v[40:43], v[160:163]
    ds_read_b128 a[252:255], v28 offset:8448
    v_mfma_f32_16x16x32_bf16 v[164:167], a[224:227], v[44:47], v[164:167]
    v_or_b32_e64 v9, s3, 3
    buffer_store_dword v9, v6, s[4:7], s54 offen offset:512
    buffer_load_dwordx4 v[32:35], v5, s[4:7], s84 offen offset:1024 sc1
    buffer_load_dwordx4 a[100:103], v4, s[4:7], s68 offen offset:2304
    v_mfma_f32_16x16x32_bf16 v[172:175], a[228:231], v[44:47], v[172:175]
    ds_read_b128 a[224:227], v28 offset:10240
    s_waitcnt lgkmcnt(3)
    v_mfma_f32_16x16x32_bf16 v[168:171], a[228:231], v[40:43], v[168:171]
    buffer_load_dwordx4 v[36:39], v5, s[4:7], s84 offen offset:1280 sc1
    v_mfma_f32_16x16x32_bf16 v[160:163], a[232:235], v[48:51], v[160:163]
    ds_read_b128 a[228:231], v28 offset:10496
    v_mfma_f32_16x16x32_bf16 v[164:167], a[232:235], v[52:55], v[164:167]
    v_pk_mul_f32 v[224:225], v[144:145], v[26:27] op_sel:[0,0] op_sel_hi:[1,0]
    v_pk_mul_f32 v[226:227], v[146:147], v[26:27] op_sel:[0,0] op_sel_hi:[1,0]
    v_pk_mul_f32 v[228:229], v[148:149], v[26:27] op_sel:[0,1] op_sel_hi:[1,1]
    v_pk_mul_f32 v[230:231], v[150:151], v[26:27] op_sel:[0,1] op_sel_hi:[1,1]
    v_pk_mul_f32 v[144:145], v[144:145], v[152:153]
    v_pk_mul_f32 v[146:147], v[146:147], v[154:155]
    v_pk_mul_f32 v[148:149], v[148:149], v[156:157]
    v_pk_mul_f32 v[150:151], v[150:151], v[158:159]
    v_mfma_f32_16x16x32_bf16 v[172:175], a[236:239], v[52:55], v[172:175]
    ds_read_b128 a[232:235], v28 offset:12288
    buffer_load_dwordx4 v[40:43], v5, s[4:7], s88 offen offset:1024 sc1
    v_mfma_f32_16x16x32_bf16 v[168:171], a[236:239], v[48:51], v[168:171]
    s_add_u32 s68, s58, 0x1000
    buffer_load_dwordx4 a[132:135], v4, s[4:7], s68 offen offset:1024
    v_mfma_f32_16x16x32_bf16 v[160:163], a[240:243], v[56:59], v[160:163]
    ds_read_b128 a[236:239], v28 offset:12544
    v_exp_f32 v224, v224
    v_mfma_f32_16x16x32_bf16 v[164:167], a[240:243], v[60:63], v[164:167]
    v_exp_f32 v225, v225
    v_mfma_f32_16x16x32_bf16 v[172:175], a[244:247], v[60:63], v[172:175]
    ds_read_b128 a[240:243], v28 offset:14336
    s_waitcnt lgkmcnt(3)
    v_mfma_f32_16x16x32_bf16 v[168:171], a[244:247], v[56:59], v[168:171]
    buffer_load_dwordx4 v[44:47], v5, s[4:7], s88 offen offset:1280 sc1
    v_mfma_f32_16x16x32_bf16 v[160:163], a[248:251], v[64:67], v[160:163]
    ds_read_b128 a[244:247], v28 offset:14592
    buffer_load_dwordx4 a[160:163], v4, s[4:7], s68 offen offset:1280
    v_mfma_f32_16x16x32_bf16 v[164:167], a[248:251], v[68:71], v[164:167]
    v_exp_f32 v226, v226
    v_mfma_f32_16x16x32_bf16 v[172:175], a[252:255], v[68:71], v[172:175]
    ds_read_b128 a[248:251], v28 offset:16384
    buffer_load_dwordx4 v[48:51], v5, s[4:7], s85 offen sc1
    v_mfma_f32_16x16x32_bf16 v[168:171], a[252:255], v[64:67], v[168:171]
    v_exp_f32 v227, v227
    v_mfma_f32_16x16x32_bf16 v[160:163], a[224:227], v[72:75], v[160:163]
    ds_read_b128 a[252:255], v28 offset:16640
    v_exp_f32 v228, v228
    v_mfma_f32_16x16x32_bf16 v[164:167], a[224:227], v[76:79], v[164:167]
    v_exp_f32 v229, v229
    v_mfma_f32_16x16x32_bf16 v[172:175], a[228:231], v[76:79], v[172:175]
    ds_read_b128 a[224:227], v28 offset:18432
    s_waitcnt lgkmcnt(3)
    v_mfma_f32_16x16x32_bf16 v[168:171], a[228:231], v[72:75], v[168:171]
    buffer_load_dwordx4 v[52:55], v5, s[4:7], s85 offen offset:256 sc1
    s_add_u32 s68, s58, 0x4000
    buffer_load_dwordx4 a[188:191], v4, s[4:7], s68 offen offset:3072
    v_mfma_f32_16x16x32_bf16 v[160:163], a[232:235], v[80:83], v[160:163]
    ds_read_b128 a[228:231], v28 offset:18688
    v_mfma_f32_16x16x32_bf16 v[164:167], a[232:235], v[84:87], v[164:167]
    v_exp_f32 v230, v230
    v_exp_f32 v231, v231
    v_pk_fma_f32 v[224:225], v[224:225], v[24:25], v[24:25] op_sel:[0,1,1] op_sel_hi:[1,1,1]
    v_pk_fma_f32 v[226:227], v[226:227], v[24:25], v[24:25] op_sel:[0,1,1] op_sel_hi:[1,1,1]
    v_pk_fma_f32 v[228:229], v[228:229], v[24:25], v[24:25] op_sel:[0,0,0] op_sel_hi:[1,0,0]
    v_pk_fma_f32 v[230:231], v[230:231], v[24:25], v[24:25] op_sel:[0,0,0] op_sel_hi:[1,0,0]
    v_mfma_f32_16x16x32_bf16 v[172:175], a[236:239], v[84:87], v[172:175]
    ds_read_b128 a[232:235], v28 offset:20480
    buffer_load_dwordx4 v[56:59], v5, s[4:7], s89 offen sc1
    v_mfma_f32_16x16x32_bf16 v[168:171], a[236:239], v[80:83], v[168:171]
    v_rcp_f32 v224, v224
    v_mfma_f32_16x16x32_bf16 v[160:163], a[240:243], v[88:91], v[160:163]
    ds_read_b128 a[236:239], v28 offset:20736
    buffer_load_dwordx4 a[216:219], v4, s[4:7], s68 offen offset:3328
    v_mfma_f32_16x16x32_bf16 v[164:167], a[240:243], v[92:95], v[164:167]
    v_rcp_f32 v225, v225
    v_mfma_f32_16x16x32_bf16 v[172:175], a[244:247], v[92:95], v[172:175]
    ds_read_b128 a[240:243], v28 offset:22528
    s_waitcnt lgkmcnt(3)
    v_mfma_f32_16x16x32_bf16 v[168:171], a[244:247], v[88:91], v[168:171]
    buffer_load_dword v8, v10, s[4:7], s56 offen offset:512 sc1
    s_add_u32 s44, s3, 3
    buffer_load_dwordx4 v[60:63], v5, s[4:7], s89 offen offset:256 sc1
    v_mfma_f32_16x16x32_bf16 v[160:163], a[248:251], v[96:99], v[160:163]
    ds_read_b128 a[244:247], v28 offset:22784
    v_rcp_f32 v226, v226
    v_mfma_f32_16x16x32_bf16 v[164:167], a[248:251], v[100:103], v[164:167]
    v_rcp_f32 v227, v227
    v_mfma_f32_16x16x32_bf16 v[172:175], a[252:255], v[100:103], v[172:175]
    ds_read_b128 a[248:251], v28 offset:24576
    buffer_load_dwordx4 v[64:67], v5, s[4:7], s85 offen offset:1024 sc1
    v_mfma_f32_16x16x32_bf16 v[168:171], a[252:255], v[96:99], v[168:171]
    s_add_u32 s68, s48, 0x1000
    buffer_load_dwordx4 a[20:23], v4, s[4:7], s68 offen offset:1024
    v_mfma_f32_16x16x32_bf16 v[160:163], a[224:227], v[104:107], v[160:163]
    ds_read_b128 a[252:255], v28 offset:24832
    v_rcp_f32 v228, v228
    v_mfma_f32_16x16x32_bf16 v[164:167], a[224:227], v[108:111], v[164:167]
    v_rcp_f32 v229, v229
    v_mfma_f32_16x16x32_bf16 v[172:175], a[228:231], v[108:111], v[172:175]
    ds_read_b128 a[224:227], v28 offset:26624
    s_waitcnt lgkmcnt(3)
    v_mfma_f32_16x16x32_bf16 v[168:171], a[228:231], v[104:107], v[168:171]
    buffer_load_dwordx4 v[68:71], v5, s[4:7], s85 offen offset:1280 sc1
    v_mfma_f32_16x16x32_bf16 v[160:163], a[232:235], v[112:115], v[160:163]
    ds_read_b128 a[228:231], v28 offset:26880
    v_mfma_f32_16x16x32_bf16 v[164:167], a[232:235], v[116:119], v[164:167]
    v_or_b32_e64 v9, s3, 4
    s_waitcnt vmcnt(24)
    buffer_store_dword v9, v6, s[4:7], s54 offen offset:512
    buffer_load_dwordx4 a[48:51], v4, s[4:7], s68 offen offset:1280
    v_mfma_f32_16x16x32_bf16 v[172:175], a[236:239], v[116:119], v[172:175]
    ds_read_b128 a[232:235], v29 offset:34816
    buffer_load_dwordx4 v[72:75], v5, s[4:7], s89 offen offset:1024 sc1
    v_mfma_f32_16x16x32_bf16 v[168:171], a[236:239], v[112:115], v[168:171]
    v_rcp_f32 v230, v230
    v_rcp_f32 v231, v231
    v_pk_mul_f32 v[144:145], v[144:145], v[224:225]
    v_pk_mul_f32 v[146:147], v[146:147], v[226:227]
    v_pk_mul_f32 v[148:149], v[148:149], v[228:229]
    v_pk_mul_f32 v[150:151], v[150:151], v[230:231]
    v_mfma_f32_16x16x32_bf16 v[160:163], a[240:243], v[120:123], v[160:163]
    v_cvt_pk_bf16_f32 v236, v144, v145
    v_cvt_pk_bf16_f32 v238, v148, v149
    v_cvt_pk_bf16_f32 v237, v146, v147
    v_mfma_f32_16x16x32_bf16 v[164:167], a[240:243], v[124:127], v[164:167]
    v_cvt_pk_bf16_f32 v239, v150, v151
    v_permlane16_swap_b32 v236, v238
    v_mfma_f32_16x16x32_bf16 v[172:175], a[244:247], v[124:127], v[172:175]
    s_waitcnt lgkmcnt(1)
    buffer_load_dwordx4 v[76:79], v5, s[4:7], s89 offen offset:1280 sc1
    v_mfma_f32_16x16x32_bf16 v[168:171], a[244:247], v[120:123], v[168:171]
    s_add_u32 s68, s48, 0x4000
    buffer_load_dwordx4 a[76:79], v4, s[4:7], s68 offen offset:3072
    v_mfma_f32_16x16x32_bf16 v[160:163], a[248:251], v[128:131], v[160:163]
    v_permlane16_swap_b32 v237, v239
    buffer_store_dwordx4 v[236:239], v0, s[4:7], s57 offen offset:1024
    v_mfma_f32_16x16x32_bf16 v[164:167], a[248:251], v[132:135], v[164:167]
    v_mfma_f32_16x16x32_bf16 v[172:175], a[252:255], v[132:135], v[172:175]
    v_mfma_f32_16x16x32_bf16 v[168:171], a[252:255], v[128:131], v[168:171]
    v_mfma_f32_16x16x32_bf16 v[160:163], a[224:227], v[136:139], v[160:163]
    buffer_load_dwordx4 a[104:107], v4, s[4:7], s68 offen offset:3328
    v_mfma_f32_16x16x32_bf16 v[164:167], a[224:227], v[140:143], v[164:167]
    s_waitcnt vmcnt(11)
    v_subrev_u32 v8, s44, v8
    v_cmp_le_u32 vcc, 16, v8
    s_cbranch_vccnz Lfs_107
Lc_108:
    v_mfma_f32_16x16x32_bf16 v[172:175], a[228:231], v[140:143], v[172:175]
    s_waitcnt lgkmcnt(0)
    buffer_load_dwordx4 v[80:83], v5, s[4:7], s84 offen offset:2048 sc1
    v_mfma_f32_16x16x32_bf16 v[168:171], a[228:231], v[136:139], v[168:171]
    buffer_load_dwordx4 v[84:87], v5, s[4:7], s84 offen offset:2304 sc1
    v_mfma_f32_16x16x16_bf16 v[160:163], a[232:233], v[20:21], v[160:163]
    v_mfma_f32_16x16x16_bf16 v[164:167], a[232:233], v[22:23], v[164:167]
    v_mfma_f32_16x16x16_bf16 v[168:171], a[234:235], v[20:21], v[168:171]
    buffer_load_dwordx4 v[88:91], v5, s[4:7], s88 offen offset:2048 sc1
    v_mfma_f32_16x16x16_bf16 v[172:175], a[234:235], v[22:23], v[172:175]
    s_add_u32 s68, s58, 0x1000
    buffer_load_dwordx4 a[136:139], v4, s[4:7], s68 offen offset:2048
LstS4_0f:
    s_cmp_ge_u32 s25, 14
    s_cbranch_scc1 Lidle_109
    v_mfma_f32_16x16x32_bf16 v[176:179], a[0:3], v[240:243], v[176:179]
    buffer_load_dwordx4 v[92:95], v5, s[4:7], s88 offen offset:2304 sc1
    v_mfma_f32_16x16x32_bf16 v[184:187], a[28:31], v[240:243], v[184:187]
    v_mfma_f32_16x16x32_bf16 v[192:195], a[112:115], v[240:243], 0
    v_pk_mul_f32 v[224:225], v[160:161], v[26:27] op_sel:[0,0] op_sel_hi:[1,0]
    v_pk_mul_f32 v[226:227], v[162:163], v[26:27] op_sel:[0,0] op_sel_hi:[1,0]
    v_pk_mul_f32 v[228:229], v[164:165], v[26:27] op_sel:[0,1] op_sel_hi:[1,1]
    v_pk_mul_f32 v[230:231], v[166:167], v[26:27] op_sel:[0,1] op_sel_hi:[1,1]
    v_pk_mul_f32 v[160:161], v[160:161], v[168:169]
    v_pk_mul_f32 v[162:163], v[162:163], v[170:171]
    v_pk_mul_f32 v[164:165], v[164:165], v[172:173]
    v_pk_mul_f32 v[166:167], v[166:167], v[174:175]
    v_mfma_f32_16x16x32_bf16 v[200:203], a[140:143], v[240:243], 0
    v_exp_f32 v224, v224
    v_mfma_f32_16x16x32_bf16 v[204:207], a[140:143], v[244:247], 0
    buffer_load_dwordx4 v[96:99], v5, s[4:7], s85 offen offset:2048 sc1
    v_mfma_f32_16x16x32_bf16 v[196:199], a[112:115], v[244:247], 0
    buffer_load_dwordx4 a[164:167], v4, s[4:7], s68 offen offset:2304
    v_mfma_f32_16x16x32_bf16 v[188:191], a[28:31], v[244:247], v[188:191]
    v_exp_f32 v225, v225
    v_mfma_f32_16x16x32_bf16 v[180:183], a[0:3], v[244:247], v[180:183]
    v_exp_f32 v226, v226
    v_mfma_f32_16x16x32_bf16 v[176:179], a[56:59], v[248:251], v[176:179]
    buffer_load_dwordx4 v[100:103], v5, s[4:7], s85 offen offset:2304 sc1
    v_mfma_f32_16x16x32_bf16 v[184:187], a[84:87], v[248:251], v[184:187]
    v_exp_f32 v227, v227
    v_mfma_f32_16x16x32_bf16 v[192:195], a[168:171], v[248:251], v[192:195]
    s_add_u32 s68, s58, 0x5000
    buffer_load_dwordx4 a[192:195], v4, s[4:7], s68 offen
    v_mfma_f32_16x16x32_bf16 v[200:203], a[196:199], v[248:251], v[200:203]
    v_exp_f32 v228, v228
    v_mfma_f32_16x16x32_bf16 v[204:207], a[196:199], v[252:255], v[204:207]
    buffer_load_dwordx4 v[104:107], v5, s[4:7], s89 offen offset:2048 sc1
    v_mfma_f32_16x16x32_bf16 v[196:199], a[168:171], v[252:255], v[196:199]
    v_exp_f32 v229, v229
    v_mfma_f32_16x16x32_bf16 v[188:191], a[84:87], v[252:255], v[188:191]
    v_exp_f32 v230, v230
    v_exp_f32 v231, v231
    v_pk_fma_f32 v[224:225], v[224:225], v[24:25], v[24:25] op_sel:[0,1,1] op_sel_hi:[1,1,1]
    v_pk_fma_f32 v[226:227], v[226:227], v[24:25], v[24:25] op_sel:[0,1,1] op_sel_hi:[1,1,1]
    v_pk_fma_f32 v[228:229], v[228:229], v[24:25], v[24:25] op_sel:[0,0,0] op_sel_hi:[1,0,0]
    v_pk_fma_f32 v[230:231], v[230:231], v[24:25], v[24:25] op_sel:[0,0,0] op_sel_hi:[1,0,0]
    v_mfma_f32_16x16x32_bf16 v[180:183], a[56:59], v[252:255], v[180:183]
    v_rcp_f32 v224, v224
    v_mfma_f32_16x16x32_bf16 v[176:179], a[4:7], v[32:35], v[176:179]
    buffer_load_dwordx4 v[108:111], v5, s[4:7], s89 offen offset:2304 sc1
    v_mfma_f32_16x16x32_bf16 v[184:187], a[32:35], v[32:35], v[184:187]
    buffer_load_dwordx4 a[220:223], v4, s[4:7], s68 offen offset:256
    v_mfma_f32_16x16x32_bf16 v[192:195], a[116:119], v[32:35], v[192:195]
    v_rcp_f32 v225, v225
    v_mfma_f32_16x16x32_bf16 v[200:203], a[144:147], v[32:35], v[200:203]
    v_rcp_f32 v226, v226
    v_mfma_f32_16x16x32_bf16 v[204:207], a[144:147], v[36:39], v[204:207]
    v_or_b32_e64 v9, s3, 5
    s_waitcnt vmcnt(13)
    buffer_store_dword v9, v6, s[4:7], s54 offen offset:512
    v_mfma_f32_16x16x32_bf16 v[196:199], a[116:119], v[36:39], v[196:199]
    buffer_load_dwordx4 v[112:115], v5, s[4:7], s84 offen offset:3072 sc1
    v_mfma_f32_16x16x32_bf16 v[188:191], a[32:35], v[36:39], v[188:191]
    s_add_u32 s68, s48, 0x1000
    buffer_load_dwordx4 a[24:27], v4, s[4:7], s68 offen offset:2048
    v_mfma_f32_16x16x32_bf16 v[180:183], a[4:7], v[36:39], v[180:183]
    v_rcp_f32 v227, v227
    v_mfma_f32_16x16x32_bf16 v[176:179], a[60:63], v[40:43], v[176:179]
    buffer_load_dwordx4 v[116:119], v5, s[4:7], s84 offen offset:3328 sc1
    v_mfma_f32_16x16x32_bf16 v[184:187], a[88:91], v[40:43], v[184:187]
    v_rcp_f32 v228, v228
    v_mfma_f32_16x16x32_bf16 v[192:195], a[172:175], v[40:43], v[192:195]
    v_rcp_f32 v229, v229
    v_mfma_f32_16x16x32_bf16 v[200:203], a[200:203], v[40:43], v[200:203]
    v_rcp_f32 v230, v230
    v_rcp_f32 v231, v231
    v_pk_mul_f32 v[160:161], v[160:161], v[224:225]
    v_pk_mul_f32 v[162:163], v[162:163], v[226:227]
    v_pk_mul_f32 v[164:165], v[164:165], v[228:229]
    v_pk_mul_f32 v[166:167], v[166:167], v[230:231]
    v_mfma_f32_16x16x32_bf16 v[204:207], a[200:203], v[44:47], v[204:207]
    buffer_load_dword v8, v10, s[4:7], s56 offen offset:512 sc1
    v_mfma_f32_16x16x32_bf16 v[196:199], a[172:175], v[44:47], v[196:199]
    s_add_u32 s44, s3, 4
    buffer_load_dwordx4 v[120:123], v5, s[4:7], s88 offen offset:3072 sc1
    buffer_load_dwordx4 a[52:55], v4, s[4:7], s68 offen offset:2304
    v_mfma_f32_16x16x32_bf16 v[188:191], a[88:91], v[44:47], v[188:191]
    v_cvt_pk_bf16_f32 v232, v160, v161
    v_cvt_pk_bf16_f32 v234, v164, v165
    v_mfma_f32_16x16x32_bf16 v[180:183], a[60:63], v[44:47], v[180:183]
    v_cvt_pk_bf16_f32 v233, v162, v163
    v_cvt_pk_bf16_f32 v235, v166, v167
    v_mfma_f32_16x16x32_bf16 v[208:211], a[0:3], v[48:51], 0
    buffer_load_dwordx4 v[124:127], v5, s[4:7], s88 offen offset:3328 sc1
    v_mfma_f32_16x16x32_bf16 v[216:219], a[28:31], v[48:51], 0
    v_permlane16_swap_b32 v232, v234
    v_permlane16_swap_b32 v233, v235
    buffer_store_dwordx4 v[232:235], v0, s[4:7], s57 offen offset:2048
    v_mfma_f32_16x16x32_bf16 v[144:147], a[112:115], v[48:51], 0
    s_add_u32 s68, s48, 0x5000
    buffer_load_dwordx4 a[80:83], v4, s[4:7], s68 offen
    v_mfma_f32_16x16x32_bf16 v[152:155], a[140:143], v[48:51], 0
    v_mfma_f32_16x16x32_bf16 v[156:159], a[140:143], v[52:55], 0
    buffer_load_dwordx4 v[128:131], v5, s[4:7], s85 offen offset:3072 sc1
    v_mfma_f32_16x16x32_bf16 v[148:151], a[112:115], v[52:55], 0
    v_mfma_f32_16x16x32_bf16 v[220:223], a[28:31], v[52:55], 0
    v_mfma_f32_16x16x32_bf16 v[212:215], a[0:3], v[52:55], 0
    v_mfma_f32_16x16x32_bf16 v[208:211], a[56:59], v[56:59], v[208:211]
    buffer_load_dwordx4 v[132:135], v5, s[4:7], s85 offen offset:3328 sc1
    v_mfma_f32_16x16x32_bf16 v[216:219], a[84:87], v[56:59], v[216:219]
    buffer_load_dwordx4 a[108:111], v4, s[4:7], s68 offen offset:256
    v_mfma_f32_16x16x32_bf16 v[144:147], a[168:171], v[56:59], v[144:147]
    v_mfma_f32_16x16x32_bf16 v[152:155], a[196:199], v[56:59], v[152:155]
    v_mfma_f32_16x16x32_bf16 v[156:159], a[196:199], v[60:63], v[156:159]
    buffer_load_dwordx4 v[136:139], v5, s[4:7], s89 offen offset:3072 sc1
    v_mfma_f32_16x16x32_bf16 v[148:151], a[168:171], v[60:63], v[148:151]
    v_mfma_f32_16x16x32_bf16 v[220:223], a[84:87], v[60:63], v[220:223]
    v_mfma_f32_16x16x32_bf16 v[212:215], a[56:59], v[60:63], v[212:215]
    v_mfma_f32_16x16x32_bf16 v[208:211], a[4:7], v[64:67], v[208:211]
    buffer_load_dwordx4 v[140:143], v5, s[4:7], s89 offen offset:3328 sc1
    v_mfma_f32_16x16x32_bf16 v[216:219], a[32:35], v[64:67], v[216:219]
    v_add_u32 v28, s32, v1
    v_add_u32 v29, s33, v1
    v_mfma_f32_16x16x32_bf16 v[144:147], a[116:119], v[64:67], v[144:147]
    v_add_u32 v30, s34, v1
    v_add_u32 v31, s35, v1
    v_mfma_f32_16x16x32_bf16 v[152:155], a[144:147], v[64:67], v[152:155]
    s_waitcnt vmcnt(10)
    v_subrev_u32 v8, s44, v8
    v_cmp_le_u32 vcc, 16, v8
    s_cbranch_vccnz Lfs_110
Lc_111:
    v_mfma_f32_16x16x32_bf16 v[156:159], a[144:147], v[68:71], v[156:159]
    buffer_load_dword v8, v10, s[4:7], s56 offen offset:512 sc1
    v_mfma_f32_16x16x32_bf16 v[148:151], a[116:119], v[68:71], v[148:151]
    s_add_u32 s44, s3, 5
    buffer_load_dwordx4 v[240:243], v5, s[4:7], s86 offen sc1
    v_mfma_f32_16x16x32_bf16 v[220:223], a[32:35], v[68:71], v[220:223]
    v_mfma_f32_16x16x32_bf16 v[212:215], a[4:7], v[68:71], v[212:215]
    v_mfma_f32_16x16x32_bf16 v[208:211], a[60:63], v[72:75], v[208:211]
    buffer_load_dwordx4 v[244:247], v5, s[4:7], s86 offen offset:256 sc1
    v_mfma_f32_16x16x32_bf16 v[216:219], a[88:91], v[72:75], v[216:219]
    v_mfma_f32_16x16x32_bf16 v[144:147], a[172:175], v[72:75], v[144:147]
    v_mfma_f32_16x16x32_bf16 v[152:155], a[200:203], v[72:75], v[152:155]
    v_mfma_f32_16x16x32_bf16 v[156:159], a[200:203], v[76:79], v[156:159]
    buffer_load_dwordx4 v[248:251], v5, s[4:7], s90 offen sc1
    v_mfma_f32_16x16x32_bf16 v[148:151], a[172:175], v[76:79], v[148:151]
    v_mfma_f32_16x16x32_bf16 v[220:223], a[88:91], v[76:79], v[220:223]
    v_mfma_f32_16x16x32_bf16 v[212:215], a[60:63], v[76:79], v[212:215]
    s_barrier
    v_mfma_f32_16x16x32_bf16 v[176:179], a[8:11], v[80:83], v[176:179]
    buffer_load_dwordx4 v[252:255], v5, s[4:7], s90 offen offset:256 sc1
    v_mfma_f32_16x16x32_bf16 v[184:187], a[36:39], v[80:83], v[184:187]
    v_mfma_f32_16x16x32_bf16 v[192:195], a[120:123], v[80:83], v[192:195]
    v_or_b32_e64 v9, s3, 6
    s_waitcnt vmcnt(11)
    buffer_store_dword v9, v6, s[4:7], s54 offen offset:512
    v_mfma_f32_16x16x32_bf16 v[200:203], a[148:151], v[80:83], v[200:203]
    v_mfma_f32_16x16x32_bf16 v[204:207], a[148:151], v[84:87], v[204:207]
    buffer_load_dwordx4 v[32:35], v5, s[4:7], s87 offen sc1
    v_mfma_f32_16x16x32_bf16 v[196:199], a[120:123], v[84:87], v[196:199]
    v_mfma_f32_16x16x32_bf16 v[188:191], a[36:39], v[84:87], v[188:191]
    v_mfma_f32_16x16x32_bf16 v[180:183], a[8:11], v[84:87], v[180:183]
    v_mfma_f32_16x16x32_bf16 v[176:179], a[64:67], v[88:91], v[176:179]
    buffer_load_dwordx4 v[36:39], v5, s[4:7], s87 offen offset:256 sc1
    v_mfma_f32_16x16x32_bf16 v[184:187], a[92:95], v[88:91], v[184:187]
    v_mfma_f32_16x16x32_bf16 v[192:195], a[176:179], v[88:91], v[192:195]
    v_mfma_f32_16x16x32_bf16 v[200:203], a[204:207], v[88:91], v[200:203]
    s_waitcnt vmcnt(7)
    v_subrev_u32 v8, s44, v8
    v_cmp_le_u32 vcc, 16, v8
    s_cbranch_vccnz Lfs_112
Lc_113:
    v_mfma_f32_16x16x32_bf16 v[204:207], a[204:207], v[92:95], v[204:207]
    buffer_load_dwordx4 v[40:43], v5, s[4:7], s91 offen sc1
    v_mfma_f32_16x16x32_bf16 v[196:199], a[176:179], v[92:95], v[196:199]
    v_mfma_f32_16x16x32_bf16 v[188:191], a[92:95], v[92:95], v[188:191]
    v_mfma_f32_16x16x32_bf16 v[180:183], a[64:67], v[92:95], v[180:183]
    v_mfma_f32_16x16x32_bf16 v[208:211], a[8:11], v[96:99], v[208:211]
    buffer_load_dwordx4 v[44:47], v5, s[4:7], s91 offen offset:256 sc1
    v_mfma_f32_16x16x32_bf16 v[216:219], a[36:39], v[96:99], v[216:219]
    v_mfma_f32_16x16x32_bf16 v[144:147], a[120:123], v[96:99], v[144:147]
    v_mfma_f32_16x16x32_bf16 v[152:155], a[148:151], v[96:99], v[152:155]
    v_mfma_f32_16x16x32_bf16 v[156:159], a[148:151], v[100:103], v[156:159]
    buffer_load_dwordx4 v[48:51], v5, s[4:7], s86 offen offset:1024 sc1
    v_mfma_f32_16x16x32_bf16 v[148:151], a[120:123], v[100:103], v[148:151]
    v_mov_b32 v224, -1
    v_lshlrev_b32 v225, 1, v1
    v_mfma_f32_16x16x32_bf16 v[220:223], a[36:39], v[100:103], v[220:223]
    s_add_u32 s92, s57, 0x0
    s_add_u32 s93, s49, 0x4000
    v_mfma_f32_16x16x32_bf16 v[212:215], a[8:11], v[100:103], v[212:215]
    v_or_b32_e64 v162, s3, 1
    v_lshrrev_b32 v166, 4, v1
    v_mfma_f32_16x16x32_bf16 v[208:211], a[64:67], v[104:107], v[208:211]
    buffer_load_dwordx4 v[52:55], v5, s[4:7], s86 offen offset:1280 sc1
    v_mfma_f32_16x16x32_bf16 v[216:219], a[92:95], v[104:107], v[216:219]
    v_and_b32 v166, 32, v166
    v_add_u32 v166, v166, v10
    v_mfma_f32_16x16x32_bf16 v[144:147], a[176:179], v[104:107], v[144:147]
    v_mov_b32 v164, 0x10000000
    v_mfma_f32_16x16x32_bf16 v[152:155], a[204:207], v[104:107], v[152:155]
    s_mov_b32 s20, 0xff000000
    s_mov_b32 s21, 0xff000000
    v_cndmask_b32_e64 v165, v164, v1, s[20:21]
    v_cndmask_b32_e64 v164, v164, v166, s[20:21]
    v_mfma_f32_16x16x32_bf16 v[156:159], a[204:207], v[108:111], v[156:159]
    buffer_load_dwordx4 v[56:59], v5, s[4:7], s90 offen offset:1024 sc1
    v_mfma_f32_16x16x32_bf16 v[148:151], a[176:179], v[108:111], v[148:151]
    v_mfma_f32_16x16x32_bf16 v[220:223], a[92:95], v[108:111], v[220:223]
    v_mfma_f32_16x16x32_bf16 v[212:215], a[64:67], v[108:111], v[212:215]
    v_mfma_f32_16x16x32_bf16 v[192:195], a[124:127], v[112:115], v[192:195]
    buffer_load_dwordx4 v[60:63], v5, s[4:7], s90 offen offset:1280 sc1
    v_mfma_f32_16x16x32_bf16 v[200:203], a[152:155], v[112:115], v[200:203]
    v_mfma_f32_16x16x32_bf16 v[204:207], a[152:155], v[116:119], v[204:207]
    v_mfma_f32_16x16x32_bf16 v[196:199], a[124:127], v[116:119], v[196:199]
    v_mfma_f32_16x16x32_bf16 v[192:195], a[180:183], v[120:123], v[192:195]
    buffer_load_dwordx4 v[64:67], v5, s[4:7], s87 offen offset:1024 sc1
    v_mfma_f32_16x16x32_bf16 v[200:203], a[208:211], v[120:123], v[200:203]
    v_mfma_f32_16x16x32_bf16 v[204:207], a[208:211], v[124:127], v[204:207]
    v_mfma_f32_16x16x32_bf16 v[196:199], a[180:183], v[124:127], v[196:199]
    v_mfma_f32_16x16x32_bf16 v[208:211], a[12:15], v[128:131], v[208:211]
    buffer_load_dwordx4 v[68:71], v5, s[4:7], s87 offen offset:1280 sc1
    v_mfma_f32_16x16x32_bf16 v[216:219], a[40:43], v[128:131], v[216:219]
    v_mfma_f32_16x16x32_bf16 v[144:147], a[124:127], v[128:131], v[144:147]
    v_mfma_f32_16x16x32_bf16 v[152:155], a[152:155], v[128:131], v[152:155]
    v_mfma_f32_16x16x32_bf16 v[156:159], a[152:155], v[132:135], v[156:159]
    buffer_load_dword v8, v10, s[4:7], s56 offen offset:512 sc1
    v_mfma_f32_16x16x32_bf16 v[148:151], a[124:127], v[132:135], v[148:151]
    s_add_u32 s44, s3, 6
    buffer_load_dwordx4 v[72:75], v5, s[4:7], s91 offen offset:1024 sc1
    v_mfma_f32_16x16x32_bf16 v[220:223], a[40:43], v[132:135], v[220:223]
    v_mfma_f32_16x16x32_bf16 v[212:215], a[12:15], v[132:135], v[212:215]
    v_mfma_f32_16x16x32_bf16 v[208:211], a[68:71], v[136:139], v[208:211]
    buffer_load_dwordx4 v[76:79], v5, s[4:7], s91 offen offset:1280 sc1
    v_mfma_f32_16x16x32_bf16 v[216:219], a[96:99], v[136:139], v[216:219]
    v_mfma_f32_16x16x32_bf16 v[144:147], a[180:183], v[136:139], v[144:147]
    v_mfma_f32_16x16x32_bf16 v[152:155], a[208:211], v[136:139], v[152:155]
    v_mfma_f32_16x16x32_bf16 v[156:159], a[208:211], v[140:143], v[156:159]
    v_mfma_f32_16x16x32_bf16 v[148:151], a[180:183], v[140:143], v[148:151]
    v_mfma_f32_16x16x32_bf16 v[220:223], a[96:99], v[140:143], v[220:223]
    v_mfma_f32_16x16x32_bf16 v[212:215], a[68:71], v[140:143], v[212:215]
    s_waitcnt vmcnt(17)
    v_mfma_f32_16x16x32_bf16 v[192:195], a[128:131], v[240:243], v[192:195]
    v_mfma_f32_16x16x32_bf16 v[200:203], a[156:159], v[240:243], v[200:203]
    s_waitcnt vmcnt(16)
    v_mfma_f32_16x16x32_bf16 v[204:207], a[156:159], v[244:247], v[204:207]
    v_mfma_f32_16x16x32_bf16 v[196:199], a[128:131], v[244:247], v[196:199]
    s_waitcnt vmcnt(15)
    v_mfma_f32_16x16x32_bf16 v[192:195], a[184:187], v[248:251], v[192:195]
    s_add_u32 m0, s55, 0x7000
    s_add_u32 s76, s96, 0x7000
    buffer_load_dwordx4 v7, s[4:7], s76 offen lds
    v_mfma_f32_16x16x32_bf16 v[200:203], a[212:215], v[248:251], v[200:203]
    s_waitcnt vmcnt(15)
    v_mfma_f32_16x16x32_bf16 v[204:207], a[212:215], v[252:255], v[204:207]
    v_mfma_f32_16x16x32_bf16 v[196:199], a[184:187], v[252:255], v[196:199]
    s_waitcnt vmcnt(13)
    v_mfma_f32_16x16x32_bf16 v[208:211], a[16:19], v[32:35], v[208:211]
    buffer_load_dwordx4 v7, s[4:7], s76 offen offset:1024 lds
    v_mfma_f32_16x16x32_bf16 v[216:219], a[44:47], v[32:35], v[216:219]
    v_mfma_f32_16x16x32_bf16 v[144:147], a[128:131], v[32:35], v[144:147]
    v_mfma_f32_16x16x32_bf16 v[152:155], a[156:159], v[32:35], v[152:155]
    s_waitcnt vmcnt(4)
    v_subrev_u32 v8, s44, v8
    v_cmp_le_u32 vcc, 16, v8
    s_cbranch_vccnz Lfs_114
Lc_115:
    s_barrier
    v_mfma_f32_16x16x32_bf16 v[156:159], a[156:159], v[36:39], v[156:159]
    buffer_load_dwordx4 v[80:83], v5, s[4:7], s86 offen offset:2048 sc1
    v_mfma_f32_16x16x32_bf16 v[148:151], a[128:131], v[36:39], v[148:151]
    buffer_load_dwordx4 v[84:87], v5, s[4:7], s86 offen offset:2304 sc1
    buffer_load_dwordx4 v[88:91], v5, s[4:7], s90 offen offset:2048 sc1
    buffer_load_dwordx4 v[92:95], v5, s[4:7], s90 offen offset:2304 sc1
    buffer_load_dwordx4 v[96:99], v5, s[4:7], s87 offen offset:2048 sc1
    buffer_load_dwordx4 v7, s[4:7], s76 offen offset:2048 lds
    v_mfma_f32_16x16x32_bf16 v[220:223], a[44:47], v[36:39], v[220:223]
    v_mfma_f32_16x16x32_bf16 v[212:215], a[16:19], v[36:39], v[212:215]
    v_mfma_f32_16x16x32_bf16 v[208:211], a[72:75], v[40:43], v[208:211]
    buffer_load_dwordx4 v[100:103], v5, s[4:7], s87 offen offset:2304 sc1
    v_mfma_f32_16x16x32_bf16 v[216:219], a[100:103], v[40:43], v[216:219]
    buffer_load_dwordx4 v7, s[4:7], s76 offen offset:3072 lds
    s_add_u32 m0, s55, 0x8000
    s_add_u32 s76, s76, 4096
    v_mfma_f32_16x16x32_bf16 v[144:147], a[184:187], v[40:43], v[144:147]
    v_mfma_f32_16x16x32_bf16 v[152:155], a[212:215], v[40:43], v[152:155]
    v_mfma_f32_16x16x32_bf16 v[156:159], a[212:215], v[44:47], v[156:159]
    buffer_load_dwordx4 v[104:107], v5, s[4:7], s91 offen offset:2048 sc1
    v_mfma_f32_16x16x32_bf16 v[148:151], a[184:187], v[44:47], v[148:151]
    v_mfma_f32_16x16x32_bf16 v[220:223], a[100:103], v[44:47], v[220:223]
    buffer_load_dwordx4 v7, s[4:7], s76 offen lds
    buffer_load_dwordx4 v[108:111], v5, s[4:7], s91 offen offset:2304 sc1
    v_mfma_f32_16x16x32_bf16 v[212:215], a[72:75], v[44:47], v[212:215]
    v_mfma_f32_16x16x32_bf16 v[192:195], a[132:135], v[48:51], v[192:195]
    v_mfma_f32_16x16x32_bf16 v[200:203], a[160:163], v[48:51], v[200:203]
    v_mfma_f32_16x16x32_bf16 v[204:207], a[160:163], v[52:55], v[204:207]
    buffer_load_dwordx4 v7, s[4:7], s76 offen offset:1024 lds
    v_mfma_f32_16x16x32_bf16 v[196:199], a[132:135], v[52:55], v[196:199]
    v_mfma_f32_16x16x32_bf16 v[192:195], a[188:191], v[56:59], v[192:195]
    v_mfma_f32_16x16x32_bf16 v[200:203], a[216:219], v[56:59], v[200:203]
    v_mfma_f32_16x16x32_bf16 v[204:207], a[216:219], v[60:63], v[204:207]
    buffer_load_dwordx4 v7, s[4:7], s76 offen offset:2048 lds
    v_mfma_f32_16x16x32_bf16 v[196:199], a[188:191], v[60:63], v[196:199]
    v_mfma_f32_16x16x32_bf16 v[208:211], a[20:23], v[64:67], v[208:211]
    v_mfma_f32_16x16x32_bf16 v[216:219], a[48:51], v[64:67], v[216:219]
    v_mfma_f32_16x16x32_bf16 v[144:147], a[132:135], v[64:67], v[144:147]
    s_add_u32 m0, s55, 0x0
    s_add_u32 s75, s96, 0x0
    buffer_load_dwordx4 v7, s[4:7], s75 offen lds
    v_mfma_f32_16x16x32_bf16 v[152:155], a[160:163], v[64:67], v[152:155]
    v_mfma_f32_16x16x32_bf16 v[156:159], a[160:163], v[68:71], v[156:159]
    v_mfma_f32_16x16x32_bf16 v[148:151], a[132:135], v[68:71], v[148:151]
    v_mfma_f32_16x16x32_bf16 v[220:223], a[48:51], v[68:71], v[220:223]
    buffer_load_dwordx4 v7, s[4:7], s75 offen offset:1024 lds
    v_mfma_f32_16x16x32_bf16 v[212:215], a[20:23], v[68:71], v[212:215]
    s_waitcnt vmcnt(18)
    v_mfma_f32_16x16x32_bf16 v[208:211], a[76:79], v[72:75], v[208:211]
    v_mfma_f32_16x16x32_bf16 v[216:219], a[104:107], v[72:75], v[216:219]
    v_mfma_f32_16x16x32_bf16 v[144:147], a[188:191], v[72:75], v[144:147]
    v_mfma_f32_16x16x32_bf16 v[152:155], a[216:219], v[72:75], v[152:155]
    s_waitcnt vmcnt(17)
    v_mfma_f32_16x16x32_bf16 v[156:159], a[216:219], v[76:79], v[156:159]
    buffer_load_dwordx4 v7, s[4:7], s75 offen offset:2048 lds
    v_mfma_f32_16x16x32_bf16 v[148:151], a[188:191], v[76:79], v[148:151]
    v_mfma_f32_16x16x32_bf16 v[220:223], a[104:107], v[76:79], v[220:223]
    v_mfma_f32_16x16x32_bf16 v[212:215], a[76:79], v[76:79], v[212:215]
    s_waitcnt vmcnt(15)
    v_mfma_f32_16x16x32_bf16 v[192:195], a[136:139], v[80:83], v[192:195]
    buffer_load_dwordx4 v7, s[4:7], s75 offen offset:3072 lds
    s_add_u32 m0, s55, 0x1000
    s_add_u32 s75, s75, 4096
    v_mfma_f32_16x16x32_bf16 v[200:203], a[164:167], v[80:83], v[200:203]
    s_waitcnt vmcnt(15)
    v_mfma_f32_16x16x32_bf16 v[204:207], a[164:167], v[84:87], v[204:207]
    v_mfma_f32_16x16x32_bf16 v[196:199], a[136:139], v[84:87], v[196:199]
    s_waitcnt vmcnt(14)
    v_mfma_f32_16x16x32_bf16 v[192:195], a[192:195], v[88:91], v[192:195]
    buffer_load_dwordx4 v7, s[4:7], s75 offen lds
    v_mfma_f32_16x16x32_bf16 v[200:203], a[220:223], v[88:91], v[200:203]
    s_waitcnt vmcnt(14)
    v_mfma_f32_16x16x32_bf16 v[204:207], a[220:223], v[92:95], v[204:207]
    v_mfma_f32_16x16x32_bf16 v[196:199], a[192:195], v[92:95], v[196:199]
    s_waitcnt vmcnt(13)
    v_mfma_f32_16x16x32_bf16 v[208:211], a[24:27], v[96:99], v[208:211]
    buffer_load_dwordx4 v7, s[4:7], s75 offen offset:1024 lds
    v_mfma_f32_16x16x32_bf16 v[216:219], a[52:55], v[96:99], v[216:219]
    s_waitcnt vmcnt(12)
    v_mfma_f32_16x16x32_bf16 v[220:223], a[52:55], v[100:103], v[220:223]
    ds_write_b128 v28, v[192:195] offset:0
    v_mfma_f32_16x16x32_bf16 v[212:215], a[24:27], v[100:103], v[212:215]
    ds_write_b128 v28, v[196:199] offset:1024
    s_waitcnt vmcnt(10)
    v_mfma_f32_16x16x32_bf16 v[208:211], a[80:83], v[104:107], v[208:211]
    buffer_load_dwordx4 v7, s[4:7], s75 offen offset:2048 lds
    buffer_store_dword v224, v225, s[4:7], s57 offen
    v_mfma_f32_16x16x32_bf16 v[216:219], a[108:111], v[104:107], v[216:219]
    ds_write_b128 v28, v[200:203] offset:2048
    s_waitcnt vmcnt(10)
    v_mfma_f32_16x16x32_bf16 v[220:223], a[108:111], v[108:111], v[220:223]
    ds_write_b128 v28, v[204:207] offset:3072
    v_mfma_f32_16x16x32_bf16 v[212:215], a[80:83], v[108:111], v[212:215]
    v_mfma_f32_16x16x32_bf16 v[144:147], a[136:139], v[96:99], v[144:147]
    v_mfma_f32_16x16x32_bf16 v[152:155], a[164:167], v[96:99], v[152:155]
    v_mfma_f32_16x16x32_bf16 v[156:159], a[164:167], v[100:103], v[156:159]
    ds_write_b128 v29, v[208:211] offset:0
    v_mfma_f32_16x16x32_bf16 v[148:151], a[136:139], v[100:103], v[148:151]
    s_nop 2
    ds_write_b128 v29, v[212:215] offset:1024
    v_mfma_f32_16x16x32_bf16 v[144:147], a[192:195], v[104:107], v[144:147]
    ds_write_b128 v29, v[216:219] offset:2048
    v_mfma_f32_16x16x32_bf16 v[152:155], a[220:223], v[104:107], v[152:155]
    ds_write_b128 v29, v[220:223] offset:3072
    v_mfma_f32_16x16x32_bf16 v[156:159], a[220:223], v[108:111], v[156:159]
    v_mfma_f32_16x16x32_bf16 v[148:151], a[192:195], v[108:111], v[148:151]
    v_mfma_f32_16x16x32_bf16 v[176:179], a[12:15], v[112:115], v[176:179]
    v_mfma_f32_16x16x32_bf16 v[184:187], a[40:43], v[112:115], v[184:187]
    v_mfma_f32_16x16x32_bf16 v[188:191], a[40:43], v[116:119], v[188:191]
    ds_write_b128 v30, v[144:147] offset:0
    v_mfma_f32_16x16x32_bf16 v[180:183], a[12:15], v[116:119], v[180:183]
    s_nop 2
    ds_write_b128 v30, v[148:151] offset:1024
    v_mfma_f32_16x16x32_bf16 v[176:179], a[68:71], v[120:123], v[176:179]
    ds_write_b128 v30, v[152:155] offset:2048
    v_mfma_f32_16x16x32_bf16 v[184:187], a[96:99], v[120:123], v[184:187]
    ds_write_b128 v30, v[156:159] offset:3072
    v_mfma_f32_16x16x32_bf16 v[188:191], a[96:99], v[124:127], v[188:191]
    v_mfma_f32_16x16x32_bf16 v[180:183], a[68:71], v[124:127], v[180:183]
    v_mfma_f32_16x16x32_bf16 v[176:179], a[16:19], v[240:243], v[176:179]
    v_mfma_f32_16x16x32_bf16 v[184:187], a[44:47], v[240:243], v[184:187]
    s_waitcnt lgkmcnt(0)
    s_barrier
    v_mfma_f32_16x16x32_bf16 v[188:191], a[44:47], v[244:247], v[188:191]
    ds_read_b128 v[192:195], v31 offset:0
    ds_read_b128 v[208:211], v31 offset:4096
    v_mfma_f32_16x16x32_bf16 v[180:183], a[16:19], v[244:247], v[180:183]
    ds_read_b128 v[144:147], v31 offset:8192
    ds_read_b128 v[196:199], v31 offset:1024
    v_mfma_f32_16x16x32_bf16 v[176:179], a[72:75], v[248:251], v[176:179]
    ds_read_b128 v[212:215], v31 offset:5120
    ds_read_b128 v[148:151], v31 offset:9216
    v_mfma_f32_16x16x32_bf16 v[184:187], a[100:103], v[248:251], v[184:187]
    ds_read_b128 v[200:203], v31 offset:2048
    ds_read_b128 v[216:219], v31 offset:6144
    v_mfma_f32_16x16x32_bf16 v[188:191], a[100:103], v[252:255], v[188:191]
    ds_read_b128 v[152:155], v31 offset:10240
    ds_read_b128 v[204:207], v31 offset:3072
    v_mfma_f32_16x16x32_bf16 v[180:183], a[72:75], v[252:255], v[180:183]
    ds_read_b128 v[220:223], v31 offset:7168
    ds_read_b128 v[156:159], v31 offset:11264
    v_mfma_f32_16x16x32_bf16 v[176:179], a[20:23], v[48:51], v[176:179]
    s_waitcnt lgkmcnt(10)
    v_add_f32 v192, v192, v208
    v_add_f32 v193, v193, v209
    v_mfma_f32_16x16x32_bf16 v[184:187], a[48:51], v[48:51], v[184:187]
    v_add_f32 v194, v194, v210
    v_add_f32 v195, v195, v211
    v_mfma_f32_16x16x32_bf16 v[188:191], a[48:51], v[52:55], v[188:191]
    s_waitcnt lgkmcnt(9)
    v_add_f32 v192, v192, v144
    v_add_f32 v193, v193, v145
    v_mfma_f32_16x16x32_bf16 v[180:183], a[20:23], v[52:55], v[180:183]
    v_add_f32 v194, v194, v146
    v_add_f32 v195, v195, v147
    v_mfma_f32_16x16x32_bf16 v[176:179], a[76:79], v[56:59], v[176:179]
    s_waitcnt lgkmcnt(7)
    v_add_f32 v196, v196, v212
    v_add_f32 v197, v197, v213
    v_mfma_f32_16x16x32_bf16 v[184:187], a[104:107], v[56:59], v[184:187]
    v_add_f32 v198, v198, v214
    v_add_f32 v199, v199, v215
    v_mfma_f32_16x16x32_bf16 v[188:191], a[104:107], v[60:63], v[188:191]
    s_waitcnt lgkmcnt(6)
    v_add_f32 v196, v196, v148
    v_add_f32 v197, v197, v149
    v_mfma_f32_16x16x32_bf16 v[180:183], a[76:79], v[60:63], v[180:183]
    v_add_f32 v198, v198, v150
    v_add_f32 v199, v199, v151
    v_mfma_f32_16x16x32_bf16 v[176:179], a[24:27], v[80:83], v[176:179]
    s_waitcnt lgkmcnt(4)
    v_add_f32 v200, v200, v216
    v_add_f32 v201, v201, v217
    v_mfma_f32_16x16x32_bf16 v[184:187], a[52:55], v[80:83], v[184:187]
    v_add_f32 v202, v202, v218
    v_add_f32 v203, v203, v219
    v_mfma_f32_16x16x32_bf16 v[188:191], a[52:55], v[84:87], v[188:191]
    s_waitcnt vmcnt(0)
    buffer_store_dword v162, v6, s[4:7], s100 offen offset:256
    v_mfma_f32_16x16x32_bf16 v[180:183], a[24:27], v[84:87], v[180:183]
    s_waitcnt lgkmcnt(3)
    v_add_f32 v200, v200, v152
    v_add_f32 v201, v201, v153
    v_mfma_f32_16x16x32_bf16 v[176:179], a[80:83], v[88:91], v[176:179]
    v_add_f32 v202, v202, v154
    v_add_f32 v203, v203, v155
    v_mfma_f32_16x16x32_bf16 v[184:187], a[108:111], v[88:91], v[184:187]
    s_waitcnt lgkmcnt(1)
    v_add_f32 v204, v204, v220
    v_add_f32 v205, v205, v221
    v_mfma_f32_16x16x32_bf16 v[188:191], a[108:111], v[92:95], v[188:191]
    v_add_f32 v206, v206, v222
    v_add_f32 v207, v207, v223
    v_mfma_f32_16x16x32_bf16 v[180:183], a[80:83], v[92:95], v[180:183]
    s_waitcnt lgkmcnt(0)
    v_add_f32 v204, v204, v156
    v_add_f32 v205, v205, v157
    v_add_f32 v206, v206, v158
    v_add_f32 v207, v207, v159
    v_pk_add_f32 v[176:177], v[176:177], v[192:193]
    v_pk_add_f32 v[178:179], v[178:179], v[194:195]
    v_cvt_pk_bf16_f32 v12, v176, v177
    v_cvt_pk_bf16_f32 v13, v178, v179
    v_pk_add_f32 v[180:181], v[180:181], v[196:197]
    v_pk_add_f32 v[182:183], v[182:183], v[198:199]
    v_cvt_pk_bf16_f32 v14, v180, v181
    v_cvt_pk_bf16_f32 v15, v182, v183
    s_nop 0
    v_permlane16_swap_b32 v12, v14
    v_permlane16_swap_b32 v13, v15
    buffer_store_dwordx4 v[12:15], v1, s[4:7], s92 offen
    v_pk_add_f32 v[184:185], v[184:185], v[200:201]
    v_pk_add_f32 v[186:187], v[186:187], v[202:203]
    v_cvt_pk_bf16_f32 v16, v184, v185
    v_cvt_pk_bf16_f32 v17, v186, v187
    v_pk_add_f32 v[188:189], v[188:189], v[204:205]
    v_pk_add_f32 v[190:191], v[190:191], v[206:207]
    v_cvt_pk_bf16_f32 v18, v188, v189
    v_cvt_pk_bf16_f32 v19, v190, v191
    s_nop 0
    v_permlane16_swap_b32 v16, v18
    v_permlane16_swap_b32 v17, v19
    buffer_store_dwordx4 v[16:19], v1, s[4:7], s92 offen offset:1024
    v_dot2_f32_bf16 v160, v12, s23, 0
    v_dot2_f32_bf16 v161, v12, v12, 0
    v_dot2_f32_bf16 v160, v13, s23, v160
    v_dot2_f32_bf16 v161, v13, v13, v161
    buffer_store_dwordx4 v[12:15], v165, s[4:7], s50 offen sc1
    v_dot2_f32_bf16 v160, v14, s23, v160
    v_dot2_f32_bf16 v161, v14, v14, v161
    v_dot2_f32_bf16 v160, v15, s23, v160
    v_dot2_f32_bf16 v161, v15, v15, v161
    buffer_store_dwordx4 v[16:19], v165, s[4:7], s50 offen offset:1024 sc1
    v_dot2_f32_bf16 v160, v16, s23, v160
    v_dot2_f32_bf16 v161, v16, v16, v161
    v_dot2_f32_bf16 v160, v17, s23, v160
    v_dot2_f32_bf16 v161, v17, v17, v161
    v_dot2_f32_bf16 v160, v18, s23, v160
    v_dot2_f32_bf16 v161, v18, v18, v161
    v_dot2_f32_bf16 v160, v19, s23, v160
    v_dot2_f32_bf16 v161, v19, v19, v161
    s_nop 2
    v_permlane32_swap_b32 v160, v161
    v_add_f32 v160, v160, v161
    buffer_store_dword v160, v2, s[4:7], s93 offen
    buffer_store_dword v160, v164, s[4:7], s51 offen sc1
LstS1_1f:
    s_add_u32 s88, s37, 0x4000
    s_waitcnt lgkmcnt(0)
    s_barrier
    s_add_u32 s96, s38, s55
    s_min_u32 s92, s24, 2
    s_lshl_b32 s92, s92, 10
    s_add_u32 m0, s92, 86016
    s_lshl_b32 s22, s25, 12
    s_add_u32 s92, s92, s22
    s_add_u32 s92, s92, 0x120000
    s_add_u32 s92, s92, s26
    buffer_load_dwordx4 v1, s[4:7], s92 offen lds
    s_add_u32 m0, s55, 0xe000
    s_add_u32 s61, s96, 0xe000
    buffer_load_dwordx4 v7, s[4:7], s61 offen lds
    buffer_load_dwordx4 v7, s[4:7], s61 offen offset:1024 lds
    buffer_load_dwordx4 v7, s[4:7], s61 offen offset:2048 lds
    buffer_load_dwordx4 v7, s[4:7], s61 offen offset:3072 lds
    s_add_u32 m0, s55, 0xf000
    s_add_u32 s61, s61, 4096
    buffer_load_dwordx4 v7, s[4:7], s61 offen lds
    buffer_load_dwordx4 v7, s[4:7], s61 offen offset:1024 lds
    buffer_load_dwordx4 v7, s[4:7], s61 offen offset:2048 lds
    buffer_load_dword v8, v11, s[4:7], s101 offen offset:256 sc1
    s_add_u32 s63, s3, 1
    s_lshl_b32 s92, s55, 1
    v_add_u32 v31, s92, v1
    v_add_u32 v29, 57344, v1
    s_lshl_b32 s84, s24, 12
    s_add_u32 s84, s84, 90112
    v_add_u32 v28, s84, v1
    v_mov_b32 v252, 0
    v_mov_b32 v253, 0
    v_mov_b32 v254, 0
    v_mov_b32 v255, 0
    ds_write_b128 v28, v[252:255] offset:0
    ds_write_b128 v28, v[252:255] offset:1024
    ds_read_b128 a[224:227], v1 offset:0
    ds_read_b128 a[228:231], v1 offset:1024
    ds_read_b128 a[232:235], v1 offset:2048
    ds_read_b128 a[236:239], v1 offset:3072
    ds_read_b128 a[240:243], v1 offset:4096
    ds_read_b128 a[244:247], v1 offset:5120
    ds_read_b128 a[248:251], v1 offset:6144
    buffer_load_dword v9, v11, s[4:7], s101 offen offset:256 sc1
Lp_117:
    s_waitcnt vmcnt(1)
    v_subrev_u32 v8, s63, v8
    v_cmp_le_u32 vcc, 16, v8
    s_cbranch_vccz Lo_118
    buffer_load_dword v8, v11, s[4:7], s101 offen offset:256 sc1
    s_waitcnt vmcnt(1)
    v_subrev_u32 v9, s63, v9
    v_cmp_le_u32 vcc, 16, v9
    s_cbranch_vccz Lo_118
    buffer_load_dword v9, v11, s[4:7], s101 offen offset:256 sc1
    s_sub_u32 s30, s30, 1
    s_cbranch_scc0 Lp_117
    s_mov_b32 s30, 0
Lo_118:
    buffer_load_dwordx4 v[32:35], v1, s[4:7], s36 offen sc1
    buffer_load_dwordx4 v[36:39], v1, s[4:7], s36 offen offset:1024 sc1
    buffer_load_dwordx4 v[40:43], v0, s[4:7], s36 offen offset:3072 sc1
    s_add_u32 s62, s36, 0x2000
    buffer_load_dwordx4 v[44:47], v1, s[4:7], s62 offen sc1
    s_add_u32 s62, s36, 0xe000
    buffer_load_dwordx4 v[48:51], v1, s[4:7], s62 offen sc1
    buffer_load_dwordx4 v[52:55], v1, s[4:7], s62 offen offset:1024 sc1
    buffer_load_dwordx4 v[56:59], v0, s[4:7], s62 offen offset:3072 sc1
    s_add_u32 s62, s36, 0x10000
    buffer_load_dwordx4 v[60:63], v1, s[4:7], s62 offen sc1
    s_waitcnt lgkmcnt(3)
    s_waitcnt vmcnt(7)
    v_cmp_u_f32 vcc, v32, v32
    s_cbranch_vccnz Lfc_119
Lc_120:
    s_barrier
    v_mfma_f32_32x32x16_bf16 v[144:159], a[224:227], v[32:35], 0
    ds_read_b128 a[252:255], v1 offset:7168
    s_waitcnt vmcnt(6)
    v_cmp_u_f32 vcc, v36, v36
    s_add_u32 s62, s36, 0x1c000
    buffer_load_dwordx4 v[64:67], v1, s[4:7], s62 offen sc1
    v_mfma_f32_32x32x16_bf16 v[160:175], a[228:231], v[32:35], 0
    ds_read_b128 a[224:227], v29 offset:3072
    s_cbranch_vccnz Lfc_122
Lc_123:
    s_add_u32 s89, s26, 0x10000
    s_add_u32 s90, s26, 0x17000
    s_add_u32 s89, s89, s55
    v_and_b32 v25, 0x380, v1
    v_mfma_f32_32x32x16_bf16 v[144:159], a[232:235], v[36:39], v[144:159]
    ds_read_b128 a[228:231], v1 offset:8192
    s_waitcnt vmcnt(5)
    v_cmp_u_f32 vcc, v40, v44
    buffer_load_dwordx4 v[68:71], v1, s[4:7], s62 offen offset:1024 sc1
    v_add_u32 v25, v25, v10
    v_lshlrev_b32 v25, 2, v25
    v_mfma_f32_32x32x16_bf16 v[160:175], a[236:239], v[36:39], v[160:175]
    ds_read_b128 a[232:235], v1 offset:9216
    s_cbranch_vccnz Lfc_125
Lc_126:
    v_add_u32 v25, 384, v25
    v_lshrrev_b32 v30, 2, v1
    v_and_b32 v30, 0x80, v30
    s_waitcnt lgkmcnt(3)
    v_mfma_f32_32x32x16_bf16 v[144:159], a[240:243], v[40:43], v[144:159]
    ds_read_b128 a[236:239], v29 offset:4096
    buffer_load_dword v192, v2, s[4:7], s88 offen sc1
    buffer_load_dwordx4 v[72:75], v0, s[4:7], s62 offen offset:3072 sc1
    v_lshl_add_u32 v30, v10, 2, v30
    v_mfma_f32_32x32x16_bf16 v[160:175], a[244:247], v[40:43], v[160:175]
    ds_read_b128 a[240:243], v1 offset:10240
    buffer_load_dword v193, v2, s[4:7], s88 offen offset:256 sc1
    v_add_u32 v30, s84, v30
    v_mfma_f32_32x32x16_bf16 v[144:159], a[248:251], v[44:47], v[144:159]
    ds_read_b128 a[244:247], v1 offset:11264
    buffer_load_dword v194, v2, s[4:7], s88 offen offset:512 sc1
    buffer_load_dword v195, v2, s[4:7], s88 offen offset:768 sc1
    s_add_u32 s62, s36, 0x1e000
    buffer_load_dwordx4 v[76:79], v1, s[4:7], s62 offen sc1
    v_mfma_f32_32x32x16_bf16 v[160:175], a[252:255], v[44:47], v[160:175]
    ds_read_b128 a[248:251], v29 offset:5120
    s_waitcnt vmcnt(10)
    v_cmp_u_f32 vcc, v48, v52
    buffer_load_dword v196, v2, s[4:7], s88 offen offset:1024 sc1
    s_waitcnt lgkmcnt(3)
    v_mfma_f32_32x32x16_bf16 v[176:191], v[44:47], a[224:227], 0
    ds_read_b128 a[252:255], v1 offset:12288
    s_cbranch_vccnz Lfc_128
Lc_129:
    buffer_load_dword v197, v2, s[4:7], s88 offen offset:1280 sc1
    v_mfma_f32_32x32x16_bf16 v[144:159], a[228:231], v[48:51], v[144:159]
    ds_read_b128 a[224:227], v1 offset:13312
    buffer_load_dword v198, v2, s[4:7], s88 offen offset:1536 sc1
    s_add_u32 s62, s36, 0x2a000
    buffer_load_dwordx4 v[80:83], v1, s[4:7], s62 offen sc1
    v_mfma_f32_32x32x16_bf16 v[160:175], a[232:235], v[48:51], v[160:175]
    ds_read_b128 a[228:231], v29 offset:6144
    buffer_load_dword v199, v2, s[4:7], s88 offen offset:1792 sc1
    buffer_load_dword v200, v2, s[4:7], s88 offen offset:2048 sc1
    v_mfma_f32_32x32x16_bf16 v[176:191], v[48:51], a[236:239], v[176:191]
    ds_read_b128 a[232:235], v1 offset:14336
    buffer_load_dword v201, v2, s[4:7], s88 offen offset:2304 sc1
    s_waitcnt lgkmcnt(3)
    v_mfma_f32_32x32x16_bf16 v[144:159], a[240:243], v[52:55], v[144:159]
    ds_read_b128 a[236:239], v1 offset:15360
    buffer_load_dword v202, v2, s[4:7], s88 offen offset:2560 sc1
    buffer_load_dwordx4 v[84:87], v1, s[4:7], s62 offen offset:1024 sc1
    v_mfma_f32_32x32x16_bf16 v[160:175], a[244:247], v[52:55], v[160:175]
    ds_read_b128 a[240:243], v29 offset:7168
    s_waitcnt vmcnt(17)
    v_cmp_u_f32 vcc, v56, v60
    buffer_load_dword v203, v2, s[4:7], s88 offen offset:2816 sc1
    v_mfma_f32_32x32x16_bf16 v[176:191], v[52:55], a[248:251], v[176:191]
    ds_read_b128 a[244:247], v1 offset:16384
    s_cbranch_vccnz Lfc_131
Lc_132:
    s_add_u32 m0, s84, 2048
    s_nop 0
    buffer_load_dwordx4 v25, s[4:7], s89 offen sc1 lds
    buffer_load_dword v204, v2, s[4:7], s88 offen offset:3072 sc1
    buffer_load_dword v205, v2, s[4:7], s88 offen offset:3328 sc1
    v_mfma_f32_32x32x16_bf16 v[144:159], a[252:255], v[56:59], v[144:159]
    ds_read_b128 a[248:251], v1 offset:17408
    s_sub_u32 m0, s84, 256
    s_nop 0
    buffer_load_dwordx4 v25, s[4:7], s89 offen offset:3072 sc1 lds
    buffer_load_dwordx4 v[88:91], v0, s[4:7], s62 offen offset:3072 sc1
    s_waitcnt lgkmcnt(3)
    v_mfma_f32_32x32x16_bf16 v[160:175], a[224:227], v[56:59], v[160:175]
    ds_read_b128 a[252:255], v29 offset:8192
    buffer_load_dword v208, v2, s[4:7], s90 offen sc1
    v_mfma_f32_32x32x16_bf16 v[176:191], v[56:59], a[228:231], v[176:191]
    ds_read_b128 a[224:227], v1 offset:18432
    buffer_load_dword v209, v2, s[4:7], s90 offen offset:256 sc1
    v_lshrrev_b32 v59, 2, v2
    v_not_b32 v59, v59
    v_mov_b32 v58, 0xff000000
    v_mfma_f32_32x32x16_bf16 v[144:159], a[232:235], v[60:63], v[144:159]
    ds_read_b128 a[228:231], v1 offset:19456
    buffer_load_dword v210, v2, s[4:7], s90 offen offset:512 sc1
    s_add_u32 s62, s36, 0x2c000
    buffer_load_dwordx4 v[92:95], v1, s[4:7], s62 offen sc1
    buffer_load_dword v211, v2, s[4:7], s90 offen offset:640 sc1
    v_mfma_f32_32x32x16_bf16 v[160:175], a[236:239], v[60:63], v[160:175]
    ds_read_b128 a[232:235], v29 offset:9216
    s_lshr_b32 s22, s24, 1
    s_lshl_b32 s87, s22, 10
    s_sub_u32 s20, s22, 1
    s_sub_u32 s21, 0, s22
    s_and_b32 s22, s24, 1
    s_lshl3_add_u32 s87, s22, s87
    s_sub_u32 s18, 0, s22
    s_mov_b32 s19, s18
    s_andn2_b64 s[16:17], s[20:21], s[18:19]
    s_and_b64 s[18:19], s[20:21], s[18:19]
    s_waitcnt lgkmcnt(3)
    v_mfma_f32_32x32x16_bf16 v[176:191], v[60:63], a[240:243], v[176:191]
    ds_read_b128 a[236:239], v1 offset:20480
    v_and_b32 v9, 0x70, v1
    v_and_b32 v5, 64, v2
    v_xor_b32 v9, v9, v5
    v_lshrrev_b32 v5, 7, v1
    v_mul_u32_u24 v5, 896, v5
    s_waitcnt vmcnt(27)
    v_mfma_f32_32x32x16_bf16 v[144:159], a[244:247], v[64:67], v[144:159]
    ds_read_b128 a[240:243], v1 offset:21504
    s_add_u32 s62, s36, 0x38000
    buffer_load_dwordx4 v[96:99], v1, s[4:7], s62 offen sc1
    v_add_u32 v9, v9, v5
    v_add_u32 v5, 6144, v9
    v_mfma_f32_32x32x16_bf16 v[160:175], a[248:251], v[64:67], v[160:175]
    ds_read_b128 a[244:247], v29 offset:10240
    s_lshr_b32 s64, s25, 1
    s_lshl_b32 s64, s64, 7
    s_mul_i32 s22, s24, 100352
    s_add_u32 s64, s64, s22
    s_cmp_ge_u32 s25, 14
    s_cselect_b32 s64, 0x10000000, s64
    s_lshl_b32 s59, s55, 1
    v_mfma_f32_32x32x16_bf16 v[176:191], v[64:67], a[252:255], v[176:191]
    ds_read_b128 a[248:251], v1 offset:22528
    s_add_u32 s87, s87, 104448
    s_lshl_b32 s86, s24, 12
    s_add_u32 s84, s86, 90112
    s_sub_u32 s86, s86, 4096
    s_waitcnt lgkmcnt(3)
    s_waitcnt vmcnt(27)
    v_mfma_f32_32x32x16_bf16 v[144:159], a[224:227], v[68:71], v[144:159]
    ds_read_b128 a[252:255], v1 offset:23552
    buffer_load_dwordx4 v[100:103], v1, s[4:7], s62 offen offset:1024 sc1
    s_and_b32 s86, s86, 0x3000
    s_add_u32 s86, s86, 90112
    s_lshl_b32 s93, s24, 7
    v_mfma_f32_32x32x16_bf16 v[160:175], a[228:231], v[68:71], v[160:175]
    ds_read_b128 a[224:227], v29 offset:11264
    s_add_u32 s85, s93, 102016
    s_add_u32 s93, s93, 89216
    s_mov_b32 s94, 0xff000000
    s_mov_b32 s95, 0xff000000
    s_and_b32 s70, s31, 0xff
    v_mfma_f32_32x32x16_bf16 v[176:191], v[68:71], a[232:235], v[176:191]
    ds_read_b128 a[228:231], v1 offset:24576
    s_mov_b32 s71, s70
    v_lshrrev_b32 v59, v59, v58
    v_bfe_u32 v58, v1, 9, 1
    v_lshlrev_b32 v58, 2, v58
    v_lshrrev_b32 v59, v58, v59
    s_waitcnt vmcnt(26)
    v_mfma_f32_32x32x16_bf16 v[144:159], a[236:239], v[72:75], v[144:159]
    ds_read_b128 a[232:235], v1 offset:25600
    buffer_load_dwordx4 v[104:107], v0, s[4:7], s62 offen offset:3072 sc1
    v_not_b32 v59, v59
    v_bfe_i32 v44, v59, 0, 1
    s_waitcnt lgkmcnt(3)
    v_mfma_f32_32x32x16_bf16 v[160:175], a[240:243], v[72:75], v[160:175]
    ds_read_b128 a[236:239], v29 offset:12288
    v_bfe_i32 v45, v59, 1, 1
    v_bfe_i32 v46, v59, 2, 1
    v_bfe_i32 v47, v59, 3, 1
    v_bfe_i32 v48, v59, 8, 1
    v_bfe_i32 v49, v59, 9, 1
    v_mfma_f32_32x32x16_bf16 v[176:191], v[72:75], a[244:247], v[176:191]
    ds_read_b128 a[240:243], v1 offset:26624
    v_bfe_i32 v50, v59, 10, 1
    v_bfe_i32 v51, v59, 11, 1
    v_bfe_i32 v52, v59, 16, 1
    v_bfe_i32 v53, v59, 17, 1
    v_bfe_i32 v54, v59, 18, 1
    s_waitcnt vmcnt(23)
    v_mfma_f32_32x32x16_bf16 v[144:159], a[248:251], v[76:79], v[144:159]
    ds_read_b128 a[244:247], v1 offset:27648
    s_add_u32 s62, s36, 0x3a000
    buffer_load_dwordx4 v[108:111], v1, s[4:7], s62 offen sc1
    v_bfe_i32 v55, v59, 19, 1
    v_bfe_i32 v56, v59, 24, 1
    v_mfma_f32_32x32x16_bf16 v[160:175], a[252:255], v[76:79], v[160:175]
    ds_read_b128 a[248:251], v1 offset:28672
    v_bfe_i32 v57, v59, 25, 1
    v_bfe_i32 v58, v59, 26, 1
    v_bfe_i32 v59, v59, 27, 1
    s_waitcnt lgkmcnt(3)
    v_mfma_f32_32x32x16_bf16 v[176:191], v[76:79], a[224:227], v[176:191]
    ds_read_b128 a[252:255], v1 offset:29696
    s_waitcnt vmcnt(20)
    v_mfma_f32_32x32x16_bf16 v[144:159], a[228:231], v[80:83], v[144:159]
    ds_read_b128 a[224:227], v1 offset:30720
    s_add_u32 s62, s36, 0x46000
    buffer_load_dwordx4 v[112:115], v1, s[4:7], s62 offen sc1
    v_add_f32 v192, v192, v193
    v_add_f32 v194, v194, v195
    v_mfma_f32_32x32x16_bf16 v[160:175], a[232:235], v[80:83], v[160:175]
    ds_read_b128 a[228:231], v1 offset:31744
    v_add_f32 v196, v196, v197
    s_waitcnt vmcnt(20)
    v_add_f32 v198, v198, v199
    s_waitcnt vmcnt(18)
    v_add_f32 v200, v200, v201
    s_waitcnt vmcnt(15)
    v_add_f32 v202, v202, v203
    s_waitcnt vmcnt(12)
    v_add_f32 v204, v204, v205
    v_mfma_f32_32x32x16_bf16 v[176:191], v[80:83], a[236:239], v[176:191]
    ds_read_b128 a[232:235], v1 offset:32768
    v_add_f32 v192, v192, v194
    v_add_f32 v196, v196, v198
    v_add_f32 v200, v200, v202
    v_add_f32 v192, v192, v196
    s_waitcnt lgkmcnt(3)
    v_mfma_f32_32x32x16_bf16 v[144:159], a[240:243], v[84:87], v[144:159]
    ds_read_b128 a[236:239], v1 offset:33792
    buffer_load_dwordx4 v[116:119], v1, s[4:7], s62 offen offset:1024 sc1
    s_waitcnt vmcnt(6)
    ds_read_b128 v[224:227], v30 offset:2048
    ds_read_b128 v[228:231], v30 offset:2304
    v_mfma_f32_32x32x16_bf16 v[160:175], a[244:247], v[84:87], v[160:175]
    ds_read_b128 a[240:243], v1 offset:34816
    ds_read_b128 v[232:235], v30 offset:2560
    ds_read_b128 v[236:239], v30 offset:2816
    v_add_f32 v200, v200, v204
    v_add_f32 v192, v192, v200
    v_cmp_u_f32 vcc, v192, v192
    s_cbranch_vccnz Lnn_158
Lc_159:
    v_mov_b32 v216, v192
    v_mfma_f32_32x32x16_bf16 v[144:159], a[248:251], v[88:91], v[144:159]
    ds_read_b128 a[244:247], v31 offset:0
    buffer_load_dwordx4 v[120:123], v0, s[4:7], s62 offen offset:3072 sc1
    ds_read_b128 v[240:243], v30 offset:3072
    ds_read_b128 v[244:247], v30 offset:3328
    ds_read_b128 v[248:251], v30 offset:3584
    v_mfma_f32_32x32x16_bf16 v[160:175], a[252:255], v[88:91], v[160:175]
    ds_read_b128 a[248:251], v1 offset:35840
    v_mov_b32 v217, v216
    s_nop 0
    s_nop 0
    v_permlane32_swap_b32 v216, v217
    v_mul_f32 v216, 0xbb124925, v216
    s_waitcnt lgkmcnt(10)
    v_mfma_f32_32x32x16_bf16 v[144:159], a[224:227], v[92:95], v[144:159]
    ds_read_b128 a[252:255], v31 offset:2048
    s_add_u32 s62, s36, 0x48000
    buffer_load_dwordx4 v[124:127], v1, s[4:7], s62 offen sc1
    v_max3_u32 v27, v208, v209, v210
    s_waitcnt lgkmcnt(10)
    v_max3_u32 v27, v27, v211, v224
    v_mfma_f32_32x32x16_bf16 v[160:175], a[228:231], v[92:95], v[160:175]
    ds_read_b128 a[224:227], v1 offset:36864
    s_waitcnt lgkmcnt(8)
    v_max3_u32 v27, v27, v228, v232
    s_waitcnt lgkmcnt(5)
    v_max3_u32 v27, v27, v236, v240
    s_waitcnt lgkmcnt(3)
    v_max3_u32 v27, v27, v244, v248
    v_cmp_eq_u32 vcc, -1, v27
    s_cbranch_vccnz Lre_162
Lc_163:
    s_waitcnt vmcnt(7)
    v_mfma_f32_32x32x16_bf16 v[144:159], a[232:235], v[96:99], v[144:159]
    ds_read_b128 a[228:231], v31 offset:4096
    s_add_u32 s62, s36, 0x54000
    buffer_load_dwordx4 v[128:131], v1, s[4:7], s62 offen sc1
    ds_write_b128 v28, v[252:255] offset:2048
    v_mfma_f32_32x32x16_bf16 v[160:175], a[236:239], v[96:99], v[160:175]
    ds_read_b128 a[232:235], v1 offset:37888
    v_mov_b32 v218, 0x3727c5ac
    v_fmac_f32 v218, 0x3b124925, v217
    v_fma_f32 v219, -v216, v216, v218
    v_max_f32 v219, 0x3727c5ac, v219
    s_waitcnt lgkmcnt(4)
    s_waitcnt vmcnt(7)
    v_mfma_f32_32x32x16_bf16 v[144:159], a[240:243], v[100:103], v[144:159]
    ds_read_b128 a[236:239], v31 offset:6144
    buffer_load_dwordx4 v[132:135], v1, s[4:7], s62 offen offset:1024 sc1
    ds_write_b128 v28, v[252:255] offset:3072
    v_cvt_pk_bf16_f32 v20, v216, v216
    v_mfma_f32_32x32x16_bf16 v[192:207], a[244:247], v[224:227], 0
    ds_read_b128 a[240:243], v1 offset:38912
    v_rsq_f32 v24, v219
    v_and_b32 v220, 0xffff0000, v20
    v_sub_f32 v220, v216, v220
    v_cvt_pk_bf16_f32 v21, v220, v220
    v_mfma_f32_32x32x16_bf16 v[160:175], a[248:251], v[100:103], v[160:175]
    ds_read_b128 a[244:247], v31 offset:8192
    v_mov_b32 v22, v20
    v_mov_b32 v23, v21
    v_mul_f32 v26, 0x3e8b97f6, v24
    v_lshrrev_b32 v25, 1, v3
    v_add_u32 v25, s93, v25
    v_mfma_f32_32x32x16_bf16 v[192:207], a[252:255], v[228:231], v[192:207]
    ds_read_b128 a[248:251], v1 offset:39936
    ds_write_b32 v25, v24
    v_add_u32 v30, s85, v1
    s_waitcnt lgkmcnt(5)
    s_waitcnt vmcnt(7)
    v_mfma_f32_32x32x16_bf16 v[144:159], a[224:227], v[104:107], v[144:159]
    ds_read_b128 a[252:255], v31 offset:10240
    buffer_load_dwordx4 v[136:139], v0, s[4:7], s62 offen offset:3072 sc1
    s_mov_b32 s20, 0
    s_mov_b32 s21, -1
    v_cndmask_b32_e64 v211, 0, v211, s[20:21]
    v_mfma_f32_32x32x16_bf16 v[192:207], a[228:231], v[232:235], v[192:207]
    ds_read_b128 a[224:227], v1 offset:40960
    v_add_f32 v208, v208, v209
    v_add_f32 v210, v210, v211
    v_add_f32 v208, v208, v210
    v_mov_b32 v209, v208
    s_nop 0
    v_mfma_f32_32x32x16_bf16 v[160:175], a[232:235], v[104:107], v[160:175]
    ds_read_b128 a[228:231], v31 offset:12288
    v_permlane32_swap_b32 v208, v209
    v_add_f32 v208, v208, v209
    v_mov_b32 v209, v208
    s_nop 0
    s_nop 0
    v_permlane16_swap_b32 v208, v209
    v_mfma_f32_32x32x16_bf16 v[192:207], a[236:239], v[236:239], v[192:207]
    ds_read_b128 a[232:235], v1 offset:41984
    v_add_f32 v208, v208, v209
    s_nop 0
    s_nop 0
    v_mov_b32_dpp v210, v208 row_ror:8 row_mask:0xf bank_mask:0xf
    s_waitcnt lgkmcnt(3)
    s_waitcnt vmcnt(7)
    v_mfma_f32_32x32x16_bf16 v[144:159], a[240:243], v[108:111], v[144:159]
    ds_read_b128 a[236:239], v29 offset:29696
    s_add_u32 s62, s36, 0x56000
    buffer_load_dwordx4 v[140:143], v1, s[4:7], s62 offen sc1
    v_mfma_f32_32x32x16_bf16 v[192:207], a[244:247], v[240:243], v[192:207]
    ds_read_b128 a[240:243], v1 offset:43008
    s_mov_b32 s20, 0xff00ff00
    s_mov_b32 s21, 0xff00ff00
    v_cndmask_b32_e64 v209, v210, v208, s[20:21]
    v_cndmask_b32_e64 v208, v208, v210, s[20:21]
    v_mul_f32 v208, 0xbb124925, v208
    v_mfma_f32_32x32x16_bf16 v[160:175], a[248:251], v[108:111], v[160:175]
    ds_read_b128 a[244:247], v29 offset:29696
    v_mov_b32 v210, 0x3727c5ac
    v_fmac_f32 v210, 0x3b124925, v209
    v_fma_f32 v211, -v208, v208, v210
    v_max_f32 v211, 0x3727c5ac, v211
    v_cvt_pk_bf16_f32 v252, v208, v208
    v_mfma_f32_32x32x16_bf16 v[192:207], a[252:255], v[244:247], v[192:207]
    ds_read_b128 a[248:251], v1 offset:44032
    v_rsq_f32 v213, v211
    v_and_b32 v212, 0xffff0000, v252
    v_sub_f32 v212, v208, v212
    s_waitcnt lgkmcnt(3)
    s_waitcnt vmcnt(7)
    v_mfma_f32_32x32x16_bf16 v[144:159], a[224:227], v[112:115], v[144:159]
    ds_read_b128 a[252:255], v29 offset:28672
    v_cvt_pk_bf16_f32 v253, v212, v212
    v_cndmask_b32_e64 v254, 0, v252, s[18:19]
    v_cndmask_b32_e64 v255, 0, v253, s[18:19]
    v_cndmask_b32_e64 v252, 0, v252, s[16:17]
    v_cndmask_b32_e64 v253, 0, v253, s[16:17]
    v_mfma_f32_32x32x16_bf16 v[192:207], a[228:231], v[248:251], v[192:207]
    ds_read_b128 a[224:227], v1 offset:45056
    v_add_u32 v214, 89184, v10
    ds_write_b32 v214, v213
    v_mfma_f32_32x32x16_bf16 v[160:175], a[232:235], v[112:115], v[160:175]
    v_add_u32 v31, s55, v29
    ds_read_b128 a[228:231], v31 offset:0
    v_mfma_f32_32x32x16_bf16 v[144:159], a[236:239], v[20:23], v[144:159]
    ds_read_b128 a[232:235], v1 offset:46080
    s_waitcnt lgkmcnt(4)
    s_waitcnt vmcnt(6)
    v_mfma_f32_32x32x16_bf16 v[144:159], a[240:243], v[116:119], v[144:159]
    ds_read_b128 a[236:239], v31 offset:1024
    v_mfma_f32_32x32x16_bf16 v[192:207], a[244:247], v[252:255], v[192:207]
    ds_read_b128 a[240:243], v1 offset:47104
    v_mfma_f32_32x32x16_bf16 v[160:175], a[248:251], v[116:119], v[160:175]
    s_lshl_b32 s22, s24, 12
    s_add_u32 s22, s22, LstS2_1f-Lpc_3
    v_lshlrev_b32 v27, 2, v1
    buffer_load_dword v8, v27, s[12:15], s22 offen
    ds_read_b128 a[244:247], v31 offset:2048
    v_mfma_f32_32x32x16_bf16 v[160:175], a[252:255], v[20:23], v[160:175]
    ds_read_b128 a[248:251], v1 offset:48128
    s_nop 2
    v_cvt_pk_bf16_f32 v192, v192, v193
    v_cvt_pk_bf16_f32 v193, v194, v195
    v_cvt_pk_bf16_f32 v194, v196, v197
    v_cvt_pk_bf16_f32 v195, v198, v199
    s_waitcnt lgkmcnt(3)
    s_waitcnt vmcnt(6)
    v_mfma_f32_32x32x16_bf16 v[144:159], a[224:227], v[120:123], v[144:159]
    ds_read_b128 a[252:255], v31 offset:3072
    v_cvt_pk_bf16_f32 v196, v200, v201
    v_cvt_pk_bf16_f32 v197, v202, v203
    v_cvt_pk_bf16_f32 v198, v204, v205
    v_cvt_pk_bf16_f32 v199, v206, v207
    v_mfma_f32_32x32x16_bf16 v[208:223], v[224:227], a[228:231], 0
    ds_read_b128 a[224:227], v1 offset:49152
    s_mov_b64 exec, s[94:95]
    ds_write_b128 v30, v[192:195]
    ds_write_b128 v30, v[196:199] offset:1024
    s_mov_b64 exec, -1
    v_mfma_f32_32x32x16_bf16 v[160:175], a[232:235], v[120:123], v[160:175]
    ds_read_b128 a[228:231], v31 offset:4096
    v_add_u32 v224, s86, v1
    v_lshrrev_b32 v226, 5, v1
    v_and_b32 v226, 16, v226
    v_sub_u32 v25, v25, v226
    v_mfma_f32_32x32x16_bf16 v[208:223], v[228:231], a[236:239], v[208:223]
    ds_read_b128 a[232:235], v1 offset:50176
    s_waitcnt lgkmcnt(5)
    s_waitcnt vmcnt(5)
    v_mfma_f32_32x32x16_bf16 v[144:159], a[240:243], v[124:127], v[144:159]
    ds_read_b128 a[236:239], v31 offset:5120
    v_mfma_f32_32x32x16_bf16 v[208:223], v[232:235], a[244:247], v[208:223]
    ds_read_b128 a[240:243], v1 offset:51200
    v_bfi_b32 v228, 31, v226, v25
    v_subrev_u32 v229, 4, v25
    v_bfi_b32 v229, 31, v226, v229
    v_subrev_u32 v230, 8, v25
    v_bfi_b32 v230, 31, v226, v230
    v_mfma_f32_32x32x16_bf16 v[160:175], a[248:251], v[124:127], v[160:175]
    ds_read_b128 a[244:247], v31 offset:6144
    v_subrev_u32 v231, 12, v25
    v_bfi_b32 v231, 31, v226, v231
    v_cndmask_b32_e64 v232, 0, v44, s[70:71]
    v_cndmask_b32_e64 v233, 0, v45, s[70:71]
    v_cndmask_b32_e64 v234, 0, v46, s[70:71]
    v_mfma_f32_32x32x16_bf16 v[208:223], v[236:239], a[252:255], v[208:223]
    ds_read_b128 a[248:251], v1 offset:52224
    v_cndmask_b32_e64 v235, 0, v47, s[70:71]
    v_perm_b32 v236, v45, v44, s53
    v_perm_b32 v237, v47, v46, s53
    v_perm_b32 v238, v49, v48, s53
    s_waitcnt lgkmcnt(3)
    s_waitcnt vmcnt(4)
    v_mfma_f32_32x32x16_bf16 v[144:159], a[224:227], v[128:131], v[144:159]
    ds_read_b128 a[252:255], v29 offset:30720
    v_perm_b32 v239, v51, v50, s53
    v_mfma_f32_32x32x16_bf16 v[208:223], v[240:243], a[228:231], v[208:223]
    ds_read_b128 a[224:227], v1 offset:53248
    v_perm_b32 v240, v53, v52, s53
    v_perm_b32 v241, v55, v54, s53
    v_perm_b32 v242, v57, v56, s53
    v_perm_b32 v243, v59, v58, s53
    v_mfma_f32_32x32x16_bf16 v[160:175], a[232:235], v[128:131], v[160:175]
    ds_read_b128 a[228:231], v1 offset:54272
    v_mfma_f32_32x32x16_bf16 v[208:223], v[244:247], a[236:239], v[208:223]
    ds_read_b128 a[232:235], v1 offset:55296
    v_cndmask_b32_e64 v244, 0, v236, s[70:71]
    v_cndmask_b32_e64 v245, 0, v237, s[70:71]
    v_add_u32 v225, s87, v1
    s_lshl2_add_u32 s93, s25, s101
    s_waitcnt lgkmcnt(3)
    s_waitcnt vmcnt(3)
    v_mfma_f32_32x32x16_bf16 v[144:159], a[240:243], v[132:135], v[144:159]
    ds_read_b128 a[236:239], v1 offset:56320
    v_mfma_f32_32x32x16_bf16 v[208:223], v[248:251], a[244:247], v[208:223]
    ds_read_b128 a[240:243], v29 offset:0
    v_mov_b32 v248, -1
    v_lshlrev_b32 v249, 1, v1
    v_mfma_f32_32x32x16_bf16 v[160:175], a[248:251], v[132:135], v[160:175]
    ds_read_b128 a[244:247], v29 offset:1024
    v_mfma_f32_32x32x16_bf16 v[208:223], v[252:255], a[252:255], v[208:223]
    ds_read_b128 a[248:251], v29 offset:2048
    s_waitcnt lgkmcnt(3)
    s_waitcnt vmcnt(2)
    v_mfma_f32_32x32x16_bf16 v[144:159], a[224:227], v[136:139], v[144:159]
    ds_read_b128 a[252:255], v29 offset:13312
    v_mfma_f32_32x32x16_bf16 v[160:175], a[228:231], v[136:139], v[160:175]
    ds_read_b128 a[224:227], v29 offset:14336
    buffer_store_dword v248, v249, s[4:7], s57 offen offset:2048
    s_add_u32 s22, s57, 4096
    buffer_store_dword v248, v249, s[4:7], s22 offen offset:1024
    s_waitcnt vmcnt(3)
    v_mfma_f32_32x32x16_bf16 v[144:159], a[232:235], v[140:143], v[144:159]
    ds_read_b128 a[228:231], v29 offset:15360
    v_cvt_pk_bf16_f32 v246, v220, v221
    v_cvt_pk_bf16_f32 v247, v222, v223
    v_mfma_f32_32x32x16_bf16 v[160:175], a[236:239], v[140:143], v[160:175]
    ds_read_b128 a[232:235], v29 offset:16384
    s_waitcnt lgkmcnt(3)
    s_nop 5
    v_cmp_u_f32 vcc, v144, v144
    s_cbranch_vccnz Lnn_134
Lc_135:
    v_mfma_f32_32x32x16_bf16 v[176:191], v[32:35], a[240:243], v[176:191]
    ds_read_b128 a[236:239], v29 offset:17408
    v_cvt_pk_bf16_f32 v144, v144, v145
    v_cvt_pk_bf16_f32 v145, v146, v147
    v_cvt_pk_bf16_f32 v146, v148, v149
    v_cvt_pk_bf16_f32 v147, v150, v151
    v_cvt_pk_bf16_f32 v148, v152, v153
    v_mfma_f32_32x32x16_bf16 v[176:191], v[36:39], a[244:247], v[176:191]
    v_cvt_pk_bf16_f32 v149, v154, v155
    v_cvt_pk_bf16_f32 v150, v156, v157
    v_cvt_pk_bf16_f32 v151, v158, v159
    s_cmp_eq_u32 s24, 3
    s_cbranch_scc1 Lk_164
    s_mov_b64 exec, s[94:95]
    ds_write_b128 v28, v[144:147]
    ds_write_b128 v28, v[148:151] offset:1024
    s_mov_b64 exec, -1
Lk_164:
    v_mfma_f32_32x32x16_bf16 v[176:191], v[40:43], a[248:251], v[176:191]
    v_cvt_pk_bf16_f32 v160, v160, v161
    v_cvt_pk_bf16_f32 v161, v162, v163
    s_waitcnt lgkmcnt(0)
    s_barrier
    ds_read_b128 v[152:155], v224
    ds_read_b128 v[156:159], v224 offset:1024
    v_mfma_f32_32x32x16_bf16 v[176:191], v[84:87], a[252:255], v[176:191]
    s_add_u32 m0, s59, 0x0
    s_nop 0
    buffer_load_dwordx4 v9, s[40:43], s64 offen lds
    v_mfma_f32_32x32x16_bf16 v[176:191], v[88:91], a[224:227], v[176:191]
    buffer_load_dwordx4 v5, s[40:43], s64 offen offset:1024 lds
    v_cvt_pk_bf16_f32 v162, v164, v165
    v_cvt_pk_bf16_f32 v163, v166, v167
    v_mfma_f32_32x32x16_bf16 v[176:191], v[92:95], a[228:231], v[176:191]
    ds_read_b128 a[240:243], v29 offset:18432
    s_add_u32 m0, s59, 0x800
    s_add_u32 s64, s64, 14336
    buffer_load_dwordx4 v9, s[40:43], s64 offen lds
    v_mfma_f32_32x32x16_bf16 v[176:191], v[96:99], a[232:235], v[176:191]
    ds_read_b128 a[244:247], v29 offset:19456
    buffer_load_dwordx4 v5, s[40:43], s64 offen offset:1024 lds
    v_cvt_pk_bf16_f32 v164, v168, v169
    v_cvt_pk_bf16_f32 v165, v170, v171
    v_cvt_pk_bf16_f32 v166, v172, v173
    v_cvt_pk_bf16_f32 v167, v174, v175
    v_mfma_f32_32x32x16_bf16 v[176:191], v[100:103], a[236:239], v[176:191]
    ds_read_b128 a[248:251], v29 offset:20480
    ds_read_b32 v228, v228 offset:0
    ds_read_b32 v229, v229 offset:4
    ds_read_b32 v230, v230 offset:8
    ds_read_b32 v231, v231 offset:12
    s_waitcnt lgkmcnt(8)
    v_mfma_f32_32x32x16_bf16 v[208:223], v[152:155], v[160:163], 0
    ds_read_b128 a[252:255], v29 offset:21504
    s_add_u32 m0, s59, 0x1000
    s_add_u32 s64, s64, 14336
    buffer_load_dwordx4 v9, s[40:43], s64 offen lds
    v_mfma_f32_32x32x16_bf16 v[60:75], v[144:147], v[160:163], v[44:59]
    ds_read_b128 a[224:227], v29 offset:22528
    buffer_load_dwordx4 v5, s[40:43], s64 offen offset:1024 lds
    s_waitcnt lgkmcnt(9)
    v_mfma_f32_32x32x16_bf16 v[208:223], v[156:159], v[164:167], v[208:223]
    ds_read_b128 a[228:231], v29 offset:23552
    s_add_u32 m0, s59, 0x1800
    s_add_u32 s64, s64, 14336
    buffer_load_dwordx4 v9, s[40:43], s64 offen lds
    v_mfma_f32_32x32x16_bf16 v[60:75], v[148:151], v[164:167], v[60:75]
    ds_read_b128 a[232:235], v29 offset:24576
    buffer_load_dwordx4 v5, s[40:43], s64 offen offset:1024 lds
    s_waitcnt lgkmcnt(3)
    v_mfma_f32_32x32x16_bf16 v[176:191], v[104:107], a[240:243], v[176:191]
    ds_read_b128 a[236:239], v29 offset:25600
    s_nop 1
    v_add_f32 v208, v208, v212
    v_add_f32 v209, v209, v213
    v_add_f32 v210, v210, v214
    v_add_f32 v211, v211, v215
    v_add_f32 v216, v216, v220
    v_mfma_f32_32x32x16_bf16 v[176:191], v[108:111], a[244:247], v[176:191]
    ds_read_b128 a[240:243], v29 offset:26624
    s_add_u32 m0, s59, 0x2000
    s_add_u32 s64, s64, 14336
    buffer_load_dwordx4 v9, s[40:43], s64 offen lds
    v_mfma_f32_32x32x16_bf16 v[176:191], v[112:115], a[248:251], v[176:191]
    ds_read_b128 a[244:247], v29 offset:27648
    buffer_load_dwordx4 v5, s[40:43], s64 offen offset:1024 lds
    v_add_f32 v217, v217, v221
    v_mfma_f32_32x32x16_bf16 v[176:191], v[116:119], a[252:255], v[176:191]
    ds_read_b128 a[248:251], v29 offset:30720
    s_add_u32 m0, s59, 0x2800
    s_add_u32 s64, s64, 14336
    buffer_load_dwordx4 v9, s[40:43], s64 offen lds
    s_waitcnt lgkmcnt(3)
    v_mfma_f32_32x32x16_bf16 v[176:191], v[120:123], a[224:227], v[176:191]
    buffer_load_dwordx4 v5, s[40:43], s64 offen offset:1024 lds
    v_add_f32 v218, v218, v222
    v_add_f32 v219, v219, v223
    v_mfma_f32_32x32x16_bf16 v[176:191], v[124:127], a[228:231], v[176:191]
    v_add_f32 v208, v208, v216
    v_add_f32 v209, v209, v217
    v_add_f32 v210, v210, v218
    v_add_f32 v211, v211, v219
    v_max3_f32 v60, v60, v64, v68
    v_max3_f32 v61, v61, v65, v69
    v_mfma_f32_32x32x16_bf16 v[176:191], v[128:131], a[232:235], v[176:191]
    s_add_u32 m0, s59, 0x3000
    s_add_u32 s64, s64, 14336
    buffer_load_dwordx4 v9, s[40:43], s64 offen lds
    v_mfma_f32_32x32x16_bf16 v[176:191], v[132:135], a[236:239], v[176:191]
    v_max3_f32 v62, v62, v66, v70
    v_max3_f32 v63, v63, v67, v71
    v_bfi_b32 v208, v232, v208, -1
    v_bfi_b32 v209, v233, v209, -1
    v_bfi_b32 v210, v234, v210, -1
    s_waitcnt lgkmcnt(0)
    v_mfma_f32_32x32x16_bf16 v[176:191], v[136:139], a[240:243], v[176:191]
    buffer_load_dwordx4 v5, s[40:43], s64 offen offset:1024 lds
    v_bfi_b32 v211, v235, v211, -1
    v_max3_f32 v208, v208, v60, v72
    v_mfma_f32_32x32x16_bf16 v[176:191], v[140:143], a[244:247], v[176:191]
    v_max3_f32 v209, v209, v61, v73
    v_max3_f32 v210, v210, v62, v74
    v_max3_f32 v211, v211, v63, v75
    v_mul_f32 v208, v208, v228
    v_mul_f32 v209, v209, v229
    v_mul_f32 v210, v210, v230
    v_mfma_f32_32x32x16_bf16 v[176:191], v[20:23], a[248:251], v[176:191]
    v_mul_f32 v211, v211, v231
    v_max_f32 v212, v208, v209
    v_max3_f32 v212, v212, v210, v211
    v_mov_b32 v213, v212
    s_nop 1
    v_permlane32_swap_b32 v212, v213
    v_max_f32 v212, v212, v213
    v_mul_f32 v212, v212, v26
    v_fma_f32 v208, v208, v26, -v212
    v_fma_f32 v209, v209, v26, -v212
    v_fma_f32 v210, v210, v26, -v212
    v_fma_f32 v211, v211, v26, -v212
    v_exp_f32_e64 v208, v208 clamp
    v_exp_f32_e64 v209, v209 clamp
    v_exp_f32_e64 v210, v210 clamp
    v_exp_f32_e64 v211, v211 clamp
    v_add_f32 v212, v208, v209
    v_add_f32 v213, v210, v211
    v_add_f32 v212, v212, v213
    v_mov_b32 v213, v212
    v_mul_f32 v208, v208, v228
    v_mul_f32 v209, v209, v229
    v_permlane32_swap_b32 v212, v213
    v_add_f32 v212, v212, v213
    v_rcp_f32 v212, v212
    v_mul_f32 v210, v210, v230
    v_mul_f32 v211, v211, v231
    v_mul_f32 v208, v208, v212
    v_mul_f32 v209, v209, v212
    v_mul_f32 v210, v210, v212
    v_mul_f32 v211, v211, v212
    v_cvt_pk_bf16_f32 v212, v208, v209
    v_cvt_pk_bf16_f32 v213, v210, v211
    v_bfi_b32 v192, v236, 0, v212
    v_bfi_b32 v193, v237, 0, v213
    v_bfi_b32 v194, v238, 0, v212
    v_bfi_b32 v195, v239, 0, v213
    v_bfi_b32 v196, v240, 0, v212
    v_bfi_b32 v197, v241, 0, v213
    v_bfi_b32 v198, v242, 0, v212
    v_bfi_b32 v199, v243, 0, v213
    v_and_b32 v200, v244, v212
    v_and_b32 v201, v245, v213
    v_and_b32 v202, v244, v212
    v_and_b32 v203, v245, v213
    v_cvt_pk_bf16_f32 v66, v188, v189
    v_cvt_pk_bf16_f32 v67, v190, v191
    ds_write_b64 v28, v[66:67] offset:3080
    ds_write_b64 v225, v[246:247]
    v_cvt_pk_bf16_f32 v60, v176, v177
    v_cvt_pk_bf16_f32 v61, v178, v179
    v_cvt_pk_bf16_f32 v62, v180, v181
    v_cvt_pk_bf16_f32 v63, v182, v183
    v_cvt_pk_bf16_f32 v64, v184, v185
    v_cvt_pk_bf16_f32 v65, v186, v187
    v_mfma_f32_32x32x16_bf16 v[44:59], v[60:63], v[192:195], 0
    s_waitcnt lgkmcnt(0)
    s_barrier
    ds_read_b128 v[168:171], v224 offset:2048
    ds_read_b128 v[172:175], v224 offset:3072
    v_mfma_f32_32x32x16_bf16 v[44:59], v[64:67], v[196:199], v[44:59]
    v_or_b32_e64 v27, s3, 1
    s_waitcnt vmcnt(14)
    buffer_store_dword v27, v6, s[4:7], s93 offen
Lef_165:
    s_waitcnt lgkmcnt(1)
    v_mfma_f32_32x32x16_bf16 v[44:59], v[168:171], v[200:203], v[44:59]
    s_waitcnt lgkmcnt(0)
    v_mfma_f32_32x32x16_bf16 v[44:59], v[172:175], v[200:203], v[44:59]
    s_nop 11
    v_cvt_pk_bf16_f32 v44, v44, v45
    v_cvt_pk_bf16_f32 v45, v46, v47
    v_cvt_pk_bf16_f32 v46, v48, v49
    v_cvt_pk_bf16_f32 v47, v50, v51
    buffer_store_dwordx4 v[44:47], v1, s[4:7], s57 offen offset:2048
    v_cvt_pk_bf16_f32 v48, v52, v53
    v_cvt_pk_bf16_f32 v49, v54, v55
    v_cvt_pk_bf16_f32 v50, v56, v57
    v_cvt_pk_bf16_f32 v51, v58, v59
    buffer_store_dwordx4 v[48:51], v1, s[4:7], s57 offen offset:3072
LstS2_1f:
    s_add_u32 m0, s55, 0xe000
    s_add_u32 s65, s39, 0x2a000
    buffer_load_dwordx4 v1, s[4:7], s65 offen lds
    buffer_load_dwordx4 v1, s[4:7], s65 offen offset:1024 lds
    buffer_load_dwordx4 v1, s[4:7], s65 offen offset:2048 lds
    buffer_load_dwordx4 v1, s[4:7], s65 offen offset:3072 lds
    s_add_u32 m0, s55, 0xf000
    s_nop 0
    buffer_load_dwordx4 v0, s[4:7], s65 offen lds
    buffer_load_dwordx4 v0, s[4:7], s65 offen offset:1024 lds
    buffer_load_dwordx4 v0, s[4:7], s65 offen offset:2048 lds
    s_cmp_ge_u32 s25, 14
    s_cbranch_scc1 Lidle_166
    s_and_b32 s86, s24, 1
    s_lshl_b32 s87, s86, 5
    s_andn2_b32 s85, s100, 63
    s_add_u32 s85, s85, s87
    buffer_load_dword v8, v10, s[4:7], s85 offen sc1
    s_add_u32 s68, s3, 1
    s_lshl_b32 s87, s86, 1
    s_sub_u32 s87, s87, s24
    s_mul_i32 s87, s87, 114688
    s_add_u32 s84, s87, s46
    s_mul_i32 s87, s86, 28736
    s_add_u32 s87, s87, 0
    v_and_b32 v146, 0x58, v3
    v_and_b32 v147, 0x60, v3
    v_lshl_add_u32 v146, v147, 2, v146
    v_bfe_u32 v147, v3, 7, 1
    v_lshl_add_u32 v146, v147, 5, v146
    v_xor_b32 v146, s87, v146
    v_xor_b32 v147, 64, v146
    v_and_b32 v145, 0x200, v1
    v_add_u32 v144, v145, v146
    v_add_u32 v145, v145, v147
    s_lshl_b32 s87, s24, 12
    s_add_u32 s87, s87, 90112
    v_add_u32 v31, s87, v1
    v_xor_b32 v28, 0x1000, v31
    v_lshlrev_b32 v176, 16, v12
    v_and_b32 v177, 0xffff0000, v12
    v_lshlrev_b32 v178, 16, v13
    v_and_b32 v179, 0xffff0000, v13
    v_lshlrev_b32 v180, 16, v14
    v_and_b32 v181, 0xffff0000, v14
    v_lshlrev_b32 v182, 16, v15
    v_and_b32 v183, 0xffff0000, v15
    v_lshlrev_b32 v184, 16, v16
    v_and_b32 v185, 0xffff0000, v16
    v_lshlrev_b32 v186, 16, v17
    v_and_b32 v187, 0xffff0000, v17
    v_lshlrev_b32 v188, 16, v18
    v_and_b32 v189, 0xffff0000, v18
    v_lshlrev_b32 v190, 16, v19
    v_and_b32 v191, 0xffff0000, v19
    s_add_u32 s92, s57, 0x1400
    s_add_u32 s93, s49, 0x8000
    v_or_b32_e64 v162, s3, 2
    s_waitcnt vmcnt(11)
    s_barrier
    ds_read_b64_tr_b16 v[96:97], v145 offset:0
    ds_read_b64_tr_b16 v[98:99], v145 offset:1024
    ds_read_b64_tr_b16 v[100:101], v144 offset:0
    ds_read_b64_tr_b16 v[102:103], v144 offset:1024
    ds_read_b64_tr_b16 v[104:105], v145 offset:2048
    ds_read_b64_tr_b16 v[106:107], v147 offset:3072
    ds_read_b64_tr_b16 v[108:109], v144 offset:2048
    ds_read_b64_tr_b16 v[110:111], v146 offset:3072
    ds_read_b64_tr_b16 v[112:113], v145 offset:3584
    ds_read_b64_tr_b16 v[114:115], v145 offset:4608
    ds_read_b64_tr_b16 v[116:117], v144 offset:3584
    ds_read_b64_tr_b16 v[118:119], v144 offset:4608
    ds_read_b64_tr_b16 v[120:121], v145 offset:5632
    ds_read_b64_tr_b16 v[122:123], v147 offset:6656
    ds_read_b64_tr_b16 v[124:125], v144 offset:5632
    ds_read_b64_tr_b16 v[126:127], v146 offset:6656
    ds_read_b64_tr_b16 v[128:129], v145 offset:7168
    ds_read_b64_tr_b16 v[130:131], v145 offset:8192
    ds_read_b64_tr_b16 v[132:133], v144 offset:7168
    ds_read_b64_tr_b16 v[134:135], v144 offset:8192
    ds_read_b64_tr_b16 v[136:137], v145 offset:9216
    ds_read_b64_tr_b16 v[138:139], v147 offset:10240
    ds_read_b64_tr_b16 v[140:141], v144 offset:9216
    ds_read_b64_tr_b16 v[142:143], v146 offset:10240
    ds_read_b64_tr_b16 v[224:225], v145 offset:10752
    ds_read_b64_tr_b16 v[226:227], v145 offset:11776
    ds_read_b64_tr_b16 v[228:229], v144 offset:10752
    ds_read_b64_tr_b16 v[230:231], v144 offset:11776
    ds_read_b64_tr_b16 v[232:233], v145 offset:12800
    ds_read_b64_tr_b16 v[234:235], v147 offset:13824
    ds_read_b64_tr_b16 v[236:237], v144 offset:12800
    ds_read_b64_tr_b16 v[238:239], v146 offset:13824
    ds_read_b64_tr_b16 v[240:241], v145 offset:14336
    ds_read_b64_tr_b16 v[242:243], v145 offset:15360
    ds_read_b64_tr_b16 v[244:245], v145 offset:16384
    ds_read_b64_tr_b16 v[246:247], v147 offset:17408
    ds_read_b64_tr_b16 v[248:249], v145 offset:17920
    ds_read_b64_tr_b16 v[250:251], v145 offset:18944
    ds_read_b64_tr_b16 v[252:253], v145 offset:19968
    ds_read_b64_tr_b16 v[254:255], v147 offset:20992
    ds_read_b64_tr_b16 a[224:225], v145 offset:21504
    ds_read_b64_tr_b16 a[226:227], v145 offset:22528
    ds_read_b64_tr_b16 a[228:229], v145 offset:23552
    ds_read_b64_tr_b16 a[230:231], v147 offset:24576
    ds_read_b64_tr_b16 a[232:233], v145 offset:25088
    ds_read_b64_tr_b16 a[234:235], v145 offset:26112
    ds_read_b64_tr_b16 a[236:237], v145 offset:27136
    ds_read_b64_tr_b16 a[238:239], v147 offset:28160
    ds_read_b64_tr_b16 a[240:241], v144 offset:14336
    ds_read_b64_tr_b16 a[242:243], v144 offset:15360
    ds_read_b64_tr_b16 a[244:245], v144 offset:16384
    ds_read_b64_tr_b16 a[246:247], v146 offset:17408
    ds_read_b64_tr_b16 a[248:249], v144 offset:17920
    ds_read_b64_tr_b16 a[250:251], v144 offset:18944
    ds_read_b64_tr_b16 a[252:253], v144 offset:19968
    ds_read_b64_tr_b16 a[254:255], v146 offset:20992
    ds_read_b64_tr_b16 v[208:209], v144 offset:21504
    ds_read_b64_tr_b16 v[210:211], v144 offset:22528
    ds_read_b64_tr_b16 v[212:213], v144 offset:23552
    ds_read_b64_tr_b16 v[214:215], v146 offset:24576
    ds_read_b64_tr_b16 v[216:217], v144 offset:25088
    ds_read_b64_tr_b16 v[218:219], v144 offset:26112
    ds_read_b64_tr_b16 v[220:221], v144 offset:27136
    ds_read_b64_tr_b16 v[222:223], v146 offset:28160
    buffer_load_dword v9, v10, s[4:7], s85 offen sc1
Lp_167:
    s_waitcnt vmcnt(1)
    v_subrev_u32 v8, s68, v8
    v_cmp_le_u32 vcc, 16, v8
    s_cbranch_vccz Lo_168
    buffer_load_dword v8, v10, s[4:7], s85 offen sc1
    s_waitcnt vmcnt(1)
    v_subrev_u32 v9, s68, v9
    v_cmp_le_u32 vcc, 16, v9
    s_cbranch_vccz Lo_168
    buffer_load_dword v9, v10, s[4:7], s85 offen sc1
    s_sub_u32 s30, s30, 1
    s_cbranch_scc0 Lp_167
    s_mov_b32 s30, 0
Lo_168:
    buffer_load_dwordx4 v[32:35], v1, s[4:7], s84 offen offset:2048 sc1
    buffer_load_dwordx4 v[36:39], v1, s[4:7], s84 offen offset:3072 sc1
    s_add_u32 s67, s84, 0x6000
    buffer_load_dwordx4 v[40:43], v0, s[4:7], s67 offen offset:2048 sc1
    buffer_load_dwordx4 v[44:47], v0, s[4:7], s67 offen offset:3072 sc1
    s_add_u32 s67, s84, 0xe000
    buffer_load_dwordx4 v[48:51], v1, s[4:7], s67 offen offset:2048 sc1
    buffer_load_dwordx4 v[52:55], v1, s[4:7], s67 offen offset:3072 sc1
    s_add_u32 s67, s84, 0x14000
    buffer_load_dwordx4 v[56:59], v0, s[4:7], s67 offen offset:2048 sc1
    buffer_load_dwordx4 v[60:63], v0, s[4:7], s67 offen offset:3072 sc1
    s_waitcnt vmcnt(7)
    v_cmp_u_f32 vcc, v32, v32
    s_cbranch_vccnz Lfc_169
Lc_170:
    s_waitcnt lgkmcnt(15)
    v_mfma_f32_32x32x16_bf16 v[192:207], v[96:99], v[32:35], 0
    s_add_u32 s67, s84, 0x1c000
    buffer_load_dwordx4 v[64:67], v1, s[4:7], s67 offen offset:2048 sc1
    s_waitcnt vmcnt(7)
    v_cmp_u_f32 vcc, v36, v36
    v_mfma_f32_32x32x16_bf16 v[176:191], v[100:103], v[32:35], v[176:191]
    buffer_load_dwordx4 v[68:71], v1, s[4:7], s67 offen offset:3072 sc1
    s_cbranch_vccnz Lfc_172
Lc_173:
    v_mfma_f32_32x32x16_bf16 v[192:207], v[104:107], v[36:39], v[192:207]
    s_add_u32 s67, s84, 0x22000
    buffer_load_dwordx4 v[72:75], v0, s[4:7], s67 offen offset:2048 sc1
    s_waitcnt vmcnt(7)
    v_cmp_u_f32 vcc, v40, v44
    v_mfma_f32_32x32x16_bf16 v[176:191], v[108:111], v[36:39], v[176:191]
    buffer_load_dwordx4 v[76:79], v0, s[4:7], s67 offen offset:3072 sc1
    s_cbranch_vccnz Lfc_175
Lc_176:
    v_mfma_f32_32x32x16_bf16 v[192:207], v[112:115], v[40:43], v[192:207]
    s_add_u32 s67, s84, 0x2a000
    buffer_load_dwordx4 v[80:83], v1, s[4:7], s67 offen offset:2048 sc1
    v_mfma_f32_32x32x16_bf16 v[176:191], v[116:119], v[40:43], v[176:191]
    buffer_load_dwordx4 v[84:87], v1, s[4:7], s67 offen offset:3072 sc1
    v_mfma_f32_32x32x16_bf16 v[192:207], v[120:123], v[44:47], v[192:207]
    s_add_u32 s67, s84, 0x30000
    buffer_load_dwordx4 v[88:91], v0, s[4:7], s67 offen offset:2048 sc1
    s_waitcnt vmcnt(9)
    v_cmp_u_f32 vcc, v48, v52
    v_mfma_f32_32x32x16_bf16 v[176:191], v[124:127], v[44:47], v[176:191]
    buffer_load_dwordx4 v[92:95], v0, s[4:7], s67 offen offset:3072 sc1
    s_cbranch_vccnz Lfc_178
Lc_179:
    v_mfma_f32_32x32x16_bf16 v[192:207], v[128:131], v[48:51], v[192:207]
    v_mfma_f32_32x32x16_bf16 v[176:191], v[132:135], v[48:51], v[176:191]
    v_mfma_f32_32x32x16_bf16 v[192:207], v[136:139], v[52:55], v[192:207]
    s_lshl_b32 s22, s24, 12
    s_add_u32 s22, s22, LstS3_1f-Lpc_3
    v_lshlrev_b32 v27, 2, v1
    buffer_load_dword v8, v27, s[12:15], s22 offen
    s_waitcnt vmcnt(9)
    v_cmp_u_f32 vcc, v56, v60
    v_mfma_f32_32x32x16_bf16 v[176:191], v[140:143], v[52:55], v[176:191]
    s_cbranch_vccnz Lfc_181
Lc_182:
    v_mfma_f32_32x32x16_bf16 v[192:207], v[224:227], v[56:59], v[192:207]
    v_mfma_f32_32x32x16_bf16 v[176:191], v[228:231], v[56:59], v[176:191]
    v_mfma_f32_32x32x16_bf16 v[192:207], v[232:235], v[60:63], v[192:207]
    s_waitcnt vmcnt(7)
    v_cmp_u_f32 vcc, v64, v68
    s_waitcnt lgkmcnt(0)
    s_barrier
    v_mfma_f32_32x32x16_bf16 v[176:191], v[236:239], v[60:63], v[176:191]
    s_cbranch_vccnz Lfc_184
Lc_185:
    v_mfma_f32_32x32x16_bf16 v[192:207], v[240:243], v[64:67], v[192:207]
    s_waitcnt vmcnt(5)
    v_cmp_u_f32 vcc, v72, v76
    v_mfma_f32_32x32x16_bf16 v[192:207], v[244:247], v[68:71], v[192:207]
    s_cbranch_vccnz Lfc_187
Lc_188:
    v_mfma_f32_32x32x16_bf16 v[192:207], v[248:251], v[72:75], v[192:207]
    s_waitcnt vmcnt(3)
    v_cmp_u_f32 vcc, v80, v84
    s_add_u32 m0, s55, 0x0
    s_add_u32 s69, s39, 0x23000
    buffer_load_dwordx4 v1, s[4:7], s69 offen lds
    v_mfma_f32_32x32x16_bf16 v[192:207], v[252:255], v[76:79], v[192:207]
    s_cbranch_vccnz Lfc_190
Lc_191:
    v_mfma_f32_32x32x16_bf16 v[192:207], a[224:227], v[80:83], v[192:207]
    s_waitcnt vmcnt(2)
    v_cmp_u_f32 vcc, v88, v92
    buffer_load_dwordx4 v1, s[4:7], s69 offen offset:1024 lds
    v_mfma_f32_32x32x16_bf16 v[192:207], a[228:231], v[84:87], v[192:207]
    s_cbranch_vccnz Lfc_193
Lc_194:
    v_mfma_f32_32x32x16_bf16 v[192:207], a[232:235], v[88:91], v[192:207]
    v_mfma_f32_32x32x16_bf16 v[192:207], a[236:239], v[92:95], v[192:207]
    buffer_load_dwordx4 v1, s[4:7], s69 offen offset:2048 lds
    v_mfma_f32_32x32x16_bf16 v[176:191], a[240:243], v[64:67], v[176:191]
    v_mfma_f32_32x32x16_bf16 v[176:191], a[244:247], v[68:71], v[176:191]
    s_nop 8
    ds_write_b128 v28, v[192:195] offset:0
    buffer_load_dwordx4 v1, s[4:7], s69 offen offset:3072 lds
    s_add_u32 m0, s55, 0x1000
    v_mfma_f32_32x32x16_bf16 v[176:191], a[248:251], v[72:75], v[176:191]
    ds_write_b128 v28, v[196:199] offset:1024
    v_mfma_f32_32x32x16_bf16 v[176:191], a[252:255], v[76:79], v[176:191]
    ds_write_b128 v28, v[200:203] offset:2048
    buffer_load_dwordx4 v0, s[4:7], s69 offen lds
    v_mfma_f32_32x32x16_bf16 v[176:191], v[208:211], v[80:83], v[176:191]
    ds_write_b128 v28, v[204:207] offset:3072
    v_mfma_f32_32x32x16_bf16 v[176:191], v[212:215], v[84:87], v[176:191]
    buffer_load_dwordx4 v0, s[4:7], s69 offen offset:1024 lds
    v_mfma_f32_32x32x16_bf16 v[176:191], v[216:219], v[88:91], v[176:191]
    v_mfma_f32_32x32x16_bf16 v[176:191], v[220:223], v[92:95], v[176:191]
    buffer_load_dwordx4 v0, s[4:7], s69 offen offset:2048 lds
    s_waitcnt lgkmcnt(0)
    s_barrier
    ds_read_b128 v[192:195], v31 offset:0
    ds_read_b128 v[196:199], v31 offset:1024
    ds_read_b128 v[200:203], v31 offset:2048
    ds_read_b128 v[204:207], v31 offset:3072
    buffer_store_dword v162, v6, s[4:7], s100 offen offset:256
    s_waitcnt lgkmcnt(3)
    s_nop 2
    v_pk_add_f32 v[176:177], v[176:177], v[192:193]
    v_pk_add_f32 v[178:179], v[178:179], v[194:195]
    v_cvt_pk_bf16_f32 v12, v176, v177
    v_cvt_pk_bf16_f32 v13, v178, v179
    s_waitcnt lgkmcnt(2)
    v_pk_add_f32 v[180:181], v[180:181], v[196:197]
    v_pk_add_f32 v[182:183], v[182:183], v[198:199]
    v_cvt_pk_bf16_f32 v14, v180, v181
    v_cvt_pk_bf16_f32 v15, v182, v183
    buffer_store_dwordx4 v[12:15], v1, s[4:7], s92 offen
    s_waitcnt lgkmcnt(1)
    v_pk_add_f32 v[184:185], v[184:185], v[200:201]
    v_pk_add_f32 v[186:187], v[186:187], v[202:203]
    v_cvt_pk_bf16_f32 v16, v184, v185
    v_cvt_pk_bf16_f32 v17, v186, v187
    s_waitcnt lgkmcnt(0)
    v_pk_add_f32 v[188:189], v[188:189], v[204:205]
    v_pk_add_f32 v[190:191], v[190:191], v[206:207]
    v_cvt_pk_bf16_f32 v18, v188, v189
    v_cvt_pk_bf16_f32 v19, v190, v191
    buffer_store_dwordx4 v[16:19], v1, s[4:7], s92 offen offset:1024
    v_dot2_f32_bf16 v160, v12, s23, 0
    v_dot2_f32_bf16 v161, v12, v12, 0
    v_dot2_f32_bf16 v160, v13, s23, v160
    v_dot2_f32_bf16 v161, v13, v13, v161
    v_dot2_f32_bf16 v160, v14, s23, v160
    v_dot2_f32_bf16 v161, v14, v14, v161
    v_dot2_f32_bf16 v160, v15, s23, v160
    v_dot2_f32_bf16 v161, v15, v15, v161
    v_dot2_f32_bf16 v160, v16, s23, v160
    v_dot2_f32_bf16 v161, v16, v16, v161
    v_dot2_f32_bf16 v160, v17, s23, v160
    v_dot2_f32_bf16 v161, v17, v17, v161
    v_dot2_f32_bf16 v160, v18, s23, v160
    v_dot2_f32_bf16 v161, v18, v18, v161
    v_dot2_f32_bf16 v160, v19, s23, v160
    v_dot2_f32_bf16 v161, v19, v19, v161
    s_nop 2
    v_permlane32_swap_b32 v160, v161
    v_add_f32 v160, v160, v161
    buffer_store_dword v160, v2, s[4:7], s93 offen
LstS3_1f:
    s_waitcnt lgkmcnt(0)
    s_barrier
    s_lshl_b32 s22, s24, 12
    s_add_u32 s22, s22, LstS4_1f-Lpc_3
    v_lshlrev_b32 v27, 2, v1
    buffer_load_dword v9, v27, s[12:15], s22 offen
    buffer_load_dword v8, v11, s[4:7], s101 offen offset:256 sc1
    s_add_u32 s71, s3, 2
    s_add_u32 s93, s37, 0x8000
    v_lshrrev_b32 v30, 1, v1
    v_xor_b32 v30, v30, v1
    v_and_b32 v30, 64, v30
    v_mul_u32_u24 v30, 3, v30
    v_and_b32 v29, 0x100, v1
    v_mul_u32_u24 v5, 111, v29
    v_add_u32 v5, v5, v1
    v_mad_u32_u24 v31, v29, 3, v1
    v_xor_b32 v28, v31, v30
    v_add_u32 v29, 57344, v28
    v_add_u32 v30, 106496, v28
    ds_read_b128 a[224:227], v30 offset:0
    ds_read_b128 a[228:231], v30 offset:28672
    ds_read_b128 a[232:235], v29 offset:0
    ds_read_b128 a[236:239], v30 offset:256
    ds_read_b128 a[240:243], v30 offset:28928
    ds_read_b128 a[244:247], v29 offset:256
    ds_read_b128 a[248:251], v30 offset:2048
    buffer_load_dword v9, v11, s[4:7], s101 offen offset:256 sc1
Lp_197:
    s_waitcnt vmcnt(1)
    v_subrev_u32 v8, s71, v8
    v_cmp_le_u32 vcc, 16, v8
    s_cbranch_vccz Lo_198
    buffer_load_dword v8, v11, s[4:7], s101 offen offset:256 sc1
    s_waitcnt vmcnt(1)
    v_subrev_u32 v9, s71, v9
    v_cmp_le_u32 vcc, 16, v9
    s_cbranch_vccz Lo_198
    buffer_load_dword v9, v11, s[4:7], s101 offen offset:256 sc1
    s_sub_u32 s30, s30, 1
    s_cbranch_scc0 Lp_197
    s_mov_b32 s30, 0
Lo_198:
    s_add_u32 s70, s36, 0x1000
    buffer_load_dwordx4 v[32:35], v31, s[4:7], s70 offen offset:1024 sc1
    buffer_load_dwordx4 v[36:39], v31, s[4:7], s70 offen offset:1280 sc1
    s_add_u32 s70, s36, 0x3000
    buffer_load_dwordx4 v[40:43], v31, s[4:7], s70 offen sc1
    buffer_load_dwordx4 v[44:47], v31, s[4:7], s70 offen offset:256 sc1
    s_add_u32 s70, s36, 0xf000
    buffer_load_dwordx4 v[48:51], v31, s[4:7], s70 offen offset:1024 sc1
    buffer_load_dwordx4 v[52:55], v31, s[4:7], s70 offen offset:1280 sc1
    s_add_u32 s70, s36, 0x11000
    buffer_load_dwordx4 v[56:59], v31, s[4:7], s70 offen sc1
    buffer_load_dwordx4 v[60:63], v31, s[4:7], s70 offen offset:256 sc1
    s_add_u32 s70, s36, 0x1d000
    buffer_load_dwordx4 v[64:67], v31, s[4:7], s70 offen offset:1024 sc1
    buffer_load_dwordx4 v[68:71], v31, s[4:7], s70 offen offset:1280 sc1
    s_add_u32 s70, s36, 0x1f000
    buffer_load_dwordx4 v[72:75], v31, s[4:7], s70 offen sc1
    buffer_load_dwordx4 v[76:79], v31, s[4:7], s70 offen offset:256 sc1
    s_waitcnt lgkmcnt(3)
    s_waitcnt vmcnt(10)
    v_cmp_u_f32 vcc, v32, v36
    s_cbranch_vccnz Lfc_199
Lc_200:
    v_mfma_f32_16x16x32_bf16 v[148:151], a[224:227], v[36:39], 0
    ds_read_b128 a[252:255], v30 offset:30720
    v_mfma_f32_16x16x32_bf16 v[144:147], a[224:227], v[32:35], 0
    s_add_u32 s70, s36, 0x2b000
    buffer_load_dwordx4 v[80:83], v31, s[4:7], s70 offen offset:1024 sc1
    v_mfma_f32_16x16x32_bf16 v[160:163], a[228:231], v[32:35], 0
    ds_read_b128 a[224:227], v29 offset:2048
    v_mfma_f32_16x16x32_bf16 v[164:167], a[228:231], v[36:39], 0
    v_mfma_f32_16x16x32_bf16 v[180:183], a[232:235], v[36:39], 0
    ds_read_b128 a[228:231], v30 offset:2304
    buffer_load_dwordx4 v[84:87], v31, s[4:7], s70 offen offset:1280 sc1
    v_mfma_f32_16x16x32_bf16 v[176:179], a[232:235], v[32:35], 0
    v_mfma_f32_16x16x32_bf16 v[152:155], a[236:239], v[32:35], 0
    ds_read_b128 a[232:235], v30 offset:30976
    s_waitcnt lgkmcnt(3)
    v_mfma_f32_16x16x32_bf16 v[156:159], a[236:239], v[36:39], 0
    v_mfma_f32_16x16x32_bf16 v[172:175], a[240:243], v[36:39], 0
    ds_read_b128 a[236:239], v29 offset:2304
    s_waitcnt vmcnt(10)
    v_cmp_u_f32 vcc, v40, v44
    v_mfma_f32_16x16x32_bf16 v[168:171], a[240:243], v[32:35], 0
    s_add_u32 s70, s36, 0x2d000
    buffer_load_dwordx4 v[88:91], v31, s[4:7], s70 offen sc1
    v_mfma_f32_16x16x32_bf16 v[184:187], a[244:247], v[32:35], 0
    ds_read_b128 a[240:243], v30 offset:4096
    s_cbranch_vccnz Lfc_202
Lc_203:
    v_mfma_f32_16x16x32_bf16 v[188:191], a[244:247], v[36:39], 0
    v_mfma_f32_16x16x32_bf16 v[148:151], a[248:251], v[44:47], v[148:151]
    ds_read_b128 a[244:247], v30 offset:32768
    buffer_load_dwordx4 v[92:95], v31, s[4:7], s70 offen offset:256 sc1
    v_mfma_f32_16x16x32_bf16 v[144:147], a[248:251], v[40:43], v[144:147]
    v_mfma_f32_16x16x32_bf16 v[160:163], a[252:255], v[40:43], v[160:163]
    ds_read_b128 a[248:251], v29 offset:4096
    s_waitcnt lgkmcnt(3)
    v_mfma_f32_16x16x32_bf16 v[164:167], a[252:255], v[44:47], v[164:167]
    v_mfma_f32_16x16x32_bf16 v[180:183], a[224:227], v[44:47], v[180:183]
    ds_read_b128 a[252:255], v30 offset:4352
    v_mfma_f32_16x16x32_bf16 v[176:179], a[224:227], v[40:43], v[176:179]
    s_add_u32 s70, s36, 0x39000
    buffer_load_dwordx4 v[96:99], v31, s[4:7], s70 offen offset:1024 sc1
    v_mfma_f32_16x16x32_bf16 v[152:155], a[228:231], v[40:43], v[152:155]
    ds_read_b128 a[224:227], v30 offset:33024
    v_mfma_f32_16x16x32_bf16 v[156:159], a[228:231], v[44:47], v[156:159]
    v_mfma_f32_16x16x32_bf16 v[172:175], a[232:235], v[44:47], v[172:175]
    ds_read_b128 a[228:231], v29 offset:4352
    s_waitcnt vmcnt(11)
    v_cmp_u_f32 vcc, v48, v52
    v_mfma_f32_16x16x32_bf16 v[168:171], a[232:235], v[40:43], v[168:171]
    buffer_load_dwordx4 v[100:103], v31, s[4:7], s70 offen offset:1280 sc1
    v_mfma_f32_16x16x32_bf16 v[184:187], a[236:239], v[40:43], v[184:187]
    ds_read_b128 a[232:235], v30 offset:6144
    s_waitcnt lgkmcnt(3)
    s_cbranch_vccnz Lfc_205
Lc_206:
    v_mfma_f32_16x16x32_bf16 v[188:191], a[236:239], v[44:47], v[188:191]
    v_mfma_f32_16x16x32_bf16 v[148:151], a[240:243], v[52:55], v[148:151]
    ds_read_b128 a[236:239], v30 offset:34816
    v_mfma_f32_16x16x32_bf16 v[144:147], a[240:243], v[48:51], v[144:147]
    s_add_u32 s70, s36, 0x3b000
    buffer_load_dwordx4 v[104:107], v31, s[4:7], s70 offen sc1
    v_mfma_f32_16x16x32_bf16 v[160:163], a[244:247], v[48:51], v[160:163]
    ds_read_b128 a[240:243], v29 offset:6144
    v_mfma_f32_16x16x32_bf16 v[164:167], a[244:247], v[52:55], v[164:167]
    v_mfma_f32_16x16x32_bf16 v[180:183], a[248:251], v[52:55], v[180:183]
    ds_read_b128 a[244:247], v30 offset:6400
    buffer_load_dwordx4 v[108:111], v31, s[4:7], s70 offen offset:256 sc1
    v_mfma_f32_16x16x32_bf16 v[176:179], a[248:251], v[48:51], v[176:179]
    v_mfma_f32_16x16x32_bf16 v[152:155], a[252:255], v[48:51], v[152:155]
    ds_read_b128 a[248:251], v30 offset:35072
    s_waitcnt lgkmcnt(3)
    v_mfma_f32_16x16x32_bf16 v[156:159], a[252:255], v[52:55], v[156:159]
    v_mfma_f32_16x16x32_bf16 v[172:175], a[224:227], v[52:55], v[172:175]
    ds_read_b128 a[252:255], v29 offset:6400
    s_waitcnt vmcnt(12)
    v_cmp_u_f32 vcc, v56, v60
    v_mfma_f32_16x16x32_bf16 v[168:171], a[224:227], v[48:51], v[168:171]
    s_add_u32 s70, s36, 0x47000
    buffer_load_dwordx4 v[112:115], v31, s[4:7], s70 offen offset:1024 sc1
    v_mfma_f32_16x16x32_bf16 v[184:187], a[228:231], v[48:51], v[184:187]
    ds_read_b128 a[224:227], v30 offset:8192
    s_cbranch_vccnz Lfc_208
Lc_209:
    v_mfma_f32_16x16x32_bf16 v[188:191], a[228:231], v[52:55], v[188:191]
    v_mfma_f32_16x16x32_bf16 v[148:151], a[232:235], v[60:63], v[148:151]
    ds_read_b128 a[228:231], v30 offset:36864
    v_mfma_f32_16x16x32_bf16 v[144:147], a[232:235], v[56:59], v[144:147]
    v_mfma_f32_16x16x32_bf16 v[160:163], a[236:239], v[56:59], v[160:163]
    ds_read_b128 a[232:235], v29 offset:8192
    s_waitcnt lgkmcnt(3)
    v_mfma_f32_16x16x32_bf16 v[164:167], a[236:239], v[60:63], v[164:167]
    buffer_load_dwordx4 v[116:119], v31, s[4:7], s70 offen offset:1280 sc1
    v_mfma_f32_16x16x32_bf16 v[180:183], a[240:243], v[60:63], v[180:183]
    ds_read_b128 a[236:239], v30 offset:8448
    v_mfma_f32_16x16x32_bf16 v[176:179], a[240:243], v[56:59], v[176:179]
    v_mfma_f32_16x16x32_bf16 v[152:155], a[244:247], v[56:59], v[152:155]
    ds_read_b128 a[240:243], v30 offset:37120
    v_mfma_f32_16x16x32_bf16 v[156:159], a[244:247], v[60:63], v[156:159]
    s_add_u32 s70, s36, 0x49000
    buffer_load_dwordx4 v[120:123], v31, s[4:7], s70 offen sc1
    v_mfma_f32_16x16x32_bf16 v[172:175], a[248:251], v[60:63], v[172:175]
    ds_read_b128 a[244:247], v29 offset:8448
    s_waitcnt vmcnt(13)
    v_cmp_u_f32 vcc, v64, v68
    v_mfma_f32_16x16x32_bf16 v[168:171], a[248:251], v[56:59], v[168:171]
    v_mfma_f32_16x16x32_bf16 v[184:187], a[252:255], v[56:59], v[184:187]
    ds_read_b128 a[248:251], v30 offset:10240
    s_waitcnt lgkmcnt(3)
    s_cbranch_vccnz Lfc_211
Lc_212:
    v_mfma_f32_16x16x32_bf16 v[188:191], a[252:255], v[60:63], v[188:191]
    buffer_load_dwordx4 v[124:127], v31, s[4:7], s70 offen offset:256 sc1
    v_mfma_f32_16x16x32_bf16 v[148:151], a[224:227], v[68:71], v[148:151]
    ds_read_b128 a[252:255], v30 offset:38912
    v_mfma_f32_16x16x32_bf16 v[144:147], a[224:227], v[64:67], v[144:147]
    v_mfma_f32_16x16x32_bf16 v[160:163], a[228:231], v[64:67], v[160:163]
    ds_read_b128 a[224:227], v29 offset:10240
    v_mfma_f32_16x16x32_bf16 v[164:167], a[228:231], v[68:71], v[164:167]
    s_add_u32 s70, s36, 0x55000
    buffer_load_dwordx4 v[128:131], v31, s[4:7], s70 offen offset:1024 sc1
    v_mfma_f32_16x16x32_bf16 v[180:183], a[232:235], v[68:71], v[180:183]
    ds_read_b128 a[228:231], v30 offset:10496
    v_mfma_f32_16x16x32_bf16 v[176:179], a[232:235], v[64:67], v[176:179]
    v_mfma_f32_16x16x32_bf16 v[152:155], a[236:239], v[64:67], v[152:155]
    ds_read_b128 a[232:235], v30 offset:39168
    s_waitcnt lgkmcnt(3)
    v_mfma_f32_16x16x32_bf16 v[156:159], a[236:239], v[68:71], v[156:159]
    s_lshl_b32 s94, s24, 11
    s_add_u32 m0, s94, 86016
    s_lshl_b32 s95, s25, 13
    s_add_u32 s94, s94, s95
    s_add_u32 s94, s94, 0x1d0000
    buffer_load_dwordx4 v1, s[4:7], s94 offen lds
    v_mfma_f32_16x16x32_bf16 v[172:175], a[240:243], v[68:71], v[172:175]
    ds_read_b128 a[236:239], v29 offset:10496
    s_waitcnt vmcnt(14)
    v_cmp_u_f32 vcc, v72, v76
    v_mfma_f32_16x16x32_bf16 v[168:171], a[240:243], v[64:67], v[168:171]
    v_mfma_f32_16x16x32_bf16 v[184:187], a[244:247], v[64:67], v[184:187]
    ds_read_b128 a[240:243], v30 offset:12288
    s_cbranch_vccnz Lfc_214
Lc_215:
    v_mfma_f32_16x16x32_bf16 v[188:191], a[244:247], v[68:71], v[188:191]
    buffer_load_dword v208, v2, s[4:7], s93 offen sc1
    v_mfma_f32_16x16x32_bf16 v[148:151], a[248:251], v[76:79], v[148:151]
    ds_read_b128 a[244:247], v30 offset:40960
    buffer_load_dwordx4 v[132:135], v31, s[4:7], s70 offen offset:1280 sc1
    v_mfma_f32_16x16x32_bf16 v[144:147], a[248:251], v[72:75], v[144:147]
    v_mfma_f32_16x16x32_bf16 v[160:163], a[252:255], v[72:75], v[160:163]
    ds_read_b128 a[248:251], v29 offset:12288
    s_waitcnt lgkmcnt(3)
    v_mfma_f32_16x16x32_bf16 v[164:167], a[252:255], v[76:79], v[164:167]
    v_mfma_f32_16x16x32_bf16 v[180:183], a[224:227], v[76:79], v[180:183]
    ds_read_b128 a[252:255], v30 offset:12544
    buffer_load_dword v209, v2, s[4:7], s93 offen offset:256 sc1
    v_mfma_f32_16x16x32_bf16 v[176:179], a[224:227], v[72:75], v[176:179]
    v_mfma_f32_16x16x32_bf16 v[152:155], a[228:231], v[72:75], v[152:155]
    ds_read_b128 a[224:227], v30 offset:41216
    buffer_load_dwordx4 v1, s[4:7], s94 offen offset:1024 lds
    v_mfma_f32_16x16x32_bf16 v[156:159], a[228:231], v[76:79], v[156:159]
    v_mfma_f32_16x16x32_bf16 v[172:175], a[232:235], v[76:79], v[172:175]
    ds_read_b128 a[228:231], v29 offset:12544
    s_waitcnt vmcnt(16)
    v_cmp_u_f32 vcc, v80, v84
    v_mfma_f32_16x16x32_bf16 v[168:171], a[232:235], v[72:75], v[168:171]
    v_mfma_f32_16x16x32_bf16 v[184:187], a[236:239], v[72:75], v[184:187]
    ds_read_b128 a[232:235], v30 offset:14336
    s_waitcnt lgkmcnt(3)
    s_cbranch_vccnz Lfc_217
Lc_218:
    v_mfma_f32_16x16x32_bf16 v[188:191], a[236:239], v[76:79], v[188:191]
    buffer_load_dword v210, v2, s[4:7], s93 offen offset:512 sc1
    v_mfma_f32_16x16x32_bf16 v[148:151], a[240:243], v[84:87], v[148:151]
    ds_read_b128 a[236:239], v30 offset:43008
    buffer_load_dword v211, v2, s[4:7], s93 offen offset:768 sc1
    v_mfma_f32_16x16x32_bf16 v[144:147], a[240:243], v[80:83], v[144:147]
    v_mfma_f32_16x16x32_bf16 v[160:163], a[244:247], v[80:83], v[160:163]
    ds_read_b128 a[240:243], v29 offset:14336
    buffer_load_dword v212, v2, s[4:7], s93 offen offset:1024 sc1
    v_mfma_f32_16x16x32_bf16 v[164:167], a[244:247], v[84:87], v[164:167]
    v_mfma_f32_16x16x32_bf16 v[180:183], a[248:251], v[84:87], v[180:183]
    ds_read_b128 a[244:247], v30 offset:14592
    buffer_load_dword v213, v2, s[4:7], s93 offen offset:1280 sc1
    v_mfma_f32_16x16x32_bf16 v[176:179], a[248:251], v[80:83], v[176:179]
    v_mfma_f32_16x16x32_bf16 v[152:155], a[252:255], v[80:83], v[152:155]
    ds_read_b128 a[248:251], v30 offset:43264
    s_waitcnt lgkmcnt(3)
    v_mfma_f32_16x16x32_bf16 v[156:159], a[252:255], v[84:87], v[156:159]
    s_add_u32 s70, s36, 0x57000
    buffer_load_dwordx4 v[136:139], v31, s[4:7], s70 offen sc1
    v_mfma_f32_16x16x32_bf16 v[172:175], a[224:227], v[84:87], v[172:175]
    ds_read_b128 a[252:255], v29 offset:14592
    s_waitcnt vmcnt(19)
    v_cmp_u_f32 vcc, v88, v92
    v_mfma_f32_16x16x32_bf16 v[168:171], a[224:227], v[80:83], v[168:171]
    v_mfma_f32_16x16x32_bf16 v[184:187], a[228:231], v[80:83], v[184:187]
    ds_read_b128 a[224:227], v30 offset:16384
    s_cbranch_vccnz Lfc_220
Lc_221:
    v_mfma_f32_16x16x32_bf16 v[188:191], a[228:231], v[84:87], v[188:191]
    buffer_load_dword v214, v2, s[4:7], s93 offen offset:1536 sc1
    v_mfma_f32_16x16x32_bf16 v[148:151], a[232:235], v[92:95], v[148:151]
    ds_read_b128 a[228:231], v30 offset:45056
    buffer_load_dword v215, v2, s[4:7], s93 offen offset:1792 sc1
    v_mfma_f32_16x16x32_bf16 v[144:147], a[232:235], v[88:91], v[144:147]
    v_mfma_f32_16x16x32_bf16 v[160:163], a[236:239], v[88:91], v[160:163]
    ds_read_b128 a[232:235], v29 offset:16384
    s_waitcnt lgkmcnt(3)
    v_mfma_f32_16x16x32_bf16 v[164:167], a[236:239], v[92:95], v[164:167]
    buffer_load_dword v216, v2, s[4:7], s93 offen offset:2048 sc1
    v_mfma_f32_16x16x32_bf16 v[180:183], a[240:243], v[92:95], v[180:183]
    ds_read_b128 a[236:239], v30 offset:16640
    buffer_load_dwordx4 v[140:143], v31, s[4:7], s70 offen offset:256 sc1
    v_mfma_f32_16x16x32_bf16 v[176:179], a[240:243], v[88:91], v[176:179]
    v_mfma_f32_16x16x32_bf16 v[152:155], a[244:247], v[88:91], v[152:155]
    ds_read_b128 a[240:243], v30 offset:45312
    v_mfma_f32_16x16x32_bf16 v[156:159], a[244:247], v[92:95], v[156:159]
    v_mfma_f32_16x16x32_bf16 v[172:175], a[248:251], v[92:95], v[172:175]
    ds_read_b128 a[244:247], v29 offset:16640
    s_waitcnt vmcnt(21)
    v_cmp_u_f32 vcc, v96, v100
    v_mfma_f32_16x16x32_bf16 v[168:171], a[248:251], v[88:91], v[168:171]
    buffer_load_dword v217, v2, s[4:7], s93 offen offset:2304 sc1
    v_mfma_f32_16x16x32_bf16 v[184:187], a[252:255], v[88:91], v[184:187]
    ds_read_b128 a[248:251], v30 offset:18432
    s_waitcnt lgkmcnt(3)
    s_cbranch_vccnz Lfc_223
Lc_224:
    v_mfma_f32_16x16x32_bf16 v[188:191], a[252:255], v[92:95], v[188:191]
    buffer_load_dword v218, v2, s[4:7], s93 offen offset:2560 sc1
    v_mfma_f32_16x16x32_bf16 v[148:151], a[224:227], v[100:103], v[148:151]
    ds_read_b128 a[252:255], v30 offset:47104
    buffer_load_dword v219, v2, s[4:7], s93 offen offset:2816 sc1
    v_mfma_f32_16x16x32_bf16 v[144:147], a[224:227], v[96:99], v[144:147]
    v_mfma_f32_16x16x32_bf16 v[160:163], a[228:231], v[96:99], v[160:163]
    ds_read_b128 a[224:227], v29 offset:18432
    buffer_load_dword v220, v2, s[4:7], s93 offen offset:3072 sc1
    v_mfma_f32_16x16x32_bf16 v[164:167], a[228:231], v[100:103], v[164:167]
    v_mfma_f32_16x16x32_bf16 v[180:183], a[232:235], v[100:103], v[180:183]
    ds_read_b128 a[228:231], v30 offset:18688
    buffer_load_dword v221, v2, s[4:7], s93 offen offset:3328 sc1
    v_mfma_f32_16x16x32_bf16 v[176:179], a[232:235], v[96:99], v[176:179]
    v_mfma_f32_16x16x32_bf16 v[152:155], a[236:239], v[96:99], v[152:155]
    ds_read_b128 a[232:235], v30 offset:47360
    s_waitcnt lgkmcnt(3)
    v_mfma_f32_16x16x32_bf16 v[156:159], a[236:239], v[100:103], v[156:159]
    s_add_u32 m0, s55, 0x7000
    s_add_u32 s72, s39, 0xe000
    buffer_load_dwordx4 v1, s[4:7], s72 offen lds
    v_mfma_f32_16x16x32_bf16 v[172:175], a[240:243], v[100:103], v[172:175]
    ds_read_b128 a[236:239], v29 offset:18688
    s_waitcnt vmcnt(25)
    v_cmp_u_f32 vcc, v104, v108
    v_mfma_f32_16x16x32_bf16 v[168:171], a[240:243], v[96:99], v[168:171]
    v_mfma_f32_16x16x32_bf16 v[184:187], a[244:247], v[96:99], v[184:187]
    ds_read_b128 a[240:243], v30 offset:20480
    s_cbranch_vccnz Lfc_226
Lc_227:
    buffer_load_dwordx4 v1, s[4:7], s72 offen offset:1024 lds
    v_mfma_f32_16x16x32_bf16 v[188:191], a[244:247], v[100:103], v[188:191]
    v_mfma_f32_16x16x32_bf16 v[148:151], a[248:251], v[108:111], v[148:151]
    ds_read_b128 a[244:247], v30 offset:49152
    v_mfma_f32_16x16x32_bf16 v[144:147], a[248:251], v[104:107], v[144:147]
    v_mfma_f32_16x16x32_bf16 v[160:163], a[252:255], v[104:107], v[160:163]
    ds_read_b128 a[248:251], v29 offset:20480
    s_waitcnt lgkmcnt(3)
    buffer_load_dwordx4 v1, s[4:7], s72 offen offset:2048 lds
    v_mfma_f32_16x16x32_bf16 v[164:167], a[252:255], v[108:111], v[164:167]
    v_mfma_f32_16x16x32_bf16 v[180:183], a[224:227], v[108:111], v[180:183]
    ds_read_b128 a[252:255], v30 offset:20736
    v_mfma_f32_16x16x32_bf16 v[176:179], a[224:227], v[104:107], v[176:179]
    v_mfma_f32_16x16x32_bf16 v[152:155], a[228:231], v[104:107], v[152:155]
    ds_read_b128 a[224:227], v30 offset:49408
    buffer_load_dwordx4 v1, s[4:7], s72 offen offset:3072 lds
    s_add_u32 m0, s55, 0x8000
    v_mfma_f32_16x16x32_bf16 v[156:159], a[228:231], v[108:111], v[156:159]
    v_mfma_f32_16x16x32_bf16 v[172:175], a[232:235], v[108:111], v[172:175]
    ds_read_b128 a[228:231], v29 offset:20736
    s_waitcnt vmcnt(26)
    v_cmp_u_f32 vcc, v112, v116
    v_mfma_f32_16x16x32_bf16 v[168:171], a[232:235], v[104:107], v[168:171]
    v_mfma_f32_16x16x32_bf16 v[184:187], a[236:239], v[104:107], v[184:187]
    ds_read_b128 a[232:235], v30 offset:22528
    s_waitcnt lgkmcnt(3)
    s_cbranch_vccnz Lfc_229
Lc_230:
    v_mfma_f32_16x16x32_bf16 v[188:191], a[236:239], v[108:111], v[188:191]
    buffer_load_dwordx4 v0, s[4:7], s72 offen lds
    v_mfma_f32_16x16x32_bf16 v[148:151], a[240:243], v[116:119], v[148:151]
    ds_read_b128 a[236:239], v30 offset:51200
    v_mfma_f32_16x16x32_bf16 v[144:147], a[240:243], v[112:115], v[144:147]
    v_mfma_f32_16x16x32_bf16 v[160:163], a[244:247], v[112:115], v[160:163]
    ds_read_b128 a[240:243], v29 offset:22528
    buffer_load_dwordx4 v0, s[4:7], s72 offen offset:1024 lds
    v_mfma_f32_16x16x32_bf16 v[164:167], a[244:247], v[116:119], v[164:167]
    v_mfma_f32_16x16x32_bf16 v[180:183], a[248:251], v[116:119], v[180:183]
    ds_read_b128 a[244:247], v30 offset:22784
    v_mfma_f32_16x16x32_bf16 v[176:179], a[248:251], v[112:115], v[176:179]
    v_mfma_f32_16x16x32_bf16 v[152:155], a[252:255], v[112:115], v[152:155]
    ds_read_b128 a[248:251], v30 offset:51456
    s_waitcnt lgkmcnt(3)
    buffer_load_dwordx4 v0, s[4:7], s72 offen offset:2048 lds
    v_mfma_f32_16x16x32_bf16 v[156:159], a[252:255], v[116:119], v[156:159]
    v_mfma_f32_16x16x32_bf16 v[172:175], a[224:227], v[116:119], v[172:175]
    ds_read_b128 a[252:255], v29 offset:22784
    s_waitcnt vmcnt(27)
    v_cmp_u_f32 vcc, v120, v124
    v_mfma_f32_16x16x32_bf16 v[168:171], a[224:227], v[112:115], v[168:171]
    v_mfma_f32_16x16x32_bf16 v[184:187], a[228:231], v[112:115], v[184:187]
    ds_read_b128 a[224:227], v30 offset:24576
    s_cbranch_vccnz Lfc_232
Lc_233:
    v_mfma_f32_16x16x32_bf16 v[188:191], a[228:231], v[116:119], v[188:191]
    v_mfma_f32_16x16x32_bf16 v[148:151], a[232:235], v[124:127], v[148:151]
    ds_read_b128 a[228:231], v30 offset:53248
    v_mfma_f32_16x16x32_bf16 v[144:147], a[232:235], v[120:123], v[144:147]
    v_mfma_f32_16x16x32_bf16 v[160:163], a[236:239], v[120:123], v[160:163]
    ds_read_b128 a[232:235], v29 offset:24576
    s_waitcnt lgkmcnt(3)
    v_mfma_f32_16x16x32_bf16 v[164:167], a[236:239], v[124:127], v[164:167]
    v_mfma_f32_16x16x32_bf16 v[180:183], a[240:243], v[124:127], v[180:183]
    ds_read_b128 a[236:239], v30 offset:24832
    v_mfma_f32_16x16x32_bf16 v[176:179], a[240:243], v[120:123], v[176:179]
    v_mfma_f32_16x16x32_bf16 v[152:155], a[244:247], v[120:123], v[152:155]
    ds_read_b128 a[240:243], v30 offset:53504
    v_mfma_f32_16x16x32_bf16 v[156:159], a[244:247], v[124:127], v[156:159]
    v_mfma_f32_16x16x32_bf16 v[172:175], a[248:251], v[124:127], v[172:175]
    ds_read_b128 a[244:247], v29 offset:24832
    s_waitcnt vmcnt(23)
    v_cmp_u_f32 vcc, v128, v132
    v_mfma_f32_16x16x32_bf16 v[168:171], a[248:251], v[120:123], v[168:171]
    v_mfma_f32_16x16x32_bf16 v[184:187], a[252:255], v[120:123], v[184:187]
    ds_read_b128 a[248:251], v30 offset:26624
    s_waitcnt lgkmcnt(3)
    s_cbranch_vccnz Lfc_235
Lc_236:
    v_mfma_f32_16x16x32_bf16 v[188:191], a[252:255], v[124:127], v[188:191]
    v_mfma_f32_16x16x32_bf16 v[148:151], a[224:227], v[132:135], v[148:151]
    ds_read_b128 a[252:255], v30 offset:55296
    v_mfma_f32_16x16x32_bf16 v[144:147], a[224:227], v[128:131], v[144:147]
    v_mfma_f32_16x16x32_bf16 v[160:163], a[228:231], v[128:131], v[160:163]
    ds_read_b128 a[224:227], v29 offset:26624
    v_mfma_f32_16x16x32_bf16 v[164:167], a[228:231], v[132:135], v[164:167]
    v_mfma_f32_16x16x32_bf16 v[180:183], a[232:235], v[132:135], v[180:183]
    ds_read_b128 a[228:231], v30 offset:26880
    v_mfma_f32_16x16x32_bf16 v[176:179], a[232:235], v[128:131], v[176:179]
    v_mfma_f32_16x16x32_bf16 v[152:155], a[236:239], v[128:131], v[152:155]
    ds_read_b128 a[232:235], v30 offset:55552
    s_waitcnt lgkmcnt(3)
    v_mfma_f32_16x16x32_bf16 v[156:159], a[236:239], v[132:135], v[156:159]
    v_mfma_f32_16x16x32_bf16 v[172:175], a[240:243], v[132:135], v[172:175]
    ds_read_b128 a[236:239], v29 offset:26880
    s_waitcnt vmcnt(12)
    v_cmp_u_f32 vcc, v136, v140
    v_mfma_f32_16x16x32_bf16 v[168:171], a[240:243], v[128:131], v[168:171]
    v_mfma_f32_16x16x32_bf16 v[184:187], a[244:247], v[128:131], v[184:187]
    s_barrier
    ds_read_b128 a[240:243], v28 offset:0
    v_mfma_f32_16x16x32_bf16 v[188:191], a[244:247], v[132:135], v[188:191]
    s_cbranch_vccnz Lfc_238
Lc_239:
    v_mfma_f32_16x16x32_bf16 v[148:151], a[248:251], v[140:143], v[148:151]
    ds_read_b128 a[244:247], v28 offset:256
    v_mfma_f32_16x16x32_bf16 v[144:147], a[248:251], v[136:139], v[144:147]
    v_mfma_f32_16x16x32_bf16 v[160:163], a[252:255], v[136:139], v[160:163]
    ds_read_b128 a[248:251], v28 offset:2048
    s_waitcnt lgkmcnt(3)
    v_add_f32 v208, v208, v209
    v_mfma_f32_16x16x32_bf16 v[164:167], a[252:255], v[140:143], v[164:167]
    v_add_f32 v210, v210, v211
    v_add_f32 v212, v212, v213
    v_add_f32 v214, v214, v215
    v_mfma_f32_16x16x32_bf16 v[180:183], a[224:227], v[140:143], v[180:183]
    ds_read_b128 a[252:255], v28 offset:2304
    s_waitcnt vmcnt(11)
    v_add_f32 v216, v216, v217
    s_waitcnt vmcnt(9)
    v_add_f32 v218, v218, v219
    v_mfma_f32_16x16x32_bf16 v[176:179], a[224:227], v[136:139], v[176:179]
    s_waitcnt vmcnt(7)
    v_add_f32 v220, v220, v221
    v_add_f32 v208, v208, v210
    v_add_f32 v212, v212, v214
    v_mfma_f32_16x16x32_bf16 v[152:155], a[228:231], v[136:139], v[152:155]
    ds_read_b128 a[224:227], v28 offset:4096
    v_add_f32 v216, v216, v218
    v_add_f32 v208, v208, v212
    v_mfma_f32_16x16x32_bf16 v[156:159], a[228:231], v[140:143], v[156:159]
    v_add_f32 v216, v216, v220
    v_add_f32 v208, v208, v216
    v_mfma_f32_16x16x32_bf16 v[172:175], a[232:235], v[140:143], v[172:175]
    ds_read_b128 a[228:231], v28 offset:4352
    v_mfma_f32_16x16x32_bf16 v[168:171], a[232:235], v[136:139], v[168:171]
    v_mfma_f32_16x16x32_bf16 v[184:187], a[236:239], v[136:139], v[184:187]
    ds_read_b128 a[232:235], v29 offset:30976
    s_waitcnt lgkmcnt(3)
    v_mfma_f32_16x16x32_bf16 v[188:191], a[236:239], v[140:143], v[188:191]
    v_cmp_u_f32 vcc, v208, v208
    s_cbranch_vccnz Lnn_241
Lc_242:
    v_mfma_f32_16x16x32_bf16 v[192:195], a[240:243], v[32:35], 0
    v_mov_b32 v209, v208
    s_nop 0
    v_mfma_f32_16x16x32_bf16 v[196:199], a[240:243], v[36:39], 0
    v_permlane32_swap_b32 v208, v209
    s_barrier
    v_mfma_f32_16x16x32_bf16 v[204:207], a[244:247], v[36:39], 0
    ds_read_b128 a[236:239], v29 offset:32768
    v_mul_f32 v208, 0xbb124925, v208
    v_mov_b32 v210, 0x3727c5ac
    v_mfma_f32_16x16x32_bf16 v[200:203], a[244:247], v[32:35], 0
    s_add_u32 m0, s55, 0x1a000
    s_add_u32 s73, s39, 0x7000
    buffer_load_dwordx4 v1, s[4:7], s73 offen lds
    v_mfma_f32_16x16x32_bf16 v[192:195], a[248:251], v[40:43], v[192:195]
    v_fmac_f32 v210, 0x3b124925, v209
    v_fma_f32 v25, -v208, v208, v210
    v_max_f32 v25, 0x3727c5ac, v25
    v_mfma_f32_16x16x32_bf16 v[196:199], a[248:251], v[44:47], v[196:199]
    v_cvt_pk_bf16_f32 v20, v208, v208
    v_rsq_f32 v24, v25
    v_mfma_f32_16x16x32_bf16 v[204:207], a[252:255], v[44:47], v[204:207]
    ds_read_b128 a[240:243], v29 offset:34816
    s_waitcnt lgkmcnt(2)
    buffer_load_dwordx4 v1, s[4:7], s73 offen offset:1024 lds
    v_mfma_f32_16x16x32_bf16 v[200:203], a[252:255], v[40:43], v[200:203]
    v_and_b32 v212, 0xffff0000, v20
    v_sub_f32 v212, v208, v212
    v_cvt_pk_bf16_f32 v21, v212, v212
    v_mfma_f32_16x16x32_bf16 v[192:195], a[224:227], v[48:51], v[192:195]
    v_mov_b32 v22, v20
    v_mov_b32 v23, v21
    v_mul_f32 v26, 0xbfb8aa3b, v24
    v_mfma_f32_16x16x32_bf16 v[196:199], a[224:227], v[52:55], v[196:199]
    v_permlane16_swap_b32 v20, v22
    v_mfma_f32_16x16x32_bf16 v[204:207], a[228:231], v[52:55], v[204:207]
    ds_read_b128 a[244:247], v28 offset:6144
    buffer_load_dwordx4 v1, s[4:7], s73 offen offset:2048 lds
    v_mfma_f32_16x16x32_bf16 v[200:203], a[228:231], v[48:51], v[200:203]
    v_permlane16_swap_b32 v21, v23
    v_mov_b32 v27, v26
    s_nop 0
    v_mfma_f32_16x16x16_bf16 v[144:147], a[232:233], v[20:21], v[144:147]
    ds_read_b128 a[248:251], v28 offset:6400
    v_mov_b32 v24, v25
    v_mfma_f32_16x16x16_bf16 v[148:151], a[232:233], v[22:23], v[148:151]
    v_permlane16_swap_b32 v26, v27
    v_mfma_f32_16x16x16_bf16 v[152:155], a[234:235], v[20:21], v[152:155]
    ds_read_b128 a[252:255], v28 offset:8192
    s_waitcnt lgkmcnt(3)
    v_mfma_f32_16x16x16_bf16 v[156:159], a[234:235], v[22:23], v[156:159]
    buffer_load_dwordx4 v1, s[4:7], s73 offen offset:3072 lds
    s_add_u32 m0, s55, 0x1b000
    v_mfma_f32_16x16x16_bf16 v[160:163], a[236:237], v[20:21], v[160:163]
    ds_read_b128 a[224:227], v28 offset:8448
    v_permlane16_swap_b32 v25, v24
    v_mfma_f32_16x16x16_bf16 v[164:167], a[236:237], v[22:23], v[164:167]
    v_mfma_f32_16x16x16_bf16 v[168:171], a[238:239], v[20:21], v[168:171]
    ds_read_b128 a[228:231], v28 offset:10240
    buffer_load_dwordx4 v0, s[4:7], s73 offen lds
    v_mfma_f32_16x16x16_bf16 v[172:175], a[238:239], v[22:23], v[172:175]
    v_mfma_f32_16x16x16_bf16 v[176:179], a[240:241], v[20:21], v[176:179]
    ds_read_b128 a[232:235], v28 offset:10496
    v_mfma_f32_16x16x16_bf16 v[180:183], a[240:241], v[22:23], v[180:183]
    v_pk_mul_f32 v[224:225], v[144:145], v[26:27] op_sel:[0,0] op_sel_hi:[1,0]
    v_pk_mul_f32 v[226:227], v[146:147], v[26:27] op_sel:[0,0] op_sel_hi:[1,0]
    v_pk_mul_f32 v[228:229], v[148:149], v[26:27] op_sel:[0,1] op_sel_hi:[1,1]
    v_pk_mul_f32 v[230:231], v[150:151], v[26:27] op_sel:[0,1] op_sel_hi:[1,1]
    v_pk_mul_f32 v[144:145], v[144:145], v[152:153]
    v_pk_mul_f32 v[146:147], v[146:147], v[154:155]
    v_pk_mul_f32 v[148:149], v[148:149], v[156:157]
    v_pk_mul_f32 v[150:151], v[150:151], v[158:159]
    v_mfma_f32_16x16x16_bf16 v[184:187], a[242:243], v[20:21], v[184:187]
    ds_read_b128 a[236:239], v28 offset:12288
    s_waitcnt lgkmcnt(3)
    buffer_load_dwordx4 v0, s[4:7], s73 offen offset:1024 lds
    v_mfma_f32_16x16x16_bf16 v[188:191], a[242:243], v[22:23], v[188:191]
    v_exp_f32 v224, v224
    v_mfma_f32_16x16x32_bf16 v[192:195], a[244:247], v[56:59], v[192:195]
    ds_read_b128 a[240:243], v28 offset:12544
    v_exp_f32 v225, v225
    v_mfma_f32_16x16x32_bf16 v[196:199], a[244:247], v[60:63], v[196:199]
    v_exp_f32 v226, v226
    v_mfma_f32_16x16x32_bf16 v[204:207], a[248:251], v[60:63], v[204:207]
    ds_read_b128 a[244:247], v28 offset:14336
    buffer_load_dwordx4 v0, s[4:7], s73 offen offset:2048 lds
    v_mfma_f32_16x16x32_bf16 v[200:203], a[248:251], v[56:59], v[200:203]
    v_exp_f32 v227, v227
    v_mfma_f32_16x16x32_bf16 v[192:195], a[252:255], v[64:67], v[192:195]
    ds_read_b128 a[248:251], v28 offset:14592
    v_exp_f32 v228, v228
    v_mfma_f32_16x16x32_bf16 v[196:199], a[252:255], v[68:71], v[196:199]
    v_exp_f32 v229, v229
    v_mfma_f32_16x16x32_bf16 v[204:207], a[224:227], v[68:71], v[204:207]
    ds_read_b128 a[252:255], v28 offset:16384
    s_waitcnt lgkmcnt(3)
    v_mfma_f32_16x16x32_bf16 v[200:203], a[224:227], v[64:67], v[200:203]
    s_add_u32 m0, s55, 0x21000
    s_add_u32 s74, s39, 0x0
    buffer_load_dwordx4 v1, s[4:7], s74 offen lds
    v_mfma_f32_16x16x32_bf16 v[192:195], a[228:231], v[72:75], v[192:195]
    ds_read_b128 a[224:227], v28 offset:16640
    v_mfma_f32_16x16x32_bf16 v[196:199], a[228:231], v[76:79], v[196:199]
    v_exp_f32 v230, v230
    v_exp_f32 v231, v231
    v_pk_fma_f32 v[224:225], v[224:225], v[24:25], v[24:25] op_sel:[0,1,1] op_sel_hi:[1,1,1]
    v_pk_fma_f32 v[226:227], v[226:227], v[24:25], v[24:25] op_sel:[0,1,1] op_sel_hi:[1,1,1]
    v_pk_fma_f32 v[228:229], v[228:229], v[24:25], v[24:25] op_sel:[0,0,0] op_sel_hi:[1,0,0]
    v_pk_fma_f32 v[230:231], v[230:231], v[24:25], v[24:25] op_sel:[0,0,0] op_sel_hi:[1,0,0]
    v_mfma_f32_16x16x32_bf16 v[204:207], a[232:235], v[76:79], v[204:207]
    ds_read_b128 a[228:231], v28 offset:18432
    buffer_load_dwordx4 v1, s[4:7], s74 offen offset:1024 lds
    v_mfma_f32_16x16x32_bf16 v[200:203], a[232:235], v[72:75], v[200:203]
    v_rcp_f32 v224, v224
    v_mfma_f32_16x16x32_bf16 v[192:195], a[236:239], v[80:83], v[192:195]
    ds_read_b128 a[232:235], v28 offset:18688
    v_rcp_f32 v225, v225
    v_mfma_f32_16x16x32_bf16 v[196:199], a[236:239], v[84:87], v[196:199]
    v_rcp_f32 v226, v226
    v_mfma_f32_16x16x32_bf16 v[204:207], a[240:243], v[84:87], v[204:207]
    ds_read_b128 a[236:239], v28 offset:20480
    s_waitcnt lgkmcnt(3)
    buffer_load_dwordx4 v1, s[4:7], s74 offen offset:2048 lds
    v_mfma_f32_16x16x32_bf16 v[200:203], a[240:243], v[80:83], v[200:203]
    v_rcp_f32 v227, v227
    v_mfma_f32_16x16x32_bf16 v[192:195], a[244:247], v[88:91], v[192:195]
    ds_read_b128 a[240:243], v28 offset:20736
    v_rcp_f32 v228, v228
    v_mfma_f32_16x16x32_bf16 v[196:199], a[244:247], v[92:95], v[196:199]
    v_rcp_f32 v229, v229
    v_mfma_f32_16x16x32_bf16 v[204:207], a[248:251], v[92:95], v[204:207]
    ds_read_b128 a[244:247], v28 offset:22528
    buffer_load_dwordx4 v1, s[4:7], s74 offen offset:3072 lds
    s_add_u32 m0, s55, 0x22000
    v_mfma_f32_16x16x32_bf16 v[200:203], a[248:251], v[88:91], v[200:203]
    v_rcp_f32 v230, v230
    v_rcp_f32 v231, v231
    v_pk_mul_f32 v[144:145], v[144:145], v[224:225]
    v_pk_mul_f32 v[146:147], v[146:147], v[226:227]
    v_pk_mul_f32 v[148:149], v[148:149], v[228:229]
    v_pk_mul_f32 v[150:151], v[150:151], v[230:231]
    v_mfma_f32_16x16x32_bf16 v[192:195], a[252:255], v[96:99], v[192:195]
    ds_read_b128 a[248:251], v28 offset:22784
    buffer_load_dwordx4 v0, s[4:7], s74 offen lds
    v_cvt_pk_bf16_f32 v232, v144, v145
    v_mfma_f32_16x16x32_bf16 v[196:199], a[252:255], v[100:103], v[196:199]
    v_cvt_pk_bf16_f32 v234, v148, v149
    v_cvt_pk_bf16_f32 v233, v146, v147
    v_cvt_pk_bf16_f32 v235, v150, v151
    v_mfma_f32_16x16x32_bf16 v[204:207], a[224:227], v[100:103], v[204:207]
    ds_read_b128 a[252:255], v28 offset:24576
    s_waitcnt lgkmcnt(3)
    v_mfma_f32_16x16x32_bf16 v[200:203], a[224:227], v[96:99], v[200:203]
    v_permlane16_swap_b32 v232, v234
    v_mfma_f32_16x16x32_bf16 v[192:195], a[228:231], v[104:107], v[192:195]
    ds_read_b128 a[224:227], v28 offset:24832
    buffer_load_dwordx4 v0, s[4:7], s74 offen offset:1024 lds
    v_mfma_f32_16x16x32_bf16 v[196:199], a[228:231], v[108:111], v[196:199]
    v_permlane16_swap_b32 v233, v235
    v_mfma_f32_16x16x32_bf16 v[204:207], a[232:235], v[108:111], v[204:207]
    ds_read_b128 a[228:231], v28 offset:26624
    v_mfma_f32_16x16x32_bf16 v[200:203], a[232:235], v[104:107], v[200:203]
    buffer_store_dwordx4 v[232:235], v1, s[4:7], s57 offen sc1
    v_mfma_f32_16x16x32_bf16 v[192:195], a[236:239], v[112:115], v[192:195]
    ds_read_b128 a[232:235], v28 offset:26880
    v_mfma_f32_16x16x32_bf16 v[196:199], a[236:239], v[116:119], v[196:199]
    v_pk_mul_f32 v[224:225], v[160:161], v[26:27] op_sel:[0,0] op_sel_hi:[1,0]
    v_pk_mul_f32 v[226:227], v[162:163], v[26:27] op_sel:[0,0] op_sel_hi:[1,0]
    v_pk_mul_f32 v[228:229], v[164:165], v[26:27] op_sel:[0,1] op_sel_hi:[1,1]
    v_pk_mul_f32 v[230:231], v[166:167], v[26:27] op_sel:[0,1] op_sel_hi:[1,1]
    v_pk_mul_f32 v[160:161], v[160:161], v[168:169]
    v_pk_mul_f32 v[162:163], v[162:163], v[170:171]
    v_pk_mul_f32 v[164:165], v[164:165], v[172:173]
    v_pk_mul_f32 v[166:167], v[166:167], v[174:175]
    v_mfma_f32_16x16x32_bf16 v[204:207], a[240:243], v[116:119], v[204:207]
    ds_read_b128 a[236:239], v29 offset:33024
    s_waitcnt lgkmcnt(3)
    v_mfma_f32_16x16x32_bf16 v[200:203], a[240:243], v[112:115], v[200:203]
    v_exp_f32 v224, v224
    v_mfma_f32_16x16x32_bf16 v[192:195], a[244:247], v[120:123], v[192:195]
    v_exp_f32 v225, v225
    v_mfma_f32_16x16x32_bf16 v[196:199], a[244:247], v[124:127], v[196:199]
    v_exp_f32 v226, v226
    v_mfma_f32_16x16x32_bf16 v[204:207], a[248:251], v[124:127], v[204:207]
    s_waitcnt vmcnt(14)
    s_barrier
    ds_read_b128 a[240:243], v28 offset:28672
    v_mfma_f32_16x16x32_bf16 v[200:203], a[248:251], v[120:123], v[200:203]
    buffer_load_dwordx4 v0, s[4:7], s74 offen offset:2048 lds
    v_exp_f32 v227, v227
    v_mfma_f32_16x16x32_bf16 v[192:195], a[252:255], v[128:131], v[192:195]
    ds_read_b128 a[244:247], v28 offset:28928
    v_exp_f32 v228, v228
    v_mfma_f32_16x16x32_bf16 v[196:199], a[252:255], v[132:135], v[196:199]
    v_exp_f32 v229, v229
    v_mfma_f32_16x16x32_bf16 v[204:207], a[224:227], v[132:135], v[204:207]
    ds_read_b128 a[248:251], v28 offset:30720
    s_waitcnt lgkmcnt(3)
    v_mfma_f32_16x16x32_bf16 v[200:203], a[224:227], v[128:131], v[200:203]
    v_exp_f32 v230, v230
    v_exp_f32 v231, v231
    v_pk_fma_f32 v[224:225], v[224:225], v[24:25], v[24:25] op_sel:[0,1,1] op_sel_hi:[1,1,1]
    v_pk_fma_f32 v[226:227], v[226:227], v[24:25], v[24:25] op_sel:[0,1,1] op_sel_hi:[1,1,1]
    v_pk_fma_f32 v[228:229], v[228:229], v[24:25], v[24:25] op_sel:[0,0,0] op_sel_hi:[1,0,0]
    v_pk_fma_f32 v[230:231], v[230:231], v[24:25], v[24:25] op_sel:[0,0,0] op_sel_hi:[1,0,0]
    v_mfma_f32_16x16x32_bf16 v[192:195], a[228:231], v[136:139], v[192:195]
    ds_read_b128 a[252:255], v28 offset:30976
    v_rcp_f32 v224, v224
    v_mfma_f32_16x16x32_bf16 v[196:199], a[228:231], v[140:143], v[196:199]
    v_rcp_f32 v225, v225
    v_mfma_f32_16x16x32_bf16 v[204:207], a[232:235], v[140:143], v[204:207]
    ds_read_b128 a[224:227], v28 offset:32768
    v_rcp_f32 v226, v226
    v_mfma_f32_16x16x32_bf16 v[200:203], a[232:235], v[136:139], v[200:203]
    v_rcp_f32 v227, v227
    v_mfma_f32_16x16x16_bf16 v[192:195], a[236:237], v[20:21], v[192:195]
    ds_read_b128 a[228:231], v28 offset:33024
    v_rcp_f32 v228, v228
    v_mfma_f32_16x16x16_bf16 v[196:199], a[236:237], v[22:23], v[196:199]
    v_rcp_f32 v229, v229
    v_mfma_f32_16x16x16_bf16 v[200:203], a[238:239], v[20:21], v[200:203]
    ds_read_b128 a[232:235], v28 offset:34816
    s_waitcnt lgkmcnt(3)
    v_mfma_f32_16x16x16_bf16 v[204:207], a[238:239], v[22:23], v[204:207]
    v_rcp_f32 v230, v230
    v_rcp_f32 v231, v231
    v_pk_mul_f32 v[160:161], v[160:161], v[224:225]
    v_pk_mul_f32 v[162:163], v[162:163], v[226:227]
    v_pk_mul_f32 v[164:165], v[164:165], v[228:229]
    v_pk_mul_f32 v[166:167], v[166:167], v[230:231]
    v_mfma_f32_16x16x32_bf16 v[208:211], a[240:243], v[32:35], 0
    ds_read_b128 a[236:239], v28 offset:35072
    v_cvt_pk_bf16_f32 v236, v160, v161
    v_cvt_pk_bf16_f32 v238, v164, v165
    v_mfma_f32_16x16x32_bf16 v[212:215], a[240:243], v[36:39], 0
    v_cvt_pk_bf16_f32 v237, v162, v163
    v_cvt_pk_bf16_f32 v239, v166, v167
    s_add_u32 s84, s46, 0x0
    v_mfma_f32_16x16x32_bf16 v[220:223], a[244:247], v[36:39], 0
    ds_read_b128 a[240:243], v28 offset:36864
    v_permlane16_swap_b32 v236, v238
    v_mfma_f32_16x16x32_bf16 v[216:219], a[244:247], v[32:35], 0
    v_permlane16_swap_b32 v237, v239
    s_add_u32 s85, s47, 0x0
    v_mfma_f32_16x16x32_bf16 v[208:211], a[248:251], v[40:43], v[208:211]
    ds_read_b128 a[244:247], v28 offset:37120
    s_add_u32 s86, s46, 0x1000
    s_add_u32 s87, s47, 0x1000
    v_mfma_f32_16x16x32_bf16 v[212:215], a[248:251], v[44:47], v[212:215]
    buffer_store_dwordx4 v[236:239], v1, s[4:7], s57 offen offset:1024 sc1
    v_mfma_f32_16x16x32_bf16 v[220:223], a[252:255], v[44:47], v[220:223]
    ds_read_b128 a[248:251], v28 offset:38912
    s_waitcnt lgkmcnt(3)
    s_add_u32 s88, s46, 0xe000
    v_mfma_f32_16x16x32_bf16 v[216:219], a[252:255], v[40:43], v[216:219]
    v_pk_mul_f32 v[224:225], v[176:177], v[26:27] op_sel:[0,0] op_sel_hi:[1,0]
    v_pk_mul_f32 v[226:227], v[178:179], v[26:27] op_sel:[0,0] op_sel_hi:[1,0]
    v_pk_mul_f32 v[228:229], v[180:181], v[26:27] op_sel:[0,1] op_sel_hi:[1,1]
    v_pk_mul_f32 v[230:231], v[182:183], v[26:27] op_sel:[0,1] op_sel_hi:[1,1]
    v_pk_mul_f32 v[176:177], v[176:177], v[184:185]
    v_pk_mul_f32 v[178:179], v[178:179], v[186:187]
    v_pk_mul_f32 v[180:181], v[180:181], v[188:189]
    v_pk_mul_f32 v[182:183], v[182:183], v[190:191]
    v_mfma_f32_16x16x32_bf16 v[208:211], a[224:227], v[48:51], v[208:211]
    ds_read_b128 a[252:255], v28 offset:39168
    v_exp_f32 v224, v224
    v_mfma_f32_16x16x32_bf16 v[212:215], a[224:227], v[52:55], v[212:215]
    v_exp_f32 v225, v225
    s_add_u32 s89, s47, 0xe000
    v_mfma_f32_16x16x32_bf16 v[220:223], a[228:231], v[52:55], v[220:223]
    ds_read_b128 a[224:227], v28 offset:40960
    v_exp_f32 v226, v226
    v_mfma_f32_16x16x32_bf16 v[216:219], a[228:231], v[48:51], v[216:219]
    v_exp_f32 v227, v227
    s_add_u32 s90, s46, 0xf000
    v_mfma_f32_16x16x32_bf16 v[208:211], a[232:235], v[56:59], v[208:211]
    ds_read_b128 a[228:231], v28 offset:41216
    v_exp_f32 v228, v228
    v_mfma_f32_16x16x32_bf16 v[212:215], a[232:235], v[60:63], v[212:215]
    v_exp_f32 v229, v229
    s_add_u32 s91, s47, 0xf000
    v_mfma_f32_16x16x32_bf16 v[220:223], a[236:239], v[60:63], v[220:223]
    ds_read_b128 a[232:235], v28 offset:43008
    s_waitcnt lgkmcnt(3)
    v_mfma_f32_16x16x32_bf16 v[216:219], a[236:239], v[56:59], v[216:219]
    v_exp_f32 v230, v230
    v_exp_f32 v231, v231
    v_pk_fma_f32 v[224:225], v[224:225], v[24:25], v[24:25] op_sel:[0,1,1] op_sel_hi:[1,1,1]
    v_pk_fma_f32 v[226:227], v[226:227], v[24:25], v[24:25] op_sel:[0,1,1] op_sel_hi:[1,1,1]
    v_pk_fma_f32 v[228:229], v[228:229], v[24:25], v[24:25] op_sel:[0,0,0] op_sel_hi:[1,0,0]
    v_pk_fma_f32 v[230:231], v[230:231], v[24:25], v[24:25] op_sel:[0,0,0] op_sel_hi:[1,0,0]
    v_mfma_f32_16x16x32_bf16 v[208:211], a[240:243], v[64:67], v[208:211]
    ds_read_b128 a[236:239], v28 offset:43264
    v_rcp_f32 v224, v224
    v_mfma_f32_16x16x32_bf16 v[212:215], a[240:243], v[68:71], v[212:215]
    v_rcp_f32 v225, v225
    v_mfma_f32_16x16x32_bf16 v[220:223], a[244:247], v[68:71], v[220:223]
    ds_read_b128 a[240:243], v28 offset:45056
    v_rcp_f32 v226, v226
    v_mfma_f32_16x16x32_bf16 v[216:219], a[244:247], v[64:67], v[216:219]
    v_rcp_f32 v227, v227
    v_mfma_f32_16x16x32_bf16 v[208:211], a[248:251], v[72:75], v[208:211]
    ds_read_b128 a[244:247], v28 offset:45312
    v_rcp_f32 v228, v228
    v_mfma_f32_16x16x32_bf16 v[212:215], a[248:251], v[76:79], v[212:215]
    v_rcp_f32 v229, v229
    v_mfma_f32_16x16x32_bf16 v[220:223], a[252:255], v[76:79], v[220:223]
    ds_read_b128 a[248:251], v28 offset:47104
    s_waitcnt lgkmcnt(3)
    v_mfma_f32_16x16x32_bf16 v[216:219], a[252:255], v[72:75], v[216:219]
    v_rcp_f32 v230, v230
    v_rcp_f32 v231, v231
    v_pk_mul_f32 v[176:177], v[176:177], v[224:225]
    v_pk_mul_f32 v[178:179], v[178:179], v[226:227]
    v_pk_mul_f32 v[180:181], v[180:181], v[228:229]
    v_pk_mul_f32 v[182:183], v[182:183], v[230:231]
    v_mfma_f32_16x16x32_bf16 v[208:211], a[224:227], v[80:83], v[208:211]
    ds_read_b128 a[252:255], v28 offset:47360
    v_cvt_pk_bf16_f32 v232, v176, v177
    v_cvt_pk_bf16_f32 v234, v180, v181
    v_mfma_f32_16x16x32_bf16 v[212:215], a[224:227], v[84:87], v[212:215]
    v_cvt_pk_bf16_f32 v233, v178, v179
    v_cvt_pk_bf16_f32 v235, v182, v183
    v_mfma_f32_16x16x32_bf16 v[220:223], a[228:231], v[84:87], v[220:223]
    ds_read_b128 a[224:227], v28 offset:49152
    v_permlane16_swap_b32 v232, v234
    v_mfma_f32_16x16x32_bf16 v[216:219], a[228:231], v[80:83], v[216:219]
    v_permlane16_swap_b32 v233, v235
    v_mfma_f32_16x16x32_bf16 v[208:211], a[232:235], v[88:91], v[208:211]
    ds_read_b128 a[228:231], v28 offset:49408
    v_mfma_f32_16x16x32_bf16 v[212:215], a[232:235], v[92:95], v[212:215]
    buffer_store_dwordx4 v[232:235], v1, s[4:7], s57 offen offset:2048
    v_mfma_f32_16x16x32_bf16 v[220:223], a[236:239], v[92:95], v[220:223]
    ds_read_b128 a[232:235], v28 offset:51200
    s_waitcnt lgkmcnt(3)
    v_mfma_f32_16x16x32_bf16 v[216:219], a[236:239], v[88:91], v[216:219]
    v_pk_mul_f32 v[224:225], v[192:193], v[26:27] op_sel:[0,0] op_sel_hi:[1,0]
    v_pk_mul_f32 v[226:227], v[194:195], v[26:27] op_sel:[0,0] op_sel_hi:[1,0]
    v_pk_mul_f32 v[228:229], v[196:197], v[26:27] op_sel:[0,1] op_sel_hi:[1,1]
    v_pk_mul_f32 v[230:231], v[198:199], v[26:27] op_sel:[0,1] op_sel_hi:[1,1]
    v_pk_mul_f32 v[192:193], v[192:193], v[200:201]
    v_pk_mul_f32 v[194:195], v[194:195], v[202:203]
    v_pk_mul_f32 v[196:197], v[196:197], v[204:205]
    v_pk_mul_f32 v[198:199], v[198:199], v[206:207]
    v_mfma_f32_16x16x32_bf16 v[208:211], a[240:243], v[96:99], v[208:211]
    ds_read_b128 a[236:239], v28 offset:51456
    v_exp_f32 v224, v224
    v_mfma_f32_16x16x32_bf16 v[212:215], a[240:243], v[100:103], v[212:215]
    v_exp_f32 v225, v225
    v_mfma_f32_16x16x32_bf16 v[220:223], a[244:247], v[100:103], v[220:223]
    ds_read_b128 a[240:243], v28 offset:53248
    v_exp_f32 v226, v226
    v_mfma_f32_16x16x32_bf16 v[216:219], a[244:247], v[96:99], v[216:219]
    v_exp_f32 v227, v227
    v_mfma_f32_16x16x32_bf16 v[208:211], a[248:251], v[104:107], v[208:211]
    ds_read_b128 a[244:247], v28 offset:53504
    v_exp_f32 v228, v228
    v_mfma_f32_16x16x32_bf16 v[212:215], a[248:251], v[108:111], v[212:215]
    v_exp_f32 v229, v229
    v_mfma_f32_16x16x32_bf16 v[220:223], a[252:255], v[108:111], v[220:223]
    ds_read_b128 a[248:251], v28 offset:55296
    s_waitcnt lgkmcnt(3)
    v_mfma_f32_16x16x32_bf16 v[216:219], a[252:255], v[104:107], v[216:219]
    v_exp_f32 v230, v230
    v_exp_f32 v231, v231
    v_pk_fma_f32 v[224:225], v[224:225], v[24:25], v[24:25] op_sel:[0,1,1] op_sel_hi:[1,1,1]
    v_pk_fma_f32 v[226:227], v[226:227], v[24:25], v[24:25] op_sel:[0,1,1] op_sel_hi:[1,1,1]
    v_pk_fma_f32 v[228:229], v[228:229], v[24:25], v[24:25] op_sel:[0,0,0] op_sel_hi:[1,0,0]
    v_pk_fma_f32 v[230:231], v[230:231], v[24:25], v[24:25] op_sel:[0,0,0] op_sel_hi:[1,0,0]
    v_mfma_f32_16x16x32_bf16 v[208:211], a[224:227], v[112:115], v[208:211]
    ds_read_b128 a[252:255], v28 offset:55552
    v_rcp_f32 v224, v224
    v_mfma_f32_16x16x32_bf16 v[212:215], a[224:227], v[116:119], v[212:215]
    v_rcp_f32 v225, v225
    v_mfma_f32_16x16x32_bf16 v[220:223], a[228:231], v[116:119], v[220:223]
    ds_read_b128 a[224:227], v29 offset:30720
    v_rcp_f32 v226, v226
    v_mfma_f32_16x16x32_bf16 v[216:219], a[228:231], v[112:115], v[216:219]
    v_rcp_f32 v227, v227
    v_mfma_f32_16x16x32_bf16 v[208:211], a[232:235], v[120:123], v[208:211]
    v_rcp_f32 v228, v228
    v_mfma_f32_16x16x32_bf16 v[212:215], a[232:235], v[124:127], v[212:215]
    v_rcp_f32 v229, v229
    v_mfma_f32_16x16x32_bf16 v[220:223], a[236:239], v[124:127], v[220:223]
    s_waitcnt vmcnt(10)
    s_barrier
    ds_read_b128 a[228:231], v30 offset:0
    v_mfma_f32_16x16x32_bf16 v[216:219], a[236:239], v[120:123], v[216:219]
    s_waitcnt lgkmcnt(2)
    v_mfma_f32_16x16x32_bf16 v[208:211], a[240:243], v[128:131], v[208:211]
    ds_read_b128 a[232:235], v30 offset:256
    v_mfma_f32_16x16x32_bf16 v[212:215], a[240:243], v[132:135], v[212:215]
    v_rcp_f32 v230, v230
    v_rcp_f32 v231, v231
    v_pk_mul_f32 v[192:193], v[192:193], v[224:225]
    v_pk_mul_f32 v[194:195], v[194:195], v[226:227]
    v_pk_mul_f32 v[196:197], v[196:197], v[228:229]
    v_pk_mul_f32 v[198:199], v[198:199], v[230:231]
    v_mfma_f32_16x16x32_bf16 v[220:223], a[244:247], v[132:135], v[220:223]
    ds_read_b128 a[236:239], v30 offset:2048
    v_mfma_f32_16x16x32_bf16 v[216:219], a[244:247], v[128:131], v[216:219]
    v_or_b32_e64 v9, s3, 9
    s_waitcnt vmcnt(1)
    buffer_store_dword v9, v6, s[4:7], s54 offen offset:512
    v_mfma_f32_16x16x32_bf16 v[208:211], a[248:251], v[136:139], v[208:211]
    ds_read_b128 a[240:243], v30 offset:2304
    v_cvt_pk_bf16_f32 v236, v192, v193
    v_cvt_pk_bf16_f32 v238, v196, v197
    v_mfma_f32_16x16x32_bf16 v[212:215], a[248:251], v[140:143], v[212:215]
    v_cvt_pk_bf16_f32 v237, v194, v195
    v_cvt_pk_bf16_f32 v239, v198, v199
    v_mfma_f32_16x16x32_bf16 v[220:223], a[252:255], v[140:143], v[220:223]
    ds_read_b128 a[244:247], v30 offset:4096
    s_waitcnt lgkmcnt(3)
    v_mfma_f32_16x16x32_bf16 v[216:219], a[252:255], v[136:139], v[216:219]
    v_permlane16_swap_b32 v236, v238
    v_mfma_f32_16x16x16_bf16 v[208:211], a[224:225], v[20:21], v[208:211]
    ds_read_b128 a[248:251], v30 offset:4352
    v_permlane16_swap_b32 v237, v239
    v_mfma_f32_16x16x16_bf16 v[212:215], a[224:225], v[22:23], v[212:215]
    buffer_store_dwordx4 v[236:239], v1, s[4:7], s57 offen offset:3072
    v_mfma_f32_16x16x16_bf16 v[216:219], a[226:227], v[20:21], v[216:219]
    ds_read_b128 a[252:255], v30 offset:6144
    v_permlane16_swap_b32 v12, v14
    v_mfma_f32_16x16x16_bf16 v[220:223], a[226:227], v[22:23], v[220:223]
    v_permlane16_swap_b32 v13, v15
    v_mfma_f32_16x16x32_bf16 v[144:147], a[228:231], v[32:35], 0
    ds_read_b128 a[224:227], v30 offset:6400
    v_permlane16_swap_b32 v16, v18
    v_mfma_f32_16x16x32_bf16 v[148:151], a[228:231], v[36:39], 0
    v_permlane16_swap_b32 v17, v19
    v_lshlrev_b32 v176, 16, v12
    v_mfma_f32_16x16x32_bf16 v[156:159], a[232:235], v[36:39], 0
    ds_read_b128 a[228:231], v30 offset:8192
    s_waitcnt lgkmcnt(3)
    v_and_b32 v177, 0xffff0000, v12
    v_mfma_f32_16x16x32_bf16 v[152:155], a[232:235], v[32:35], 0
    v_lshlrev_b32 v178, 16, v13
    v_and_b32 v179, 0xffff0000, v13
    v_lshlrev_b32 v180, 16, v14
    v_mfma_f32_16x16x32_bf16 v[144:147], a[236:239], v[40:43], v[144:147]
    ds_read_b128 a[232:235], v30 offset:8448
    v_and_b32 v181, 0xffff0000, v14
    v_lshlrev_b32 v182, 16, v15
    v_mfma_f32_16x16x32_bf16 v[148:151], a[236:239], v[44:47], v[148:151]
    v_and_b32 v183, 0xffff0000, v15
    v_lshlrev_b32 v184, 16, v16
    v_and_b32 v185, 0xffff0000, v16
    v_mfma_f32_16x16x32_bf16 v[156:159], a[240:243], v[44:47], v[156:159]
    ds_read_b128 a[236:239], v30 offset:10240
    v_lshlrev_b32 v186, 16, v17
    v_and_b32 v187, 0xffff0000, v17
    v_mfma_f32_16x16x32_bf16 v[152:155], a[240:243], v[40:43], v[152:155]
    v_lshlrev_b32 v188, 16, v18
    v_and_b32 v189, 0xffff0000, v18
    v_lshlrev_b32 v190, 16, v19
    v_mfma_f32_16x16x32_bf16 v[144:147], a[244:247], v[48:51], v[144:147]
    ds_read_b128 a[240:243], v30 offset:10496
    v_and_b32 v191, 0xffff0000, v19
    v_mfma_f32_16x16x32_bf16 v[148:151], a[244:247], v[52:55], v[148:151]
    v_pk_mul_f32 v[224:225], v[208:209], v[26:27] op_sel:[0,0] op_sel_hi:[1,0]
    v_pk_mul_f32 v[226:227], v[210:211], v[26:27] op_sel:[0,0] op_sel_hi:[1,0]
    v_pk_mul_f32 v[228:229], v[212:213], v[26:27] op_sel:[0,1] op_sel_hi:[1,1]
    v_pk_mul_f32 v[230:231], v[214:215], v[26:27] op_sel:[0,1] op_sel_hi:[1,1]
    v_pk_mul_f32 v[208:209], v[208:209], v[216:217]
    v_pk_mul_f32 v[210:211], v[210:211], v[218:219]
    v_pk_mul_f32 v[212:213], v[212:213], v[220:221]
    v_pk_mul_f32 v[214:215], v[214:215], v[222:223]
    v_mfma_f32_16x16x32_bf16 v[156:159], a[248:251], v[52:55], v[156:159]
    ds_read_b128 a[244:247], v30 offset:12288
    s_waitcnt lgkmcnt(3)
    v_mfma_f32_16x16x32_bf16 v[152:155], a[248:251], v[48:51], v[152:155]
    v_exp_f32 v224, v224
    v_mfma_f32_16x16x32_bf16 v[144:147], a[252:255], v[56:59], v[144:147]
    ds_read_b128 a[248:251], v30 offset:12544
    v_exp_f32 v225, v225
    v_mfma_f32_16x16x32_bf16 v[148:151], a[252:255], v[60:63], v[148:151]
    v_exp_f32 v226, v226
    v_mfma_f32_16x16x32_bf16 v[156:159], a[224:227], v[60:63], v[156:159]
    ds_read_b128 a[252:255], v30 offset:14336
    v_exp_f32 v227, v227
    v_mfma_f32_16x16x32_bf16 v[152:155], a[224:227], v[56:59], v[152:155]
    v_exp_f32 v228, v228
    v_mfma_f32_16x16x32_bf16 v[144:147], a[228:231], v[64:67], v[144:147]
    ds_read_b128 a[224:227], v30 offset:14592
    v_exp_f32 v229, v229
    v_mfma_f32_16x16x32_bf16 v[148:151], a[228:231], v[68:71], v[148:151]
    v_exp_f32 v230, v230
    v_exp_f32 v231, v231
    v_pk_fma_f32 v[224:225], v[224:225], v[24:25], v[24:25] op_sel:[0,1,1] op_sel_hi:[1,1,1]
    v_pk_fma_f32 v[226:227], v[226:227], v[24:25], v[24:25] op_sel:[0,1,1] op_sel_hi:[1,1,1]
    v_pk_fma_f32 v[228:229], v[228:229], v[24:25], v[24:25] op_sel:[0,0,0] op_sel_hi:[1,0,0]
    v_pk_fma_f32 v[230:231], v[230:231], v[24:25], v[24:25] op_sel:[0,0,0] op_sel_hi:[1,0,0]
    v_mfma_f32_16x16x32_bf16 v[156:159], a[232:235], v[68:71], v[156:159]
    ds_read_b128 a[228:231], v30 offset:16384
    s_waitcnt lgkmcnt(3)
    v_mfma_f32_16x16x32_bf16 v[152:155], a[232:235], v[64:67], v[152:155]
    v_rcp_f32 v224, v224
    v_mfma_f32_16x16x32_bf16 v[144:147], a[236:239], v[72:75], v[144:147]
    ds_read_b128 a[232:235], v30 offset:16640
    buffer_load_dword v8, v10, s[4:7], s56 offen offset:512 sc1
    v_mfma_f32_16x16x32_bf16 v[148:151], a[236:239], v[76:79], v[148:151]
    s_add_u32 s44, s3, 9
    v_rcp_f32 v225, v225
    v_mfma_f32_16x16x32_bf16 v[156:159], a[240:243], v[76:79], v[156:159]
    ds_read_b128 a[236:239], v30 offset:18432
    v_rcp_f32 v226, v226
    v_mfma_f32_16x16x32_bf16 v[152:155], a[240:243], v[72:75], v[152:155]
    v_rcp_f32 v227, v227
    v_mfma_f32_16x16x32_bf16 v[144:147], a[244:247], v[80:83], v[144:147]
    ds_read_b128 a[240:243], v30 offset:18688
    v_rcp_f32 v228, v228
    v_mfma_f32_16x16x32_bf16 v[148:151], a[244:247], v[84:87], v[148:151]
    v_rcp_f32 v229, v229
    v_mfma_f32_16x16x32_bf16 v[156:159], a[248:251], v[84:87], v[156:159]
    ds_read_b128 a[244:247], v30 offset:20480
    s_waitcnt lgkmcnt(3)
    v_mfma_f32_16x16x32_bf16 v[152:155], a[248:251], v[80:83], v[152:155]
    v_rcp_f32 v230, v230
    v_rcp_f32 v231, v231
    v_pk_mul_f32 v[208:209], v[208:209], v[224:225]
    v_pk_mul_f32 v[210:211], v[210:211], v[226:227]
    v_pk_mul_f32 v[212:213], v[212:213], v[228:229]
    v_pk_mul_f32 v[214:215], v[214:215], v[230:231]
    v_mfma_f32_16x16x32_bf16 v[144:147], a[252:255], v[88:91], v[144:147]
    ds_read_b128 a[248:251], v30 offset:20736
    v_cvt_pk_bf16_f32 v232, v208, v209
    v_cvt_pk_bf16_f32 v234, v212, v213
    v_mfma_f32_16x16x32_bf16 v[148:151], a[252:255], v[92:95], v[148:151]
    v_cvt_pk_bf16_f32 v233, v210, v211
    v_cvt_pk_bf16_f32 v235, v214, v215
    v_mfma_f32_16x16x32_bf16 v[156:159], a[224:227], v[92:95], v[156:159]
    ds_read_b128 a[252:255], v30 offset:22528
    v_permlane16_swap_b32 v232, v234
    v_mfma_f32_16x16x32_bf16 v[152:155], a[224:227], v[88:91], v[152:155]
    v_permlane16_swap_b32 v233, v235
    v_mfma_f32_16x16x32_bf16 v[144:147], a[228:231], v[96:99], v[144:147]
    ds_read_b128 a[224:227], v30 offset:22784
    v_mfma_f32_16x16x32_bf16 v[148:151], a[228:231], v[100:103], v[148:151]
    buffer_store_dwordx4 v[232:235], v0, s[4:7], s57 offen
    v_mfma_f32_16x16x32_bf16 v[156:159], a[232:235], v[100:103], v[156:159]
    ds_read_b128 a[228:231], v30 offset:24576
    s_waitcnt lgkmcnt(3)
    v_mfma_f32_16x16x32_bf16 v[152:155], a[232:235], v[96:99], v[152:155]
    v_mfma_f32_16x16x32_bf16 v[144:147], a[236:239], v[104:107], v[144:147]
    ds_read_b128 a[232:235], v30 offset:24832
    v_mfma_f32_16x16x32_bf16 v[148:151], a[236:239], v[108:111], v[148:151]
    v_mfma_f32_16x16x32_bf16 v[156:159], a[240:243], v[108:111], v[156:159]
    ds_read_b128 a[236:239], v30 offset:26624
    v_mfma_f32_16x16x32_bf16 v[152:155], a[240:243], v[104:107], v[152:155]
    v_mfma_f32_16x16x32_bf16 v[144:147], a[244:247], v[112:115], v[144:147]
    ds_read_b128 a[240:243], v30 offset:26880
    v_mfma_f32_16x16x32_bf16 v[148:151], a[244:247], v[116:119], v[148:151]
    v_or_b32_e64 v9, s3, 11
    s_waitcnt vmcnt(2)
    buffer_store_dword v9, v6, s[4:7], s54 offen offset:512
    v_mfma_f32_16x16x32_bf16 v[156:159], a[248:251], v[116:119], v[156:159]
    ds_read_b128 a[244:247], v29 offset:28928
    s_waitcnt lgkmcnt(3)
    v_mfma_f32_16x16x32_bf16 v[152:155], a[248:251], v[112:115], v[152:155]
    s_waitcnt vmcnt(2)
    v_subrev_u32 v8, s44, v8
    v_cmp_le_u32 vcc, 16, v8
    s_cbranch_vccnz Lfs_245
Lc_246:
    v_mfma_f32_16x16x32_bf16 v[144:147], a[252:255], v[120:123], v[144:147]
    buffer_load_dwordx4 v[240:243], v5, s[4:7], s84 offen sc1
    v_mfma_f32_16x16x32_bf16 v[148:151], a[252:255], v[124:127], v[148:151]
    v_mfma_f32_16x16x32_bf16 v[156:159], a[224:227], v[124:127], v[156:159]
    s_barrier
    ds_read_b128 a[248:251], v30 offset:28672
    v_mfma_f32_16x16x32_bf16 v[152:155], a[224:227], v[120:123], v[152:155]
    v_mfma_f32_16x16x32_bf16 v[144:147], a[228:231], v[128:131], v[144:147]
    ds_read_b128 a[252:255], v30 offset:28928
    buffer_load_dwordx4 v[244:247], v5, s[4:7], s84 offen offset:256 sc1
    v_mfma_f32_16x16x32_bf16 v[148:151], a[228:231], v[132:135], v[148:151]
    v_mfma_f32_16x16x32_bf16 v[156:159], a[232:235], v[132:135], v[156:159]
    ds_read_b128 a[224:227], v30 offset:30720
    s_waitcnt lgkmcnt(3)
    v_mfma_f32_16x16x32_bf16 v[152:155], a[232:235], v[128:131], v[152:155]
    v_mfma_f32_16x16x32_bf16 v[144:147], a[236:239], v[136:139], v[144:147]
    ds_read_b128 a[228:231], v30 offset:30976
    buffer_load_dwordx4 v[248:251], v5, s[4:7], s88 offen sc1
    v_mfma_f32_16x16x32_bf16 v[148:151], a[236:239], v[140:143], v[148:151]
    v_mfma_f32_16x16x32_bf16 v[156:159], a[240:243], v[140:143], v[156:159]
    ds_read_b128 a[232:235], v30 offset:32768
    v_mfma_f32_16x16x32_bf16 v[152:155], a[240:243], v[136:139], v[152:155]
    v_mfma_f32_16x16x16_bf16 v[144:147], a[244:245], v[20:21], v[144:147]
    ds_read_b128 a[236:239], v30 offset:33024
    buffer_load_dwordx4 v[252:255], v5, s[4:7], s88 offen offset:256 sc1
    v_mfma_f32_16x16x16_bf16 v[148:151], a[244:245], v[22:23], v[148:151]
    v_mfma_f32_16x16x16_bf16 v[152:155], a[246:247], v[20:21], v[152:155]
    ds_read_b128 a[240:243], v30 offset:34816
    s_waitcnt lgkmcnt(3)
    v_mfma_f32_16x16x16_bf16 v[156:159], a[246:247], v[22:23], v[156:159]
    v_mfma_f32_16x16x32_bf16 v[160:163], a[248:251], v[32:35], 0
    ds_read_b128 a[244:247], v30 offset:35072
    v_mfma_f32_16x16x32_bf16 v[164:167], a[248:251], v[36:39], 0
    v_mfma_f32_16x16x32_bf16 v[172:175], a[252:255], v[36:39], 0
    ds_read_b128 a[248:251], v30 offset:36864
    v_mfma_f32_16x16x32_bf16 v[168:171], a[252:255], v[32:35], 0
    v_mfma_f32_16x16x32_bf16 v[160:163], a[224:227], v[40:43], v[160:163]
    ds_read_b128 a[252:255], v30 offset:37120
    buffer_load_dwordx4 v[32:35], v5, s[4:7], s84 offen offset:1024 sc1
    v_mfma_f32_16x16x32_bf16 v[164:167], a[224:227], v[44:47], v[164:167]
    v_pk_mul_f32 v[224:225], v[144:145], v[26:27] op_sel:[0,0] op_sel_hi:[1,0]
    v_pk_mul_f32 v[226:227], v[146:147], v[26:27] op_sel:[0,0] op_sel_hi:[1,0]
    v_pk_mul_f32 v[228:229], v[148:149], v[26:27] op_sel:[0,1] op_sel_hi:[1,1]
    v_pk_mul_f32 v[230:231], v[150:151], v[26:27] op_sel:[0,1] op_sel_hi:[1,1]
    v_pk_mul_f32 v[144:145], v[144:145], v[152:153]
    v_pk_mul_f32 v[146:147], v[146:147], v[154:155]
    v_pk_mul_f32 v[148:149], v[148:149], v[156:157]
    v_pk_mul_f32 v[150:151], v[150:151], v[158:159]
    v_mfma_f32_16x16x32_bf16 v[172:175], a[228:231], v[44:47], v[172:175]
    ds_read_b128 a[224:227], v30 offset:38912
    s_waitcnt lgkmcnt(3)
    v_mfma_f32_16x16x32_bf16 v[168:171], a[228:231], v[40:43], v[168:171]
    buffer_load_dwordx4 v[36:39], v5, s[4:7], s84 offen offset:1280 sc1
    v_mfma_f32_16x16x32_bf16 v[160:163], a[232:235], v[48:51], v[160:163]
    ds_read_b128 a[228:231], v30 offset:39168
    v_exp_f32 v224, v224
    v_mfma_f32_16x16x32_bf16 v[164:167], a[232:235], v[52:55], v[164:167]
    v_exp_f32 v225, v225
    v_mfma_f32_16x16x32_bf16 v[172:175], a[236:239], v[52:55], v[172:175]
    ds_read_b128 a[232:235], v30 offset:40960
    buffer_load_dwordx4 v[40:43], v5, s[4:7], s88 offen offset:1024 sc1
    v_mfma_f32_16x16x32_bf16 v[168:171], a[236:239], v[48:51], v[168:171]
    v_exp_f32 v226, v226
    v_mfma_f32_16x16x32_bf16 v[160:163], a[240:243], v[56:59], v[160:163]
    ds_read_b128 a[236:239], v30 offset:41216
    v_exp_f32 v227, v227
    v_mfma_f32_16x16x32_bf16 v[164:167], a[240:243], v[60:63], v[164:167]
    v_exp_f32 v228, v228
    v_mfma_f32_16x16x32_bf16 v[172:175], a[244:247], v[60:63], v[172:175]
    ds_read_b128 a[240:243], v30 offset:43008
    s_waitcnt lgkmcnt(3)
    v_mfma_f32_16x16x32_bf16 v[168:171], a[244:247], v[56:59], v[168:171]
    buffer_load_dwordx4 v[44:47], v5, s[4:7], s88 offen offset:1280 sc1
    v_mfma_f32_16x16x32_bf16 v[160:163], a[248:251], v[64:67], v[160:163]
    ds_read_b128 a[244:247], v30 offset:43264
    v_exp_f32 v229, v229
    v_mfma_f32_16x16x32_bf16 v[164:167], a[248:251], v[68:71], v[164:167]
    v_exp_f32 v230, v230
    v_exp_f32 v231, v231
    v_pk_fma_f32 v[224:225], v[224:225], v[24:25], v[24:25] op_sel:[0,1,1] op_sel_hi:[1,1,1]
    v_pk_fma_f32 v[226:227], v[226:227], v[24:25], v[24:25] op_sel:[0,1,1] op_sel_hi:[1,1,1]
    v_pk_fma_f32 v[228:229], v[228:229], v[24:25], v[24:25] op_sel:[0,0,0] op_sel_hi:[1,0,0]
    v_pk_fma_f32 v[230:231], v[230:231], v[24:25], v[24:25] op_sel:[0,0,0] op_sel_hi:[1,0,0]
    v_mfma_f32_16x16x32_bf16 v[172:175], a[252:255], v[68:71], v[172:175]
    ds_read_b128 a[248:251], v30 offset:45056
    buffer_load_dword v8, v10, s[4:7], s56 offen offset:512 sc1
    v_mfma_f32_16x16x32_bf16 v[168:171], a[252:255], v[64:67], v[168:171]
    s_add_u32 s44, s3, 11
    buffer_load_dwordx4 v[48:51], v5, s[4:7], s85 offen sc1
    v_mfma_f32_16x16x32_bf16 v[160:163], a[224:227], v[72:75], v[160:163]
    ds_read_b128 a[252:255], v30 offset:45312
    v_rcp_f32 v224, v224
    v_mfma_f32_16x16x32_bf16 v[164:167], a[224:227], v[76:79], v[164:167]
    v_rcp_f32 v225, v225
    v_mfma_f32_16x16x32_bf16 v[172:175], a[228:231], v[76:79], v[172:175]
    ds_read_b128 a[224:227], v30 offset:47104
    s_waitcnt lgkmcnt(3)
    v_mfma_f32_16x16x32_bf16 v[168:171], a[228:231], v[72:75], v[168:171]
    buffer_load_dwordx4 v[52:55], v5, s[4:7], s85 offen offset:256 sc1
    v_mfma_f32_16x16x32_bf16 v[160:163], a[232:235], v[80:83], v[160:163]
    ds_read_b128 a[228:231], v30 offset:47360
    v_rcp_f32 v226, v226
    v_mfma_f32_16x16x32_bf16 v[164:167], a[232:235], v[84:87], v[164:167]
    v_rcp_f32 v227, v227
    v_mfma_f32_16x16x32_bf16 v[172:175], a[236:239], v[84:87], v[172:175]
    ds_read_b128 a[232:235], v30 offset:49152
    buffer_load_dwordx4 v[56:59], v5, s[4:7], s89 offen sc1
    v_mfma_f32_16x16x32_bf16 v[168:171], a[236:239], v[80:83], v[168:171]
    v_rcp_f32 v228, v228
    v_mfma_f32_16x16x32_bf16 v[160:163], a[240:243], v[88:91], v[160:163]
    ds_read_b128 a[236:239], v30 offset:49408
    v_rcp_f32 v229, v229
    v_mfma_f32_16x16x32_bf16 v[164:167], a[240:243], v[92:95], v[164:167]
    v_rcp_f32 v230, v230
    v_rcp_f32 v231, v231
    v_pk_mul_f32 v[144:145], v[144:145], v[224:225]
    v_pk_mul_f32 v[146:147], v[146:147], v[226:227]
    v_pk_mul_f32 v[148:149], v[148:149], v[228:229]
    v_pk_mul_f32 v[150:151], v[150:151], v[230:231]
    v_mfma_f32_16x16x32_bf16 v[172:175], a[244:247], v[92:95], v[172:175]
    ds_read_b128 a[240:243], v30 offset:51200
    s_waitcnt lgkmcnt(3)
    v_cvt_pk_bf16_f32 v236, v144, v145
    v_mfma_f32_16x16x32_bf16 v[168:171], a[244:247], v[88:91], v[168:171]
    buffer_load_dwordx4 v[60:63], v5, s[4:7], s89 offen offset:256 sc1
    v_cvt_pk_bf16_f32 v238, v148, v149
    v_mfma_f32_16x16x32_bf16 v[160:163], a[248:251], v[96:99], v[160:163]
    ds_read_b128 a[244:247], v30 offset:51456
    v_cvt_pk_bf16_f32 v237, v146, v147
    v_cvt_pk_bf16_f32 v239, v150, v151
    v_mfma_f32_16x16x32_bf16 v[164:167], a[248:251], v[100:103], v[164:167]
    v_permlane16_swap_b32 v236, v238
    v_mfma_f32_16x16x32_bf16 v[172:175], a[252:255], v[100:103], v[172:175]
    ds_read_b128 a[248:251], v30 offset:53248
    buffer_load_dwordx4 v[64:67], v5, s[4:7], s85 offen offset:1024 sc1
    v_mfma_f32_16x16x32_bf16 v[168:171], a[252:255], v[96:99], v[168:171]
    v_permlane16_swap_b32 v237, v239
    v_mfma_f32_16x16x32_bf16 v[160:163], a[224:227], v[104:107], v[160:163]
    ds_read_b128 a[252:255], v30 offset:53504
    v_mfma_f32_16x16x32_bf16 v[164:167], a[224:227], v[108:111], v[164:167]
    buffer_store_dwordx4 v[236:239], v0, s[4:7], s57 offen offset:1024
    v_mfma_f32_16x16x32_bf16 v[172:175], a[228:231], v[108:111], v[172:175]
    ds_read_b128 a[224:227], v30 offset:55296
    s_waitcnt lgkmcnt(3)
    v_mfma_f32_16x16x32_bf16 v[168:171], a[228:231], v[104:107], v[168:171]
    v_mfma_f32_16x16x32_bf16 v[160:163], a[232:235], v[112:115], v[160:163]
    ds_read_b128 a[228:231], v30 offset:55552
    v_mfma_f32_16x16x32_bf16 v[164:167], a[232:235], v[116:119], v[164:167]
    s_waitcnt vmcnt(6)
    v_subrev_u32 v8, s44, v8
    v_cmp_le_u32 vcc, 16, v8
    s_cbranch_vccnz Lfs_247
Lc_248:
    v_mfma_f32_16x16x32_bf16 v[172:175], a[236:239], v[116:119], v[172:175]
    ds_read_b128 a[232:235], v29 offset:28672
    v_mfma_f32_16x16x32_bf16 v[168:171], a[236:239], v[112:115], v[168:171]
    v_mfma_f32_16x16x32_bf16 v[160:163], a[240:243], v[120:123], v[160:163]
    buffer_load_dwordx4 v[68:71], v5, s[4:7], s85 offen offset:1280 sc1
    v_mfma_f32_16x16x32_bf16 v[164:167], a[240:243], v[124:127], v[164:167]
    v_mfma_f32_16x16x32_bf16 v[172:175], a[244:247], v[124:127], v[172:175]
    s_waitcnt lgkmcnt(1)
    v_mfma_f32_16x16x32_bf16 v[168:171], a[244:247], v[120:123], v[168:171]
    v_mfma_f32_16x16x32_bf16 v[160:163], a[248:251], v[128:131], v[160:163]
    v_mfma_f32_16x16x32_bf16 v[164:167], a[248:251], v[132:135], v[164:167]
    v_mfma_f32_16x16x32_bf16 v[172:175], a[252:255], v[132:135], v[172:175]
    buffer_load_dwordx4 v[72:75], v5, s[4:7], s89 offen offset:1024 sc1
    v_mfma_f32_16x16x32_bf16 v[168:171], a[252:255], v[128:131], v[168:171]
    v_mfma_f32_16x16x32_bf16 v[160:163], a[224:227], v[136:139], v[160:163]
    v_or_b32_e64 v9, s3, 12
    buffer_store_dword v9, v6, s[4:7], s54 offen offset:512
    v_mfma_f32_16x16x32_bf16 v[164:167], a[224:227], v[140:143], v[164:167]
    v_mfma_f32_16x16x32_bf16 v[172:175], a[228:231], v[140:143], v[172:175]
    s_waitcnt lgkmcnt(0)
    buffer_load_dwordx4 v[76:79], v5, s[4:7], s89 offen offset:1280 sc1
    v_mfma_f32_16x16x32_bf16 v[168:171], a[228:231], v[136:139], v[168:171]
    v_mfma_f32_16x16x16_bf16 v[160:163], a[232:233], v[20:21], v[160:163]
    v_mfma_f32_16x16x16_bf16 v[164:167], a[232:233], v[22:23], v[164:167]
    v_mfma_f32_16x16x16_bf16 v[168:171], a[234:235], v[20:21], v[168:171]
    buffer_load_dwordx4 v[80:83], v5, s[4:7], s84 offen offset:2048 sc1
    v_mfma_f32_16x16x16_bf16 v[172:175], a[234:235], v[22:23], v[172:175]
LstS4_1f:
    s_cmp_ge_u32 s25, 14
    s_cbranch_scc1 Lidle_249
    v_mfma_f32_16x16x32_bf16 v[176:179], a[12:15], v[240:243], v[176:179]
    v_mfma_f32_16x16x32_bf16 v[184:187], a[40:43], v[240:243], v[184:187]
    v_mfma_f32_16x16x32_bf16 v[192:195], a[124:127], v[240:243], 0
    v_pk_mul_f32 v[224:225], v[160:161], v[26:27] op_sel:[0,0] op_sel_hi:[1,0]
    v_pk_mul_f32 v[226:227], v[162:163], v[26:27] op_sel:[0,0] op_sel_hi:[1,0]
    v_pk_mul_f32 v[228:229], v[164:165], v[26:27] op_sel:[0,1] op_sel_hi:[1,1]
    v_pk_mul_f32 v[230:231], v[166:167], v[26:27] op_sel:[0,1] op_sel_hi:[1,1]
    v_pk_mul_f32 v[160:161], v[160:161], v[168:169]
    v_pk_mul_f32 v[162:163], v[162:163], v[170:171]
    v_pk_mul_f32 v[164:165], v[164:165], v[172:173]
    v_pk_mul_f32 v[166:167], v[166:167], v[174:175]
    v_mfma_f32_16x16x32_bf16 v[200:203], a[152:155], v[240:243], 0
    v_exp_f32 v224, v224
    v_mfma_f32_16x16x32_bf16 v[204:207], a[152:155], v[244:247], 0
    buffer_load_dwordx4 v[84:87], v5, s[4:7], s84 offen offset:2304 sc1
    v_mfma_f32_16x16x32_bf16 v[196:199], a[124:127], v[244:247], 0
    v_exp_f32 v225, v225
    v_mfma_f32_16x16x32_bf16 v[188:191], a[40:43], v[244:247], v[188:191]
    v_exp_f32 v226, v226
    v_mfma_f32_16x16x32_bf16 v[180:183], a[12:15], v[244:247], v[180:183]
    v_exp_f32 v227, v227
    v_mfma_f32_16x16x32_bf16 v[176:179], a[68:71], v[248:251], v[176:179]
    buffer_load_dwordx4 v[88:91], v5, s[4:7], s88 offen offset:2048 sc1
    v_mfma_f32_16x16x32_bf16 v[184:187], a[96:99], v[248:251], v[184:187]
    v_exp_f32 v228, v228
    v_mfma_f32_16x16x32_bf16 v[192:195], a[180:183], v[248:251], v[192:195]
    v_exp_f32 v229, v229
    v_mfma_f32_16x16x32_bf16 v[200:203], a[208:211], v[248:251], v[200:203]
    v_exp_f32 v230, v230
    v_exp_f32 v231, v231
    v_pk_fma_f32 v[224:225], v[224:225], v[24:25], v[24:25] op_sel:[0,1,1] op_sel_hi:[1,1,1]
    v_pk_fma_f32 v[226:227], v[226:227], v[24:25], v[24:25] op_sel:[0,1,1] op_sel_hi:[1,1,1]
    v_pk_fma_f32 v[228:229], v[228:229], v[24:25], v[24:25] op_sel:[0,0,0] op_sel_hi:[1,0,0]
    v_pk_fma_f32 v[230:231], v[230:231], v[24:25], v[24:25] op_sel:[0,0,0] op_sel_hi:[1,0,0]
    v_mfma_f32_16x16x32_bf16 v[204:207], a[208:211], v[252:255], v[204:207]
    buffer_load_dwordx4 v[92:95], v5, s[4:7], s88 offen offset:2304 sc1
    v_mfma_f32_16x16x32_bf16 v[196:199], a[180:183], v[252:255], v[196:199]
    v_rcp_f32 v224, v224
    v_mfma_f32_16x16x32_bf16 v[188:191], a[96:99], v[252:255], v[188:191]
    v_rcp_f32 v225, v225
    v_mfma_f32_16x16x32_bf16 v[180:183], a[68:71], v[252:255], v[180:183]
    v_rcp_f32 v226, v226
    v_mfma_f32_16x16x32_bf16 v[176:179], a[16:19], v[32:35], v[176:179]
    buffer_load_dword v8, v10, s[4:7], s56 offen offset:512 sc1
    v_mfma_f32_16x16x32_bf16 v[184:187], a[44:47], v[32:35], v[184:187]
    s_add_u32 s44, s3, 12
    v_mfma_f32_16x16x32_bf16 v[192:195], a[128:131], v[32:35], v[192:195]
    buffer_load_dwordx4 v[96:99], v5, s[4:7], s85 offen offset:2048 sc1
    v_mfma_f32_16x16x32_bf16 v[200:203], a[156:159], v[32:35], v[200:203]
    v_rcp_f32 v227, v227
    v_mfma_f32_16x16x32_bf16 v[204:207], a[156:159], v[36:39], v[204:207]
    v_or_b32_e64 v9, s3, 13
    s_waitcnt vmcnt(10)
    buffer_store_dword v9, v6, s[4:7], s54 offen offset:512
    v_mfma_f32_16x16x32_bf16 v[196:199], a[128:131], v[36:39], v[196:199]
    v_rcp_f32 v228, v228
    v_mfma_f32_16x16x32_bf16 v[188:191], a[44:47], v[36:39], v[188:191]
    buffer_load_dwordx4 v[100:103], v5, s[4:7], s85 offen offset:2304 sc1
    v_mfma_f32_16x16x32_bf16 v[180:183], a[16:19], v[36:39], v[180:183]
    v_rcp_f32 v229, v229
    v_mfma_f32_16x16x32_bf16 v[176:179], a[72:75], v[40:43], v[176:179]
    v_rcp_f32 v230, v230
    v_rcp_f32 v231, v231
    v_pk_mul_f32 v[160:161], v[160:161], v[224:225]
    v_pk_mul_f32 v[162:163], v[162:163], v[226:227]
    v_pk_mul_f32 v[164:165], v[164:165], v[228:229]
    v_pk_mul_f32 v[166:167], v[166:167], v[230:231]
    v_mfma_f32_16x16x32_bf16 v[184:187], a[100:103], v[40:43], v[184:187]
    v_cvt_pk_bf16_f32 v232, v160, v161
    v_cvt_pk_bf16_f32 v234, v164, v165
    v_mfma_f32_16x16x32_bf16 v[192:195], a[184:187], v[40:43], v[192:195]
    buffer_load_dwordx4 v[104:107], v5, s[4:7], s89 offen offset:2048 sc1
    v_mfma_f32_16x16x32_bf16 v[200:203], a[212:215], v[40:43], v[200:203]
    v_cvt_pk_bf16_f32 v233, v162, v163
    v_cvt_pk_bf16_f32 v235, v166, v167
    v_mfma_f32_16x16x32_bf16 v[204:207], a[212:215], v[44:47], v[204:207]
    v_permlane16_swap_b32 v232, v234
    v_mfma_f32_16x16x32_bf16 v[196:199], a[184:187], v[44:47], v[196:199]
    v_permlane16_swap_b32 v233, v235
    v_mfma_f32_16x16x32_bf16 v[188:191], a[100:103], v[44:47], v[188:191]
    buffer_load_dwordx4 v[108:111], v5, s[4:7], s89 offen offset:2304 sc1
    v_mfma_f32_16x16x32_bf16 v[180:183], a[72:75], v[44:47], v[180:183]
    buffer_store_dwordx4 v[232:235], v0, s[4:7], s57 offen offset:2048
    v_mfma_f32_16x16x32_bf16 v[208:211], a[12:15], v[48:51], 0
    v_mfma_f32_16x16x32_bf16 v[216:219], a[40:43], v[48:51], 0
    v_mfma_f32_16x16x32_bf16 v[144:147], a[124:127], v[48:51], 0
    v_mfma_f32_16x16x32_bf16 v[152:155], a[152:155], v[48:51], 0
    v_mfma_f32_16x16x32_bf16 v[156:159], a[152:155], v[52:55], 0
    buffer_load_dwordx4 v[112:115], v5, s[4:7], s84 offen offset:3072 sc1
    v_mfma_f32_16x16x32_bf16 v[148:151], a[124:127], v[52:55], 0
    v_mfma_f32_16x16x32_bf16 v[220:223], a[40:43], v[52:55], 0
    v_mfma_f32_16x16x32_bf16 v[212:215], a[12:15], v[52:55], 0
    s_waitcnt vmcnt(7)
    v_subrev_u32 v8, s44, v8
    v_cmp_le_u32 vcc, 16, v8
    s_cbranch_vccnz Lfs_250
Lc_251:
    v_mfma_f32_16x16x32_bf16 v[208:211], a[68:71], v[56:59], v[208:211]
    buffer_load_dwordx4 v[116:119], v5, s[4:7], s84 offen offset:3328 sc1
    v_mfma_f32_16x16x32_bf16 v[216:219], a[96:99], v[56:59], v[216:219]
    v_mfma_f32_16x16x32_bf16 v[144:147], a[180:183], v[56:59], v[144:147]
    v_mfma_f32_16x16x32_bf16 v[152:155], a[208:211], v[56:59], v[152:155]
    v_mfma_f32_16x16x32_bf16 v[156:159], a[208:211], v[60:63], v[156:159]
    buffer_load_dwordx4 v[120:123], v5, s[4:7], s88 offen offset:3072 sc1
    v_mfma_f32_16x16x32_bf16 v[148:151], a[180:183], v[60:63], v[148:151]
    v_mfma_f32_16x16x32_bf16 v[220:223], a[96:99], v[60:63], v[220:223]
    v_mfma_f32_16x16x32_bf16 v[212:215], a[68:71], v[60:63], v[212:215]
    s_barrier
    v_mfma_f32_16x16x32_bf16 v[208:211], a[16:19], v[64:67], v[208:211]
    buffer_load_dword v8, v10, s[4:7], s56 offen offset:512 sc1
    v_mfma_f32_16x16x32_bf16 v[216:219], a[44:47], v[64:67], v[216:219]
    s_add_u32 s44, s3, 13
    buffer_load_dwordx4 v[124:127], v5, s[4:7], s88 offen offset:3328 sc1
    v_mfma_f32_16x16x32_bf16 v[144:147], a[128:131], v[64:67], v[144:147]
    v_or_b32_e64 v9, s3, 14
    s_waitcnt vmcnt(5)
    buffer_store_dword v9, v6, s[4:7], s54 offen offset:512
    v_mfma_f32_16x16x32_bf16 v[152:155], a[156:159], v[64:67], v[152:155]
    v_add_u32 v28, s32, v1
    v_add_u32 v29, s33, v1
    v_mfma_f32_16x16x32_bf16 v[156:159], a[156:159], v[68:71], v[156:159]
    buffer_load_dwordx4 v[128:131], v5, s[4:7], s85 offen offset:3072 sc1
    v_mfma_f32_16x16x32_bf16 v[148:151], a[128:131], v[68:71], v[148:151]
    v_add_u32 v30, s34, v1
    v_add_u32 v31, s35, v1
    v_mfma_f32_16x16x32_bf16 v[220:223], a[44:47], v[68:71], v[220:223]
    v_mfma_f32_16x16x32_bf16 v[212:215], a[16:19], v[68:71], v[212:215]
    v_mfma_f32_16x16x32_bf16 v[208:211], a[72:75], v[72:75], v[208:211]
    buffer_load_dwordx4 v[132:135], v5, s[4:7], s85 offen offset:3328 sc1
    v_mfma_f32_16x16x32_bf16 v[216:219], a[100:103], v[72:75], v[216:219]
    v_mfma_f32_16x16x32_bf16 v[144:147], a[184:187], v[72:75], v[144:147]
    v_mfma_f32_16x16x32_bf16 v[152:155], a[212:215], v[72:75], v[152:155]
    v_mfma_f32_16x16x32_bf16 v[156:159], a[212:215], v[76:79], v[156:159]
    buffer_load_dwordx4 v[136:139], v5, s[4:7], s89 offen offset:3072 sc1
    v_mfma_f32_16x16x32_bf16 v[148:151], a[184:187], v[76:79], v[148:151]
    v_mfma_f32_16x16x32_bf16 v[220:223], a[100:103], v[76:79], v[220:223]
    v_mfma_f32_16x16x32_bf16 v[212:215], a[72:75], v[76:79], v[212:215]
    v_mfma_f32_16x16x32_bf16 v[176:179], a[24:27], v[80:83], v[176:179]
    buffer_load_dwordx4 v[140:143], v5, s[4:7], s89 offen offset:3328 sc1
    v_mfma_f32_16x16x32_bf16 v[184:187], a[52:55], v[80:83], v[184:187]
    v_mfma_f32_16x16x32_bf16 v[192:195], a[136:139], v[80:83], v[192:195]
    v_mfma_f32_16x16x32_bf16 v[200:203], a[164:167], v[80:83], v[200:203]
    v_mfma_f32_16x16x32_bf16 v[204:207], a[164:167], v[84:87], v[204:207]
    buffer_load_dwordx4 v[240:243], v5, s[4:7], s86 offen sc1
    v_mfma_f32_16x16x32_bf16 v[196:199], a[136:139], v[84:87], v[196:199]
    v_mfma_f32_16x16x32_bf16 v[188:191], a[52:55], v[84:87], v[188:191]
    v_mfma_f32_16x16x32_bf16 v[180:183], a[24:27], v[84:87], v[180:183]
    s_waitcnt vmcnt(7)
    v_subrev_u32 v8, s44, v8
    v_cmp_le_u32 vcc, 16, v8
    s_cbranch_vccnz Lfs_252
Lc_253:
    v_mfma_f32_16x16x32_bf16 v[176:179], a[80:83], v[88:91], v[176:179]
    buffer_load_dwordx4 v[244:247], v5, s[4:7], s86 offen offset:256 sc1
    v_mfma_f32_16x16x32_bf16 v[184:187], a[108:111], v[88:91], v[184:187]
    v_mfma_f32_16x16x32_bf16 v[192:195], a[192:195], v[88:91], v[192:195]
    v_mfma_f32_16x16x32_bf16 v[200:203], a[220:223], v[88:91], v[200:203]
    v_mfma_f32_16x16x32_bf16 v[204:207], a[220:223], v[92:95], v[204:207]
    buffer_load_dwordx4 v[248:251], v5, s[4:7], s90 offen sc1
    v_mfma_f32_16x16x32_bf16 v[196:199], a[192:195], v[92:95], v[196:199]
    v_mfma_f32_16x16x32_bf16 v[188:191], a[108:111], v[92:95], v[188:191]
    v_mfma_f32_16x16x32_bf16 v[180:183], a[80:83], v[92:95], v[180:183]
    v_mfma_f32_16x16x32_bf16 v[208:211], a[24:27], v[96:99], v[208:211]
    buffer_load_dword v8, v10, s[4:7], s56 offen offset:512 sc1
    v_mfma_f32_16x16x32_bf16 v[216:219], a[52:55], v[96:99], v[216:219]
    s_add_u32 s44, s3, 14
    buffer_load_dwordx4 v[252:255], v5, s[4:7], s90 offen offset:256 sc1
    v_mfma_f32_16x16x32_bf16 v[144:147], a[136:139], v[96:99], v[144:147]
    v_mfma_f32_16x16x32_bf16 v[152:155], a[164:167], v[96:99], v[152:155]
    v_mfma_f32_16x16x32_bf16 v[156:159], a[164:167], v[100:103], v[156:159]
    buffer_load_dwordx4 v[32:35], v5, s[4:7], s87 offen sc1
    v_mfma_f32_16x16x32_bf16 v[148:151], a[136:139], v[100:103], v[148:151]
    v_mul_u32_u24 v164, 224, v3
    v_lshrrev_b32 v165, 5, v1
    v_mfma_f32_16x16x32_bf16 v[220:223], a[52:55], v[100:103], v[220:223]
    v_and_b32 v165, 16, v165
    v_add_u32 v164, v164, v165
    v_mfma_f32_16x16x32_bf16 v[212:215], a[24:27], v[100:103], v[212:215]
    v_mfma_f32_16x16x32_bf16 v[208:211], a[80:83], v[104:107], v[208:211]
    buffer_load_dwordx4 v[36:39], v5, s[4:7], s87 offen offset:256 sc1
    v_mfma_f32_16x16x32_bf16 v[216:219], a[108:111], v[104:107], v[216:219]
    v_mfma_f32_16x16x32_bf16 v[144:147], a[192:195], v[104:107], v[144:147]
    v_mfma_f32_16x16x32_bf16 v[152:155], a[220:223], v[104:107], v[152:155]
    v_mfma_f32_16x16x32_bf16 v[156:159], a[220:223], v[108:111], v[156:159]
    buffer_load_dwordx4 v[40:43], v5, s[4:7], s91 offen sc1
    v_mfma_f32_16x16x32_bf16 v[148:151], a[192:195], v[108:111], v[148:151]
    v_mfma_f32_16x16x32_bf16 v[220:223], a[108:111], v[108:111], v[220:223]
    v_mfma_f32_16x16x32_bf16 v[212:215], a[80:83], v[108:111], v[212:215]
    v_mfma_f32_16x16x32_bf16 v[192:195], a[132:135], v[112:115], v[192:195]
    buffer_load_dwordx4 v[44:47], v5, s[4:7], s91 offen offset:256 sc1
    v_mfma_f32_16x16x32_bf16 v[200:203], a[160:163], v[112:115], v[200:203]
    v_mfma_f32_16x16x32_bf16 v[204:207], a[160:163], v[116:119], v[204:207]
    v_mfma_f32_16x16x32_bf16 v[196:199], a[132:135], v[116:119], v[196:199]
    v_mfma_f32_16x16x32_bf16 v[192:195], a[188:191], v[120:123], v[192:195]
    buffer_load_dwordx4 v[48:51], v5, s[4:7], s86 offen offset:1024 sc1
    v_mfma_f32_16x16x32_bf16 v[200:203], a[216:219], v[120:123], v[200:203]
    s_waitcnt vmcnt(15)
    v_mfma_f32_16x16x32_bf16 v[204:207], a[216:219], v[124:127], v[204:207]
    v_mfma_f32_16x16x32_bf16 v[196:199], a[188:191], v[124:127], v[196:199]
    s_waitcnt vmcnt(6)
    v_subrev_u32 v8, s44, v8
    v_cmp_le_u32 vcc, 16, v8
    s_cbranch_vccnz Lfs_254
Lc_255:
    v_mfma_f32_16x16x32_bf16 v[208:211], a[20:23], v[128:131], v[208:211]
    buffer_load_dwordx4 v[52:55], v5, s[4:7], s86 offen offset:1280 sc1
    v_mfma_f32_16x16x32_bf16 v[216:219], a[48:51], v[128:131], v[216:219]
    v_mfma_f32_16x16x32_bf16 v[144:147], a[132:135], v[128:131], v[144:147]
    v_mfma_f32_16x16x32_bf16 v[152:155], a[160:163], v[128:131], v[152:155]
    v_mfma_f32_16x16x32_bf16 v[156:159], a[160:163], v[132:135], v[156:159]
    buffer_load_dwordx4 v[56:59], v5, s[4:7], s90 offen offset:1024 sc1
    v_mfma_f32_16x16x32_bf16 v[148:151], a[132:135], v[132:135], v[148:151]
    v_mfma_f32_16x16x32_bf16 v[220:223], a[48:51], v[132:135], v[220:223]
    v_mfma_f32_16x16x32_bf16 v[212:215], a[20:23], v[132:135], v[212:215]
    v_mfma_f32_16x16x32_bf16 v[208:211], a[76:79], v[136:139], v[208:211]
    buffer_load_dwordx4 v[60:63], v5, s[4:7], s90 offen offset:1280 sc1
    v_mfma_f32_16x16x32_bf16 v[216:219], a[104:107], v[136:139], v[216:219]
    v_mfma_f32_16x16x32_bf16 v[144:147], a[188:191], v[136:139], v[144:147]
    v_mfma_f32_16x16x32_bf16 v[152:155], a[216:219], v[136:139], v[152:155]
    v_mfma_f32_16x16x32_bf16 v[156:159], a[216:219], v[140:143], v[156:159]
    buffer_load_dwordx4 v[64:67], v5, s[4:7], s87 offen offset:1024 sc1
    v_mfma_f32_16x16x32_bf16 v[148:151], a[188:191], v[140:143], v[148:151]
    v_mfma_f32_16x16x32_bf16 v[220:223], a[104:107], v[140:143], v[220:223]
    v_mfma_f32_16x16x32_bf16 v[212:215], a[76:79], v[140:143], v[212:215]
    v_mfma_f32_16x16x32_bf16 v[192:195], a[120:123], v[240:243], v[192:195]
    buffer_load_dwordx4 v[68:71], v5, s[4:7], s87 offen offset:1280 sc1
    v_mfma_f32_16x16x32_bf16 v[200:203], a[148:151], v[240:243], v[200:203]
    v_mfma_f32_16x16x32_bf16 v[204:207], a[148:151], v[244:247], v[204:207]
    v_mfma_f32_16x16x32_bf16 v[196:199], a[120:123], v[244:247], v[196:199]
    v_mfma_f32_16x16x32_bf16 v[192:195], a[176:179], v[248:251], v[192:195]
    buffer_load_dwordx4 v[72:75], v5, s[4:7], s91 offen offset:1024 sc1
    v_mfma_f32_16x16x32_bf16 v[200:203], a[204:207], v[248:251], v[200:203]
    s_waitcnt vmcnt(11)
    v_mfma_f32_16x16x32_bf16 v[204:207], a[204:207], v[252:255], v[204:207]
    v_mfma_f32_16x16x32_bf16 v[196:199], a[176:179], v[252:255], v[196:199]
    s_waitcnt vmcnt(10)
    v_mfma_f32_16x16x32_bf16 v[208:211], a[8:11], v[32:35], v[208:211]
    buffer_load_dwordx4 v[76:79], v5, s[4:7], s91 offen offset:1280 sc1
    v_mfma_f32_16x16x32_bf16 v[216:219], a[36:39], v[32:35], v[216:219]
    v_mfma_f32_16x16x32_bf16 v[144:147], a[120:123], v[32:35], v[144:147]
    v_mfma_f32_16x16x32_bf16 v[152:155], a[148:151], v[32:35], v[152:155]
    s_waitcnt vmcnt(10)
    v_mfma_f32_16x16x32_bf16 v[156:159], a[148:151], v[36:39], v[156:159]
    buffer_load_dwordx4 v[80:83], v5, s[4:7], s86 offen offset:2048 sc1
    v_mfma_f32_16x16x32_bf16 v[148:151], a[120:123], v[36:39], v[148:151]
    v_mfma_f32_16x16x32_bf16 v[220:223], a[36:39], v[36:39], v[220:223]
    v_mfma_f32_16x16x32_bf16 v[212:215], a[8:11], v[36:39], v[212:215]
    s_waitcnt vmcnt(10)
    v_mfma_f32_16x16x32_bf16 v[208:211], a[64:67], v[40:43], v[208:211]
    buffer_load_dwordx4 v[84:87], v5, s[4:7], s86 offen offset:2304 sc1
    v_mfma_f32_16x16x32_bf16 v[216:219], a[92:95], v[40:43], v[216:219]
    v_mfma_f32_16x16x32_bf16 v[144:147], a[176:179], v[40:43], v[144:147]
    v_mfma_f32_16x16x32_bf16 v[152:155], a[204:207], v[40:43], v[152:155]
    s_waitcnt vmcnt(10)
    v_mfma_f32_16x16x32_bf16 v[156:159], a[204:207], v[44:47], v[156:159]
    buffer_load_dwordx4 v[88:91], v5, s[4:7], s90 offen offset:2048 sc1
    v_mfma_f32_16x16x32_bf16 v[148:151], a[176:179], v[44:47], v[148:151]
    v_mfma_f32_16x16x32_bf16 v[220:223], a[92:95], v[44:47], v[220:223]
    v_mfma_f32_16x16x32_bf16 v[212:215], a[64:67], v[44:47], v[212:215]
    s_waitcnt vmcnt(10)
    v_mfma_f32_16x16x32_bf16 v[192:195], a[116:119], v[48:51], v[192:195]
    buffer_load_dwordx4 v[92:95], v5, s[4:7], s90 offen offset:2304 sc1
    v_mfma_f32_16x16x32_bf16 v[200:203], a[144:147], v[48:51], v[200:203]
    s_waitcnt vmcnt(10)
    v_mfma_f32_16x16x32_bf16 v[204:207], a[144:147], v[52:55], v[204:207]
    v_mfma_f32_16x16x32_bf16 v[196:199], a[116:119], v[52:55], v[196:199]
    s_waitcnt vmcnt(9)
    v_mfma_f32_16x16x32_bf16 v[192:195], a[172:175], v[56:59], v[192:195]
    buffer_load_dwordx4 v[96:99], v5, s[4:7], s87 offen offset:2048 sc1
    v_mfma_f32_16x16x32_bf16 v[200:203], a[200:203], v[56:59], v[200:203]
    s_waitcnt vmcnt(9)
    v_mfma_f32_16x16x32_bf16 v[204:207], a[200:203], v[60:63], v[204:207]
    v_mfma_f32_16x16x32_bf16 v[196:199], a[172:175], v[60:63], v[196:199]
    s_waitcnt vmcnt(8)
    v_mfma_f32_16x16x32_bf16 v[208:211], a[4:7], v[64:67], v[208:211]
    buffer_load_dwordx4 v[100:103], v5, s[4:7], s87 offen offset:2304 sc1
    v_mfma_f32_16x16x32_bf16 v[216:219], a[32:35], v[64:67], v[216:219]
    v_mfma_f32_16x16x32_bf16 v[144:147], a[116:119], v[64:67], v[144:147]
    v_mfma_f32_16x16x32_bf16 v[152:155], a[144:147], v[64:67], v[152:155]
    s_waitcnt vmcnt(8)
    v_mfma_f32_16x16x32_bf16 v[156:159], a[144:147], v[68:71], v[156:159]
    buffer_load_dwordx4 v[104:107], v5, s[4:7], s91 offen offset:2048 sc1
    v_mfma_f32_16x16x32_bf16 v[148:151], a[116:119], v[68:71], v[148:151]
    v_mfma_f32_16x16x32_bf16 v[220:223], a[32:35], v[68:71], v[220:223]
    buffer_load_dwordx4 v[108:111], v5, s[4:7], s91 offen offset:2304 sc1
    v_mfma_f32_16x16x32_bf16 v[212:215], a[4:7], v[68:71], v[212:215]
    s_waitcnt vmcnt(9)
    v_mfma_f32_16x16x32_bf16 v[208:211], a[60:63], v[72:75], v[208:211]
    v_mfma_f32_16x16x32_bf16 v[216:219], a[88:91], v[72:75], v[216:219]
    v_mfma_f32_16x16x32_bf16 v[144:147], a[172:175], v[72:75], v[144:147]
    v_mfma_f32_16x16x32_bf16 v[152:155], a[200:203], v[72:75], v[152:155]
    s_waitcnt vmcnt(8)
    v_mfma_f32_16x16x32_bf16 v[156:159], a[200:203], v[76:79], v[156:159]
    v_mfma_f32_16x16x32_bf16 v[148:151], a[172:175], v[76:79], v[148:151]
    v_mfma_f32_16x16x32_bf16 v[220:223], a[88:91], v[76:79], v[220:223]
    v_mfma_f32_16x16x32_bf16 v[212:215], a[60:63], v[76:79], v[212:215]
    s_waitcnt vmcnt(7)
    v_mfma_f32_16x16x32_bf16 v[192:195], a[112:115], v[80:83], v[192:195]
    v_mfma_f32_16x16x32_bf16 v[200:203], a[140:143], v[80:83], v[200:203]
    s_waitcnt vmcnt(6)
    v_mfma_f32_16x16x32_bf16 v[204:207], a[140:143], v[84:87], v[204:207]
    v_mfma_f32_16x16x32_bf16 v[196:199], a[112:115], v[84:87], v[196:199]
    s_waitcnt vmcnt(5)
    v_mfma_f32_16x16x32_bf16 v[192:195], a[168:171], v[88:91], v[192:195]
    v_mfma_f32_16x16x32_bf16 v[200:203], a[196:199], v[88:91], v[200:203]
    s_waitcnt vmcnt(4)
    v_mfma_f32_16x16x32_bf16 v[204:207], a[196:199], v[92:95], v[204:207]
    v_mfma_f32_16x16x32_bf16 v[196:199], a[168:171], v[92:95], v[196:199]
    s_waitcnt vmcnt(3)
    v_mfma_f32_16x16x32_bf16 v[208:211], a[0:3], v[96:99], v[208:211]
    v_mfma_f32_16x16x32_bf16 v[216:219], a[28:31], v[96:99], v[216:219]
    s_waitcnt vmcnt(2)
    v_mfma_f32_16x16x32_bf16 v[220:223], a[28:31], v[100:103], v[220:223]
    ds_write_b128 v28, v[192:195] offset:0
    v_mfma_f32_16x16x32_bf16 v[212:215], a[0:3], v[100:103], v[212:215]
    s_nop 0
    ds_write_b128 v28, v[196:199] offset:1024
    s_waitcnt vmcnt(1)
    v_mfma_f32_16x16x32_bf16 v[208:211], a[56:59], v[104:107], v[208:211]
    ds_write_b128 v28, v[200:203] offset:2048
    v_mfma_f32_16x16x32_bf16 v[216:219], a[84:87], v[104:107], v[216:219]
    ds_write_b128 v28, v[204:207] offset:3072
    s_waitcnt vmcnt(0)
    v_mfma_f32_16x16x32_bf16 v[220:223], a[84:87], v[108:111], v[220:223]
    v_mfma_f32_16x16x32_bf16 v[212:215], a[56:59], v[108:111], v[212:215]
    v_mfma_f32_16x16x32_bf16 v[144:147], a[112:115], v[96:99], v[144:147]
    v_mfma_f32_16x16x32_bf16 v[152:155], a[140:143], v[96:99], v[152:155]
    v_mfma_f32_16x16x32_bf16 v[156:159], a[140:143], v[100:103], v[156:159]
    ds_write_b128 v29, v[208:211] offset:0
    v_mfma_f32_16x16x32_bf16 v[148:151], a[112:115], v[100:103], v[148:151]
    s_nop 2
    ds_write_b128 v29, v[212:215] offset:1024
    v_mfma_f32_16x16x32_bf16 v[144:147], a[168:171], v[104:107], v[144:147]
    ds_write_b128 v29, v[216:219] offset:2048
    v_mfma_f32_16x16x32_bf16 v[152:155], a[196:199], v[104:107], v[152:155]
    ds_write_b128 v29, v[220:223] offset:3072
    v_mfma_f32_16x16x32_bf16 v[156:159], a[196:199], v[108:111], v[156:159]
    s_and_b32 s22, s2, 128
    s_or_b32 s22, s22, s29
    s_cmp_lg_u32 s22, 0
    s_cbranch_scc1 Lwb_256
    buffer_wbl2 sc1
Lwb_256:
    v_mfma_f32_16x16x32_bf16 v[148:151], a[168:171], v[108:111], v[148:151]
    v_mfma_f32_16x16x32_bf16 v[176:179], a[20:23], v[112:115], v[176:179]
    v_mfma_f32_16x16x32_bf16 v[184:187], a[48:51], v[112:115], v[184:187]
    v_mfma_f32_16x16x32_bf16 v[188:191], a[48:51], v[116:119], v[188:191]
    ds_write_b128 v30, v[144:147] offset:0
    v_mfma_f32_16x16x32_bf16 v[180:183], a[20:23], v[116:119], v[180:183]
    s_nop 2
    ds_write_b128 v30, v[148:151] offset:1024
    v_mfma_f32_16x16x32_bf16 v[176:179], a[76:79], v[120:123], v[176:179]
    ds_write_b128 v30, v[152:155] offset:2048
    v_mfma_f32_16x16x32_bf16 v[184:187], a[104:107], v[120:123], v[184:187]
    ds_write_b128 v30, v[156:159] offset:3072
    v_mfma_f32_16x16x32_bf16 v[188:191], a[104:107], v[124:127], v[188:191]
    v_mfma_f32_16x16x32_bf16 v[180:183], a[76:79], v[124:127], v[180:183]
    v_mfma_f32_16x16x32_bf16 v[176:179], a[8:11], v[240:243], v[176:179]
    v_mfma_f32_16x16x32_bf16 v[184:187], a[36:39], v[240:243], v[184:187]
    s_waitcnt lgkmcnt(0)
    s_barrier
    v_mfma_f32_16x16x32_bf16 v[188:191], a[36:39], v[244:247], v[188:191]
    ds_read_b128 v[192:195], v31 offset:0
    ds_read_b128 v[208:211], v31 offset:4096
    v_mfma_f32_16x16x32_bf16 v[180:183], a[8:11], v[244:247], v[180:183]
    ds_read_b128 v[144:147], v31 offset:8192
    ds_read_b128 v[196:199], v31 offset:1024
    v_mfma_f32_16x16x32_bf16 v[176:179], a[64:67], v[248:251], v[176:179]
    ds_read_b128 v[212:215], v31 offset:5120
    ds_read_b128 v[148:151], v31 offset:9216
    v_mfma_f32_16x16x32_bf16 v[184:187], a[92:95], v[248:251], v[184:187]
    ds_read_b128 v[200:203], v31 offset:2048
    ds_read_b128 v[216:219], v31 offset:6144
    v_mfma_f32_16x16x32_bf16 v[188:191], a[92:95], v[252:255], v[188:191]
    ds_read_b128 v[152:155], v31 offset:10240
    ds_read_b128 v[204:207], v31 offset:3072
    v_mfma_f32_16x16x32_bf16 v[180:183], a[64:67], v[252:255], v[180:183]
    ds_read_b128 v[220:223], v31 offset:7168
    ds_read_b128 v[156:159], v31 offset:11264
    v_mfma_f32_16x16x32_bf16 v[176:179], a[4:7], v[48:51], v[176:179]
    s_waitcnt lgkmcnt(10)
    v_add_f32 v192, v192, v208
    v_add_f32 v193, v193, v209
    v_mfma_f32_16x16x32_bf16 v[184:187], a[32:35], v[48:51], v[184:187]
    v_add_f32 v194, v194, v210
    v_add_f32 v195, v195, v211
    v_mfma_f32_16x16x32_bf16 v[188:191], a[32:35], v[52:55], v[188:191]
    s_waitcnt lgkmcnt(9)
    v_add_f32 v192, v192, v144
    v_add_f32 v193, v193, v145
    v_mfma_f32_16x16x32_bf16 v[180:183], a[4:7], v[52:55], v[180:183]
    v_add_f32 v194, v194, v146
    v_add_f32 v195, v195, v147
    v_mfma_f32_16x16x32_bf16 v[176:179], a[60:63], v[56:59], v[176:179]
    s_waitcnt lgkmcnt(7)
    v_add_f32 v196, v196, v212
    v_add_f32 v197, v197, v213
    v_mfma_f32_16x16x32_bf16 v[184:187], a[88:91], v[56:59], v[184:187]
    v_add_f32 v198, v198, v214
    v_add_f32 v199, v199, v215
    v_mfma_f32_16x16x32_bf16 v[188:191], a[88:91], v[60:63], v[188:191]
    s_waitcnt lgkmcnt(6)
    v_add_f32 v196, v196, v148
    v_add_f32 v197, v197, v149
    v_mfma_f32_16x16x32_bf16 v[180:183], a[60:63], v[60:63], v[180:183]
    v_add_f32 v198, v198, v150
    v_add_f32 v199, v199, v151
    v_mfma_f32_16x16x32_bf16 v[176:179], a[0:3], v[80:83], v[176:179]
    s_waitcnt lgkmcnt(4)
    v_add_f32 v200, v200, v216
    v_add_f32 v201, v201, v217
    v_mfma_f32_16x16x32_bf16 v[184:187], a[28:31], v[80:83], v[184:187]
    v_add_f32 v202, v202, v218
    v_add_f32 v203, v203, v219
    v_mfma_f32_16x16x32_bf16 v[188:191], a[28:31], v[84:87], v[188:191]
    s_waitcnt lgkmcnt(3)
    v_add_f32 v200, v200, v152
    v_add_f32 v201, v201, v153
    v_mfma_f32_16x16x32_bf16 v[180:183], a[0:3], v[84:87], v[180:183]
    v_add_f32 v202, v202, v154
    v_add_f32 v203, v203, v155
    v_mfma_f32_16x16x32_bf16 v[176:179], a[56:59], v[88:91], v[176:179]
    s_waitcnt lgkmcnt(1)
    v_add_f32 v204, v204, v220
    v_add_f32 v205, v205, v221
    v_mfma_f32_16x16x32_bf16 v[184:187], a[84:87], v[88:91], v[184:187]
    v_add_f32 v206, v206, v222
    v_add_f32 v207, v207, v223
    v_mfma_f32_16x16x32_bf16 v[188:191], a[84:87], v[92:95], v[188:191]
    s_waitcnt lgkmcnt(0)
    v_add_f32 v204, v204, v156
    v_add_f32 v205, v205, v157
    v_mfma_f32_16x16x32_bf16 v[180:183], a[56:59], v[92:95], v[180:183]
    v_add_f32 v206, v206, v158
    v_add_f32 v207, v207, v159
    v_pk_add_f32 v[176:177], v[176:177], v[192:193]
    v_pk_add_f32 v[178:179], v[178:179], v[194:195]
    v_cvt_pk_bf16_f32 v12, v176, v177
    v_cvt_pk_bf16_f32 v13, v178, v179
    s_nop 1
    v_pk_add_f32 v[180:181], v[180:181], v[196:197]
    v_pk_add_f32 v[182:183], v[182:183], v[198:199]
    v_cvt_pk_bf16_f32 v14, v180, v181
    v_cvt_pk_bf16_f32 v15, v182, v183
    s_nop 0
    v_permlane16_swap_b32 v12, v14
    v_permlane16_swap_b32 v13, v15
    s_nop 0
    v_permlane32_swap_b32 v12, v14
    v_permlane32_swap_b32 v13, v15
    buffer_store_dwordx4 v[12:15], v164, s[8:11], s52 offen
    v_pk_add_f32 v[184:185], v[184:185], v[200:201]
    v_pk_add_f32 v[186:187], v[186:187], v[202:203]
    v_cvt_pk_bf16_f32 v16, v184, v185
    v_cvt_pk_bf16_f32 v17, v186, v187
    v_pk_add_f32 v[188:189], v[188:189], v[204:205]
    v_pk_add_f32 v[190:191], v[190:191], v[206:207]
    v_cvt_pk_bf16_f32 v18, v188, v189
    v_cvt_pk_bf16_f32 v19, v190, v191
    s_nop 0
    v_permlane16_swap_b32 v16, v18
    v_permlane16_swap_b32 v17, v19
    s_nop 0
    v_permlane32_swap_b32 v16, v18
    v_permlane32_swap_b32 v17, v19
    buffer_store_dwordx4 v[16:19], v164, s[8:11], s52 offen offset:32
Lfin_2:
Lend_1:
    s_endpgm
LuN_4:
    s_mov_b32 s71, 0x10000000
    s_or_b32 s62, s2, s24
    s_cbranch_scc1 LuJ_5
    s_mov_b32 s92, s96
    s_and_b32 s93, s97, 0xffff
    s_movk_i32 s94, 256
    s_mov_b32 s95, 0x00020000
    s_lshl_b32 s54, s54, 4
    s_or_b32 s54, s54, 16
    v_mov_b32 v144, s54
    v_lshlrev_b32 v145, 8, v31
    buffer_store_dword v144, v145, s[92:95], 0 offen sc1
    s_branch LuJ_5
Lu4_7:
    s_sub_u32 s62, s2, 16
    s_cmp_ge_u32 s62, 98
    s_cbranch_scc1 LuD_8
    s_mul_i32 s63, s62, 9363
    s_lshr_b32 s63, s63, 16
    s_mul_i32 s64, s63, 7
    s_sub_u32 s64, s62, s64
    s_lshl_b32 s63, s63, 1
    s_add_u32 s63, s63, s61
    s_lshl_b32 s65, s63, 3
    s_add_u32 s65, s65, s60
    s_mul_i32 s65, s65, 7168
    s_lshl_b32 s66, s64, 7
    s_add_u32 s96, s65, s66
    s_lshl_b32 s64, s64, 1
    s_add_u32 s64, s64, s60
    s_mul_i32 s64, s64, 28
    s_add_u32 s64, s64, s63
    s_lshl_b32 s64, s64, 12
    s_add_u32 s40, s64, 0x1ff400
    s_branch LuD_8
Lfs_11:
    s_cmp_eq_u32 s30, 0
    s_cbranch_scc1 Lc_12
    s_sub_u32 s30, s30, 1
    buffer_load_dword v25, off, s[92:95], 0 sc1
    s_waitcnt vmcnt(0)
    v_cmp_eq_u32 vcc, 0, v25
    s_cbranch_vccnz Lfs_11
    s_branch Lc_12
LnoB_13:
    buffer_load_dword v189, off, s[4:7], s71
    buffer_load_dword v189, off, s[4:7], s71
    buffer_load_dword v189, off, s[4:7], s71
    buffer_load_dword v189, off, s[4:7], s71
    s_branch LnoC_14
Lfs_15:
    s_cmp_eq_u32 s30, 0
    s_cbranch_scc1 Lc_16
    s_sub_u32 s30, s30, 1
    buffer_load_dword v8, v26, s[4:7], s66 offen sc1
    s_waitcnt vmcnt(0)
    v_xor_b32 v8, s3, v8
    v_cmp_le_u32 vcc, s79, v8
    s_cbranch_vccnz Lfs_15
    s_branch Lc_16
Lfs_19:
    s_cmp_eq_u32 s30, 0
    s_cbranch_scc1 Lc_20
    s_sub_u32 s30, s30, 1
    buffer_load_dwordx2 v[216:217], v8, s[4:7], s64 offen sc1
    s_waitcnt vmcnt(0)
    v_xor_b32 v217, s3, v217
    v_cmp_le_u32 vcc, 16, v217
    s_cbranch_vccnz Lfs_19
    s_branch Lc_20
Lfs_21:
    s_cmp_eq_u32 s30, 0
    s_cbranch_scc1 Lc_22
    s_sub_u32 s30, s30, 1
    buffer_load_dwordx2 v[208:209], v9, s[4:7], s65 offen sc1
    s_waitcnt vmcnt(0)
    v_xor_b32 v209, s3, v209
    v_cmp_le_u32 vcc, 16, v209
    s_cbranch_vccnz Lfs_21
    s_branch Lc_22
Lfs_23:
    s_cmp_eq_u32 s30, 0
    s_cbranch_scc1 Lc_24
    s_sub_u32 s30, s30, 1
    buffer_load_dword v8, v25, s[4:7], s91 offen sc1
    s_waitcnt vmcnt(0)
    v_xor_b32 v8, s3, v8
    v_cmp_le_u32 vcc, s79, v8
    s_cbranch_vccnz Lfs_23
    s_branch Lc_24
Lidle_26:
    s_waitcnt lgkmcnt(0)
    s_nop 7
    s_nop 7
    s_waitcnt vmcnt(0)
    s_barrier
    s_add_u32 m0, s55, 0xe000
    s_add_u32 s64, s39, 0xe000
    buffer_load_dwordx4 v1, s[4:7], s64 offen lds
    buffer_load_dwordx4 v1, s[4:7], s64 offen offset:1024 lds
    buffer_load_dwordx4 v1, s[4:7], s64 offen offset:2048 lds
    buffer_load_dwordx4 v1, s[4:7], s64 offen offset:3072 lds
    s_add_u32 m0, s55, 0xf000
    s_nop 0
    buffer_load_dwordx4 v0, s[4:7], s64 offen lds
    buffer_load_dwordx4 v0, s[4:7], s64 offen offset:1024 lds
    buffer_load_dwordx4 v0, s[4:7], s64 offen offset:2048 lds
    s_waitcnt vmcnt(0) lgkmcnt(0)
    s_branch LstS3_0f
Lfc_29:
    buffer_load_dwordx4 v[32:35], v1, s[4:7], s84 offen offset:2048 sc1
    s_sub_u32 s30, s30, 1
    s_cbranch_scc1 Lo_31
    s_waitcnt vmcnt(0)
    v_cmp_eq_u32 vcc, -1, v32
    s_cbranch_vccnz Lfc_29
    s_branch Lc_30
Lo_31:
    s_mov_b32 s30, 0
    s_waitcnt vmcnt(0)
    s_branch Lc_30
Lfc_32:
    buffer_load_dwordx4 v[36:39], v1, s[4:7], s84 offen offset:3072 sc1
    s_sub_u32 s30, s30, 1
    s_cbranch_scc1 Lo_34
    s_waitcnt vmcnt(0)
    v_cmp_eq_u32 vcc, -1, v36
    s_cbranch_vccnz Lfc_32
    s_branch Lc_33
Lo_34:
    s_mov_b32 s30, 0
    s_waitcnt vmcnt(0)
    s_branch Lc_33
Lfc_35:
    s_add_u32 s97, s84, 0x6000
    buffer_load_dwordx4 v[40:43], v0, s[4:7], s97 offen offset:2048 sc1
    buffer_load_dwordx4 v[44:47], v0, s[4:7], s97 offen offset:3072 sc1
    s_sub_u32 s30, s30, 1
    s_cbranch_scc1 Lo_37
    s_waitcnt vmcnt(0)
    v_cmp_eq_u32 vcc, -1, v40
    s_cbranch_vccnz Lfc_35
    v_cmp_eq_u32 vcc, -1, v44
    s_cbranch_vccnz Lfc_35
    s_branch Lc_36
Lo_37:
    s_mov_b32 s30, 0
    s_waitcnt vmcnt(0)
    s_branch Lc_36
Lfc_38:
    s_add_u32 s97, s84, 0xe000
    buffer_load_dwordx4 v[48:51], v1, s[4:7], s97 offen offset:2048 sc1
    buffer_load_dwordx4 v[52:55], v1, s[4:7], s97 offen offset:3072 sc1
    s_sub_u32 s30, s30, 1
    s_cbranch_scc1 Lo_40
    s_waitcnt vmcnt(0)
    v_cmp_eq_u32 vcc, -1, v48
    s_cbranch_vccnz Lfc_38
    v_cmp_eq_u32 vcc, -1, v52
    s_cbranch_vccnz Lfc_38
    s_branch Lc_39
Lo_40:
    s_mov_b32 s30, 0
    s_waitcnt vmcnt(0)
    s_branch Lc_39
Lfc_41:
    s_add_u32 s97, s84, 0x14000
    buffer_load_dwordx4 v[56:59], v0, s[4:7], s97 offen offset:2048 sc1
    buffer_load_dwordx4 v[60:63], v0, s[4:7], s97 offen offset:3072 sc1
    s_sub_u32 s30, s30, 1
    s_cbranch_scc1 Lo_43
    s_waitcnt vmcnt(0)
    v_cmp_eq_u32 vcc, -1, v56
    s_cbranch_vccnz Lfc_41
    v_cmp_eq_u32 vcc, -1, v60
    s_cbranch_vccnz Lfc_41
    s_branch Lc_42
Lo_43:
    s_mov_b32 s30, 0
    s_waitcnt vmcnt(0)
    s_branch Lc_42
Lfc_44:
    s_add_u32 s97, s84, 0x1c000
    buffer_load_dwordx4 v[64:67], v1, s[4:7], s97 offen offset:2048 sc1
    buffer_load_dwordx4 v[68:71], v1, s[4:7], s97 offen offset:3072 sc1
    s_sub_u32 s30, s30, 1
    s_cbranch_scc1 Lo_46
    s_waitcnt vmcnt(0)
    v_cmp_eq_u32 vcc, -1, v64
    s_cbranch_vccnz Lfc_44
    v_cmp_eq_u32 vcc, -1, v68
    s_cbranch_vccnz Lfc_44
    s_branch Lc_45
Lo_46:
    s_mov_b32 s30, 0
    s_waitcnt vmcnt(0)
    s_branch Lc_45
Lfc_47:
    s_add_u32 s97, s84, 0x22000
    buffer_load_dwordx4 v[72:75], v0, s[4:7], s97 offen offset:2048 sc1
    buffer_load_dwordx4 v[76:79], v0, s[4:7], s97 offen offset:3072 sc1
    s_sub_u32 s30, s30, 1
    s_cbranch_scc1 Lo_49
    s_waitcnt vmcnt(0)
    v_cmp_eq_u32 vcc, -1, v72
    s_cbranch_vccnz Lfc_47
    v_cmp_eq_u32 vcc, -1, v76
    s_cbranch_vccnz Lfc_47
    s_branch Lc_48
Lo_49:
    s_mov_b32 s30, 0
    s_waitcnt vmcnt(0)
    s_branch Lc_48
Lfc_50:
    s_add_u32 s97, s84, 0x2a000
    buffer_load_dwordx4 v[80:83], v1, s[4:7], s97 offen offset:2048 sc1
    buffer_load_dwordx4 v[84:87], v1, s[4:7], s97 offen offset:3072 sc1
    s_sub_u32 s30, s30, 1
    s_cbranch_scc1 Lo_52
    s_waitcnt vmcnt(0)
    v_cmp_eq_u32 vcc, -1, v80
    s_cbranch_vccnz Lfc_50
    v_cmp_eq_u32 vcc, -1, v84
    s_cbranch_vccnz Lfc_50
    s_branch Lc_51
Lo_52:
    s_mov_b32 s30, 0
    s_waitcnt vmcnt(0)
    s_branch Lc_51
Lfc_53:
    s_add_u32 s97, s84, 0x30000
    buffer_load_dwordx4 v[88:91], v0, s[4:7], s97 offen offset:2048 sc1
    buffer_load_dwordx4 v[92:95], v0, s[4:7], s97 offen offset:3072 sc1
    s_sub_u32 s30, s30, 1
    s_cbranch_scc1 Lo_55
    s_waitcnt vmcnt(0)
    v_cmp_eq_u32 vcc, -1, v88
    s_cbranch_vccnz Lfc_53
    v_cmp_eq_u32 vcc, -1, v92
    s_cbranch_vccnz Lfc_53
    s_branch Lc_54
Lo_55:
    s_mov_b32 s30, 0
    s_waitcnt vmcnt(0)
    s_branch Lc_54
Lfc_59:
    s_add_u32 s97, s36, 0x1000
    buffer_load_dwordx4 v[32:35], v31, s[4:7], s97 offen offset:1024 sc1
    buffer_load_dwordx4 v[36:39], v31, s[4:7], s97 offen offset:1280 sc1
    s_sub_u32 s30, s30, 1
    s_cbranch_scc1 Lo_61
    s_waitcnt vmcnt(0)
    v_cmp_eq_u32 vcc, -1, v32
    s_cbranch_vccnz Lfc_59
    v_cmp_eq_u32 vcc, -1, v36
    s_cbranch_vccnz Lfc_59
    s_branch Lc_60
Lo_61:
    s_mov_b32 s30, 0
    s_waitcnt vmcnt(0)
    s_branch Lc_60
Lfc_62:
    s_add_u32 s97, s36, 0x3000
    buffer_load_dwordx4 v[40:43], v31, s[4:7], s97 offen sc1
    buffer_load_dwordx4 v[44:47], v31, s[4:7], s97 offen offset:256 sc1
    s_sub_u32 s30, s30, 1
    s_cbranch_scc1 Lo_64
    s_waitcnt vmcnt(0)
    v_cmp_eq_u32 vcc, -1, v40
    s_cbranch_vccnz Lfc_62
    v_cmp_eq_u32 vcc, -1, v44
    s_cbranch_vccnz Lfc_62
    s_branch Lc_63
Lo_64:
    s_mov_b32 s30, 0
    s_waitcnt vmcnt(0)
    s_branch Lc_63
Lfc_65:
    s_add_u32 s97, s36, 0xf000
    buffer_load_dwordx4 v[48:51], v31, s[4:7], s97 offen offset:1024 sc1
    buffer_load_dwordx4 v[52:55], v31, s[4:7], s97 offen offset:1280 sc1
    s_sub_u32 s30, s30, 1
    s_cbranch_scc1 Lo_67
    s_waitcnt vmcnt(0)
    v_cmp_eq_u32 vcc, -1, v48
    s_cbranch_vccnz Lfc_65
    v_cmp_eq_u32 vcc, -1, v52
    s_cbranch_vccnz Lfc_65
    s_branch Lc_66
Lo_67:
    s_mov_b32 s30, 0
    s_waitcnt vmcnt(0)
    s_branch Lc_66
Lfc_68:
    s_add_u32 s97, s36, 0x11000
    buffer_load_dwordx4 v[56:59], v31, s[4:7], s97 offen sc1
    buffer_load_dwordx4 v[60:63], v31, s[4:7], s97 offen offset:256 sc1
    s_sub_u32 s30, s30, 1
    s_cbranch_scc1 Lo_70
    s_waitcnt vmcnt(0)
    v_cmp_eq_u32 vcc, -1, v56
    s_cbranch_vccnz Lfc_68
    v_cmp_eq_u32 vcc, -1, v60
    s_cbranch_vccnz Lfc_68
    s_branch Lc_69
Lo_70:
    s_mov_b32 s30, 0
    s_waitcnt vmcnt(0)
    s_branch Lc_69
Lfc_71:
    s_add_u32 s97, s36, 0x1d000
    buffer_load_dwordx4 v[64:67], v31, s[4:7], s97 offen offset:1024 sc1
    buffer_load_dwordx4 v[68:71], v31, s[4:7], s97 offen offset:1280 sc1
    s_sub_u32 s30, s30, 1
    s_cbranch_scc1 Lo_73
    s_waitcnt vmcnt(0)
    v_cmp_eq_u32 vcc, -1, v64
    s_cbranch_vccnz Lfc_71
    v_cmp_eq_u32 vcc, -1, v68
    s_cbranch_vccnz Lfc_71
    s_branch Lc_72
Lo_73:
    s_mov_b32 s30, 0
    s_waitcnt vmcnt(0)
    s_branch Lc_72
Lfc_74:
    s_add_u32 s97, s36, 0x1f000
    buffer_load_dwordx4 v[72:75], v31, s[4:7], s97 offen sc1
    buffer_load_dwordx4 v[76:79], v31, s[4:7], s97 offen offset:256 sc1
    s_sub_u32 s30, s30, 1
    s_cbranch_scc1 Lo_76
    s_waitcnt vmcnt(0)
    v_cmp_eq_u32 vcc, -1, v72
    s_cbranch_vccnz Lfc_74
    v_cmp_eq_u32 vcc, -1, v76
    s_cbranch_vccnz Lfc_74
    s_branch Lc_75
Lo_76:
    s_mov_b32 s30, 0
    s_waitcnt vmcnt(0)
    s_branch Lc_75
Lfc_77:
    s_add_u32 s97, s36, 0x2b000
    buffer_load_dwordx4 v[80:83], v31, s[4:7], s97 offen offset:1024 sc1
    buffer_load_dwordx4 v[84:87], v31, s[4:7], s97 offen offset:1280 sc1
    s_sub_u32 s30, s30, 1
    s_cbranch_scc1 Lo_79
    s_waitcnt vmcnt(0)
    v_cmp_eq_u32 vcc, -1, v80
    s_cbranch_vccnz Lfc_77
    v_cmp_eq_u32 vcc, -1, v84
    s_cbranch_vccnz Lfc_77
    s_branch Lc_78
Lo_79:
    s_mov_b32 s30, 0
    s_waitcnt vmcnt(0)
    s_branch Lc_78
Lfc_80:
    s_add_u32 s97, s36, 0x2d000
    buffer_load_dwordx4 v[88:91], v31, s[4:7], s97 offen sc1
    buffer_load_dwordx4 v[92:95], v31, s[4:7], s97 offen offset:256 sc1
    s_sub_u32 s30, s30, 1
    s_cbranch_scc1 Lo_82
    s_waitcnt vmcnt(0)
    v_cmp_eq_u32 vcc, -1, v88
    s_cbranch_vccnz Lfc_80
    v_cmp_eq_u32 vcc, -1, v92
    s_cbranch_vccnz Lfc_80
    s_branch Lc_81
Lo_82:
    s_mov_b32 s30, 0
    s_waitcnt vmcnt(0)
    s_branch Lc_81
Lfc_83:
    s_add_u32 s97, s36, 0x39000
    buffer_load_dwordx4 v[96:99], v31, s[4:7], s97 offen offset:1024 sc1
    buffer_load_dwordx4 v[100:103], v31, s[4:7], s97 offen offset:1280 sc1
    s_sub_u32 s30, s30, 1
    s_cbranch_scc1 Lo_85
    s_waitcnt vmcnt(0)
    v_cmp_eq_u32 vcc, -1, v96
    s_cbranch_vccnz Lfc_83
    v_cmp_eq_u32 vcc, -1, v100
    s_cbranch_vccnz Lfc_83
    s_branch Lc_84
Lo_85:
    s_mov_b32 s30, 0
    s_waitcnt vmcnt(0)
    s_branch Lc_84
Lfc_86:
    s_add_u32 s97, s36, 0x3b000
    buffer_load_dwordx4 v[104:107], v31, s[4:7], s97 offen sc1
    buffer_load_dwordx4 v[108:111], v31, s[4:7], s97 offen offset:256 sc1
    s_sub_u32 s30, s30, 1
    s_cbranch_scc1 Lo_88
    s_waitcnt vmcnt(0)
    v_cmp_eq_u32 vcc, -1, v104
    s_cbranch_vccnz Lfc_86
    v_cmp_eq_u32 vcc, -1, v108
    s_cbranch_vccnz Lfc_86
    s_branch Lc_87
Lo_88:
    s_mov_b32 s30, 0
    s_waitcnt vmcnt(0)
    s_branch Lc_87
Lfc_89:
    s_add_u32 s97, s36, 0x47000
    buffer_load_dwordx4 v[112:115], v31, s[4:7], s97 offen offset:1024 sc1
    buffer_load_dwordx4 v[116:119], v31, s[4:7], s97 offen offset:1280 sc1
    s_sub_u32 s30, s30, 1
    s_cbranch_scc1 Lo_91
    s_waitcnt vmcnt(0)
    v_cmp_eq_u32 vcc, -1, v112
    s_cbranch_vccnz Lfc_89
    v_cmp_eq_u32 vcc, -1, v116
    s_cbranch_vccnz Lfc_89
    s_branch Lc_90
Lo_91:
    s_mov_b32 s30, 0
    s_waitcnt vmcnt(0)
    s_branch Lc_90
Lfc_92:
    s_add_u32 s97, s36, 0x49000
    buffer_load_dwordx4 v[120:123], v31, s[4:7], s97 offen sc1
    buffer_load_dwordx4 v[124:127], v31, s[4:7], s97 offen offset:256 sc1
    s_sub_u32 s30, s30, 1
    s_cbranch_scc1 Lo_94
    s_waitcnt vmcnt(0)
    v_cmp_eq_u32 vcc, -1, v120
    s_cbranch_vccnz Lfc_92
    v_cmp_eq_u32 vcc, -1, v124
    s_cbranch_vccnz Lfc_92
    s_branch Lc_93
Lo_94:
    s_mov_b32 s30, 0
    s_waitcnt vmcnt(0)
    s_branch Lc_93
Lfc_95:
    s_add_u32 s97, s36, 0x55000
    buffer_load_dwordx4 v[128:131], v31, s[4:7], s97 offen offset:1024 sc1
    buffer_load_dwordx4 v[132:135], v31, s[4:7], s97 offen offset:1280 sc1
    s_sub_u32 s30, s30, 1
    s_cbranch_scc1 Lo_97
    s_waitcnt vmcnt(0)
    v_cmp_eq_u32 vcc, -1, v128
    s_cbranch_vccnz Lfc_95
    v_cmp_eq_u32 vcc, -1, v132
    s_cbranch_vccnz Lfc_95
    s_branch Lc_96
Lo_97:
    s_mov_b32 s30, 0
    s_waitcnt vmcnt(0)
    s_branch Lc_96
Lfc_98:
    s_add_u32 s97, s36, 0x57000
    buffer_load_dwordx4 v[136:139], v31, s[4:7], s97 offen sc1
    buffer_load_dwordx4 v[140:143], v31, s[4:7], s97 offen offset:256 sc1
    s_sub_u32 s30, s30, 1
    s_cbranch_scc1 Lo_100
    s_waitcnt vmcnt(0)
    v_cmp_eq_u32 vcc, -1, v136
    s_cbranch_vccnz Lfc_98
    v_cmp_eq_u32 vcc, -1, v140
    s_cbranch_vccnz Lfc_98
    s_branch Lc_99
Lo_100:
    s_mov_b32 s30, 0
    s_waitcnt vmcnt(0)
    s_branch Lc_99
Lnn_101:
    s_nop 7
    s_nop 7
Lr_103:
    buffer_load_dword v208, v2, s[4:7], s93 offen sc1
    buffer_load_dword v209, v2, s[4:7], s93 offen offset:256 sc1
    buffer_load_dword v210, v2, s[4:7], s93 offen offset:512 sc1
    buffer_load_dword v211, v2, s[4:7], s93 offen offset:768 sc1
    buffer_load_dword v212, v2, s[4:7], s93 offen offset:1024 sc1
    buffer_load_dword v213, v2, s[4:7], s93 offen offset:1280 sc1
    buffer_load_dword v214, v2, s[4:7], s93 offen offset:1536 sc1
    buffer_load_dword v215, v2, s[4:7], s93 offen offset:1792 sc1
    buffer_load_dword v216, v2, s[4:7], s93 offen offset:2048 sc1
    buffer_load_dword v217, v2, s[4:7], s93 offen offset:2304 sc1
    buffer_load_dword v218, v2, s[4:7], s93 offen offset:2560 sc1
    buffer_load_dword v219, v2, s[4:7], s93 offen offset:2816 sc1
    buffer_load_dword v220, v2, s[4:7], s93 offen offset:3072 sc1
    buffer_load_dword v221, v2, s[4:7], s93 offen offset:3328 sc1
    s_waitcnt vmcnt(0)
    v_max3_u32 v223, v208, v209, v210
    v_max3_u32 v223, v223, v211, v212
    v_max3_u32 v223, v223, v213, v214
    v_max3_u32 v223, v223, v215, v216
    v_max3_u32 v223, v223, v217, v218
    v_max3_u32 v223, v223, v219, v220
    v_max_u32 v223, v223, v221
    v_cmp_eq_u32 vcc, -1, v223
    s_cbranch_vccz Lg_104
    s_sub_u32 s30, s30, 1
    s_cbranch_scc0 Lr_103
    s_mov_b32 s30, 0
Lg_104:
    v_add_f32 v208, v208, v209
    v_add_f32 v210, v210, v211
    v_add_f32 v212, v212, v213
    v_add_f32 v214, v214, v215
    v_add_f32 v216, v216, v217
    v_add_f32 v218, v218, v219
    v_add_f32 v220, v220, v221
    v_add_f32 v208, v208, v210
    v_add_f32 v212, v212, v214
    v_add_f32 v216, v216, v218
    v_add_f32 v208, v208, v212
    v_add_f32 v216, v216, v220
    v_add_f32 v208, v208, v216
    s_waitcnt vmcnt(0) lgkmcnt(0)
    s_nop 7
    s_nop 7
    s_branch Lc_102
Lfs_105:
    s_cmp_eq_u32 s30, 0
    s_cbranch_scc1 Lc_106
    s_sub_u32 s30, s30, 1
    buffer_load_dword v8, v10, s[4:7], s56 offen offset:512 sc1
    s_waitcnt vmcnt(0)
    v_subrev_u32 v8, s44, v8
    v_cmp_le_u32 vcc, 16, v8
    s_cbranch_vccnz Lfs_105
    s_branch Lc_106
Lfs_107:
    s_cmp_eq_u32 s30, 0
    s_cbranch_scc1 Lc_108
    s_sub_u32 s30, s30, 1
    buffer_load_dword v8, v10, s[4:7], s56 offen offset:512 sc1
    s_waitcnt vmcnt(0)
    v_subrev_u32 v8, s44, v8
    v_cmp_le_u32 vcc, 16, v8
    s_cbranch_vccnz Lfs_107
    s_branch Lc_108
Lidle_109:
    s_waitcnt lgkmcnt(0)
    s_nop 7
    s_nop 7
    v_pk_mul_f32 v[224:225], v[160:161], v[26:27] op_sel:[0,0] op_sel_hi:[1,0]
    v_pk_mul_f32 v[226:227], v[162:163], v[26:27] op_sel:[0,0] op_sel_hi:[1,0]
    v_pk_mul_f32 v[228:229], v[164:165], v[26:27] op_sel:[0,1] op_sel_hi:[1,1]
    v_pk_mul_f32 v[230:231], v[166:167], v[26:27] op_sel:[0,1] op_sel_hi:[1,1]
    v_pk_mul_f32 v[160:161], v[160:161], v[168:169]
    v_pk_mul_f32 v[162:163], v[162:163], v[170:171]
    v_pk_mul_f32 v[164:165], v[164:165], v[172:173]
    v_pk_mul_f32 v[166:167], v[166:167], v[174:175]
    v_exp_f32 v224, v224
    v_exp_f32 v225, v225
    v_exp_f32 v226, v226
    v_exp_f32 v227, v227
    v_exp_f32 v228, v228
    v_exp_f32 v229, v229
    v_exp_f32 v230, v230
    v_exp_f32 v231, v231
    v_pk_fma_f32 v[224:225], v[224:225], v[24:25], v[24:25] op_sel:[0,1,1] op_sel_hi:[1,1,1]
    v_pk_fma_f32 v[226:227], v[226:227], v[24:25], v[24:25] op_sel:[0,1,1] op_sel_hi:[1,1,1]
    v_pk_fma_f32 v[228:229], v[228:229], v[24:25], v[24:25] op_sel:[0,0,0] op_sel_hi:[1,0,0]
    v_pk_fma_f32 v[230:231], v[230:231], v[24:25], v[24:25] op_sel:[0,0,0] op_sel_hi:[1,0,0]
    v_rcp_f32 v224, v224
    v_rcp_f32 v225, v225
    v_rcp_f32 v226, v226
    v_rcp_f32 v227, v227
    v_rcp_f32 v228, v228
    v_rcp_f32 v229, v229
    v_rcp_f32 v230, v230
    v_rcp_f32 v231, v231
    v_pk_mul_f32 v[160:161], v[160:161], v[224:225]
    v_pk_mul_f32 v[162:163], v[162:163], v[226:227]
    v_pk_mul_f32 v[164:165], v[164:165], v[228:229]
    v_pk_mul_f32 v[166:167], v[166:167], v[230:231]
    v_cvt_pk_bf16_f32 v232, v160, v161
    v_cvt_pk_bf16_f32 v234, v164, v165
    v_cvt_pk_bf16_f32 v233, v162, v163
    v_cvt_pk_bf16_f32 v235, v166, v167
    v_permlane16_swap_b32 v232, v234
    s_nop 0
    v_permlane16_swap_b32 v233, v235
    buffer_store_dwordx4 v[232:235], v0, s[4:7], s57 offen offset:2048
    v_or_b32_e64 v9, s3, 6
    s_waitcnt vmcnt(0)
    buffer_store_dword v9, v6, s[4:7], s54 offen offset:512
    v_lshlrev_b32 v4, 3, v1
    v_min_u32 v4, 7040, v4
    s_barrier
    s_add_u32 m0, s55, 0x7000
    s_add_u32 s76, s96, 0x7000
    buffer_load_dwordx4 v7, s[4:7], s76 offen lds
    buffer_load_dwordx4 v7, s[4:7], s76 offen offset:1024 lds
    buffer_load_dwordx4 v7, s[4:7], s76 offen offset:2048 lds
    buffer_load_dwordx4 v7, s[4:7], s76 offen offset:3072 lds
    s_add_u32 m0, s55, 0x8000
    s_add_u32 s76, s76, 4096
    buffer_load_dwordx4 v7, s[4:7], s76 offen lds
    buffer_load_dwordx4 v7, s[4:7], s76 offen offset:1024 lds
    buffer_load_dwordx4 v7, s[4:7], s76 offen offset:2048 lds
    s_add_u32 m0, s55, 0x0
    s_add_u32 s75, s96, 0x0
    buffer_load_dwordx4 v7, s[4:7], s75 offen lds
    buffer_load_dwordx4 v7, s[4:7], s75 offen offset:1024 lds
    buffer_load_dwordx4 v7, s[4:7], s75 offen offset:2048 lds
    buffer_load_dwordx4 v7, s[4:7], s75 offen offset:3072 lds
    s_add_u32 m0, s55, 0x1000
    s_add_u32 s75, s75, 4096
    buffer_load_dwordx4 v7, s[4:7], s75 offen lds
    buffer_load_dwordx4 v7, s[4:7], s75 offen offset:1024 lds
    buffer_load_dwordx4 v7, s[4:7], s75 offen offset:2048 lds
    s_lshr_b32 s22, s2, 7
    s_lshl_b32 s22, s22, 3
    s_add_u32 s22, s22, s29
    s_sub_u32 s22, s22, 56
    s_mul_i32 s22, s22, 86016
    s_add_u32 s22, s22, 57344
    s_mov_b32 s20, 0x7f7f7f7f
    s_mov_b32 s21, 0x007f7f7f
    v_cndmask_b32_e64 v27, 2.0, v4, s[20:21]
    buffer_load_dword v5, v27, s[4:7], s22 offen
    s_add_u32 s22, s22, 7168
    buffer_load_dword v5, v27, s[4:7], s22 offen
    s_add_u32 s22, s22, 7168
    buffer_load_dword v5, v27, s[4:7], s22 offen
    s_add_u32 s22, s22, 7168
    buffer_load_dword v5, v27, s[4:7], s22 offen
    s_add_u32 s22, s22, 7168
    s_sub_u32 s22, s29, 56
    s_lshl_b32 s22, s22, 13
    s_add_u32 s22, s22, s26
    s_add_u32 s22, s22, 0x120000
    buffer_load_dword v5, v4, s[4:7], s22 offen
    s_waitcnt vmcnt(0) lgkmcnt(0)
    s_branch LstS1_1f
Lfs_110:
    s_cmp_eq_u32 s30, 0
    s_cbranch_scc1 Lc_111
    s_sub_u32 s30, s30, 1
    buffer_load_dword v8, v10, s[4:7], s56 offen offset:512 sc1
    s_waitcnt vmcnt(0)
    v_subrev_u32 v8, s44, v8
    v_cmp_le_u32 vcc, 16, v8
    s_cbranch_vccnz Lfs_110
    s_branch Lc_111
Lfs_112:
    s_cmp_eq_u32 s30, 0
    s_cbranch_scc1 Lc_113
    s_sub_u32 s30, s30, 1
    buffer_load_dword v8, v10, s[4:7], s56 offen offset:512 sc1
    s_waitcnt vmcnt(0)
    v_subrev_u32 v8, s44, v8
    v_cmp_le_u32 vcc, 16, v8
    s_cbranch_vccnz Lfs_112
    s_branch Lc_113
Lfs_114:
    s_cmp_eq_u32 s30, 0
    s_cbranch_scc1 Lc_115
    s_sub_u32 s30, s30, 1
    buffer_load_dword v8, v10, s[4:7], s56 offen offset:512 sc1
    s_waitcnt vmcnt(0)
    v_subrev_u32 v8, s44, v8
    v_cmp_le_u32 vcc, 16, v8
    s_cbranch_vccnz Lfs_114
    s_branch Lc_115
Lfc_119:
    buffer_load_dwordx4 v[32:35], v1, s[4:7], s36 offen sc1
    s_sub_u32 s30, s30, 1
    s_cbranch_scc1 Lo_121
    s_waitcnt vmcnt(0)
    v_cmp_eq_u32 vcc, -1, v32
    s_cbranch_vccnz Lfc_119
    s_branch Lc_120
Lo_121:
    s_mov_b32 s30, 0
    s_waitcnt vmcnt(0)
    s_branch Lc_120
Lfc_122:
    buffer_load_dwordx4 v[36:39], v1, s[4:7], s36 offen offset:1024 sc1
    s_sub_u32 s30, s30, 1
    s_cbranch_scc1 Lo_124
    s_waitcnt vmcnt(0)
    v_cmp_eq_u32 vcc, -1, v36
    s_cbranch_vccnz Lfc_122
    s_branch Lc_123
Lo_124:
    s_mov_b32 s30, 0
    s_waitcnt vmcnt(0)
    s_branch Lc_123
Lfc_125:
    buffer_load_dwordx4 v[40:43], v0, s[4:7], s36 offen offset:3072 sc1
    s_add_u32 s97, s36, 0x2000
    buffer_load_dwordx4 v[44:47], v1, s[4:7], s97 offen sc1
    s_sub_u32 s30, s30, 1
    s_cbranch_scc1 Lo_127
    s_waitcnt vmcnt(0)
    v_cmp_eq_u32 vcc, -1, v40
    s_cbranch_vccnz Lfc_125
    v_cmp_eq_u32 vcc, -1, v44
    s_cbranch_vccnz Lfc_125
    s_branch Lc_126
Lo_127:
    s_mov_b32 s30, 0
    s_waitcnt vmcnt(0)
    s_branch Lc_126
Lfc_128:
    s_add_u32 s97, s36, 0xe000
    buffer_load_dwordx4 v[48:51], v1, s[4:7], s97 offen sc1
    buffer_load_dwordx4 v[52:55], v1, s[4:7], s97 offen offset:1024 sc1
    s_sub_u32 s30, s30, 1
    s_cbranch_scc1 Lo_130
    s_waitcnt vmcnt(0)
    v_cmp_eq_u32 vcc, -1, v48
    s_cbranch_vccnz Lfc_128
    v_cmp_eq_u32 vcc, -1, v52
    s_cbranch_vccnz Lfc_128
    s_branch Lc_129
Lo_130:
    s_mov_b32 s30, 0
    s_waitcnt vmcnt(0)
    s_branch Lc_129
Lfc_131:
    s_add_u32 s97, s36, 0xe000
    buffer_load_dwordx4 v[56:59], v0, s[4:7], s97 offen offset:3072 sc1
    s_add_u32 s97, s36, 0x10000
    buffer_load_dwordx4 v[60:63], v1, s[4:7], s97 offen sc1
    s_sub_u32 s30, s30, 1
    s_cbranch_scc1 Lo_133
    s_waitcnt vmcnt(0)
    v_cmp_eq_u32 vcc, -1, v56
    s_cbranch_vccnz Lfc_131
    v_cmp_eq_u32 vcc, -1, v60
    s_cbranch_vccnz Lfc_131
    s_branch Lc_132
Lo_133:
    s_mov_b32 s30, 0
    s_waitcnt vmcnt(0)
    s_branch Lc_132
Lnn_134:
    s_nop 7
    s_nop 7
Lr_136:
    buffer_load_dwordx4 v[32:35], v1, s[4:7], s36 offen sc1
    buffer_load_dwordx4 v[36:39], v1, s[4:7], s36 offen offset:1024 sc1
    buffer_load_dwordx4 v[40:43], v0, s[4:7], s36 offen offset:3072 sc1
    s_add_u32 s97, s36, 0x2a000
    buffer_load_dwordx4 v[84:87], v1, s[4:7], s97 offen offset:1024 sc1
    buffer_load_dwordx4 v[88:91], v0, s[4:7], s97 offen offset:3072 sc1
    s_add_u32 s97, s36, 0x2c000
    buffer_load_dwordx4 v[92:95], v1, s[4:7], s97 offen sc1
    s_add_u32 s97, s36, 0x38000
    buffer_load_dwordx4 v[96:99], v1, s[4:7], s97 offen sc1
    buffer_load_dwordx4 v[100:103], v1, s[4:7], s97 offen offset:1024 sc1
    buffer_load_dwordx4 v[104:107], v0, s[4:7], s97 offen offset:3072 sc1
    s_add_u32 s97, s36, 0x3a000
    buffer_load_dwordx4 v[108:111], v1, s[4:7], s97 offen sc1
    s_add_u32 s97, s36, 0x46000
    buffer_load_dwordx4 v[112:115], v1, s[4:7], s97 offen sc1
    buffer_load_dwordx4 v[116:119], v1, s[4:7], s97 offen offset:1024 sc1
    buffer_load_dwordx4 v[120:123], v0, s[4:7], s97 offen offset:3072 sc1
    s_add_u32 s97, s36, 0x48000
    buffer_load_dwordx4 v[124:127], v1, s[4:7], s97 offen sc1
    s_add_u32 s97, s36, 0x54000
    buffer_load_dwordx4 v[128:131], v1, s[4:7], s97 offen sc1
    buffer_load_dwordx4 v[132:135], v1, s[4:7], s97 offen offset:1024 sc1
    buffer_load_dwordx4 v[136:139], v0, s[4:7], s97 offen offset:3072 sc1
    s_add_u32 s97, s36, 0x56000
    buffer_load_dwordx4 v[140:143], v1, s[4:7], s97 offen sc1
    s_waitcnt vmcnt(0)
    v_max3_u32 v27, v32, v33, v34
    v_max3_u32 v27, v27, v35, v36
    v_max3_u32 v27, v27, v37, v38
    v_max3_u32 v27, v27, v39, v40
    v_max3_u32 v27, v27, v41, v42
    v_max3_u32 v27, v27, v43, v84
    v_max3_u32 v27, v27, v85, v86
    v_max3_u32 v27, v27, v87, v88
    v_max3_u32 v27, v27, v89, v90
    v_max3_u32 v27, v27, v91, v92
    v_max3_u32 v27, v27, v93, v94
    v_max3_u32 v27, v27, v95, v96
    v_max3_u32 v27, v27, v97, v98
    v_max3_u32 v27, v27, v99, v100
    v_max3_u32 v27, v27, v101, v102
    v_max3_u32 v27, v27, v103, v104
    v_max3_u32 v27, v27, v105, v106
    v_max3_u32 v27, v27, v107, v108
    v_max3_u32 v27, v27, v109, v110
    v_max3_u32 v27, v27, v111, v112
    v_max3_u32 v27, v27, v113, v114
    v_max3_u32 v27, v27, v115, v116
    v_max3_u32 v27, v27, v117, v118
    v_max3_u32 v27, v27, v119, v120
    v_max3_u32 v27, v27, v121, v122
    v_max3_u32 v27, v27, v123, v124
    v_max3_u32 v27, v27, v125, v126
    v_max3_u32 v27, v27, v127, v128
    v_max3_u32 v27, v27, v129, v130
    v_max3_u32 v27, v27, v131, v132
    v_max3_u32 v27, v27, v133, v134
    v_max3_u32 v27, v27, v135, v136
    v_max3_u32 v27, v27, v137, v138
    v_max3_u32 v27, v27, v139, v140
    v_max3_u32 v27, v27, v141, v142
    v_max_u32 v27, v27, v143
    v_cmp_eq_u32 vcc, -1, v27
    s_cbranch_vccz Lg_137
    s_sub_u32 s30, s30, 1
    s_cbranch_scc0 Lr_136
    s_mov_b32 s30, 0
Lg_137:
    ds_read_b128 a[224:227], v1 offset:0
    s_waitcnt lgkmcnt(0)
    v_mfma_f32_32x32x16_bf16 v[144:159], a[224:227], v[32:35], 0
    ds_read_b128 a[228:231], v1 offset:1024
    s_waitcnt lgkmcnt(0)
    v_mfma_f32_32x32x16_bf16 v[160:175], a[228:231], v[32:35], 0
    ds_read_b128 a[232:235], v1 offset:2048
    s_waitcnt lgkmcnt(0)
    v_mfma_f32_32x32x16_bf16 v[144:159], a[232:235], v[36:39], v[144:159]
    ds_read_b128 a[236:239], v1 offset:3072
    s_waitcnt lgkmcnt(0)
    v_mfma_f32_32x32x16_bf16 v[160:175], a[236:239], v[36:39], v[160:175]
    ds_read_b128 a[240:243], v1 offset:4096
    s_waitcnt lgkmcnt(0)
    v_mfma_f32_32x32x16_bf16 v[144:159], a[240:243], v[40:43], v[144:159]
    ds_read_b128 a[244:247], v1 offset:5120
    s_waitcnt lgkmcnt(0)
    v_mfma_f32_32x32x16_bf16 v[160:175], a[244:247], v[40:43], v[160:175]
    s_nop 7
Lr_138:
    s_add_u32 s97, s36, 0x2000
    buffer_load_dwordx4 v[192:195], v1, s[4:7], s97 offen sc1
    s_waitcnt vmcnt(0)
    v_max3_u32 v27, v192, v193, v194
    v_max_u32 v27, v27, v195
    v_cmp_eq_u32 vcc, -1, v27
    s_cbranch_vccz Lg_139
    s_sub_u32 s30, s30, 1
    s_cbranch_scc0 Lr_138
    s_mov_b32 s30, 0
Lg_139:
    ds_read_b128 a[248:251], v1 offset:6144
    s_waitcnt lgkmcnt(0)
    v_mfma_f32_32x32x16_bf16 v[144:159], a[248:251], v[192:195], v[144:159]
    ds_read_b128 a[252:255], v1 offset:7168
    s_waitcnt lgkmcnt(0)
    v_mfma_f32_32x32x16_bf16 v[160:175], a[252:255], v[192:195], v[160:175]
    ds_read_b128 a[224:227], v29 offset:3072
    s_waitcnt lgkmcnt(0)
    v_mfma_f32_32x32x16_bf16 v[176:191], v[192:195], a[224:227], 0
    s_nop 7
Lr_140:
    s_add_u32 s97, s36, 0xe000
    buffer_load_dwordx4 v[192:195], v1, s[4:7], s97 offen sc1
    s_waitcnt vmcnt(0)
    v_max3_u32 v27, v192, v193, v194
    v_max_u32 v27, v27, v195
    v_cmp_eq_u32 vcc, -1, v27
    s_cbranch_vccz Lg_141
    s_sub_u32 s30, s30, 1
    s_cbranch_scc0 Lr_140
    s_mov_b32 s30, 0
Lg_141:
    ds_read_b128 a[228:231], v1 offset:8192
    s_waitcnt lgkmcnt(0)
    v_mfma_f32_32x32x16_bf16 v[144:159], a[228:231], v[192:195], v[144:159]
    ds_read_b128 a[232:235], v1 offset:9216
    s_waitcnt lgkmcnt(0)
    v_mfma_f32_32x32x16_bf16 v[160:175], a[232:235], v[192:195], v[160:175]
    ds_read_b128 a[236:239], v29 offset:4096
    s_waitcnt lgkmcnt(0)
    v_mfma_f32_32x32x16_bf16 v[176:191], v[192:195], a[236:239], v[176:191]
    s_nop 7
Lr_142:
    s_add_u32 s97, s36, 0xe000
    buffer_load_dwordx4 v[192:195], v1, s[4:7], s97 offen offset:1024 sc1
    s_waitcnt vmcnt(0)
    v_max3_u32 v27, v192, v193, v194
    v_max_u32 v27, v27, v195
    v_cmp_eq_u32 vcc, -1, v27
    s_cbranch_vccz Lg_143
    s_sub_u32 s30, s30, 1
    s_cbranch_scc0 Lr_142
    s_mov_b32 s30, 0
Lg_143:
    ds_read_b128 a[240:243], v1 offset:10240
    s_waitcnt lgkmcnt(0)
    v_mfma_f32_32x32x16_bf16 v[144:159], a[240:243], v[192:195], v[144:159]
    ds_read_b128 a[244:247], v1 offset:11264
    s_waitcnt lgkmcnt(0)
    v_mfma_f32_32x32x16_bf16 v[160:175], a[244:247], v[192:195], v[160:175]
    ds_read_b128 a[248:251], v29 offset:5120
    s_waitcnt lgkmcnt(0)
    v_mfma_f32_32x32x16_bf16 v[176:191], v[192:195], a[248:251], v[176:191]
    s_nop 7
Lr_144:
    s_add_u32 s97, s36, 0xe000
    buffer_load_dwordx4 v[192:195], v0, s[4:7], s97 offen offset:3072 sc1
    s_waitcnt vmcnt(0)
    v_max3_u32 v27, v192, v193, v194
    v_max_u32 v27, v27, v195
    v_cmp_eq_u32 vcc, -1, v27
    s_cbranch_vccz Lg_145
    s_sub_u32 s30, s30, 1
    s_cbranch_scc0 Lr_144
    s_mov_b32 s30, 0
Lg_145:
    ds_read_b128 a[252:255], v1 offset:12288
    s_waitcnt lgkmcnt(0)
    v_mfma_f32_32x32x16_bf16 v[144:159], a[252:255], v[192:195], v[144:159]
    ds_read_b128 a[224:227], v1 offset:13312
    s_waitcnt lgkmcnt(0)
    v_mfma_f32_32x32x16_bf16 v[160:175], a[224:227], v[192:195], v[160:175]
    ds_read_b128 a[228:231], v29 offset:6144
    s_waitcnt lgkmcnt(0)
    v_mfma_f32_32x32x16_bf16 v[176:191], v[192:195], a[228:231], v[176:191]
    s_nop 7
Lr_146:
    s_add_u32 s97, s36, 0x10000
    buffer_load_dwordx4 v[192:195], v1, s[4:7], s97 offen sc1
    s_waitcnt vmcnt(0)
    v_max3_u32 v27, v192, v193, v194
    v_max_u32 v27, v27, v195
    v_cmp_eq_u32 vcc, -1, v27
    s_cbranch_vccz Lg_147
    s_sub_u32 s30, s30, 1
    s_cbranch_scc0 Lr_146
    s_mov_b32 s30, 0
Lg_147:
    ds_read_b128 a[232:235], v1 offset:14336
    s_waitcnt lgkmcnt(0)
    v_mfma_f32_32x32x16_bf16 v[144:159], a[232:235], v[192:195], v[144:159]
    ds_read_b128 a[236:239], v1 offset:15360
    s_waitcnt lgkmcnt(0)
    v_mfma_f32_32x32x16_bf16 v[160:175], a[236:239], v[192:195], v[160:175]
    ds_read_b128 a[240:243], v29 offset:7168
    s_waitcnt lgkmcnt(0)
    v_mfma_f32_32x32x16_bf16 v[176:191], v[192:195], a[240:243], v[176:191]
    s_nop 7
Lr_148:
    s_add_u32 s97, s36, 0x1c000
    buffer_load_dwordx4 v[192:195], v1, s[4:7], s97 offen sc1
    s_waitcnt vmcnt(0)
    v_max3_u32 v27, v192, v193, v194
    v_max_u32 v27, v27, v195
    v_cmp_eq_u32 vcc, -1, v27
    s_cbranch_vccz Lg_149
    s_sub_u32 s30, s30, 1
    s_cbranch_scc0 Lr_148
    s_mov_b32 s30, 0
Lg_149:
    ds_read_b128 a[244:247], v1 offset:16384
    s_waitcnt lgkmcnt(0)
    v_mfma_f32_32x32x16_bf16 v[144:159], a[244:247], v[192:195], v[144:159]
    ds_read_b128 a[248:251], v1 offset:17408
    s_waitcnt lgkmcnt(0)
    v_mfma_f32_32x32x16_bf16 v[160:175], a[248:251], v[192:195], v[160:175]
    ds_read_b128 a[252:255], v29 offset:8192
    s_waitcnt lgkmcnt(0)
    v_mfma_f32_32x32x16_bf16 v[176:191], v[192:195], a[252:255], v[176:191]
    s_nop 7
Lr_150:
    s_add_u32 s97, s36, 0x1c000
    buffer_load_dwordx4 v[192:195], v1, s[4:7], s97 offen offset:1024 sc1
    s_waitcnt vmcnt(0)
    v_max3_u32 v27, v192, v193, v194
    v_max_u32 v27, v27, v195
    v_cmp_eq_u32 vcc, -1, v27
    s_cbranch_vccz Lg_151
    s_sub_u32 s30, s30, 1
    s_cbranch_scc0 Lr_150
    s_mov_b32 s30, 0
Lg_151:
    ds_read_b128 a[224:227], v1 offset:18432
    s_waitcnt lgkmcnt(0)
    v_mfma_f32_32x32x16_bf16 v[144:159], a[224:227], v[192:195], v[144:159]
    ds_read_b128 a[228:231], v1 offset:19456
    s_waitcnt lgkmcnt(0)
    v_mfma_f32_32x32x16_bf16 v[160:175], a[228:231], v[192:195], v[160:175]
    ds_read_b128 a[232:235], v29 offset:9216
    s_waitcnt lgkmcnt(0)
    v_mfma_f32_32x32x16_bf16 v[176:191], v[192:195], a[232:235], v[176:191]
    s_nop 7
Lr_152:
    s_add_u32 s97, s36, 0x1c000
    buffer_load_dwordx4 v[192:195], v0, s[4:7], s97 offen offset:3072 sc1
    s_waitcnt vmcnt(0)
    v_max3_u32 v27, v192, v193, v194
    v_max_u32 v27, v27, v195
    v_cmp_eq_u32 vcc, -1, v27
    s_cbranch_vccz Lg_153
    s_sub_u32 s30, s30, 1
    s_cbranch_scc0 Lr_152
    s_mov_b32 s30, 0
Lg_153:
    ds_read_b128 a[236:239], v1 offset:20480
    s_waitcnt lgkmcnt(0)
    v_mfma_f32_32x32x16_bf16 v[144:159], a[236:239], v[192:195], v[144:159]
    ds_read_b128 a[240:243], v1 offset:21504
    s_waitcnt lgkmcnt(0)
    v_mfma_f32_32x32x16_bf16 v[160:175], a[240:243], v[192:195], v[160:175]
    ds_read_b128 a[244:247], v29 offset:10240
    s_waitcnt lgkmcnt(0)
    v_mfma_f32_32x32x16_bf16 v[176:191], v[192:195], a[244:247], v[176:191]
    s_nop 7
Lr_154:
    s_add_u32 s97, s36, 0x1e000
    buffer_load_dwordx4 v[192:195], v1, s[4:7], s97 offen sc1
    s_waitcnt vmcnt(0)
    v_max3_u32 v27, v192, v193, v194
    v_max_u32 v27, v27, v195
    v_cmp_eq_u32 vcc, -1, v27
    s_cbranch_vccz Lg_155
    s_sub_u32 s30, s30, 1
    s_cbranch_scc0 Lr_154
    s_mov_b32 s30, 0
Lg_155:
    ds_read_b128 a[248:251], v1 offset:22528
    s_waitcnt lgkmcnt(0)
    v_mfma_f32_32x32x16_bf16 v[144:159], a[248:251], v[192:195], v[144:159]
    ds_read_b128 a[252:255], v1 offset:23552
    s_waitcnt lgkmcnt(0)
    v_mfma_f32_32x32x16_bf16 v[160:175], a[252:255], v[192:195], v[160:175]
    ds_read_b128 a[224:227], v29 offset:11264
    s_waitcnt lgkmcnt(0)
    v_mfma_f32_32x32x16_bf16 v[176:191], v[192:195], a[224:227], v[176:191]
    s_nop 7
Lr_156:
    s_add_u32 s97, s36, 0x2a000
    buffer_load_dwordx4 v[192:195], v1, s[4:7], s97 offen sc1
    s_waitcnt vmcnt(0)
    v_max3_u32 v27, v192, v193, v194
    v_max_u32 v27, v27, v195
    v_cmp_eq_u32 vcc, -1, v27
    s_cbranch_vccz Lg_157
    s_sub_u32 s30, s30, 1
    s_cbranch_scc0 Lr_156
    s_mov_b32 s30, 0
Lg_157:
    ds_read_b128 a[228:231], v1 offset:24576
    s_waitcnt lgkmcnt(0)
    v_mfma_f32_32x32x16_bf16 v[144:159], a[228:231], v[192:195], v[144:159]
    ds_read_b128 a[232:235], v1 offset:25600
    s_waitcnt lgkmcnt(0)
    v_mfma_f32_32x32x16_bf16 v[160:175], a[232:235], v[192:195], v[160:175]
    ds_read_b128 a[236:239], v29 offset:12288
    s_waitcnt lgkmcnt(0)
    v_mfma_f32_32x32x16_bf16 v[176:191], v[192:195], a[236:239], v[176:191]
    ds_read_b128 a[240:243], v1 offset:26624
    s_waitcnt lgkmcnt(0)
    v_mfma_f32_32x32x16_bf16 v[144:159], a[240:243], v[84:87], v[144:159]
    ds_read_b128 a[244:247], v1 offset:27648
    s_waitcnt lgkmcnt(0)
    v_mfma_f32_32x32x16_bf16 v[160:175], a[244:247], v[84:87], v[160:175]
    ds_read_b128 a[248:251], v1 offset:28672
    s_waitcnt lgkmcnt(0)
    v_mfma_f32_32x32x16_bf16 v[144:159], a[248:251], v[88:91], v[144:159]
    ds_read_b128 a[252:255], v1 offset:29696
    s_waitcnt lgkmcnt(0)
    v_mfma_f32_32x32x16_bf16 v[160:175], a[252:255], v[88:91], v[160:175]
    ds_read_b128 a[224:227], v1 offset:30720
    s_waitcnt lgkmcnt(0)
    v_mfma_f32_32x32x16_bf16 v[144:159], a[224:227], v[92:95], v[144:159]
    ds_read_b128 a[228:231], v1 offset:31744
    s_waitcnt lgkmcnt(0)
    v_mfma_f32_32x32x16_bf16 v[160:175], a[228:231], v[92:95], v[160:175]
    ds_read_b128 a[232:235], v1 offset:32768
    s_waitcnt lgkmcnt(0)
    v_mfma_f32_32x32x16_bf16 v[144:159], a[232:235], v[96:99], v[144:159]
    ds_read_b128 a[236:239], v1 offset:33792
    s_waitcnt lgkmcnt(0)
    v_mfma_f32_32x32x16_bf16 v[160:175], a[236:239], v[96:99], v[160:175]
    ds_read_b128 a[240:243], v1 offset:34816
    s_waitcnt lgkmcnt(0)
    v_mfma_f32_32x32x16_bf16 v[144:159], a[240:243], v[100:103], v[144:159]
    ds_read_b128 a[248:251], v1 offset:35840
    s_waitcnt lgkmcnt(0)
    v_mfma_f32_32x32x16_bf16 v[160:175], a[248:251], v[100:103], v[160:175]
    ds_read_b128 a[224:227], v1 offset:36864
    s_waitcnt lgkmcnt(0)
    v_mfma_f32_32x32x16_bf16 v[144:159], a[224:227], v[104:107], v[144:159]
    ds_read_b128 a[232:235], v1 offset:37888
    s_waitcnt lgkmcnt(0)
    v_mfma_f32_32x32x16_bf16 v[160:175], a[232:235], v[104:107], v[160:175]
    ds_read_b128 a[240:243], v1 offset:38912
    s_waitcnt lgkmcnt(0)
    v_mfma_f32_32x32x16_bf16 v[144:159], a[240:243], v[108:111], v[144:159]
    ds_read_b128 a[248:251], v1 offset:39936
    s_waitcnt lgkmcnt(0)
    v_mfma_f32_32x32x16_bf16 v[160:175], a[248:251], v[108:111], v[160:175]
    ds_read_b128 a[224:227], v1 offset:40960
    s_waitcnt lgkmcnt(0)
    v_mfma_f32_32x32x16_bf16 v[144:159], a[224:227], v[112:115], v[144:159]
    ds_read_b128 a[232:235], v1 offset:41984
    s_waitcnt lgkmcnt(0)
    v_mfma_f32_32x32x16_bf16 v[160:175], a[232:235], v[112:115], v[160:175]
    ds_read_b128 a[236:239], v29 offset:29696
    s_waitcnt lgkmcnt(0)
    v_mfma_f32_32x32x16_bf16 v[144:159], a[236:239], v[20:23], v[144:159]
    ds_read_b128 a[240:243], v1 offset:43008
    s_waitcnt lgkmcnt(0)
    v_mfma_f32_32x32x16_bf16 v[144:159], a[240:243], v[116:119], v[144:159]
    ds_read_b128 a[248:251], v1 offset:44032
    s_waitcnt lgkmcnt(0)
    v_mfma_f32_32x32x16_bf16 v[160:175], a[248:251], v[116:119], v[160:175]
    ds_read_b128 a[252:255], v29 offset:28672
    s_waitcnt lgkmcnt(0)
    v_mfma_f32_32x32x16_bf16 v[160:175], a[252:255], v[20:23], v[160:175]
    ds_read_b128 a[224:227], v1 offset:45056
    s_waitcnt lgkmcnt(0)
    v_mfma_f32_32x32x16_bf16 v[144:159], a[224:227], v[120:123], v[144:159]
    ds_read_b128 a[232:235], v1 offset:46080
    s_waitcnt lgkmcnt(0)
    v_mfma_f32_32x32x16_bf16 v[160:175], a[232:235], v[120:123], v[160:175]
    ds_read_b128 a[240:243], v1 offset:47104
    s_waitcnt lgkmcnt(0)
    v_mfma_f32_32x32x16_bf16 v[144:159], a[240:243], v[124:127], v[144:159]
    ds_read_b128 a[248:251], v1 offset:48128
    s_waitcnt lgkmcnt(0)
    v_mfma_f32_32x32x16_bf16 v[160:175], a[248:251], v[124:127], v[160:175]
    ds_read_b128 a[224:227], v1 offset:49152
    s_waitcnt lgkmcnt(0)
    v_mfma_f32_32x32x16_bf16 v[144:159], a[224:227], v[128:131], v[144:159]
    ds_read_b128 a[232:235], v1 offset:50176
    s_waitcnt lgkmcnt(0)
    v_mfma_f32_32x32x16_bf16 v[160:175], a[232:235], v[128:131], v[160:175]
    ds_read_b128 a[240:243], v1 offset:51200
    s_waitcnt lgkmcnt(0)
    v_mfma_f32_32x32x16_bf16 v[144:159], a[240:243], v[132:135], v[144:159]
    ds_read_b128 a[248:251], v1 offset:52224
    s_waitcnt lgkmcnt(0)
    v_mfma_f32_32x32x16_bf16 v[160:175], a[248:251], v[132:135], v[160:175]
    ds_read_b128 a[224:227], v1 offset:53248
    s_waitcnt lgkmcnt(0)
    v_mfma_f32_32x32x16_bf16 v[144:159], a[224:227], v[136:139], v[144:159]
    ds_read_b128 a[228:231], v1 offset:54272
    s_waitcnt lgkmcnt(0)
    v_mfma_f32_32x32x16_bf16 v[160:175], a[228:231], v[136:139], v[160:175]
    ds_read_b128 a[232:235], v1 offset:55296
    s_waitcnt lgkmcnt(0)
    v_mfma_f32_32x32x16_bf16 v[144:159], a[232:235], v[140:143], v[144:159]
    ds_read_b128 a[236:239], v1 offset:56320
    s_waitcnt lgkmcnt(0)
    v_mfma_f32_32x32x16_bf16 v[160:175], a[236:239], v[140:143], v[160:175]
    s_nop 7
    ds_read_b128 a[240:243], v29 offset:0
    ds_read_b128 a[244:247], v29 offset:1024
    ds_read_b128 a[248:251], v29 offset:2048
    ds_read_b128 a[252:255], v29 offset:13312
    ds_read_b128 a[224:227], v29 offset:14336
    ds_read_b128 a[228:231], v29 offset:15360
    ds_read_b128 a[232:235], v29 offset:16384
    s_waitcnt vmcnt(0) lgkmcnt(0)
    s_nop 7
    s_nop 7
    s_branch Lc_135
Lnn_158:
    s_nop 7
    s_nop 7
Lr_160:
    buffer_load_dword v192, v2, s[4:7], s88 offen sc1
    buffer_load_dword v193, v2, s[4:7], s88 offen offset:256 sc1
    buffer_load_dword v194, v2, s[4:7], s88 offen offset:512 sc1
    buffer_load_dword v195, v2, s[4:7], s88 offen offset:768 sc1
    buffer_load_dword v196, v2, s[4:7], s88 offen offset:1024 sc1
    buffer_load_dword v197, v2, s[4:7], s88 offen offset:1280 sc1
    buffer_load_dword v198, v2, s[4:7], s88 offen offset:1536 sc1
    buffer_load_dword v199, v2, s[4:7], s88 offen offset:1792 sc1
    buffer_load_dword v200, v2, s[4:7], s88 offen offset:2048 sc1
    buffer_load_dword v201, v2, s[4:7], s88 offen offset:2304 sc1
    buffer_load_dword v202, v2, s[4:7], s88 offen offset:2560 sc1
    buffer_load_dword v203, v2, s[4:7], s88 offen offset:2816 sc1
    buffer_load_dword v204, v2, s[4:7], s88 offen offset:3072 sc1
    buffer_load_dword v205, v2, s[4:7], s88 offen offset:3328 sc1
    s_waitcnt vmcnt(0)
    v_max3_u32 v207, v192, v193, v194
    v_max3_u32 v207, v207, v195, v196
    v_max3_u32 v207, v207, v197, v198
    v_max3_u32 v207, v207, v199, v200
    v_max3_u32 v207, v207, v201, v202
    v_max3_u32 v207, v207, v203, v204
    v_max_u32 v207, v207, v205
    v_cmp_eq_u32 vcc, -1, v207
    s_cbranch_vccz Lg_161
    s_sub_u32 s30, s30, 1
    s_cbranch_scc0 Lr_160
    s_mov_b32 s30, 0
Lg_161:
    v_add_f32 v192, v192, v193
    v_add_f32 v194, v194, v195
    v_add_f32 v196, v196, v197
    v_add_f32 v198, v198, v199
    v_add_f32 v200, v200, v201
    v_add_f32 v202, v202, v203
    v_add_f32 v204, v204, v205
    v_add_f32 v192, v192, v194
    v_add_f32 v196, v196, v198
    v_add_f32 v200, v200, v202
    v_add_f32 v192, v192, v196
    v_add_f32 v200, v200, v204
    v_add_f32 v192, v192, v200
    s_waitcnt vmcnt(0) lgkmcnt(0)
    s_nop 7
    s_nop 7
    s_branch Lc_159
Lre_162:
    s_cmp_eq_u32 s30, 0
    s_cbranch_scc1 Lc_163
    s_sub_u32 s30, s30, 1
    s_mov_b32 s97, m0
    s_add_u32 m0, s84, 2048
    s_nop 0
    buffer_load_dwordx4 v25, s[4:7], s89 offen sc1 lds
    s_sub_u32 m0, s84, 256
    s_nop 0
    buffer_load_dwordx4 v25, s[4:7], s89 offen offset:3072 sc1 lds
    buffer_load_dword v208, v2, s[4:7], s90 offen sc1
    buffer_load_dword v209, v2, s[4:7], s90 offen offset:256 sc1
    buffer_load_dword v210, v2, s[4:7], s90 offen offset:512 sc1
    buffer_load_dword v211, v2, s[4:7], s90 offen offset:640 sc1
    s_mov_b32 m0, s97
    s_waitcnt vmcnt(0)
    ds_read_b128 v[224:227], v30 offset:2048
    ds_read_b128 v[228:231], v30 offset:2304
    ds_read_b128 v[232:235], v30 offset:2560
    ds_read_b128 v[236:239], v30 offset:2816
    ds_read_b128 v[240:243], v30 offset:3072
    ds_read_b128 v[244:247], v30 offset:3328
    ds_read_b128 v[248:251], v30 offset:3584
    v_max3_u32 v27, v208, v209, v210
    s_waitcnt lgkmcnt(6)
    v_max3_u32 v27, v27, v211, v224
    s_waitcnt lgkmcnt(4)
    v_max3_u32 v27, v27, v228, v232
    s_waitcnt lgkmcnt(2)
    v_max3_u32 v27, v27, v236, v240
    s_waitcnt lgkmcnt(0)
    v_max3_u32 v27, v27, v244, v248
    v_cmp_eq_u32 vcc, -1, v27
    s_cbranch_vccnz Lre_162
    s_branch Lc_163
Lidle_166:
    s_waitcnt lgkmcnt(0)
    s_nop 7
    s_nop 7
    s_waitcnt vmcnt(0)
    s_barrier
    s_add_u32 m0, s55, 0x0
    s_add_u32 s66, s39, 0x23000
    buffer_load_dwordx4 v1, s[4:7], s66 offen lds
    buffer_load_dwordx4 v1, s[4:7], s66 offen offset:1024 lds
    buffer_load_dwordx4 v1, s[4:7], s66 offen offset:2048 lds
    buffer_load_dwordx4 v1, s[4:7], s66 offen offset:3072 lds
    s_add_u32 m0, s55, 0x1000
    s_nop 0
    buffer_load_dwordx4 v0, s[4:7], s66 offen lds
    buffer_load_dwordx4 v0, s[4:7], s66 offen offset:1024 lds
    buffer_load_dwordx4 v0, s[4:7], s66 offen offset:2048 lds
    s_waitcnt vmcnt(0) lgkmcnt(0)
    s_branch LstS3_1f
Lfc_169:
    buffer_load_dwordx4 v[32:35], v1, s[4:7], s84 offen offset:2048 sc1
    s_sub_u32 s30, s30, 1
    s_cbranch_scc1 Lo_171
    s_waitcnt vmcnt(0)
    v_cmp_eq_u32 vcc, -1, v32
    s_cbranch_vccnz Lfc_169
    s_branch Lc_170
Lo_171:
    s_mov_b32 s30, 0
    s_waitcnt vmcnt(0)
    s_branch Lc_170
Lfc_172:
    buffer_load_dwordx4 v[36:39], v1, s[4:7], s84 offen offset:3072 sc1
    s_sub_u32 s30, s30, 1
    s_cbranch_scc1 Lo_174
    s_waitcnt vmcnt(0)
    v_cmp_eq_u32 vcc, -1, v36
    s_cbranch_vccnz Lfc_172
    s_branch Lc_173
Lo_174:
    s_mov_b32 s30, 0
    s_waitcnt vmcnt(0)
    s_branch Lc_173
Lfc_175:
    s_add_u32 s97, s84, 0x6000
    buffer_load_dwordx4 v[40:43], v0, s[4:7], s97 offen offset:2048 sc1
    buffer_load_dwordx4 v[44:47], v0, s[4:7], s97 offen offset:3072 sc1
    s_sub_u32 s30, s30, 1
    s_cbranch_scc1 Lo_177
    s_waitcnt vmcnt(0)
    v_cmp_eq_u32 vcc, -1, v40
    s_cbranch_vccnz Lfc_175
    v_cmp_eq_u32 vcc, -1, v44
    s_cbranch_vccnz Lfc_175
    s_branch Lc_176
Lo_177:
    s_mov_b32 s30, 0
    s_waitcnt vmcnt(0)
    s_branch Lc_176
Lfc_178:
    s_add_u32 s97, s84, 0xe000
    buffer_load_dwordx4 v[48:51], v1, s[4:7], s97 offen offset:2048 sc1
    buffer_load_dwordx4 v[52:55], v1, s[4:7], s97 offen offset:3072 sc1
    s_sub_u32 s30, s30, 1
    s_cbranch_scc1 Lo_180
    s_waitcnt vmcnt(0)
    v_cmp_eq_u32 vcc, -1, v48
    s_cbranch_vccnz Lfc_178
    v_cmp_eq_u32 vcc, -1, v52
    s_cbranch_vccnz Lfc_178
    s_branch Lc_179
Lo_180:
    s_mov_b32 s30, 0
    s_waitcnt vmcnt(0)
    s_branch Lc_179
Lfc_181:
    s_add_u32 s97, s84, 0x14000
    buffer_load_dwordx4 v[56:59], v0, s[4:7], s97 offen offset:2048 sc1
    buffer_load_dwordx4 v[60:63], v0, s[4:7], s97 offen offset:3072 sc1
    s_sub_u32 s30, s30, 1
    s_cbranch_scc1 Lo_183
    s_waitcnt vmcnt(0)
    v_cmp_eq_u32 vcc, -1, v56
    s_cbranch_vccnz Lfc_181
    v_cmp_eq_u32 vcc, -1, v60
    s_cbranch_vccnz Lfc_181
    s_branch Lc_182
Lo_183:
    s_mov_b32 s30, 0
    s_waitcnt vmcnt(0)
    s_branch Lc_182
Lfc_184:
    s_add_u32 s97, s84, 0x1c000
    buffer_load_dwordx4 v[64:67], v1, s[4:7], s97 offen offset:2048 sc1
    buffer_load_dwordx4 v[68:71], v1, s[4:7], s97 offen offset:3072 sc1
    s_sub_u32 s30, s30, 1
    s_cbranch_scc1 Lo_186
    s_waitcnt vmcnt(0)
    v_cmp_eq_u32 vcc, -1, v64
    s_cbranch_vccnz Lfc_184
    v_cmp_eq_u32 vcc, -1, v68
    s_cbranch_vccnz Lfc_184
    s_branch Lc_185
Lo_186:
    s_mov_b32 s30, 0
    s_waitcnt vmcnt(0)
    s_branch Lc_185
Lfc_187:
    s_add_u32 s97, s84, 0x22000
    buffer_load_dwordx4 v[72:75], v0, s[4:7], s97 offen offset:2048 sc1
    buffer_load_dwordx4 v[76:79], v0, s[4:7], s97 offen offset:3072 sc1
    s_sub_u32 s30, s30, 1
    s_cbranch_scc1 Lo_189
    s_waitcnt vmcnt(0)
    v_cmp_eq_u32 vcc, -1, v72
    s_cbranch_vccnz Lfc_187
    v_cmp_eq_u32 vcc, -1, v76
    s_cbranch_vccnz Lfc_187
    s_branch Lc_188
Lo_189:
    s_mov_b32 s30, 0
    s_waitcnt vmcnt(0)
    s_branch Lc_188
Lfc_190:
    s_add_u32 s97, s84, 0x2a000
    buffer_load_dwordx4 v[80:83], v1, s[4:7], s97 offen offset:2048 sc1
    buffer_load_dwordx4 v[84:87], v1, s[4:7], s97 offen offset:3072 sc1
    s_sub_u32 s30, s30, 1
    s_cbranch_scc1 Lo_192
    s_waitcnt vmcnt(0)
    v_cmp_eq_u32 vcc, -1, v80
    s_cbranch_vccnz Lfc_190
    v_cmp_eq_u32 vcc, -1, v84
    s_cbranch_vccnz Lfc_190
    s_branch Lc_191
Lo_192:
    s_mov_b32 s30, 0
    s_waitcnt vmcnt(0)
    s_branch Lc_191
Lfc_193:
    s_add_u32 s97, s84, 0x30000
    buffer_load_dwordx4 v[88:91], v0, s[4:7], s97 offen offset:2048 sc1
    buffer_load_dwordx4 v[92:95], v0, s[4:7], s97 offen offset:3072 sc1
    s_sub_u32 s30, s30, 1
    s_cbranch_scc1 Lo_195
    s_waitcnt vmcnt(0)
    v_cmp_eq_u32 vcc, -1, v88
    s_cbranch_vccnz Lfc_193
    v_cmp_eq_u32 vcc, -1, v92
    s_cbranch_vccnz Lfc_193
    s_branch Lc_194
Lo_195:
    s_mov_b32 s30, 0
    s_waitcnt vmcnt(0)
    s_branch Lc_194
Lfc_199:
    s_add_u32 s97, s36, 0x1000
    buffer_load_dwordx4 v[32:35], v31, s[4:7], s97 offen offset:1024 sc1
    buffer_load_dwordx4 v[36:39], v31, s[4:7], s97 offen offset:1280 sc1
    s_sub_u32 s30, s30, 1
    s_cbranch_scc1 Lo_201
    s_waitcnt vmcnt(0)
    v_cmp_eq_u32 vcc, -1, v32
    s_cbranch_vccnz Lfc_199
    v_cmp_eq_u32 vcc, -1, v36
    s_cbranch_vccnz Lfc_199
    s_branch Lc_200
Lo_201:
    s_mov_b32 s30, 0
    s_waitcnt vmcnt(0)
    s_branch Lc_200
Lfc_202:
    s_add_u32 s97, s36, 0x3000
    buffer_load_dwordx4 v[40:43], v31, s[4:7], s97 offen sc1
    buffer_load_dwordx4 v[44:47], v31, s[4:7], s97 offen offset:256 sc1
    s_sub_u32 s30, s30, 1
    s_cbranch_scc1 Lo_204
    s_waitcnt vmcnt(0)
    v_cmp_eq_u32 vcc, -1, v40
    s_cbranch_vccnz Lfc_202
    v_cmp_eq_u32 vcc, -1, v44
    s_cbranch_vccnz Lfc_202
    s_branch Lc_203
Lo_204:
    s_mov_b32 s30, 0
    s_waitcnt vmcnt(0)
    s_branch Lc_203
Lfc_205:
    s_add_u32 s97, s36, 0xf000
    buffer_load_dwordx4 v[48:51], v31, s[4:7], s97 offen offset:1024 sc1
    buffer_load_dwordx4 v[52:55], v31, s[4:7], s97 offen offset:1280 sc1
    s_sub_u32 s30, s30, 1
    s_cbranch_scc1 Lo_207
    s_waitcnt vmcnt(0)
    v_cmp_eq_u32 vcc, -1, v48
    s_cbranch_vccnz Lfc_205
    v_cmp_eq_u32 vcc, -1, v52
    s_cbranch_vccnz Lfc_205
    s_branch Lc_206
Lo_207:
    s_mov_b32 s30, 0
    s_waitcnt vmcnt(0)
    s_branch Lc_206
Lfc_208:
    s_add_u32 s97, s36, 0x11000
    buffer_load_dwordx4 v[56:59], v31, s[4:7], s97 offen sc1
    buffer_load_dwordx4 v[60:63], v31, s[4:7], s97 offen offset:256 sc1
    s_sub_u32 s30, s30, 1
    s_cbranch_scc1 Lo_210
    s_waitcnt vmcnt(0)
    v_cmp_eq_u32 vcc, -1, v56
    s_cbranch_vccnz Lfc_208
    v_cmp_eq_u32 vcc, -1, v60
    s_cbranch_vccnz Lfc_208
    s_branch Lc_209
Lo_210:
    s_mov_b32 s30, 0
    s_waitcnt vmcnt(0)
    s_branch Lc_209
Lfc_211:
    s_add_u32 s97, s36, 0x1d000
    buffer_load_dwordx4 v[64:67], v31, s[4:7], s97 offen offset:1024 sc1
    buffer_load_dwordx4 v[68:71], v31, s[4:7], s97 offen offset:1280 sc1
    s_sub_u32 s30, s30, 1
    s_cbranch_scc1 Lo_213
    s_waitcnt vmcnt(0)
    v_cmp_eq_u32 vcc, -1, v64
    s_cbranch_vccnz Lfc_211
    v_cmp_eq_u32 vcc, -1, v68
    s_cbranch_vccnz Lfc_211
    s_branch Lc_212
Lo_213:
    s_mov_b32 s30, 0
    s_waitcnt vmcnt(0)
    s_branch Lc_212
Lfc_214:
    s_add_u32 s97, s36, 0x1f000
    buffer_load_dwordx4 v[72:75], v31, s[4:7], s97 offen sc1
    buffer_load_dwordx4 v[76:79], v31, s[4:7], s97 offen offset:256 sc1
    s_sub_u32 s30, s30, 1
    s_cbranch_scc1 Lo_216
    s_waitcnt vmcnt(0)
    v_cmp_eq_u32 vcc, -1, v72
    s_cbranch_vccnz Lfc_214
    v_cmp_eq_u32 vcc, -1, v76
    s_cbranch_vccnz Lfc_214
    s_branch Lc_215
Lo_216:
    s_mov_b32 s30, 0
    s_waitcnt vmcnt(0)
    s_branch Lc_215
Lfc_217:
    s_add_u32 s97, s36, 0x2b000
    buffer_load_dwordx4 v[80:83], v31, s[4:7], s97 offen offset:1024 sc1
    buffer_load_dwordx4 v[84:87], v31, s[4:7], s97 offen offset:1280 sc1
    s_sub_u32 s30, s30, 1
    s_cbranch_scc1 Lo_219
    s_waitcnt vmcnt(0)
    v_cmp_eq_u32 vcc, -1, v80
    s_cbranch_vccnz Lfc_217
    v_cmp_eq_u32 vcc, -1, v84
    s_cbranch_vccnz Lfc_217
    s_branch Lc_218
Lo_219:
    s_mov_b32 s30, 0
    s_waitcnt vmcnt(0)
    s_branch Lc_218
Lfc_220:
    s_add_u32 s97, s36, 0x2d000
    buffer_load_dwordx4 v[88:91], v31, s[4:7], s97 offen sc1
    buffer_load_dwordx4 v[92:95], v31, s[4:7], s97 offen offset:256 sc1
    s_sub_u32 s30, s30, 1
    s_cbranch_scc1 Lo_222
    s_waitcnt vmcnt(0)
    v_cmp_eq_u32 vcc, -1, v88
    s_cbranch_vccnz Lfc_220
    v_cmp_eq_u32 vcc, -1, v92
    s_cbranch_vccnz Lfc_220
    s_branch Lc_221
Lo_222:
    s_mov_b32 s30, 0
    s_waitcnt vmcnt(0)
    s_branch Lc_221
Lfc_223:
    s_add_u32 s97, s36, 0x39000
    buffer_load_dwordx4 v[96:99], v31, s[4:7], s97 offen offset:1024 sc1
    buffer_load_dwordx4 v[100:103], v31, s[4:7], s97 offen offset:1280 sc1
    s_sub_u32 s30, s30, 1
    s_cbranch_scc1 Lo_225
    s_waitcnt vmcnt(0)
    v_cmp_eq_u32 vcc, -1, v96
    s_cbranch_vccnz Lfc_223
    v_cmp_eq_u32 vcc, -1, v100
    s_cbranch_vccnz Lfc_223
    s_branch Lc_224
Lo_225:
    s_mov_b32 s30, 0
    s_waitcnt vmcnt(0)
    s_branch Lc_224
Lfc_226:
    s_add_u32 s97, s36, 0x3b000
    buffer_load_dwordx4 v[104:107], v31, s[4:7], s97 offen sc1
    buffer_load_dwordx4 v[108:111], v31, s[4:7], s97 offen offset:256 sc1
    s_sub_u32 s30, s30, 1
    s_cbranch_scc1 Lo_228
    s_waitcnt vmcnt(0)
    v_cmp_eq_u32 vcc, -1, v104
    s_cbranch_vccnz Lfc_226
    v_cmp_eq_u32 vcc, -1, v108
    s_cbranch_vccnz Lfc_226
    s_branch Lc_227
Lo_228:
    s_mov_b32 s30, 0
    s_waitcnt vmcnt(0)
    s_branch Lc_227
Lfc_229:
    s_add_u32 s97, s36, 0x47000
    buffer_load_dwordx4 v[112:115], v31, s[4:7], s97 offen offset:1024 sc1
    buffer_load_dwordx4 v[116:119], v31, s[4:7], s97 offen offset:1280 sc1
    s_sub_u32 s30, s30, 1
    s_cbranch_scc1 Lo_231
    s_waitcnt vmcnt(0)
    v_cmp_eq_u32 vcc, -1, v112
    s_cbranch_vccnz Lfc_229
    v_cmp_eq_u32 vcc, -1, v116
    s_cbranch_vccnz Lfc_229
    s_branch Lc_230
Lo_231:
    s_mov_b32 s30, 0
    s_waitcnt vmcnt(0)
    s_branch Lc_230
Lfc_232:
    s_add_u32 s97, s36, 0x49000
    buffer_load_dwordx4 v[120:123], v31, s[4:7], s97 offen sc1
    buffer_load_dwordx4 v[124:127], v31, s[4:7], s97 offen offset:256 sc1
    s_sub_u32 s30, s30, 1
    s_cbranch_scc1 Lo_234
    s_waitcnt vmcnt(0)
    v_cmp_eq_u32 vcc, -1, v120
    s_cbranch_vccnz Lfc_232
    v_cmp_eq_u32 vcc, -1, v124
    s_cbranch_vccnz Lfc_232
    s_branch Lc_233
Lo_234:
    s_mov_b32 s30, 0
    s_waitcnt vmcnt(0)
    s_branch Lc_233
Lfc_235:
    s_add_u32 s97, s36, 0x55000
    buffer_load_dwordx4 v[128:131], v31, s[4:7], s97 offen offset:1024 sc1
    buffer_load_dwordx4 v[132:135], v31, s[4:7], s97 offen offset:1280 sc1
    s_sub_u32 s30, s30, 1
    s_cbranch_scc1 Lo_237
    s_waitcnt vmcnt(0)
    v_cmp_eq_u32 vcc, -1, v128
    s_cbranch_vccnz Lfc_235
    v_cmp_eq_u32 vcc, -1, v132
    s_cbranch_vccnz Lfc_235
    s_branch Lc_236
Lo_237:
    s_mov_b32 s30, 0
    s_waitcnt vmcnt(0)
    s_branch Lc_236
Lfc_238:
    s_add_u32 s97, s36, 0x57000
    buffer_load_dwordx4 v[136:139], v31, s[4:7], s97 offen sc1
    buffer_load_dwordx4 v[140:143], v31, s[4:7], s97 offen offset:256 sc1
    s_sub_u32 s30, s30, 1
    s_cbranch_scc1 Lo_240
    s_waitcnt vmcnt(0)
    v_cmp_eq_u32 vcc, -1, v136
    s_cbranch_vccnz Lfc_238
    v_cmp_eq_u32 vcc, -1, v140
    s_cbranch_vccnz Lfc_238
    s_branch Lc_239
Lo_240:
    s_mov_b32 s30, 0
    s_waitcnt vmcnt(0)
    s_branch Lc_239
Lnn_241:
    s_nop 7
    s_nop 7
Lr_243:
    buffer_load_dword v208, v2, s[4:7], s93 offen sc1
    buffer_load_dword v209, v2, s[4:7], s93 offen offset:256 sc1
    buffer_load_dword v210, v2, s[4:7], s93 offen offset:512 sc1
    buffer_load_dword v211, v2, s[4:7], s93 offen offset:768 sc1
    buffer_load_dword v212, v2, s[4:7], s93 offen offset:1024 sc1
    buffer_load_dword v213, v2, s[4:7], s93 offen offset:1280 sc1
    buffer_load_dword v214, v2, s[4:7], s93 offen offset:1536 sc1
    buffer_load_dword v215, v2, s[4:7], s93 offen offset:1792 sc1
    buffer_load_dword v216, v2, s[4:7], s93 offen offset:2048 sc1
    buffer_load_dword v217, v2, s[4:7], s93 offen offset:2304 sc1
    buffer_load_dword v218, v2, s[4:7], s93 offen offset:2560 sc1
    buffer_load_dword v219, v2, s[4:7], s93 offen offset:2816 sc1
    buffer_load_dword v220, v2, s[4:7], s93 offen offset:3072 sc1
    buffer_load_dword v221, v2, s[4:7], s93 offen offset:3328 sc1
    s_waitcnt vmcnt(0)
    v_max3_u32 v223, v208, v209, v210
    v_max3_u32 v223, v223, v211, v212
    v_max3_u32 v223, v223, v213, v214
    v_max3_u32 v223, v223, v215, v216
    v_max3_u32 v223, v223, v217, v218
    v_max3_u32 v223, v223, v219, v220
    v_max_u32 v223, v223, v221
    v_cmp_eq_u32 vcc, -1, v223
    s_cbranch_vccz Lg_244
    s_sub_u32 s30, s30, 1
    s_cbranch_scc0 Lr_243
    s_mov_b32 s30, 0
Lg_244:
    v_add_f32 v208, v208, v209
    v_add_f32 v210, v210, v211
    v_add_f32 v212, v212, v213
    v_add_f32 v214, v214, v215
    v_add_f32 v216, v216, v217
    v_add_f32 v218, v218, v219
    v_add_f32 v220, v220, v221
    v_add_f32 v208, v208, v210
    v_add_f32 v212, v212, v214
    v_add_f32 v216, v216, v218
    v_add_f32 v208, v208, v212
    v_add_f32 v216, v216, v220
    v_add_f32 v208, v208, v216
    s_waitcnt vmcnt(0) lgkmcnt(0)
    s_nop 7
    s_nop 7
    s_branch Lc_242
Lfs_245:
    s_cmp_eq_u32 s30, 0
    s_cbranch_scc1 Lc_246
    s_sub_u32 s30, s30, 1
    buffer_load_dword v8, v10, s[4:7], s56 offen offset:512 sc1
    s_waitcnt vmcnt(0)
    v_subrev_u32 v8, s44, v8
    v_cmp_le_u32 vcc, 16, v8
    s_cbranch_vccnz Lfs_245
    s_branch Lc_246
Lfs_247:
    s_cmp_eq_u32 s30, 0
    s_cbranch_scc1 Lc_248
    s_sub_u32 s30, s30, 1
    buffer_load_dword v8, v10, s[4:7], s56 offen offset:512 sc1
    s_waitcnt vmcnt(0)
    v_subrev_u32 v8, s44, v8
    v_cmp_le_u32 vcc, 16, v8
    s_cbranch_vccnz Lfs_247
    s_branch Lc_248
Lidle_249:
    s_waitcnt lgkmcnt(0)
    s_nop 7
    s_nop 7
    v_pk_mul_f32 v[224:225], v[160:161], v[26:27] op_sel:[0,0] op_sel_hi:[1,0]
    v_pk_mul_f32 v[226:227], v[162:163], v[26:27] op_sel:[0,0] op_sel_hi:[1,0]
    v_pk_mul_f32 v[228:229], v[164:165], v[26:27] op_sel:[0,1] op_sel_hi:[1,1]
    v_pk_mul_f32 v[230:231], v[166:167], v[26:27] op_sel:[0,1] op_sel_hi:[1,1]
    v_pk_mul_f32 v[160:161], v[160:161], v[168:169]
    v_pk_mul_f32 v[162:163], v[162:163], v[170:171]
    v_pk_mul_f32 v[164:165], v[164:165], v[172:173]
    v_pk_mul_f32 v[166:167], v[166:167], v[174:175]
    v_exp_f32 v224, v224
    v_exp_f32 v225, v225
    v_exp_f32 v226, v226
    v_exp_f32 v227, v227
    v_exp_f32 v228, v228
    v_exp_f32 v229, v229
    v_exp_f32 v230, v230
    v_exp_f32 v231, v231
    v_pk_fma_f32 v[224:225], v[224:225], v[24:25], v[24:25] op_sel:[0,1,1] op_sel_hi:[1,1,1]
    v_pk_fma_f32 v[226:227], v[226:227], v[24:25], v[24:25] op_sel:[0,1,1] op_sel_hi:[1,1,1]
    v_pk_fma_f32 v[228:229], v[228:229], v[24:25], v[24:25] op_sel:[0,0,0] op_sel_hi:[1,0,0]
    v_pk_fma_f32 v[230:231], v[230:231], v[24:25], v[24:25] op_sel:[0,0,0] op_sel_hi:[1,0,0]
    v_rcp_f32 v224, v224
    v_rcp_f32 v225, v225
    v_rcp_f32 v226, v226
    v_rcp_f32 v227, v227
    v_rcp_f32 v228, v228
    v_rcp_f32 v229, v229
    v_rcp_f32 v230, v230
    v_rcp_f32 v231, v231
    v_pk_mul_f32 v[160:161], v[160:161], v[224:225]
    v_pk_mul_f32 v[162:163], v[162:163], v[226:227]
    v_pk_mul_f32 v[164:165], v[164:165], v[228:229]
    v_pk_mul_f32 v[166:167], v[166:167], v[230:231]
    v_cvt_pk_bf16_f32 v232, v160, v161
    v_cvt_pk_bf16_f32 v234, v164, v165
    v_cvt_pk_bf16_f32 v233, v162, v163
    v_cvt_pk_bf16_f32 v235, v166, v167
    v_permlane16_swap_b32 v232, v234
    s_nop 0
    v_permlane16_swap_b32 v233, v235
    buffer_store_dwordx4 v[232:235], v0, s[4:7], s57 offen offset:2048
    v_or_b32_e64 v9, s3, 14
    s_waitcnt vmcnt(0)
    buffer_store_dword v9, v6, s[4:7], s54 offen offset:512
    s_waitcnt vmcnt(0) lgkmcnt(0)
    s_branch Lfin_2
Lfs_250:
    s_cmp_eq_u32 s30, 0
    s_cbranch_scc1 Lc_251
    s_sub_u32 s30, s30, 1
    buffer_load_dword v8, v10, s[4:7], s56 offen offset:512 sc1
    s_waitcnt vmcnt(0)
    v_subrev_u32 v8, s44, v8
    v_cmp_le_u32 vcc, 16, v8
    s_cbranch_vccnz Lfs_250
    s_branch Lc_251
Lfs_252:
    s_cmp_eq_u32 s30, 0
    s_cbranch_scc1 Lc_253
    s_sub_u32 s30, s30, 1
    buffer_load_dword v8, v10, s[4:7], s56 offen offset:512 sc1
    s_waitcnt vmcnt(0)
    v_subrev_u32 v8, s44, v8
    v_cmp_le_u32 vcc, 16, v8
    s_cbranch_vccnz Lfs_252
    s_branch Lc_253
Lfs_254:
    s_cmp_eq_u32 s30, 0
    s_cbranch_scc1 Lc_255
    s_sub_u32 s30, s30, 1
    buffer_load_dword v8, v10, s[4:7], s56 offen offset:512 sc1
    s_waitcnt vmcnt(0)
    v_subrev_u32 v8, s44, v8
    v_cmp_le_u32 vcc, 16, v8
    s_cbranch_vccnz Lfs_254
    s_branch Lc_255
Lfast_end:
Lslow_entry:
    s_waitcnt vmcnt(0) lgkmcnt(0)
    s_nop 7
    s_nop 7
    v_or_b32_e64 v27, s3, 0
    v_cvt_pk_bf16_f32 v176, v176, v177
    v_cvt_pk_bf16_f32 v177, v178, v179
    v_cvt_pk_bf16_f32 v178, v180, v181
    v_cvt_pk_bf16_f32 v179, v182, v183
    buffer_store_dwordx4 v[176:179], v1, s[4:7], s57 offen offset:2048 sc1
    v_cvt_pk_bf16_f32 v180, v184, v185
    v_cvt_pk_bf16_f32 v181, v186, v187
    v_cvt_pk_bf16_f32 v182, v188, v189
    v_cvt_pk_bf16_f32 v183, v190, v191
    buffer_store_dwordx4 v[180:183], v1, s[4:7], s57 offen offset:3072 sc1
    s_waitcnt vmcnt(0)
    buffer_store_dword v27, v6, s[4:7], s93 offen sc1
LstS2_0s:
    s_add_u32 m0, s55, 0x7000
    s_add_u32 s63, s39, 0x7000
    buffer_load_dwordx4 v1, s[4:7], s63 offen lds
    buffer_load_dwordx4 v1, s[4:7], s63 offen offset:1024 lds
    buffer_load_dwordx4 v1, s[4:7], s63 offen offset:2048 lds
    buffer_load_dwordx4 v1, s[4:7], s63 offen offset:3072 lds
    s_add_u32 m0, s55, 0x8000
    s_nop 0
    buffer_load_dwordx4 v0, s[4:7], s63 offen lds
    buffer_load_dwordx4 v0, s[4:7], s63 offen offset:1024 lds
    buffer_load_dwordx4 v0, s[4:7], s63 offen offset:2048 lds
    s_cmp_ge_u32 s25, 14
    s_cbranch_scc1 Lidle_281
    s_and_b32 s86, s24, 1
    s_lshl_b32 s87, s86, 5
    s_andn2_b32 s85, s100, 63
    s_add_u32 s85, s85, s87
    buffer_load_dword v8, v10, s[4:7], s85 offen sc1
    s_add_u32 s66, s3, 0
    s_lshl_b32 s87, s86, 1
    s_sub_u32 s87, s87, s24
    s_mul_i32 s87, s87, 114688
    s_add_u32 s84, s87, s46
    s_mul_i32 s87, s86, 28736
    s_add_u32 s87, s87, 106496
    v_and_b32 v146, 0x58, v3
    v_and_b32 v147, 0x60, v3
    v_lshl_add_u32 v146, v147, 2, v146
    v_bfe_u32 v147, v3, 7, 1
    v_lshl_add_u32 v146, v147, 5, v146
    v_xor_b32 v146, s87, v146
    v_xor_b32 v147, 64, v146
    v_and_b32 v145, 0x200, v1
    v_add_u32 v144, v145, v146
    v_add_u32 v145, v145, v147
    s_lshl_b32 s87, s24, 12
    s_add_u32 s87, s87, 90112
    v_add_u32 v31, s87, v1
    v_xor_b32 v28, 0x1000, v31
    v_lshlrev_b32 v176, 16, v12
    v_and_b32 v177, 0xffff0000, v12
    v_lshlrev_b32 v178, 16, v13
    v_and_b32 v179, 0xffff0000, v13
    v_lshlrev_b32 v180, 16, v14
    v_and_b32 v181, 0xffff0000, v14
    v_lshlrev_b32 v182, 16, v15
    v_and_b32 v183, 0xffff0000, v15
    v_lshlrev_b32 v184, 16, v16
    v_and_b32 v185, 0xffff0000, v16
    v_lshlrev_b32 v186, 16, v17
    v_and_b32 v187, 0xffff0000, v17
    v_lshlrev_b32 v188, 16, v18
    v_and_b32 v189, 0xffff0000, v18
    v_lshlrev_b32 v190, 16, v19
    v_and_b32 v191, 0xffff0000, v19
    s_add_u32 s92, s57, 0x1400
    s_add_u32 s93, s49, 0x0
    v_or_b32_e64 v162, s3, 0
    s_barrier
    ds_read_b64_tr_b16 v[96:97], v145 offset:0
    ds_read_b64_tr_b16 v[98:99], v145 offset:1024
    ds_read_b64_tr_b16 v[100:101], v144 offset:0
    ds_read_b64_tr_b16 v[102:103], v144 offset:1024
    ds_read_b64_tr_b16 v[104:105], v145 offset:2048
    ds_read_b64_tr_b16 v[106:107], v147 offset:3072
    ds_read_b64_tr_b16 v[108:109], v144 offset:2048
    ds_read_b64_tr_b16 v[110:111], v146 offset:3072
    ds_read_b64_tr_b16 v[112:113], v145 offset:3584
    ds_read_b64_tr_b16 v[114:115], v145 offset:4608
    ds_read_b64_tr_b16 v[116:117], v144 offset:3584
    ds_read_b64_tr_b16 v[118:119], v144 offset:4608
    ds_read_b64_tr_b16 v[120:121], v145 offset:5632
    ds_read_b64_tr_b16 v[122:123], v147 offset:6656
    ds_read_b64_tr_b16 v[124:125], v144 offset:5632
    ds_read_b64_tr_b16 v[126:127], v146 offset:6656
    ds_read_b64_tr_b16 v[128:129], v145 offset:7168
    ds_read_b64_tr_b16 v[130:131], v145 offset:8192
    ds_read_b64_tr_b16 v[132:133], v144 offset:7168
    ds_read_b64_tr_b16 v[134:135], v144 offset:8192
    ds_read_b64_tr_b16 v[136:137], v145 offset:9216
    ds_read_b64_tr_b16 v[138:139], v147 offset:10240
    ds_read_b64_tr_b16 v[140:141], v144 offset:9216
    ds_read_b64_tr_b16 v[142:143], v146 offset:10240
    ds_read_b64_tr_b16 v[224:225], v145 offset:10752
    ds_read_b64_tr_b16 v[226:227], v145 offset:11776
    ds_read_b64_tr_b16 v[228:229], v144 offset:10752
    ds_read_b64_tr_b16 v[230:231], v144 offset:11776
    ds_read_b64_tr_b16 v[232:233], v145 offset:12800
    ds_read_b64_tr_b16 v[234:235], v147 offset:13824
    ds_read_b64_tr_b16 v[236:237], v144 offset:12800
    ds_read_b64_tr_b16 v[238:239], v146 offset:13824
    ds_read_b64_tr_b16 v[240:241], v145 offset:14336
    ds_read_b64_tr_b16 v[242:243], v145 offset:15360
    ds_read_b64_tr_b16 v[244:245], v145 offset:16384
    ds_read_b64_tr_b16 v[246:247], v147 offset:17408
    ds_read_b64_tr_b16 v[248:249], v145 offset:17920
    ds_read_b64_tr_b16 v[250:251], v145 offset:18944
    ds_read_b64_tr_b16 v[252:253], v145 offset:19968
    ds_read_b64_tr_b16 v[254:255], v147 offset:20992
    ds_read_b64_tr_b16 a[224:225], v145 offset:21504
    ds_read_b64_tr_b16 a[226:227], v145 offset:22528
    ds_read_b64_tr_b16 a[228:229], v145 offset:23552
    ds_read_b64_tr_b16 a[230:231], v147 offset:24576
    ds_read_b64_tr_b16 a[232:233], v145 offset:25088
    ds_read_b64_tr_b16 a[234:235], v145 offset:26112
    ds_read_b64_tr_b16 a[236:237], v145 offset:27136
    ds_read_b64_tr_b16 a[238:239], v147 offset:28160
    ds_read_b64_tr_b16 a[240:241], v144 offset:14336
    ds_read_b64_tr_b16 a[242:243], v144 offset:15360
    ds_read_b64_tr_b16 a[244:245], v144 offset:16384
    ds_read_b64_tr_b16 a[246:247], v146 offset:17408
    ds_read_b64_tr_b16 a[248:249], v144 offset:17920
    ds_read_b64_tr_b16 a[250:251], v144 offset:18944
    ds_read_b64_tr_b16 a[252:253], v144 offset:19968
    ds_read_b64_tr_b16 a[254:255], v146 offset:20992
    ds_read_b64_tr_b16 v[208:209], v144 offset:21504
    ds_read_b64_tr_b16 v[210:211], v144 offset:22528
    ds_read_b64_tr_b16 v[212:213], v144 offset:23552
    ds_read_b64_tr_b16 v[214:215], v146 offset:24576
    ds_read_b64_tr_b16 v[216:217], v144 offset:25088
    ds_read_b64_tr_b16 v[218:219], v144 offset:26112
    ds_read_b64_tr_b16 v[220:221], v144 offset:27136
    ds_read_b64_tr_b16 v[222:223], v146 offset:28160
    buffer_load_dword v9, v10, s[4:7], s85 offen sc1
Lp_282:
    s_waitcnt vmcnt(1)
    v_subrev_u32 v8, s66, v8
    v_cmp_le_u32 vcc, 16, v8
    s_cbranch_vccz Lo_283
    buffer_load_dword v8, v10, s[4:7], s85 offen sc1
    s_waitcnt vmcnt(1)
    v_subrev_u32 v9, s66, v9
    v_cmp_le_u32 vcc, 16, v9
    s_cbranch_vccz Lo_283
    buffer_load_dword v9, v10, s[4:7], s85 offen sc1
    s_sub_u32 s30, s30, 1
    s_cbranch_scc0 Lp_282
    s_mov_b32 s30, 0
Lo_283:
    buffer_load_dwordx4 v[32:35], v1, s[4:7], s84 offen offset:2048 sc1
    buffer_load_dwordx4 v[36:39], v1, s[4:7], s84 offen offset:3072 sc1
    s_add_u32 s65, s84, 0x6000
    buffer_load_dwordx4 v[40:43], v0, s[4:7], s65 offen offset:2048 sc1
    buffer_load_dwordx4 v[44:47], v0, s[4:7], s65 offen offset:3072 sc1
    s_add_u32 s65, s84, 0xe000
    buffer_load_dwordx4 v[48:51], v1, s[4:7], s65 offen offset:2048 sc1
    buffer_load_dwordx4 v[52:55], v1, s[4:7], s65 offen offset:3072 sc1
    s_add_u32 s65, s84, 0x14000
    buffer_load_dwordx4 v[56:59], v0, s[4:7], s65 offen offset:2048 sc1
    buffer_load_dwordx4 v[60:63], v0, s[4:7], s65 offen offset:3072 sc1
    s_waitcnt vmcnt(7) lgkmcnt(15)
    v_mfma_f32_32x32x16_bf16 v[192:207], v[96:99], v[32:35], 0
    s_add_u32 s65, s84, 0x1c000
    buffer_load_dwordx4 v[64:67], v1, s[4:7], s65 offen offset:2048 sc1
    v_mfma_f32_32x32x16_bf16 v[176:191], v[100:103], v[32:35], v[176:191]
    buffer_load_dwordx4 v[68:71], v1, s[4:7], s65 offen offset:3072 sc1
    s_waitcnt vmcnt(8)
    v_mfma_f32_32x32x16_bf16 v[192:207], v[104:107], v[36:39], v[192:207]
    s_add_u32 s65, s84, 0x22000
    buffer_load_dwordx4 v[72:75], v0, s[4:7], s65 offen offset:2048 sc1
    v_mfma_f32_32x32x16_bf16 v[176:191], v[108:111], v[36:39], v[176:191]
    buffer_load_dwordx4 v[76:79], v0, s[4:7], s65 offen offset:3072 sc1
    s_waitcnt vmcnt(9)
    v_mfma_f32_32x32x16_bf16 v[192:207], v[112:115], v[40:43], v[192:207]
    s_add_u32 s65, s84, 0x2a000
    buffer_load_dwordx4 v[80:83], v1, s[4:7], s65 offen offset:2048 sc1
    v_mfma_f32_32x32x16_bf16 v[176:191], v[116:119], v[40:43], v[176:191]
    buffer_load_dwordx4 v[84:87], v1, s[4:7], s65 offen offset:3072 sc1
    s_waitcnt vmcnt(10)
    v_mfma_f32_32x32x16_bf16 v[192:207], v[120:123], v[44:47], v[192:207]
    s_add_u32 s65, s84, 0x30000
    buffer_load_dwordx4 v[88:91], v0, s[4:7], s65 offen offset:2048 sc1
    v_mfma_f32_32x32x16_bf16 v[176:191], v[124:127], v[44:47], v[176:191]
    buffer_load_dwordx4 v[92:95], v0, s[4:7], s65 offen offset:3072 sc1
    s_waitcnt vmcnt(11)
    v_mfma_f32_32x32x16_bf16 v[192:207], v[128:131], v[48:51], v[192:207]
    v_mfma_f32_32x32x16_bf16 v[176:191], v[132:135], v[48:51], v[176:191]
    s_waitcnt vmcnt(10)
    v_mfma_f32_32x32x16_bf16 v[192:207], v[136:139], v[52:55], v[192:207]
    s_lshl_b32 s22, s24, 12
    s_add_u32 s22, s22, LstS3_0s-Lpc_3
    v_lshlrev_b32 v27, 2, v1
    buffer_load_dword v8, v27, s[12:15], s22 offen
    s_add_u32 m0, s55, 0xe000
    s_add_u32 s67, s39, 0xe000
    buffer_load_dwordx4 v1, s[4:7], s67 offen lds
    v_mfma_f32_32x32x16_bf16 v[176:191], v[140:143], v[52:55], v[176:191]
    s_waitcnt vmcnt(11)
    v_mfma_f32_32x32x16_bf16 v[192:207], v[224:227], v[56:59], v[192:207]
    buffer_load_dwordx4 v1, s[4:7], s67 offen offset:1024 lds
    v_mfma_f32_32x32x16_bf16 v[176:191], v[228:231], v[56:59], v[176:191]
    buffer_load_dwordx4 v1, s[4:7], s67 offen offset:2048 lds
    s_waitcnt vmcnt(12)
    v_mfma_f32_32x32x16_bf16 v[192:207], v[232:235], v[60:63], v[192:207]
    s_waitcnt lgkmcnt(0)
    s_barrier
    v_mfma_f32_32x32x16_bf16 v[176:191], v[236:239], v[60:63], v[176:191]
    buffer_load_dwordx4 v1, s[4:7], s67 offen offset:3072 lds
    s_add_u32 m0, s55, 0xf000
    s_waitcnt vmcnt(12)
    v_mfma_f32_32x32x16_bf16 v[192:207], v[240:243], v[64:67], v[192:207]
    s_waitcnt vmcnt(11)
    v_mfma_f32_32x32x16_bf16 v[192:207], v[244:247], v[68:71], v[192:207]
    buffer_load_dwordx4 v0, s[4:7], s67 offen lds
    s_waitcnt vmcnt(11)
    v_mfma_f32_32x32x16_bf16 v[192:207], v[248:251], v[72:75], v[192:207]
    s_waitcnt vmcnt(10)
    v_mfma_f32_32x32x16_bf16 v[192:207], v[252:255], v[76:79], v[192:207]
    buffer_load_dwordx4 v0, s[4:7], s67 offen offset:1024 lds
    s_waitcnt vmcnt(10)
    v_mfma_f32_32x32x16_bf16 v[192:207], a[224:227], v[80:83], v[192:207]
    buffer_load_dwordx4 v0, s[4:7], s67 offen offset:2048 lds
    s_waitcnt vmcnt(10)
    v_mfma_f32_32x32x16_bf16 v[192:207], a[228:231], v[84:87], v[192:207]
    s_waitcnt vmcnt(9)
    v_mfma_f32_32x32x16_bf16 v[192:207], a[232:235], v[88:91], v[192:207]
    s_waitcnt vmcnt(8)
    v_mfma_f32_32x32x16_bf16 v[192:207], a[236:239], v[92:95], v[192:207]
    v_mfma_f32_32x32x16_bf16 v[176:191], a[240:243], v[64:67], v[176:191]
    v_mfma_f32_32x32x16_bf16 v[176:191], a[244:247], v[68:71], v[176:191]
    s_nop 9
    ds_write_b128 v28, v[192:195] offset:0
    v_mfma_f32_32x32x16_bf16 v[176:191], a[248:251], v[72:75], v[176:191]
    ds_write_b128 v28, v[196:199] offset:1024
    v_mfma_f32_32x32x16_bf16 v[176:191], a[252:255], v[76:79], v[176:191]
    ds_write_b128 v28, v[200:203] offset:2048
    v_mfma_f32_32x32x16_bf16 v[176:191], v[208:211], v[80:83], v[176:191]
    ds_write_b128 v28, v[204:207] offset:3072
    v_mfma_f32_32x32x16_bf16 v[176:191], v[212:215], v[84:87], v[176:191]
    v_mfma_f32_32x32x16_bf16 v[176:191], v[216:219], v[88:91], v[176:191]
    v_mfma_f32_32x32x16_bf16 v[176:191], v[220:223], v[92:95], v[176:191]
    s_waitcnt lgkmcnt(0)
    s_barrier
    ds_read_b128 v[192:195], v31 offset:0
    ds_read_b128 v[196:199], v31 offset:1024
    ds_read_b128 v[200:203], v31 offset:2048
    ds_read_b128 v[204:207], v31 offset:3072
    s_waitcnt lgkmcnt(3)
    s_nop 4
    v_pk_add_f32 v[176:177], v[176:177], v[192:193]
    v_pk_add_f32 v[178:179], v[178:179], v[194:195]
    v_cvt_pk_bf16_f32 v12, v176, v177
    v_cvt_pk_bf16_f32 v13, v178, v179
    s_waitcnt lgkmcnt(2)
    v_pk_add_f32 v[180:181], v[180:181], v[196:197]
    v_pk_add_f32 v[182:183], v[182:183], v[198:199]
    v_cvt_pk_bf16_f32 v14, v180, v181
    v_cvt_pk_bf16_f32 v15, v182, v183
    buffer_store_dwordx4 v[12:15], v1, s[4:7], s92 offen sc1
    s_waitcnt lgkmcnt(1)
    v_pk_add_f32 v[184:185], v[184:185], v[200:201]
    v_pk_add_f32 v[186:187], v[186:187], v[202:203]
    v_cvt_pk_bf16_f32 v16, v184, v185
    v_cvt_pk_bf16_f32 v17, v186, v187
    s_waitcnt lgkmcnt(0)
    v_pk_add_f32 v[188:189], v[188:189], v[204:205]
    v_pk_add_f32 v[190:191], v[190:191], v[206:207]
    v_cvt_pk_bf16_f32 v18, v188, v189
    v_cvt_pk_bf16_f32 v19, v190, v191
    buffer_store_dwordx4 v[16:19], v1, s[4:7], s92 offen offset:1024 sc1
    v_dot2_f32_bf16 v160, v12, s23, 0
    v_dot2_f32_bf16 v161, v12, v12, 0
    v_dot2_f32_bf16 v160, v13, s23, v160
    v_dot2_f32_bf16 v161, v13, v13, v161
    v_dot2_f32_bf16 v160, v14, s23, v160
    v_dot2_f32_bf16 v161, v14, v14, v161
    v_dot2_f32_bf16 v160, v15, s23, v160
    v_dot2_f32_bf16 v161, v15, v15, v161
    v_dot2_f32_bf16 v160, v16, s23, v160
    v_dot2_f32_bf16 v161, v16, v16, v161
    v_dot2_f32_bf16 v160, v17, s23, v160
    v_dot2_f32_bf16 v161, v17, v17, v161
    v_dot2_f32_bf16 v160, v18, s23, v160
    v_dot2_f32_bf16 v161, v18, v18, v161
    v_dot2_f32_bf16 v160, v19, s23, v160
    v_dot2_f32_bf16 v161, v19, v19, v161
    s_nop 2
    v_permlane32_swap_b32 v160, v161
    v_add_f32 v160, v160, v161
    buffer_store_dword v160, v2, s[4:7], s93 offen sc1
    s_waitcnt vmcnt(0)
    buffer_store_dword v162, v6, s[4:7], s100 offen offset:256 sc1
LstS3_0s:
    s_waitcnt lgkmcnt(0)
    s_barrier
    s_lshl_b32 s22, s24, 12
    s_add_u32 s22, s22, LstS4_0s-Lpc_3
    v_lshlrev_b32 v27, 2, v1
    buffer_load_dword v9, v27, s[12:15], s22 offen
    buffer_load_dword v8, v11, s[4:7], s101 offen offset:256 sc1
    s_add_u32 s70, s3, 0
    s_add_u32 s93, s37, 0x0
    v_lshrrev_b32 v30, 1, v1
    v_xor_b32 v30, v30, v1
    v_and_b32 v30, 64, v30
    v_mul_u32_u24 v30, 3, v30
    v_and_b32 v29, 0x100, v1
    v_mul_u32_u24 v5, 111, v29
    v_add_u32 v5, v5, v1
    v_mad_u32_u24 v4, v29, 27, v1
    v_xor_b32 v4, v4, v30
    v_mad_u32_u24 v31, v29, 3, v1
    v_xor_b32 v28, v31, v30
    v_add_u32 v29, 57344, v28
    v_add_u32 v30, 106496, v28
    ds_read_b128 a[224:227], v28 offset:0
    ds_read_b128 a[228:231], v28 offset:28672
    ds_read_b128 a[232:235], v29 offset:0
    ds_read_b128 a[236:239], v28 offset:256
    ds_read_b128 a[240:243], v28 offset:28928
    ds_read_b128 a[244:247], v29 offset:256
    ds_read_b128 a[248:251], v28 offset:2048
    buffer_load_dword v9, v11, s[4:7], s101 offen offset:256 sc1
Lp_285:
    s_waitcnt vmcnt(1)
    v_subrev_u32 v8, s70, v8
    v_cmp_le_u32 vcc, 16, v8
    s_cbranch_vccz Lo_286
    buffer_load_dword v8, v11, s[4:7], s101 offen offset:256 sc1
    s_waitcnt vmcnt(1)
    v_subrev_u32 v9, s70, v9
    v_cmp_le_u32 vcc, 16, v9
    s_cbranch_vccz Lo_286
    buffer_load_dword v9, v11, s[4:7], s101 offen offset:256 sc1
    s_sub_u32 s30, s30, 1
    s_cbranch_scc0 Lp_285
    s_mov_b32 s30, 0
Lo_286:
    s_add_u32 s69, s36, 0x1000
    buffer_load_dwordx4 v[32:35], v31, s[4:7], s69 offen offset:1024 sc1
    buffer_load_dwordx4 v[36:39], v31, s[4:7], s69 offen offset:1280 sc1
    s_add_u32 s69, s36, 0x3000
    buffer_load_dwordx4 v[40:43], v31, s[4:7], s69 offen sc1
    buffer_load_dwordx4 v[44:47], v31, s[4:7], s69 offen offset:256 sc1
    s_add_u32 s69, s36, 0xf000
    buffer_load_dwordx4 v[48:51], v31, s[4:7], s69 offen offset:1024 sc1
    buffer_load_dwordx4 v[52:55], v31, s[4:7], s69 offen offset:1280 sc1
    s_add_u32 s69, s36, 0x11000
    buffer_load_dwordx4 v[56:59], v31, s[4:7], s69 offen sc1
    buffer_load_dwordx4 v[60:63], v31, s[4:7], s69 offen offset:256 sc1
    s_add_u32 s69, s36, 0x1d000
    buffer_load_dwordx4 v[64:67], v31, s[4:7], s69 offen offset:1024 sc1
    buffer_load_dwordx4 v[68:71], v31, s[4:7], s69 offen offset:1280 sc1
    s_add_u32 s69, s36, 0x1f000
    buffer_load_dwordx4 v[72:75], v31, s[4:7], s69 offen sc1
    buffer_load_dwordx4 v[76:79], v31, s[4:7], s69 offen offset:256 sc1
    s_add_u32 s96, s38, s55
    s_waitcnt lgkmcnt(3)
    s_waitcnt vmcnt(10)
    v_mfma_f32_16x16x32_bf16 v[148:151], a[224:227], v[36:39], 0
    ds_read_b128 a[252:255], v28 offset:30720
    v_mfma_f32_16x16x32_bf16 v[144:147], a[224:227], v[32:35], 0
    s_add_u32 s69, s36, 0x2b000
    buffer_load_dwordx4 v[80:83], v31, s[4:7], s69 offen offset:1024 sc1
    v_mfma_f32_16x16x32_bf16 v[160:163], a[228:231], v[32:35], 0
    ds_read_b128 a[224:227], v29 offset:2048
    v_mfma_f32_16x16x32_bf16 v[164:167], a[228:231], v[36:39], 0
    v_mfma_f32_16x16x32_bf16 v[180:183], a[232:235], v[36:39], 0
    ds_read_b128 a[228:231], v28 offset:2304
    buffer_load_dwordx4 v[84:87], v31, s[4:7], s69 offen offset:1280 sc1
    v_mfma_f32_16x16x32_bf16 v[176:179], a[232:235], v[32:35], 0
    v_mfma_f32_16x16x32_bf16 v[152:155], a[236:239], v[32:35], 0
    ds_read_b128 a[232:235], v28 offset:30976
    s_waitcnt lgkmcnt(3)
    v_mfma_f32_16x16x32_bf16 v[156:159], a[236:239], v[36:39], 0
    v_mfma_f32_16x16x32_bf16 v[172:175], a[240:243], v[36:39], 0
    ds_read_b128 a[236:239], v29 offset:2304
    v_mfma_f32_16x16x32_bf16 v[168:171], a[240:243], v[32:35], 0
    s_add_u32 s69, s36, 0x2d000
    buffer_load_dwordx4 v[88:91], v31, s[4:7], s69 offen sc1
    v_mfma_f32_16x16x32_bf16 v[184:187], a[244:247], v[32:35], 0
    ds_read_b128 a[240:243], v28 offset:4096
    v_mfma_f32_16x16x32_bf16 v[188:191], a[244:247], v[36:39], 0
    s_waitcnt vmcnt(11)
    v_mfma_f32_16x16x32_bf16 v[148:151], a[248:251], v[44:47], v[148:151]
    ds_read_b128 a[244:247], v28 offset:32768
    buffer_load_dwordx4 v[92:95], v31, s[4:7], s69 offen offset:256 sc1
    v_mfma_f32_16x16x32_bf16 v[144:147], a[248:251], v[40:43], v[144:147]
    v_mfma_f32_16x16x32_bf16 v[160:163], a[252:255], v[40:43], v[160:163]
    ds_read_b128 a[248:251], v29 offset:4096
    s_waitcnt lgkmcnt(3)
    v_mfma_f32_16x16x32_bf16 v[164:167], a[252:255], v[44:47], v[164:167]
    v_mfma_f32_16x16x32_bf16 v[180:183], a[224:227], v[44:47], v[180:183]
    ds_read_b128 a[252:255], v28 offset:4352
    v_mfma_f32_16x16x32_bf16 v[176:179], a[224:227], v[40:43], v[176:179]
    s_add_u32 s69, s36, 0x39000
    buffer_load_dwordx4 v[96:99], v31, s[4:7], s69 offen offset:1024 sc1
    v_mfma_f32_16x16x32_bf16 v[152:155], a[228:231], v[40:43], v[152:155]
    ds_read_b128 a[224:227], v28 offset:33024
    v_mfma_f32_16x16x32_bf16 v[156:159], a[228:231], v[44:47], v[156:159]
    v_mfma_f32_16x16x32_bf16 v[172:175], a[232:235], v[44:47], v[172:175]
    ds_read_b128 a[228:231], v29 offset:4352
    buffer_load_dwordx4 v[100:103], v31, s[4:7], s69 offen offset:1280 sc1
    v_mfma_f32_16x16x32_bf16 v[168:171], a[232:235], v[40:43], v[168:171]
    v_mfma_f32_16x16x32_bf16 v[184:187], a[236:239], v[40:43], v[184:187]
    ds_read_b128 a[232:235], v28 offset:6144
    s_waitcnt lgkmcnt(3)
    v_mfma_f32_16x16x32_bf16 v[188:191], a[236:239], v[44:47], v[188:191]
    s_waitcnt vmcnt(12)
    v_mfma_f32_16x16x32_bf16 v[148:151], a[240:243], v[52:55], v[148:151]
    ds_read_b128 a[236:239], v28 offset:34816
    v_mfma_f32_16x16x32_bf16 v[144:147], a[240:243], v[48:51], v[144:147]
    s_add_u32 s69, s36, 0x3b000
    buffer_load_dwordx4 v[104:107], v31, s[4:7], s69 offen sc1
    v_mfma_f32_16x16x32_bf16 v[160:163], a[244:247], v[48:51], v[160:163]
    ds_read_b128 a[240:243], v29 offset:6144
    v_mfma_f32_16x16x32_bf16 v[164:167], a[244:247], v[52:55], v[164:167]
    v_mfma_f32_16x16x32_bf16 v[180:183], a[248:251], v[52:55], v[180:183]
    ds_read_b128 a[244:247], v28 offset:6400
    buffer_load_dwordx4 v[108:111], v31, s[4:7], s69 offen offset:256 sc1
    v_mfma_f32_16x16x32_bf16 v[176:179], a[248:251], v[48:51], v[176:179]
    v_mfma_f32_16x16x32_bf16 v[152:155], a[252:255], v[48:51], v[152:155]
    ds_read_b128 a[248:251], v28 offset:35072
    s_waitcnt lgkmcnt(3)
    v_mfma_f32_16x16x32_bf16 v[156:159], a[252:255], v[52:55], v[156:159]
    v_mfma_f32_16x16x32_bf16 v[172:175], a[224:227], v[52:55], v[172:175]
    ds_read_b128 a[252:255], v29 offset:6400
    v_mfma_f32_16x16x32_bf16 v[168:171], a[224:227], v[48:51], v[168:171]
    s_add_u32 s69, s36, 0x47000
    buffer_load_dwordx4 v[112:115], v31, s[4:7], s69 offen offset:1024 sc1
    v_mfma_f32_16x16x32_bf16 v[184:187], a[228:231], v[48:51], v[184:187]
    ds_read_b128 a[224:227], v28 offset:8192
    v_mfma_f32_16x16x32_bf16 v[188:191], a[228:231], v[52:55], v[188:191]
    s_waitcnt vmcnt(13)
    v_mfma_f32_16x16x32_bf16 v[148:151], a[232:235], v[60:63], v[148:151]
    ds_read_b128 a[228:231], v28 offset:36864
    v_mfma_f32_16x16x32_bf16 v[144:147], a[232:235], v[56:59], v[144:147]
    v_mfma_f32_16x16x32_bf16 v[160:163], a[236:239], v[56:59], v[160:163]
    ds_read_b128 a[232:235], v29 offset:8192
    s_waitcnt lgkmcnt(3)
    v_mfma_f32_16x16x32_bf16 v[164:167], a[236:239], v[60:63], v[164:167]
    buffer_load_dwordx4 v[116:119], v31, s[4:7], s69 offen offset:1280 sc1
    v_mfma_f32_16x16x32_bf16 v[180:183], a[240:243], v[60:63], v[180:183]
    ds_read_b128 a[236:239], v28 offset:8448
    v_mfma_f32_16x16x32_bf16 v[176:179], a[240:243], v[56:59], v[176:179]
    v_mfma_f32_16x16x32_bf16 v[152:155], a[244:247], v[56:59], v[152:155]
    ds_read_b128 a[240:243], v28 offset:37120
    s_add_u32 m0, s55, 0x1a000
    s_add_u32 s71, s39, 0x15000
    buffer_load_dwordx4 v1, s[4:7], s71 offen lds
    v_mfma_f32_16x16x32_bf16 v[156:159], a[244:247], v[60:63], v[156:159]
    v_mfma_f32_16x16x32_bf16 v[172:175], a[248:251], v[60:63], v[172:175]
    ds_read_b128 a[244:247], v29 offset:8448
    v_mfma_f32_16x16x32_bf16 v[168:171], a[248:251], v[56:59], v[168:171]
    v_mfma_f32_16x16x32_bf16 v[184:187], a[252:255], v[56:59], v[184:187]
    ds_read_b128 a[248:251], v28 offset:10240
    s_waitcnt lgkmcnt(3)
    buffer_load_dwordx4 v1, s[4:7], s71 offen offset:1024 lds
    v_mfma_f32_16x16x32_bf16 v[188:191], a[252:255], v[60:63], v[188:191]
    s_waitcnt vmcnt(14)
    v_mfma_f32_16x16x32_bf16 v[148:151], a[224:227], v[68:71], v[148:151]
    ds_read_b128 a[252:255], v28 offset:38912
    v_mfma_f32_16x16x32_bf16 v[144:147], a[224:227], v[64:67], v[144:147]
    v_mfma_f32_16x16x32_bf16 v[160:163], a[228:231], v[64:67], v[160:163]
    ds_read_b128 a[224:227], v29 offset:10240
    buffer_load_dwordx4 v1, s[4:7], s71 offen offset:2048 lds
    v_mfma_f32_16x16x32_bf16 v[164:167], a[228:231], v[68:71], v[164:167]
    v_mfma_f32_16x16x32_bf16 v[180:183], a[232:235], v[68:71], v[180:183]
    ds_read_b128 a[228:231], v28 offset:10496
    v_mfma_f32_16x16x32_bf16 v[176:179], a[232:235], v[64:67], v[176:179]
    v_mfma_f32_16x16x32_bf16 v[152:155], a[236:239], v[64:67], v[152:155]
    ds_read_b128 a[232:235], v28 offset:39168
    s_waitcnt lgkmcnt(3)
    buffer_load_dwordx4 v1, s[4:7], s71 offen offset:3072 lds
    s_add_u32 m0, s55, 0x1b000
    v_mfma_f32_16x16x32_bf16 v[156:159], a[236:239], v[68:71], v[156:159]
    v_mfma_f32_16x16x32_bf16 v[172:175], a[240:243], v[68:71], v[172:175]
    ds_read_b128 a[236:239], v29 offset:10496
    v_mfma_f32_16x16x32_bf16 v[168:171], a[240:243], v[64:67], v[168:171]
    v_mfma_f32_16x16x32_bf16 v[184:187], a[244:247], v[64:67], v[184:187]
    ds_read_b128 a[240:243], v28 offset:12288
    v_mfma_f32_16x16x32_bf16 v[188:191], a[244:247], v[68:71], v[188:191]
    s_waitcnt vmcnt(14)
    v_mfma_f32_16x16x32_bf16 v[148:151], a[248:251], v[76:79], v[148:151]
    ds_read_b128 a[244:247], v28 offset:40960
    buffer_load_dwordx4 v0, s[4:7], s71 offen lds
    v_mfma_f32_16x16x32_bf16 v[144:147], a[248:251], v[72:75], v[144:147]
    v_mfma_f32_16x16x32_bf16 v[160:163], a[252:255], v[72:75], v[160:163]
    ds_read_b128 a[248:251], v29 offset:12288
    s_waitcnt lgkmcnt(3)
    v_mfma_f32_16x16x32_bf16 v[164:167], a[252:255], v[76:79], v[164:167]
    v_mfma_f32_16x16x32_bf16 v[180:183], a[224:227], v[76:79], v[180:183]
    ds_read_b128 a[252:255], v28 offset:12544
    buffer_load_dwordx4 v0, s[4:7], s71 offen offset:1024 lds
    v_mfma_f32_16x16x32_bf16 v[176:179], a[224:227], v[72:75], v[176:179]
    v_mfma_f32_16x16x32_bf16 v[152:155], a[228:231], v[72:75], v[152:155]
    ds_read_b128 a[224:227], v28 offset:41216
    v_mfma_f32_16x16x32_bf16 v[156:159], a[228:231], v[76:79], v[156:159]
    v_mfma_f32_16x16x32_bf16 v[172:175], a[232:235], v[76:79], v[172:175]
    ds_read_b128 a[228:231], v29 offset:12544
    buffer_load_dwordx4 v0, s[4:7], s71 offen offset:2048 lds
    v_mfma_f32_16x16x32_bf16 v[168:171], a[232:235], v[72:75], v[168:171]
    v_mfma_f32_16x16x32_bf16 v[184:187], a[236:239], v[72:75], v[184:187]
    ds_read_b128 a[232:235], v28 offset:14336
    s_waitcnt lgkmcnt(3)
    v_mfma_f32_16x16x32_bf16 v[188:191], a[236:239], v[76:79], v[188:191]
    s_waitcnt vmcnt(15)
    v_mfma_f32_16x16x32_bf16 v[148:151], a[240:243], v[84:87], v[148:151]
    ds_read_b128 a[236:239], v28 offset:43008
    v_mfma_f32_16x16x32_bf16 v[144:147], a[240:243], v[80:83], v[144:147]
    s_lshl_b32 s94, s24, 11
    s_add_u32 m0, s94, 86016
    s_lshl_b32 s95, s25, 13
    s_add_u32 s94, s94, s95
    s_add_u32 s94, s94, 0x1d0000
    buffer_load_dwordx4 v1, s[4:7], s94 offen lds
    v_mfma_f32_16x16x32_bf16 v[160:163], a[244:247], v[80:83], v[160:163]
    ds_read_b128 a[240:243], v29 offset:14336
    v_mfma_f32_16x16x32_bf16 v[164:167], a[244:247], v[84:87], v[164:167]
    v_mfma_f32_16x16x32_bf16 v[180:183], a[248:251], v[84:87], v[180:183]
    ds_read_b128 a[244:247], v28 offset:14592
    buffer_load_dwordx4 v1, s[4:7], s94 offen offset:1024 lds
    v_mfma_f32_16x16x32_bf16 v[176:179], a[248:251], v[80:83], v[176:179]
    v_mfma_f32_16x16x32_bf16 v[152:155], a[252:255], v[80:83], v[152:155]
    ds_read_b128 a[248:251], v28 offset:43264
    s_waitcnt lgkmcnt(3)
    v_mfma_f32_16x16x32_bf16 v[156:159], a[252:255], v[84:87], v[156:159]
    v_mfma_f32_16x16x32_bf16 v[172:175], a[224:227], v[84:87], v[172:175]
    ds_read_b128 a[252:255], v29 offset:14592
    v_mfma_f32_16x16x32_bf16 v[168:171], a[224:227], v[80:83], v[168:171]
    s_add_u32 s69, s36, 0x49000
    buffer_load_dwordx4 v[120:123], v31, s[4:7], s69 offen sc1
    v_mfma_f32_16x16x32_bf16 v[184:187], a[228:231], v[80:83], v[184:187]
    ds_read_b128 a[224:227], v28 offset:16384
    v_mfma_f32_16x16x32_bf16 v[188:191], a[228:231], v[84:87], v[188:191]
    s_waitcnt vmcnt(16)
    v_mfma_f32_16x16x32_bf16 v[148:151], a[232:235], v[92:95], v[148:151]
    ds_read_b128 a[228:231], v28 offset:45056
    v_mfma_f32_16x16x32_bf16 v[144:147], a[232:235], v[88:91], v[144:147]
    v_mfma_f32_16x16x32_bf16 v[160:163], a[236:239], v[88:91], v[160:163]
    ds_read_b128 a[232:235], v29 offset:16384
    s_waitcnt lgkmcnt(3)
    v_mfma_f32_16x16x32_bf16 v[164:167], a[236:239], v[92:95], v[164:167]
    buffer_load_dwordx4 v[124:127], v31, s[4:7], s69 offen offset:256 sc1
    v_mfma_f32_16x16x32_bf16 v[180:183], a[240:243], v[92:95], v[180:183]
    ds_read_b128 a[236:239], v28 offset:16640
    v_mfma_f32_16x16x32_bf16 v[176:179], a[240:243], v[88:91], v[176:179]
    v_mfma_f32_16x16x32_bf16 v[152:155], a[244:247], v[88:91], v[152:155]
    ds_read_b128 a[240:243], v28 offset:45312
    v_mfma_f32_16x16x32_bf16 v[156:159], a[244:247], v[92:95], v[156:159]
    s_add_u32 s69, s36, 0x55000
    buffer_load_dwordx4 v[128:131], v31, s[4:7], s69 offen offset:1024 sc1
    v_mfma_f32_16x16x32_bf16 v[172:175], a[248:251], v[92:95], v[172:175]
    ds_read_b128 a[244:247], v29 offset:16640
    v_mfma_f32_16x16x32_bf16 v[168:171], a[248:251], v[88:91], v[168:171]
    v_mfma_f32_16x16x32_bf16 v[184:187], a[252:255], v[88:91], v[184:187]
    ds_read_b128 a[248:251], v28 offset:18432
    s_waitcnt lgkmcnt(3)
    v_mfma_f32_16x16x32_bf16 v[188:191], a[252:255], v[92:95], v[188:191]
    buffer_load_dword v208, v2, s[4:7], s93 offen sc1
    s_waitcnt vmcnt(17)
    v_mfma_f32_16x16x32_bf16 v[148:151], a[224:227], v[100:103], v[148:151]
    ds_read_b128 a[252:255], v28 offset:47104
    buffer_load_dwordx4 v[132:135], v31, s[4:7], s69 offen offset:1280 sc1
    v_mfma_f32_16x16x32_bf16 v[144:147], a[224:227], v[96:99], v[144:147]
    v_mfma_f32_16x16x32_bf16 v[160:163], a[228:231], v[96:99], v[160:163]
    ds_read_b128 a[224:227], v29 offset:18432
    v_mfma_f32_16x16x32_bf16 v[164:167], a[228:231], v[100:103], v[164:167]
    v_mfma_f32_16x16x32_bf16 v[180:183], a[232:235], v[100:103], v[180:183]
    ds_read_b128 a[228:231], v28 offset:18688
    buffer_load_dword v209, v2, s[4:7], s93 offen offset:256 sc1
    v_mfma_f32_16x16x32_bf16 v[176:179], a[232:235], v[96:99], v[176:179]
    v_mfma_f32_16x16x32_bf16 v[152:155], a[236:239], v[96:99], v[152:155]
    ds_read_b128 a[232:235], v28 offset:47360
    s_waitcnt lgkmcnt(3)
    v_mfma_f32_16x16x32_bf16 v[156:159], a[236:239], v[100:103], v[156:159]
    buffer_load_dword v210, v2, s[4:7], s93 offen offset:512 sc1
    v_mfma_f32_16x16x32_bf16 v[172:175], a[240:243], v[100:103], v[172:175]
    ds_read_b128 a[236:239], v29 offset:18688
    buffer_load_dword v211, v2, s[4:7], s93 offen offset:768 sc1
    v_mfma_f32_16x16x32_bf16 v[168:171], a[240:243], v[96:99], v[168:171]
    v_mfma_f32_16x16x32_bf16 v[184:187], a[244:247], v[96:99], v[184:187]
    ds_read_b128 a[240:243], v28 offset:20480
    buffer_load_dword v212, v2, s[4:7], s93 offen offset:1024 sc1
    v_mfma_f32_16x16x32_bf16 v[188:191], a[244:247], v[100:103], v[188:191]
    s_waitcnt vmcnt(20)
    v_mfma_f32_16x16x32_bf16 v[148:151], a[248:251], v[108:111], v[148:151]
    ds_read_b128 a[244:247], v28 offset:49152
    buffer_load_dword v213, v2, s[4:7], s93 offen offset:1280 sc1
    v_mfma_f32_16x16x32_bf16 v[144:147], a[248:251], v[104:107], v[144:147]
    v_mfma_f32_16x16x32_bf16 v[160:163], a[252:255], v[104:107], v[160:163]
    ds_read_b128 a[248:251], v29 offset:20480
    s_waitcnt lgkmcnt(3)
    v_mfma_f32_16x16x32_bf16 v[164:167], a[252:255], v[108:111], v[164:167]
    s_add_u32 s69, s36, 0x57000
    buffer_load_dwordx4 v[136:139], v31, s[4:7], s69 offen sc1
    v_mfma_f32_16x16x32_bf16 v[180:183], a[224:227], v[108:111], v[180:183]
    ds_read_b128 a[252:255], v28 offset:20736
    v_mfma_f32_16x16x32_bf16 v[176:179], a[224:227], v[104:107], v[176:179]
    v_mfma_f32_16x16x32_bf16 v[152:155], a[228:231], v[104:107], v[152:155]
    ds_read_b128 a[224:227], v28 offset:49408
    buffer_load_dword v214, v2, s[4:7], s93 offen offset:1536 sc1
    v_mfma_f32_16x16x32_bf16 v[156:159], a[228:231], v[108:111], v[156:159]
    v_mfma_f32_16x16x32_bf16 v[172:175], a[232:235], v[108:111], v[172:175]
    ds_read_b128 a[228:231], v29 offset:20736
    buffer_load_dword v215, v2, s[4:7], s93 offen offset:1792 sc1
    v_mfma_f32_16x16x32_bf16 v[168:171], a[232:235], v[104:107], v[168:171]
    v_mfma_f32_16x16x32_bf16 v[184:187], a[236:239], v[104:107], v[184:187]
    ds_read_b128 a[232:235], v28 offset:22528
    s_waitcnt lgkmcnt(3)
    v_mfma_f32_16x16x32_bf16 v[188:191], a[236:239], v[108:111], v[188:191]
    buffer_load_dword v216, v2, s[4:7], s93 offen offset:2048 sc1
    s_waitcnt vmcnt(23)
    v_mfma_f32_16x16x32_bf16 v[148:151], a[240:243], v[116:119], v[148:151]
    ds_read_b128 a[236:239], v28 offset:51200
    buffer_load_dwordx4 v[140:143], v31, s[4:7], s69 offen offset:256 sc1
    v_mfma_f32_16x16x32_bf16 v[144:147], a[240:243], v[112:115], v[144:147]
    v_mfma_f32_16x16x32_bf16 v[160:163], a[244:247], v[112:115], v[160:163]
    ds_read_b128 a[240:243], v29 offset:22528
    v_mfma_f32_16x16x32_bf16 v[164:167], a[244:247], v[116:119], v[164:167]
    v_mfma_f32_16x16x32_bf16 v[180:183], a[248:251], v[116:119], v[180:183]
    ds_read_b128 a[244:247], v28 offset:22784
    buffer_load_dword v217, v2, s[4:7], s93 offen offset:2304 sc1
    v_mfma_f32_16x16x32_bf16 v[176:179], a[248:251], v[112:115], v[176:179]
    v_mfma_f32_16x16x32_bf16 v[152:155], a[252:255], v[112:115], v[152:155]
    ds_read_b128 a[248:251], v28 offset:51456
    s_waitcnt lgkmcnt(3)
    v_mfma_f32_16x16x32_bf16 v[156:159], a[252:255], v[116:119], v[156:159]
    buffer_load_dword v218, v2, s[4:7], s93 offen offset:2560 sc1
    v_mfma_f32_16x16x32_bf16 v[172:175], a[224:227], v[116:119], v[172:175]
    ds_read_b128 a[252:255], v29 offset:22784
    buffer_load_dword v219, v2, s[4:7], s93 offen offset:2816 sc1
    v_mfma_f32_16x16x32_bf16 v[168:171], a[224:227], v[112:115], v[168:171]
    v_mfma_f32_16x16x32_bf16 v[184:187], a[228:231], v[112:115], v[184:187]
    ds_read_b128 a[224:227], v28 offset:24576
    buffer_load_dword v220, v2, s[4:7], s93 offen offset:3072 sc1
    v_mfma_f32_16x16x32_bf16 v[188:191], a[228:231], v[116:119], v[188:191]
    s_waitcnt vmcnt(17)
    v_mfma_f32_16x16x32_bf16 v[148:151], a[232:235], v[124:127], v[148:151]
    ds_read_b128 a[228:231], v28 offset:53248
    s_add_u32 m0, s55, 0x21000
    s_add_u32 s72, s39, 0x1c000
    buffer_load_dwordx4 v1, s[4:7], s72 offen lds
    v_mfma_f32_16x16x32_bf16 v[144:147], a[232:235], v[120:123], v[144:147]
    buffer_load_dword v221, v2, s[4:7], s93 offen offset:3328 sc1
    buffer_load_dwordx4 a[0:3], v4, s[4:7], s48 offen
    v_mfma_f32_16x16x32_bf16 v[160:163], a[236:239], v[120:123], v[160:163]
    ds_read_b128 a[232:235], v29 offset:24576
    s_waitcnt lgkmcnt(3)
    v_mfma_f32_16x16x32_bf16 v[164:167], a[236:239], v[124:127], v[164:167]
    v_mfma_f32_16x16x32_bf16 v[180:183], a[240:243], v[124:127], v[180:183]
    ds_read_b128 a[236:239], v28 offset:24832
    buffer_load_dwordx4 v1, s[4:7], s72 offen offset:1024 lds
    v_mfma_f32_16x16x32_bf16 v[176:179], a[240:243], v[120:123], v[176:179]
    v_mfma_f32_16x16x32_bf16 v[152:155], a[244:247], v[120:123], v[152:155]
    ds_read_b128 a[240:243], v28 offset:53504
    buffer_load_dwordx4 a[28:31], v4, s[4:7], s48 offen offset:256
    v_mfma_f32_16x16x32_bf16 v[156:159], a[244:247], v[124:127], v[156:159]
    v_mfma_f32_16x16x32_bf16 v[172:175], a[248:251], v[124:127], v[172:175]
    ds_read_b128 a[244:247], v29 offset:24832
    v_mfma_f32_16x16x32_bf16 v[168:171], a[248:251], v[120:123], v[168:171]
    v_mfma_f32_16x16x32_bf16 v[184:187], a[252:255], v[120:123], v[184:187]
    ds_read_b128 a[248:251], v28 offset:26624
    s_waitcnt lgkmcnt(3)
    buffer_load_dwordx4 v1, s[4:7], s72 offen offset:2048 lds
    v_mfma_f32_16x16x32_bf16 v[188:191], a[252:255], v[124:127], v[188:191]
    s_waitcnt vmcnt(20)
    v_mfma_f32_16x16x32_bf16 v[148:151], a[224:227], v[132:135], v[148:151]
    ds_read_b128 a[252:255], v28 offset:55296
    buffer_load_dwordx4 a[112:115], v4, s[4:7], s58 offen
    v_mfma_f32_16x16x32_bf16 v[144:147], a[224:227], v[128:131], v[144:147]
    v_mfma_f32_16x16x32_bf16 v[160:163], a[228:231], v[128:131], v[160:163]
    ds_read_b128 a[224:227], v29 offset:26624
    buffer_load_dwordx4 v1, s[4:7], s72 offen offset:3072 lds
    s_add_u32 m0, s55, 0x22000
    v_mfma_f32_16x16x32_bf16 v[164:167], a[228:231], v[132:135], v[164:167]
    v_mfma_f32_16x16x32_bf16 v[180:183], a[232:235], v[132:135], v[180:183]
    ds_read_b128 a[228:231], v28 offset:26880
    v_mfma_f32_16x16x32_bf16 v[176:179], a[232:235], v[128:131], v[176:179]
    v_mfma_f32_16x16x32_bf16 v[152:155], a[236:239], v[128:131], v[152:155]
    ds_read_b128 a[232:235], v28 offset:55552
    s_waitcnt lgkmcnt(3)
    buffer_load_dwordx4 v0, s[4:7], s72 offen lds
    v_mfma_f32_16x16x32_bf16 v[156:159], a[236:239], v[132:135], v[156:159]
    buffer_load_dwordx4 a[140:143], v4, s[4:7], s58 offen offset:256
    v_mfma_f32_16x16x32_bf16 v[172:175], a[240:243], v[132:135], v[172:175]
    ds_read_b128 a[236:239], v29 offset:26880
    v_mfma_f32_16x16x32_bf16 v[168:171], a[240:243], v[128:131], v[168:171]
    v_mfma_f32_16x16x32_bf16 v[184:187], a[244:247], v[128:131], v[184:187]
    s_barrier
    ds_read_b128 a[240:243], v30 offset:0
    buffer_load_dwordx4 v0, s[4:7], s72 offen offset:1024 lds
    v_mfma_f32_16x16x32_bf16 v[188:191], a[244:247], v[132:135], v[188:191]
    s_waitcnt vmcnt(15)
    v_mfma_f32_16x16x32_bf16 v[148:151], a[248:251], v[140:143], v[148:151]
    ds_read_b128 a[244:247], v30 offset:256
    v_mfma_f32_16x16x32_bf16 v[144:147], a[248:251], v[136:139], v[144:147]
    s_add_u32 s68, s48, 0x3000
    buffer_load_dwordx4 a[56:59], v4, s[4:7], s68 offen offset:2048
    v_mfma_f32_16x16x32_bf16 v[160:163], a[252:255], v[136:139], v[160:163]
    ds_read_b128 a[248:251], v30 offset:2048
    s_waitcnt lgkmcnt(3)
    buffer_load_dwordx4 v0, s[4:7], s72 offen offset:2048 lds
    v_add_f32 v208, v208, v209
    v_mfma_f32_16x16x32_bf16 v[164:167], a[252:255], v[140:143], v[164:167]
    v_add_f32 v210, v210, v211
    v_add_f32 v212, v212, v213
    v_add_f32 v214, v214, v215
    v_mfma_f32_16x16x32_bf16 v[180:183], a[224:227], v[140:143], v[180:183]
    ds_read_b128 a[252:255], v30 offset:2304
    s_waitcnt vmcnt(16)
    v_add_f32 v216, v216, v217
    s_waitcnt vmcnt(14)
    v_add_f32 v218, v218, v219
    v_mfma_f32_16x16x32_bf16 v[176:179], a[224:227], v[136:139], v[176:179]
    s_waitcnt vmcnt(11)
    v_add_f32 v220, v220, v221
    v_add_f32 v208, v208, v210
    v_add_f32 v212, v212, v214
    v_mfma_f32_16x16x32_bf16 v[152:155], a[228:231], v[136:139], v[152:155]
    ds_read_b128 a[224:227], v30 offset:4096
    buffer_load_dwordx4 a[84:87], v4, s[4:7], s68 offen offset:2304
    v_mfma_f32_16x16x32_bf16 v[156:159], a[228:231], v[140:143], v[156:159]
    v_add_f32 v216, v216, v218
    v_add_f32 v208, v208, v212
    v_add_f32 v216, v216, v220
    v_mfma_f32_16x16x32_bf16 v[172:175], a[232:235], v[140:143], v[172:175]
    ds_read_b128 a[228:231], v30 offset:4352
    v_add_f32 v208, v208, v216
    v_mfma_f32_16x16x32_bf16 v[168:171], a[232:235], v[136:139], v[168:171]
    v_mfma_f32_16x16x32_bf16 v[184:187], a[236:239], v[136:139], v[184:187]
    ds_read_b128 a[232:235], v29 offset:28672
    s_waitcnt lgkmcnt(3)
    v_mfma_f32_16x16x32_bf16 v[188:191], a[236:239], v[140:143], v[188:191]
    v_mfma_f32_16x16x32_bf16 v[192:195], a[240:243], v[32:35], 0
    s_add_u32 s68, s58, 0x3000
    buffer_load_dwordx4 a[168:171], v4, s[4:7], s68 offen offset:2048
    v_mfma_f32_16x16x32_bf16 v[196:199], a[240:243], v[36:39], 0
    v_mov_b32 v209, v208
    s_nop 0
    s_barrier
    v_mfma_f32_16x16x32_bf16 v[204:207], a[244:247], v[36:39], 0
    ds_read_b128 a[236:239], v29 offset:28928
    v_permlane32_swap_b32 v208, v209
    v_mfma_f32_16x16x32_bf16 v[200:203], a[244:247], v[32:35], 0
    v_mul_f32 v208, 0xbb124925, v208
    v_mov_b32 v210, 0x3727c5ac
    v_fmac_f32 v210, 0x3b124925, v209
    v_mfma_f32_16x16x32_bf16 v[192:195], a[248:251], v[40:43], v[192:195]
    v_fma_f32 v25, -v208, v208, v210
    v_max_f32 v25, 0x3727c5ac, v25
    v_cvt_pk_bf16_f32 v20, v208, v208
    v_mfma_f32_16x16x32_bf16 v[196:199], a[248:251], v[44:47], v[196:199]
    v_rsq_f32 v24, v25
    v_and_b32 v212, 0xffff0000, v20
    v_mfma_f32_16x16x32_bf16 v[204:207], a[252:255], v[44:47], v[204:207]
    ds_read_b128 a[240:243], v29 offset:30720
    s_waitcnt lgkmcnt(2)
    v_sub_f32 v212, v208, v212
    v_mfma_f32_16x16x32_bf16 v[200:203], a[252:255], v[40:43], v[200:203]
    buffer_load_dwordx4 a[196:199], v4, s[4:7], s68 offen offset:2304
    v_cvt_pk_bf16_f32 v21, v212, v212
    v_mfma_f32_16x16x32_bf16 v[192:195], a[224:227], v[48:51], v[192:195]
    v_mov_b32 v22, v20
    v_mov_b32 v23, v21
    v_mul_f32 v26, 0xbfb8aa3b, v24
    v_mfma_f32_16x16x32_bf16 v[196:199], a[224:227], v[52:55], v[196:199]
    v_permlane16_swap_b32 v20, v22
    v_mfma_f32_16x16x32_bf16 v[204:207], a[228:231], v[52:55], v[204:207]
    ds_read_b128 a[244:247], v30 offset:6144
    v_permlane16_swap_b32 v21, v23
    v_mfma_f32_16x16x32_bf16 v[200:203], a[228:231], v[48:51], v[200:203]
    v_mov_b32 v27, v26
    v_mov_b32 v24, v25
    v_mfma_f32_16x16x16_bf16 v[144:147], a[232:233], v[20:21], v[144:147]
    ds_read_b128 a[248:251], v30 offset:6400
    buffer_load_dwordx4 a[4:7], v4, s[4:7], s48 offen offset:1024
    v_mfma_f32_16x16x16_bf16 v[148:151], a[232:233], v[22:23], v[148:151]
    v_permlane16_swap_b32 v26, v27
    v_mfma_f32_16x16x16_bf16 v[152:155], a[234:235], v[20:21], v[152:155]
    ds_read_b128 a[252:255], v30 offset:8192
    s_waitcnt lgkmcnt(3)
    v_mfma_f32_16x16x16_bf16 v[156:159], a[234:235], v[22:23], v[156:159]
    v_permlane16_swap_b32 v25, v24
    v_mfma_f32_16x16x16_bf16 v[160:163], a[236:237], v[20:21], v[160:163]
    ds_read_b128 a[224:227], v30 offset:8448
    v_mfma_f32_16x16x16_bf16 v[164:167], a[236:237], v[22:23], v[164:167]
    v_mfma_f32_16x16x16_bf16 v[168:171], a[238:239], v[20:21], v[168:171]
    ds_read_b128 a[228:231], v30 offset:10240
    buffer_load_dwordx4 a[32:35], v4, s[4:7], s48 offen offset:1280
    v_mfma_f32_16x16x16_bf16 v[172:175], a[238:239], v[22:23], v[172:175]
    v_mfma_f32_16x16x16_bf16 v[176:179], a[240:241], v[20:21], v[176:179]
    ds_read_b128 a[232:235], v30 offset:10496
    v_mfma_f32_16x16x16_bf16 v[180:183], a[240:241], v[22:23], v[180:183]
    v_pk_mul_f32 v[224:225], v[144:145], v[26:27] op_sel:[0,0] op_sel_hi:[1,0]
    v_pk_mul_f32 v[226:227], v[146:147], v[26:27] op_sel:[0,0] op_sel_hi:[1,0]
    v_pk_mul_f32 v[228:229], v[148:149], v[26:27] op_sel:[0,1] op_sel_hi:[1,1]
    v_pk_mul_f32 v[230:231], v[150:151], v[26:27] op_sel:[0,1] op_sel_hi:[1,1]
    v_pk_mul_f32 v[144:145], v[144:145], v[152:153]
    v_pk_mul_f32 v[146:147], v[146:147], v[154:155]
    v_pk_mul_f32 v[148:149], v[148:149], v[156:157]
    v_pk_mul_f32 v[150:151], v[150:151], v[158:159]
    v_mfma_f32_16x16x16_bf16 v[184:187], a[242:243], v[20:21], v[184:187]
    ds_read_b128 a[236:239], v30 offset:12288
    s_waitcnt lgkmcnt(3)
    v_mfma_f32_16x16x16_bf16 v[188:191], a[242:243], v[22:23], v[188:191]
    v_exp_f32 v224, v224
    v_mfma_f32_16x16x32_bf16 v[192:195], a[244:247], v[56:59], v[192:195]
    ds_read_b128 a[240:243], v30 offset:12544
    buffer_load_dwordx4 a[116:119], v4, s[4:7], s58 offen offset:1024
    v_mfma_f32_16x16x32_bf16 v[196:199], a[244:247], v[60:63], v[196:199]
    v_exp_f32 v225, v225
    v_mfma_f32_16x16x32_bf16 v[204:207], a[248:251], v[60:63], v[204:207]
    ds_read_b128 a[244:247], v30 offset:14336
    v_exp_f32 v226, v226
    v_mfma_f32_16x16x32_bf16 v[200:203], a[248:251], v[56:59], v[200:203]
    v_exp_f32 v227, v227
    v_mfma_f32_16x16x32_bf16 v[192:195], a[252:255], v[64:67], v[192:195]
    ds_read_b128 a[248:251], v30 offset:14592
    v_exp_f32 v228, v228
    v_mfma_f32_16x16x32_bf16 v[196:199], a[252:255], v[68:71], v[196:199]
    v_exp_f32 v229, v229
    v_mfma_f32_16x16x32_bf16 v[204:207], a[224:227], v[68:71], v[204:207]
    ds_read_b128 a[252:255], v30 offset:16384
    s_waitcnt lgkmcnt(3)
    v_mfma_f32_16x16x32_bf16 v[200:203], a[224:227], v[64:67], v[200:203]
    buffer_load_dwordx4 a[144:147], v4, s[4:7], s58 offen offset:1280
    v_mfma_f32_16x16x32_bf16 v[192:195], a[228:231], v[72:75], v[192:195]
    ds_read_b128 a[224:227], v30 offset:16640
    v_mfma_f32_16x16x32_bf16 v[196:199], a[228:231], v[76:79], v[196:199]
    v_exp_f32 v230, v230
    v_exp_f32 v231, v231
    v_pk_fma_f32 v[224:225], v[224:225], v[24:25], v[24:25] op_sel:[0,1,1] op_sel_hi:[1,1,1]
    v_pk_fma_f32 v[226:227], v[226:227], v[24:25], v[24:25] op_sel:[0,1,1] op_sel_hi:[1,1,1]
    v_pk_fma_f32 v[228:229], v[228:229], v[24:25], v[24:25] op_sel:[0,0,0] op_sel_hi:[1,0,0]
    v_pk_fma_f32 v[230:231], v[230:231], v[24:25], v[24:25] op_sel:[0,0,0] op_sel_hi:[1,0,0]
    v_mfma_f32_16x16x32_bf16 v[204:207], a[232:235], v[76:79], v[204:207]
    ds_read_b128 a[228:231], v30 offset:18432
    v_rcp_f32 v224, v224
    v_mfma_f32_16x16x32_bf16 v[200:203], a[232:235], v[72:75], v[200:203]
    v_rcp_f32 v225, v225
    v_mfma_f32_16x16x32_bf16 v[192:195], a[236:239], v[80:83], v[192:195]
    ds_read_b128 a[232:235], v30 offset:18688
    v_rcp_f32 v226, v226
    v_mfma_f32_16x16x32_bf16 v[196:199], a[236:239], v[84:87], v[196:199]
    s_add_u32 s68, s48, 0x3000
    buffer_load_dwordx4 a[60:63], v4, s[4:7], s68 offen offset:3072
    v_mfma_f32_16x16x32_bf16 v[204:207], a[240:243], v[84:87], v[204:207]
    ds_read_b128 a[236:239], v30 offset:20480
    s_waitcnt lgkmcnt(3)
    v_mfma_f32_16x16x32_bf16 v[200:203], a[240:243], v[80:83], v[200:203]
    v_rcp_f32 v227, v227
    v_mfma_f32_16x16x32_bf16 v[192:195], a[244:247], v[88:91], v[192:195]
    ds_read_b128 a[240:243], v30 offset:20736
    v_rcp_f32 v228, v228
    v_mfma_f32_16x16x32_bf16 v[196:199], a[244:247], v[92:95], v[196:199]
    v_rcp_f32 v229, v229
    v_mfma_f32_16x16x32_bf16 v[204:207], a[248:251], v[92:95], v[204:207]
    ds_read_b128 a[244:247], v30 offset:22528
    buffer_load_dwordx4 a[88:91], v4, s[4:7], s68 offen offset:3328
    v_mfma_f32_16x16x32_bf16 v[200:203], a[248:251], v[88:91], v[200:203]
    v_rcp_f32 v230, v230
    v_rcp_f32 v231, v231
    v_pk_mul_f32 v[144:145], v[144:145], v[224:225]
    v_pk_mul_f32 v[146:147], v[146:147], v[226:227]
    v_pk_mul_f32 v[148:149], v[148:149], v[228:229]
    v_pk_mul_f32 v[150:151], v[150:151], v[230:231]
    v_mfma_f32_16x16x32_bf16 v[192:195], a[252:255], v[96:99], v[192:195]
    ds_read_b128 a[248:251], v30 offset:22784
    s_add_u32 m0, s55, 0xe000
    s_add_u32 s73, s39, 0x23000
    buffer_load_dwordx4 v1, s[4:7], s73 offen lds
    v_mfma_f32_16x16x32_bf16 v[196:199], a[252:255], v[100:103], v[196:199]
    v_cvt_pk_bf16_f32 v232, v144, v145
    v_cvt_pk_bf16_f32 v234, v148, v149
    v_cvt_pk_bf16_f32 v233, v146, v147
    v_mfma_f32_16x16x32_bf16 v[204:207], a[224:227], v[100:103], v[204:207]
    ds_read_b128 a[252:255], v30 offset:24576
    s_waitcnt lgkmcnt(3)
    v_cvt_pk_bf16_f32 v235, v150, v151
    v_mfma_f32_16x16x32_bf16 v[200:203], a[224:227], v[96:99], v[200:203]
    v_permlane16_swap_b32 v232, v234
    v_mfma_f32_16x16x32_bf16 v[192:195], a[228:231], v[104:107], v[192:195]
    ds_read_b128 a[224:227], v30 offset:24832
    buffer_load_dwordx4 v1, s[4:7], s73 offen offset:1024 lds
    v_permlane16_swap_b32 v233, v235
    v_mfma_f32_16x16x32_bf16 v[196:199], a[228:231], v[108:111], v[196:199]
    s_add_u32 s68, s58, 0x3000
    buffer_load_dwordx4 a[172:175], v4, s[4:7], s68 offen offset:3072
    v_mfma_f32_16x16x32_bf16 v[204:207], a[232:235], v[108:111], v[204:207]
    ds_read_b128 a[228:231], v30 offset:26624
    buffer_store_dwordx4 v[232:235], v1, s[4:7], s57 offen sc1
    v_mfma_f32_16x16x32_bf16 v[200:203], a[232:235], v[104:107], v[200:203]
    v_pk_mul_f32 v[224:225], v[160:161], v[26:27] op_sel:[0,0] op_sel_hi:[1,0]
    v_pk_mul_f32 v[226:227], v[162:163], v[26:27] op_sel:[0,0] op_sel_hi:[1,0]
    v_pk_mul_f32 v[228:229], v[164:165], v[26:27] op_sel:[0,1] op_sel_hi:[1,1]
    v_pk_mul_f32 v[230:231], v[166:167], v[26:27] op_sel:[0,1] op_sel_hi:[1,1]
    v_pk_mul_f32 v[160:161], v[160:161], v[168:169]
    v_pk_mul_f32 v[162:163], v[162:163], v[170:171]
    v_pk_mul_f32 v[164:165], v[164:165], v[172:173]
    v_pk_mul_f32 v[166:167], v[166:167], v[174:175]
    v_mfma_f32_16x16x32_bf16 v[192:195], a[236:239], v[112:115], v[192:195]
    ds_read_b128 a[232:235], v30 offset:26880
    v_exp_f32 v224, v224
    v_mfma_f32_16x16x32_bf16 v[196:199], a[236:239], v[116:119], v[196:199]
    v_exp_f32 v225, v225
    v_mfma_f32_16x16x32_bf16 v[204:207], a[240:243], v[116:119], v[204:207]
    ds_read_b128 a[236:239], v29 offset:30976
    s_waitcnt lgkmcnt(3)
    buffer_load_dwordx4 v1, s[4:7], s73 offen offset:2048 lds
    v_mfma_f32_16x16x32_bf16 v[200:203], a[240:243], v[112:115], v[200:203]
    buffer_load_dwordx4 a[200:203], v4, s[4:7], s68 offen offset:3328
    v_mfma_f32_16x16x32_bf16 v[192:195], a[244:247], v[120:123], v[192:195]
    v_exp_f32 v226, v226
    v_mfma_f32_16x16x32_bf16 v[196:199], a[244:247], v[124:127], v[196:199]
    v_exp_f32 v227, v227
    v_mfma_f32_16x16x32_bf16 v[204:207], a[248:251], v[124:127], v[204:207]
    s_waitcnt vmcnt(15)
    s_barrier
    ds_read_b128 a[240:243], v30 offset:28672
    v_mfma_f32_16x16x32_bf16 v[200:203], a[248:251], v[120:123], v[200:203]
    buffer_load_dwordx4 v1, s[4:7], s73 offen offset:3072 lds
    s_add_u32 m0, s55, 0xf000
    v_exp_f32 v228, v228
    v_mfma_f32_16x16x32_bf16 v[192:195], a[252:255], v[128:131], v[192:195]
    ds_read_b128 a[244:247], v30 offset:28928
    buffer_load_dwordx4 a[8:11], v4, s[4:7], s48 offen offset:2048
    v_mfma_f32_16x16x32_bf16 v[196:199], a[252:255], v[132:135], v[196:199]
    v_exp_f32 v229, v229
    v_mfma_f32_16x16x32_bf16 v[204:207], a[224:227], v[132:135], v[204:207]
    ds_read_b128 a[248:251], v30 offset:30720
    s_waitcnt lgkmcnt(3)
    buffer_load_dwordx4 v0, s[4:7], s73 offen lds
    v_mfma_f32_16x16x32_bf16 v[200:203], a[224:227], v[128:131], v[200:203]
    v_exp_f32 v230, v230
    v_exp_f32 v231, v231
    v_pk_fma_f32 v[224:225], v[224:225], v[24:25], v[24:25] op_sel:[0,1,1] op_sel_hi:[1,1,1]
    v_pk_fma_f32 v[226:227], v[226:227], v[24:25], v[24:25] op_sel:[0,1,1] op_sel_hi:[1,1,1]
    v_pk_fma_f32 v[228:229], v[228:229], v[24:25], v[24:25] op_sel:[0,0,0] op_sel_hi:[1,0,0]
    v_pk_fma_f32 v[230:231], v[230:231], v[24:25], v[24:25] op_sel:[0,0,0] op_sel_hi:[1,0,0]
    v_mfma_f32_16x16x32_bf16 v[192:195], a[228:231], v[136:139], v[192:195]
    ds_read_b128 a[252:255], v30 offset:30976
    v_rcp_f32 v224, v224
    v_mfma_f32_16x16x32_bf16 v[196:199], a[228:231], v[140:143], v[196:199]
    v_rcp_f32 v225, v225
    v_mfma_f32_16x16x32_bf16 v[204:207], a[232:235], v[140:143], v[204:207]
    ds_read_b128 a[224:227], v30 offset:32768
    buffer_load_dwordx4 v0, s[4:7], s73 offen offset:1024 lds
    buffer_load_dwordx4 a[36:39], v4, s[4:7], s48 offen offset:2304
    v_mfma_f32_16x16x32_bf16 v[200:203], a[232:235], v[136:139], v[200:203]
    v_rcp_f32 v226, v226
    v_mfma_f32_16x16x16_bf16 v[192:195], a[236:237], v[20:21], v[192:195]
    ds_read_b128 a[228:231], v30 offset:33024
    v_rcp_f32 v227, v227
    v_mfma_f32_16x16x16_bf16 v[196:199], a[236:237], v[22:23], v[196:199]
    v_rcp_f32 v228, v228
    v_mfma_f32_16x16x16_bf16 v[200:203], a[238:239], v[20:21], v[200:203]
    ds_read_b128 a[232:235], v30 offset:34816
    s_waitcnt lgkmcnt(3)
    buffer_load_dwordx4 v0, s[4:7], s73 offen offset:2048 lds
    v_mfma_f32_16x16x16_bf16 v[204:207], a[238:239], v[22:23], v[204:207]
    v_rcp_f32 v229, v229
    v_mfma_f32_16x16x32_bf16 v[208:211], a[240:243], v[32:35], 0
    ds_read_b128 a[236:239], v30 offset:35072
    buffer_load_dwordx4 a[120:123], v4, s[4:7], s58 offen offset:2048
    v_mfma_f32_16x16x32_bf16 v[212:215], a[240:243], v[36:39], 0
    v_rcp_f32 v230, v230
    v_rcp_f32 v231, v231
    v_pk_mul_f32 v[160:161], v[160:161], v[224:225]
    v_pk_mul_f32 v[162:163], v[162:163], v[226:227]
    v_pk_mul_f32 v[164:165], v[164:165], v[228:229]
    v_pk_mul_f32 v[166:167], v[166:167], v[230:231]
    v_mfma_f32_16x16x32_bf16 v[220:223], a[244:247], v[36:39], 0
    ds_read_b128 a[240:243], v30 offset:36864
    v_cvt_pk_bf16_f32 v236, v160, v161
    v_cvt_pk_bf16_f32 v238, v164, v165
    v_mfma_f32_16x16x32_bf16 v[216:219], a[244:247], v[32:35], 0
    v_cvt_pk_bf16_f32 v237, v162, v163
    v_cvt_pk_bf16_f32 v239, v166, v167
    s_add_u32 s84, s46, 0x0
    v_mfma_f32_16x16x32_bf16 v[208:211], a[248:251], v[40:43], v[208:211]
    ds_read_b128 a[244:247], v30 offset:37120
    v_permlane16_swap_b32 v236, v238
    v_mfma_f32_16x16x32_bf16 v[212:215], a[248:251], v[44:47], v[212:215]
    v_permlane16_swap_b32 v237, v239
    buffer_store_dwordx4 v[236:239], v1, s[4:7], s57 offen offset:1024 sc1
    v_mfma_f32_16x16x32_bf16 v[220:223], a[252:255], v[44:47], v[220:223]
    ds_read_b128 a[248:251], v30 offset:38912
    s_waitcnt lgkmcnt(3)
    s_add_u32 s85, s47, 0x0
    v_mfma_f32_16x16x32_bf16 v[216:219], a[252:255], v[40:43], v[216:219]
    buffer_load_dwordx4 a[148:151], v4, s[4:7], s58 offen offset:2304
    s_add_u32 s86, s46, 0x1000
    v_mfma_f32_16x16x32_bf16 v[208:211], a[224:227], v[48:51], v[208:211]
    ds_read_b128 a[252:255], v30 offset:39168
    s_add_u32 s87, s47, 0x1000
    s_add_u32 s88, s46, 0xe000
    v_mfma_f32_16x16x32_bf16 v[212:215], a[224:227], v[52:55], v[212:215]
    v_pk_mul_f32 v[224:225], v[176:177], v[26:27] op_sel:[0,0] op_sel_hi:[1,0]
    v_pk_mul_f32 v[226:227], v[178:179], v[26:27] op_sel:[0,0] op_sel_hi:[1,0]
    v_pk_mul_f32 v[228:229], v[180:181], v[26:27] op_sel:[0,1] op_sel_hi:[1,1]
    v_pk_mul_f32 v[230:231], v[182:183], v[26:27] op_sel:[0,1] op_sel_hi:[1,1]
    v_pk_mul_f32 v[176:177], v[176:177], v[184:185]
    v_pk_mul_f32 v[178:179], v[178:179], v[186:187]
    v_pk_mul_f32 v[180:181], v[180:181], v[188:189]
    v_pk_mul_f32 v[182:183], v[182:183], v[190:191]
    v_mfma_f32_16x16x32_bf16 v[220:223], a[228:231], v[52:55], v[220:223]
    ds_read_b128 a[224:227], v30 offset:40960
    v_exp_f32 v224, v224
    v_mfma_f32_16x16x32_bf16 v[216:219], a[228:231], v[48:51], v[216:219]
    v_exp_f32 v225, v225
    s_add_u32 s89, s47, 0xe000
    v_mfma_f32_16x16x32_bf16 v[208:211], a[232:235], v[56:59], v[208:211]
    ds_read_b128 a[228:231], v30 offset:41216
    v_exp_f32 v226, v226
    v_mfma_f32_16x16x32_bf16 v[212:215], a[232:235], v[60:63], v[212:215]
    s_add_u32 s68, s48, 0x4000
    buffer_load_dwordx4 a[64:67], v4, s[4:7], s68 offen
    v_mfma_f32_16x16x32_bf16 v[220:223], a[236:239], v[60:63], v[220:223]
    ds_read_b128 a[232:235], v30 offset:43008
    s_waitcnt lgkmcnt(3)
    s_add_u32 s90, s46, 0xf000
    v_mfma_f32_16x16x32_bf16 v[216:219], a[236:239], v[56:59], v[216:219]
    v_exp_f32 v227, v227
    s_add_u32 s91, s47, 0xf000
    v_mfma_f32_16x16x32_bf16 v[208:211], a[240:243], v[64:67], v[208:211]
    ds_read_b128 a[236:239], v30 offset:43264
    v_exp_f32 v228, v228
    v_mfma_f32_16x16x32_bf16 v[212:215], a[240:243], v[68:71], v[212:215]
    v_exp_f32 v229, v229
    v_mfma_f32_16x16x32_bf16 v[220:223], a[244:247], v[68:71], v[220:223]
    ds_read_b128 a[240:243], v30 offset:45056
    buffer_load_dwordx4 a[92:95], v4, s[4:7], s68 offen offset:256
    v_mfma_f32_16x16x32_bf16 v[216:219], a[244:247], v[64:67], v[216:219]
    v_exp_f32 v230, v230
    v_exp_f32 v231, v231
    v_pk_fma_f32 v[224:225], v[224:225], v[24:25], v[24:25] op_sel:[0,1,1] op_sel_hi:[1,1,1]
    v_pk_fma_f32 v[226:227], v[226:227], v[24:25], v[24:25] op_sel:[0,1,1] op_sel_hi:[1,1,1]
    v_pk_fma_f32 v[228:229], v[228:229], v[24:25], v[24:25] op_sel:[0,0,0] op_sel_hi:[1,0,0]
    v_pk_fma_f32 v[230:231], v[230:231], v[24:25], v[24:25] op_sel:[0,0,0] op_sel_hi:[1,0,0]
    v_mfma_f32_16x16x32_bf16 v[208:211], a[248:251], v[72:75], v[208:211]
    ds_read_b128 a[244:247], v30 offset:45312
    v_rcp_f32 v224, v224
    v_mfma_f32_16x16x32_bf16 v[212:215], a[248:251], v[76:79], v[212:215]
    v_rcp_f32 v225, v225
    v_mfma_f32_16x16x32_bf16 v[220:223], a[252:255], v[76:79], v[220:223]
    ds_read_b128 a[248:251], v30 offset:47104
    s_waitcnt lgkmcnt(3)
    v_mfma_f32_16x16x32_bf16 v[216:219], a[252:255], v[72:75], v[216:219]
    v_rcp_f32 v226, v226
    v_mfma_f32_16x16x32_bf16 v[208:211], a[224:227], v[80:83], v[208:211]
    ds_read_b128 a[252:255], v30 offset:47360
    v_rcp_f32 v227, v227
    v_mfma_f32_16x16x32_bf16 v[212:215], a[224:227], v[84:87], v[212:215]
    s_add_u32 s68, s58, 0x4000
    buffer_load_dwordx4 a[176:179], v4, s[4:7], s68 offen
    v_mfma_f32_16x16x32_bf16 v[220:223], a[228:231], v[84:87], v[220:223]
    ds_read_b128 a[224:227], v30 offset:49152
    v_rcp_f32 v228, v228
    v_mfma_f32_16x16x32_bf16 v[216:219], a[228:231], v[80:83], v[216:219]
    v_rcp_f32 v229, v229
    v_mfma_f32_16x16x32_bf16 v[208:211], a[232:235], v[88:91], v[208:211]
    ds_read_b128 a[228:231], v30 offset:49408
    v_mfma_f32_16x16x32_bf16 v[212:215], a[232:235], v[92:95], v[212:215]
    v_rcp_f32 v230, v230
    v_rcp_f32 v231, v231
    v_pk_mul_f32 v[176:177], v[176:177], v[224:225]
    v_pk_mul_f32 v[178:179], v[178:179], v[226:227]
    v_pk_mul_f32 v[180:181], v[180:181], v[228:229]
    v_pk_mul_f32 v[182:183], v[182:183], v[230:231]
    v_mfma_f32_16x16x32_bf16 v[220:223], a[236:239], v[92:95], v[220:223]
    ds_read_b128 a[232:235], v30 offset:51200
    s_waitcnt lgkmcnt(3)
    v_cvt_pk_bf16_f32 v232, v176, v177
    v_mfma_f32_16x16x32_bf16 v[216:219], a[236:239], v[88:91], v[216:219]
    buffer_load_dwordx4 a[204:207], v4, s[4:7], s68 offen offset:256
    v_cvt_pk_bf16_f32 v234, v180, v181
    v_mfma_f32_16x16x32_bf16 v[208:211], a[240:243], v[96:99], v[208:211]
    ds_read_b128 a[236:239], v30 offset:51456
    s_add_u32 m0, s55, 0x0
    s_add_u32 s74, s39, 0x2a000
    buffer_load_dwordx4 v1, s[4:7], s74 offen lds
    v_mfma_f32_16x16x32_bf16 v[212:215], a[240:243], v[100:103], v[212:215]
    v_cvt_pk_bf16_f32 v233, v178, v179
    v_cvt_pk_bf16_f32 v235, v182, v183
    v_mfma_f32_16x16x32_bf16 v[220:223], a[244:247], v[100:103], v[220:223]
    ds_read_b128 a[240:243], v30 offset:53248
    v_permlane16_swap_b32 v232, v234
    v_mfma_f32_16x16x32_bf16 v[216:219], a[244:247], v[96:99], v[216:219]
    v_permlane16_swap_b32 v233, v235
    buffer_store_dwordx4 v[232:235], v1, s[4:7], s57 offen offset:2048 sc1
    v_mfma_f32_16x16x32_bf16 v[208:211], a[248:251], v[104:107], v[208:211]
    ds_read_b128 a[244:247], v30 offset:53504
    buffer_load_dwordx4 v1, s[4:7], s74 offen offset:1024 lds
    buffer_load_dwordx4 a[124:127], v4, s[4:7], s58 offen offset:3072
    v_mfma_f32_16x16x32_bf16 v[212:215], a[248:251], v[108:111], v[212:215]
    v_pk_mul_f32 v[224:225], v[192:193], v[26:27] op_sel:[0,0] op_sel_hi:[1,0]
    v_pk_mul_f32 v[226:227], v[194:195], v[26:27] op_sel:[0,0] op_sel_hi:[1,0]
    v_pk_mul_f32 v[228:229], v[196:197], v[26:27] op_sel:[0,1] op_sel_hi:[1,1]
    v_pk_mul_f32 v[230:231], v[198:199], v[26:27] op_sel:[0,1] op_sel_hi:[1,1]
    v_pk_mul_f32 v[192:193], v[192:193], v[200:201]
    v_pk_mul_f32 v[194:195], v[194:195], v[202:203]
    v_pk_mul_f32 v[196:197], v[196:197], v[204:205]
    v_pk_mul_f32 v[198:199], v[198:199], v[206:207]
    v_mfma_f32_16x16x32_bf16 v[220:223], a[252:255], v[108:111], v[220:223]
    ds_read_b128 a[248:251], v30 offset:55296
    s_waitcnt lgkmcnt(3)
    v_mfma_f32_16x16x32_bf16 v[216:219], a[252:255], v[104:107], v[216:219]
    v_exp_f32 v224, v224
    v_mfma_f32_16x16x32_bf16 v[208:211], a[224:227], v[112:115], v[208:211]
    ds_read_b128 a[252:255], v30 offset:55552
    v_exp_f32 v225, v225
    v_mfma_f32_16x16x32_bf16 v[212:215], a[224:227], v[116:119], v[212:215]
    v_exp_f32 v226, v226
    v_mfma_f32_16x16x32_bf16 v[220:223], a[228:231], v[116:119], v[220:223]
    ds_read_b128 a[224:227], v29 offset:32768
    buffer_load_dwordx4 v1, s[4:7], s74 offen offset:2048 lds
    buffer_load_dwordx4 a[152:155], v4, s[4:7], s58 offen offset:3328
    v_mfma_f32_16x16x32_bf16 v[216:219], a[228:231], v[112:115], v[216:219]
    v_exp_f32 v227, v227
    v_mfma_f32_16x16x32_bf16 v[208:211], a[232:235], v[120:123], v[208:211]
    v_exp_f32 v228, v228
    v_mfma_f32_16x16x32_bf16 v[212:215], a[232:235], v[124:127], v[212:215]
    v_exp_f32 v229, v229
    v_mfma_f32_16x16x32_bf16 v[220:223], a[236:239], v[124:127], v[220:223]
    s_waitcnt vmcnt(13)
    s_barrier
    ds_read_b128 a[228:231], v29 offset:0
    v_mfma_f32_16x16x32_bf16 v[216:219], a[236:239], v[120:123], v[216:219]
    s_waitcnt lgkmcnt(2)
    v_or_b32_e64 v9, s3, 1
    s_waitcnt vmcnt(11)
    buffer_store_dword v9, v6, s[4:7], s54 offen offset:512 sc1
    buffer_load_dwordx4 v1, s[4:7], s74 offen offset:3072 lds
    s_add_u32 m0, s55, 0x1000
    v_mfma_f32_16x16x32_bf16 v[208:211], a[240:243], v[128:131], v[208:211]
    ds_read_b128 a[232:235], v29 offset:256
    v_mfma_f32_16x16x32_bf16 v[212:215], a[240:243], v[132:135], v[212:215]
    s_add_u32 s68, s58, 0x4000
    buffer_load_dwordx4 a[180:183], v4, s[4:7], s68 offen offset:1024
    v_mfma_f32_16x16x32_bf16 v[220:223], a[244:247], v[132:135], v[220:223]
    ds_read_b128 a[236:239], v29 offset:2048
    buffer_load_dwordx4 v0, s[4:7], s74 offen lds
    v_mfma_f32_16x16x32_bf16 v[216:219], a[244:247], v[128:131], v[216:219]
    v_exp_f32 v230, v230
    v_exp_f32 v231, v231
    v_pk_fma_f32 v[224:225], v[224:225], v[24:25], v[24:25] op_sel:[0,1,1] op_sel_hi:[1,1,1]
    v_pk_fma_f32 v[226:227], v[226:227], v[24:25], v[24:25] op_sel:[0,1,1] op_sel_hi:[1,1,1]
    v_pk_fma_f32 v[228:229], v[228:229], v[24:25], v[24:25] op_sel:[0,0,0] op_sel_hi:[1,0,0]
    v_pk_fma_f32 v[230:231], v[230:231], v[24:25], v[24:25] op_sel:[0,0,0] op_sel_hi:[1,0,0]
    v_mfma_f32_16x16x32_bf16 v[208:211], a[248:251], v[136:139], v[208:211]
    ds_read_b128 a[240:243], v29 offset:2304
    v_rcp_f32 v224, v224
    v_mfma_f32_16x16x32_bf16 v[212:215], a[248:251], v[140:143], v[212:215]
    v_rcp_f32 v225, v225
    v_mfma_f32_16x16x32_bf16 v[220:223], a[252:255], v[140:143], v[220:223]
    ds_read_b128 a[244:247], v29 offset:4096
    s_waitcnt lgkmcnt(3)
    buffer_load_dwordx4 v0, s[4:7], s74 offen offset:1024 lds
    v_mfma_f32_16x16x32_bf16 v[216:219], a[252:255], v[136:139], v[216:219]
    buffer_load_dwordx4 a[208:211], v4, s[4:7], s68 offen offset:1280
    v_mfma_f32_16x16x16_bf16 v[208:211], a[224:225], v[20:21], v[208:211]
    ds_read_b128 a[248:251], v29 offset:4352
    v_rcp_f32 v226, v226
    v_mfma_f32_16x16x16_bf16 v[212:215], a[224:225], v[22:23], v[212:215]
    v_rcp_f32 v227, v227
    v_mfma_f32_16x16x16_bf16 v[216:219], a[226:227], v[20:21], v[216:219]
    ds_read_b128 a[252:255], v29 offset:6144
    buffer_load_dwordx4 v0, s[4:7], s74 offen offset:2048 lds
    buffer_load_dwordx4 a[12:15], v4, s[4:7], s48 offen offset:3072
    v_mfma_f32_16x16x16_bf16 v[220:223], a[226:227], v[22:23], v[220:223]
    v_rcp_f32 v228, v228
    v_mfma_f32_16x16x32_bf16 v[144:147], a[228:231], v[32:35], 0
    ds_read_b128 a[224:227], v29 offset:6400
    v_rcp_f32 v229, v229
    v_mfma_f32_16x16x32_bf16 v[148:151], a[228:231], v[36:39], 0
    v_rcp_f32 v230, v230
    v_rcp_f32 v231, v231
    v_pk_mul_f32 v[192:193], v[192:193], v[224:225]
    v_pk_mul_f32 v[194:195], v[194:195], v[226:227]
    v_pk_mul_f32 v[196:197], v[196:197], v[228:229]
    v_pk_mul_f32 v[198:199], v[198:199], v[230:231]
    v_mfma_f32_16x16x32_bf16 v[156:159], a[232:235], v[36:39], 0
    ds_read_b128 a[228:231], v29 offset:8192
    s_waitcnt lgkmcnt(3)
    v_cvt_pk_bf16_f32 v236, v192, v193
    v_mfma_f32_16x16x32_bf16 v[152:155], a[232:235], v[32:35], 0
    v_cvt_pk_bf16_f32 v238, v196, v197
    v_cvt_pk_bf16_f32 v237, v194, v195
    v_cvt_pk_bf16_f32 v239, v198, v199
    v_mfma_f32_16x16x32_bf16 v[144:147], a[236:239], v[40:43], v[144:147]
    ds_read_b128 a[232:235], v29 offset:8448
    buffer_load_dwordx4 a[40:43], v4, s[4:7], s48 offen offset:3328
    v_mfma_f32_16x16x32_bf16 v[148:151], a[236:239], v[44:47], v[148:151]
    v_permlane16_swap_b32 v236, v238
    v_mfma_f32_16x16x32_bf16 v[156:159], a[240:243], v[44:47], v[156:159]
    ds_read_b128 a[236:239], v29 offset:10240
    v_permlane16_swap_b32 v237, v239
    v_mfma_f32_16x16x32_bf16 v[152:155], a[240:243], v[40:43], v[152:155]
    buffer_store_dwordx4 v[236:239], v1, s[4:7], s57 offen offset:3072 sc1
    v_permlane16_swap_b32 v12, v14
    v_mfma_f32_16x16x32_bf16 v[144:147], a[244:247], v[48:51], v[144:147]
    ds_read_b128 a[240:243], v29 offset:10496
    v_permlane16_swap_b32 v13, v15
    v_mfma_f32_16x16x32_bf16 v[148:151], a[244:247], v[52:55], v[148:151]
    v_permlane16_swap_b32 v16, v18
    v_mfma_f32_16x16x32_bf16 v[156:159], a[248:251], v[52:55], v[156:159]
    ds_read_b128 a[244:247], v29 offset:12288
    s_waitcnt lgkmcnt(3)
    v_mfma_f32_16x16x32_bf16 v[152:155], a[248:251], v[48:51], v[152:155]
    s_add_u32 s68, s48, 0x4000
    buffer_load_dwordx4 a[68:71], v4, s[4:7], s68 offen offset:1024
    v_mfma_f32_16x16x32_bf16 v[144:147], a[252:255], v[56:59], v[144:147]
    ds_read_b128 a[248:251], v29 offset:12544
    v_permlane16_swap_b32 v17, v19
    v_mfma_f32_16x16x32_bf16 v[148:151], a[252:255], v[60:63], v[148:151]
    v_lshlrev_b32 v176, 16, v12
    v_and_b32 v177, 0xffff0000, v12
    v_lshlrev_b32 v178, 16, v13
    v_mfma_f32_16x16x32_bf16 v[156:159], a[224:227], v[60:63], v[156:159]
    ds_read_b128 a[252:255], v29 offset:14336
    v_and_b32 v179, 0xffff0000, v13
    v_lshlrev_b32 v180, 16, v14
    v_mfma_f32_16x16x32_bf16 v[152:155], a[224:227], v[56:59], v[152:155]
    v_and_b32 v181, 0xffff0000, v14
    v_lshlrev_b32 v182, 16, v15
    v_and_b32 v183, 0xffff0000, v15
    v_mfma_f32_16x16x32_bf16 v[144:147], a[228:231], v[64:67], v[144:147]
    ds_read_b128 a[224:227], v29 offset:14592
    buffer_load_dwordx4 a[96:99], v4, s[4:7], s68 offen offset:1280
    v_mfma_f32_16x16x32_bf16 v[148:151], a[228:231], v[68:71], v[148:151]
    v_lshlrev_b32 v184, 16, v16
    v_and_b32 v185, 0xffff0000, v16
    v_lshlrev_b32 v186, 16, v17
    v_mfma_f32_16x16x32_bf16 v[156:159], a[232:235], v[68:71], v[156:159]
    ds_read_b128 a[228:231], v29 offset:16384
    s_waitcnt lgkmcnt(3)
    v_and_b32 v187, 0xffff0000, v17
    v_mfma_f32_16x16x32_bf16 v[152:155], a[232:235], v[64:67], v[152:155]
    v_lshlrev_b32 v188, 16, v18
    v_and_b32 v189, 0xffff0000, v18
    v_lshlrev_b32 v190, 16, v19
    v_mfma_f32_16x16x32_bf16 v[144:147], a[236:239], v[72:75], v[144:147]
    ds_read_b128 a[232:235], v29 offset:16640
    v_and_b32 v191, 0xffff0000, v19
    v_mfma_f32_16x16x32_bf16 v[148:151], a[236:239], v[76:79], v[148:151]
    v_pk_mul_f32 v[224:225], v[208:209], v[26:27] op_sel:[0,0] op_sel_hi:[1,0]
    v_pk_mul_f32 v[226:227], v[210:211], v[26:27] op_sel:[0,0] op_sel_hi:[1,0]
    v_pk_mul_f32 v[228:229], v[212:213], v[26:27] op_sel:[0,1] op_sel_hi:[1,1]
    v_pk_mul_f32 v[230:231], v[214:215], v[26:27] op_sel:[0,1] op_sel_hi:[1,1]
    v_pk_mul_f32 v[208:209], v[208:209], v[216:217]
    v_pk_mul_f32 v[210:211], v[210:211], v[218:219]
    v_pk_mul_f32 v[212:213], v[212:213], v[220:221]
    v_pk_mul_f32 v[214:215], v[214:215], v[222:223]
    v_mfma_f32_16x16x32_bf16 v[156:159], a[240:243], v[76:79], v[156:159]
    ds_read_b128 a[236:239], v29 offset:18432
    v_exp_f32 v224, v224
    v_mfma_f32_16x16x32_bf16 v[152:155], a[240:243], v[72:75], v[152:155]
    s_add_u32 s68, s58, 0x1000
    buffer_load_dwordx4 a[128:131], v4, s[4:7], s68 offen
    v_mfma_f32_16x16x32_bf16 v[144:147], a[244:247], v[80:83], v[144:147]
    ds_read_b128 a[240:243], v29 offset:18688
    v_exp_f32 v225, v225
    v_mfma_f32_16x16x32_bf16 v[148:151], a[244:247], v[84:87], v[148:151]
    v_exp_f32 v226, v226
    v_mfma_f32_16x16x32_bf16 v[156:159], a[248:251], v[84:87], v[156:159]
    ds_read_b128 a[244:247], v29 offset:20480
    s_waitcnt lgkmcnt(3)
    v_mfma_f32_16x16x32_bf16 v[152:155], a[248:251], v[80:83], v[152:155]
    v_exp_f32 v227, v227
    v_mfma_f32_16x16x32_bf16 v[144:147], a[252:255], v[88:91], v[144:147]
    ds_read_b128 a[248:251], v29 offset:20736
    buffer_load_dwordx4 a[156:159], v4, s[4:7], s68 offen offset:256
    v_mfma_f32_16x16x32_bf16 v[148:151], a[252:255], v[92:95], v[148:151]
    v_exp_f32 v228, v228
    v_mfma_f32_16x16x32_bf16 v[156:159], a[224:227], v[92:95], v[156:159]
    ds_read_b128 a[252:255], v29 offset:22528
    v_exp_f32 v229, v229
    v_mfma_f32_16x16x32_bf16 v[152:155], a[224:227], v[88:91], v[152:155]
    v_exp_f32 v230, v230
    v_exp_f32 v231, v231
    v_pk_fma_f32 v[224:225], v[224:225], v[24:25], v[24:25] op_sel:[0,1,1] op_sel_hi:[1,1,1]
    v_pk_fma_f32 v[226:227], v[226:227], v[24:25], v[24:25] op_sel:[0,1,1] op_sel_hi:[1,1,1]
    v_pk_fma_f32 v[228:229], v[228:229], v[24:25], v[24:25] op_sel:[0,0,0] op_sel_hi:[1,0,0]
    v_pk_fma_f32 v[230:231], v[230:231], v[24:25], v[24:25] op_sel:[0,0,0] op_sel_hi:[1,0,0]
    v_mfma_f32_16x16x32_bf16 v[144:147], a[228:231], v[96:99], v[144:147]
    ds_read_b128 a[224:227], v29 offset:22784
    v_rcp_f32 v224, v224
    v_mfma_f32_16x16x32_bf16 v[148:151], a[228:231], v[100:103], v[148:151]
    v_rcp_f32 v225, v225
    v_mfma_f32_16x16x32_bf16 v[156:159], a[232:235], v[100:103], v[156:159]
    ds_read_b128 a[228:231], v29 offset:24576
    s_waitcnt lgkmcnt(3)
    v_mfma_f32_16x16x32_bf16 v[152:155], a[232:235], v[96:99], v[152:155]
    s_add_u32 s68, s58, 0x4000
    buffer_load_dwordx4 a[184:187], v4, s[4:7], s68 offen offset:2048
    v_mfma_f32_16x16x32_bf16 v[144:147], a[236:239], v[104:107], v[144:147]
    ds_read_b128 a[232:235], v29 offset:24832
    v_rcp_f32 v226, v226
    v_mfma_f32_16x16x32_bf16 v[148:151], a[236:239], v[108:111], v[148:151]
    v_rcp_f32 v227, v227
    v_mfma_f32_16x16x32_bf16 v[156:159], a[240:243], v[108:111], v[156:159]
    ds_read_b128 a[236:239], v29 offset:26624
    buffer_load_dword v8, v10, s[4:7], s56 offen offset:512 sc1
    v_mfma_f32_16x16x32_bf16 v[152:155], a[240:243], v[104:107], v[152:155]
    s_add_u32 s44, s3, 1
    v_rcp_f32 v228, v228
    v_mfma_f32_16x16x32_bf16 v[144:147], a[244:247], v[112:115], v[144:147]
    ds_read_b128 a[240:243], v29 offset:26880
    buffer_load_dwordx4 a[212:215], v4, s[4:7], s68 offen offset:2304
    v_mfma_f32_16x16x32_bf16 v[148:151], a[244:247], v[116:119], v[148:151]
    v_rcp_f32 v229, v229
    v_mfma_f32_16x16x32_bf16 v[156:159], a[248:251], v[116:119], v[156:159]
    ds_read_b128 a[244:247], v29 offset:33024
    s_waitcnt lgkmcnt(3)
    v_mfma_f32_16x16x32_bf16 v[152:155], a[248:251], v[112:115], v[152:155]
    v_rcp_f32 v230, v230
    v_rcp_f32 v231, v231
    v_pk_mul_f32 v[208:209], v[208:209], v[224:225]
    v_pk_mul_f32 v[210:211], v[210:211], v[226:227]
    v_pk_mul_f32 v[212:213], v[212:213], v[228:229]
    v_pk_mul_f32 v[214:215], v[214:215], v[230:231]
    v_mfma_f32_16x16x32_bf16 v[144:147], a[252:255], v[120:123], v[144:147]
    v_cvt_pk_bf16_f32 v232, v208, v209
    v_cvt_pk_bf16_f32 v234, v212, v213
    v_cvt_pk_bf16_f32 v233, v210, v211
    v_mfma_f32_16x16x32_bf16 v[148:151], a[252:255], v[124:127], v[148:151]
    v_cvt_pk_bf16_f32 v235, v214, v215
    v_permlane16_swap_b32 v232, v234
    v_mfma_f32_16x16x32_bf16 v[156:159], a[224:227], v[124:127], v[156:159]
    s_waitcnt vmcnt(10)
    s_barrier
    ds_read_b128 a[248:251], v28 offset:0
    v_mfma_f32_16x16x32_bf16 v[152:155], a[224:227], v[120:123], v[152:155]
    s_add_u32 s68, s48, 0x1000
    buffer_load_dwordx4 a[16:19], v4, s[4:7], s68 offen
    v_mfma_f32_16x16x32_bf16 v[144:147], a[228:231], v[128:131], v[144:147]
    ds_read_b128 a[252:255], v28 offset:256
    v_permlane16_swap_b32 v233, v235
    v_mfma_f32_16x16x32_bf16 v[148:151], a[228:231], v[132:135], v[148:151]
    buffer_store_dwordx4 v[232:235], v0, s[4:7], s57 offen sc1
    v_mfma_f32_16x16x32_bf16 v[156:159], a[232:235], v[132:135], v[156:159]
    ds_read_b128 a[224:227], v28 offset:2048
    s_waitcnt lgkmcnt(3)
    v_mfma_f32_16x16x32_bf16 v[152:155], a[232:235], v[128:131], v[152:155]
    v_mfma_f32_16x16x32_bf16 v[144:147], a[236:239], v[136:139], v[144:147]
    ds_read_b128 a[228:231], v28 offset:2304
    buffer_load_dwordx4 a[44:47], v4, s[4:7], s68 offen offset:256
    v_mfma_f32_16x16x32_bf16 v[148:151], a[236:239], v[140:143], v[148:151]
    v_mfma_f32_16x16x32_bf16 v[156:159], a[240:243], v[140:143], v[156:159]
    ds_read_b128 a[232:235], v28 offset:4096
    v_mfma_f32_16x16x32_bf16 v[152:155], a[240:243], v[136:139], v[152:155]
    v_mfma_f32_16x16x16_bf16 v[144:147], a[244:245], v[20:21], v[144:147]
    ds_read_b128 a[236:239], v28 offset:4352
    v_mfma_f32_16x16x16_bf16 v[148:151], a[244:245], v[22:23], v[148:151]
    v_mfma_f32_16x16x16_bf16 v[152:155], a[246:247], v[20:21], v[152:155]
    ds_read_b128 a[240:243], v28 offset:6144
    s_waitcnt lgkmcnt(3)
    v_mfma_f32_16x16x16_bf16 v[156:159], a[246:247], v[22:23], v[156:159]
    s_add_u32 s68, s48, 0x4000
    buffer_load_dwordx4 a[72:75], v4, s[4:7], s68 offen offset:2048
    v_mfma_f32_16x16x32_bf16 v[160:163], a[248:251], v[32:35], 0
    ds_read_b128 a[244:247], v28 offset:6400
    v_mfma_f32_16x16x32_bf16 v[164:167], a[248:251], v[36:39], 0
    s_waitcnt vmcnt(5)
    v_subrev_u32 v8, s44, v8
    v_cmp_le_u32 vcc, 16, v8
    s_cbranch_vccnz Lfs_287
Lc_288:
    v_mfma_f32_16x16x32_bf16 v[172:175], a[252:255], v[36:39], 0
    ds_read_b128 a[248:251], v28 offset:8192
    buffer_load_dwordx4 v[240:243], v5, s[4:7], s84 offen sc1
    v_mfma_f32_16x16x32_bf16 v[168:171], a[252:255], v[32:35], 0
    buffer_load_dwordx4 v[244:247], v5, s[4:7], s84 offen offset:256 sc1
    buffer_load_dwordx4 v[248:251], v5, s[4:7], s88 offen sc1
    buffer_load_dwordx4 v[252:255], v5, s[4:7], s88 offen offset:256 sc1
    s_barrier
    v_mfma_f32_16x16x32_bf16 v[160:163], a[224:227], v[40:43], v[160:163]
    ds_read_b128 a[252:255], v28 offset:8448
    v_mfma_f32_16x16x32_bf16 v[164:167], a[224:227], v[44:47], v[164:167]
    v_or_b32_e64 v9, s3, 3
    buffer_store_dword v9, v6, s[4:7], s54 offen offset:512 sc1
    buffer_load_dwordx4 v[32:35], v5, s[4:7], s84 offen offset:1024 sc1
    buffer_load_dwordx4 a[100:103], v4, s[4:7], s68 offen offset:2304
    v_mfma_f32_16x16x32_bf16 v[172:175], a[228:231], v[44:47], v[172:175]
    ds_read_b128 a[224:227], v28 offset:10240
    s_waitcnt lgkmcnt(3)
    v_mfma_f32_16x16x32_bf16 v[168:171], a[228:231], v[40:43], v[168:171]
    buffer_load_dwordx4 v[36:39], v5, s[4:7], s84 offen offset:1280 sc1
    v_mfma_f32_16x16x32_bf16 v[160:163], a[232:235], v[48:51], v[160:163]
    ds_read_b128 a[228:231], v28 offset:10496
    v_mfma_f32_16x16x32_bf16 v[164:167], a[232:235], v[52:55], v[164:167]
    v_pk_mul_f32 v[224:225], v[144:145], v[26:27] op_sel:[0,0] op_sel_hi:[1,0]
    v_pk_mul_f32 v[226:227], v[146:147], v[26:27] op_sel:[0,0] op_sel_hi:[1,0]
    v_pk_mul_f32 v[228:229], v[148:149], v[26:27] op_sel:[0,1] op_sel_hi:[1,1]
    v_pk_mul_f32 v[230:231], v[150:151], v[26:27] op_sel:[0,1] op_sel_hi:[1,1]
    v_pk_mul_f32 v[144:145], v[144:145], v[152:153]
    v_pk_mul_f32 v[146:147], v[146:147], v[154:155]
    v_pk_mul_f32 v[148:149], v[148:149], v[156:157]
    v_pk_mul_f32 v[150:151], v[150:151], v[158:159]
    v_mfma_f32_16x16x32_bf16 v[172:175], a[236:239], v[52:55], v[172:175]
    ds_read_b128 a[232:235], v28 offset:12288
    buffer_load_dwordx4 v[40:43], v5, s[4:7], s88 offen offset:1024 sc1
    v_mfma_f32_16x16x32_bf16 v[168:171], a[236:239], v[48:51], v[168:171]
    s_add_u32 s68, s58, 0x1000
    buffer_load_dwordx4 a[132:135], v4, s[4:7], s68 offen offset:1024
    v_mfma_f32_16x16x32_bf16 v[160:163], a[240:243], v[56:59], v[160:163]
    ds_read_b128 a[236:239], v28 offset:12544
    v_exp_f32 v224, v224
    v_mfma_f32_16x16x32_bf16 v[164:167], a[240:243], v[60:63], v[164:167]
    v_exp_f32 v225, v225
    v_mfma_f32_16x16x32_bf16 v[172:175], a[244:247], v[60:63], v[172:175]
    ds_read_b128 a[240:243], v28 offset:14336
    s_waitcnt lgkmcnt(3)
    v_mfma_f32_16x16x32_bf16 v[168:171], a[244:247], v[56:59], v[168:171]
    buffer_load_dwordx4 v[44:47], v5, s[4:7], s88 offen offset:1280 sc1
    v_mfma_f32_16x16x32_bf16 v[160:163], a[248:251], v[64:67], v[160:163]
    ds_read_b128 a[244:247], v28 offset:14592
    buffer_load_dwordx4 a[160:163], v4, s[4:7], s68 offen offset:1280
    v_mfma_f32_16x16x32_bf16 v[164:167], a[248:251], v[68:71], v[164:167]
    v_exp_f32 v226, v226
    v_mfma_f32_16x16x32_bf16 v[172:175], a[252:255], v[68:71], v[172:175]
    ds_read_b128 a[248:251], v28 offset:16384
    buffer_load_dwordx4 v[48:51], v5, s[4:7], s85 offen sc1
    v_mfma_f32_16x16x32_bf16 v[168:171], a[252:255], v[64:67], v[168:171]
    v_exp_f32 v227, v227
    v_mfma_f32_16x16x32_bf16 v[160:163], a[224:227], v[72:75], v[160:163]
    ds_read_b128 a[252:255], v28 offset:16640
    v_exp_f32 v228, v228
    v_mfma_f32_16x16x32_bf16 v[164:167], a[224:227], v[76:79], v[164:167]
    v_exp_f32 v229, v229
    v_mfma_f32_16x16x32_bf16 v[172:175], a[228:231], v[76:79], v[172:175]
    ds_read_b128 a[224:227], v28 offset:18432
    s_waitcnt lgkmcnt(3)
    v_mfma_f32_16x16x32_bf16 v[168:171], a[228:231], v[72:75], v[168:171]
    buffer_load_dwordx4 v[52:55], v5, s[4:7], s85 offen offset:256 sc1
    s_add_u32 s68, s58, 0x4000
    buffer_load_dwordx4 a[188:191], v4, s[4:7], s68 offen offset:3072
    v_mfma_f32_16x16x32_bf16 v[160:163], a[232:235], v[80:83], v[160:163]
    ds_read_b128 a[228:231], v28 offset:18688
    v_mfma_f32_16x16x32_bf16 v[164:167], a[232:235], v[84:87], v[164:167]
    v_exp_f32 v230, v230
    v_exp_f32 v231, v231
    v_pk_fma_f32 v[224:225], v[224:225], v[24:25], v[24:25] op_sel:[0,1,1] op_sel_hi:[1,1,1]
    v_pk_fma_f32 v[226:227], v[226:227], v[24:25], v[24:25] op_sel:[0,1,1] op_sel_hi:[1,1,1]
    v_pk_fma_f32 v[228:229], v[228:229], v[24:25], v[24:25] op_sel:[0,0,0] op_sel_hi:[1,0,0]
    v_pk_fma_f32 v[230:231], v[230:231], v[24:25], v[24:25] op_sel:[0,0,0] op_sel_hi:[1,0,0]
    v_mfma_f32_16x16x32_bf16 v[172:175], a[236:239], v[84:87], v[172:175]
    ds_read_b128 a[232:235], v28 offset:20480
    buffer_load_dwordx4 v[56:59], v5, s[4:7], s89 offen sc1
    v_mfma_f32_16x16x32_bf16 v[168:171], a[236:239], v[80:83], v[168:171]
    v_rcp_f32 v224, v224
    v_mfma_f32_16x16x32_bf16 v[160:163], a[240:243], v[88:91], v[160:163]
    ds_read_b128 a[236:239], v28 offset:20736
    buffer_load_dwordx4 a[216:219], v4, s[4:7], s68 offen offset:3328
    v_mfma_f32_16x16x32_bf16 v[164:167], a[240:243], v[92:95], v[164:167]
    v_rcp_f32 v225, v225
    v_mfma_f32_16x16x32_bf16 v[172:175], a[244:247], v[92:95], v[172:175]
    ds_read_b128 a[240:243], v28 offset:22528
    s_waitcnt lgkmcnt(3)
    v_mfma_f32_16x16x32_bf16 v[168:171], a[244:247], v[88:91], v[168:171]
    buffer_load_dword v8, v10, s[4:7], s56 offen offset:512 sc1
    s_add_u32 s44, s3, 3
    buffer_load_dwordx4 v[60:63], v5, s[4:7], s89 offen offset:256 sc1
    v_mfma_f32_16x16x32_bf16 v[160:163], a[248:251], v[96:99], v[160:163]
    ds_read_b128 a[244:247], v28 offset:22784
    v_rcp_f32 v226, v226
    v_mfma_f32_16x16x32_bf16 v[164:167], a[248:251], v[100:103], v[164:167]
    v_rcp_f32 v227, v227
    v_mfma_f32_16x16x32_bf16 v[172:175], a[252:255], v[100:103], v[172:175]
    ds_read_b128 a[248:251], v28 offset:24576
    buffer_load_dwordx4 v[64:67], v5, s[4:7], s85 offen offset:1024 sc1
    v_mfma_f32_16x16x32_bf16 v[168:171], a[252:255], v[96:99], v[168:171]
    s_add_u32 s68, s48, 0x1000
    buffer_load_dwordx4 a[20:23], v4, s[4:7], s68 offen offset:1024
    v_mfma_f32_16x16x32_bf16 v[160:163], a[224:227], v[104:107], v[160:163]
    ds_read_b128 a[252:255], v28 offset:24832
    v_rcp_f32 v228, v228
    v_mfma_f32_16x16x32_bf16 v[164:167], a[224:227], v[108:111], v[164:167]
    v_rcp_f32 v229, v229
    v_mfma_f32_16x16x32_bf16 v[172:175], a[228:231], v[108:111], v[172:175]
    ds_read_b128 a[224:227], v28 offset:26624
    s_waitcnt lgkmcnt(3)
    v_mfma_f32_16x16x32_bf16 v[168:171], a[228:231], v[104:107], v[168:171]
    buffer_load_dwordx4 v[68:71], v5, s[4:7], s85 offen offset:1280 sc1
    v_mfma_f32_16x16x32_bf16 v[160:163], a[232:235], v[112:115], v[160:163]
    ds_read_b128 a[228:231], v28 offset:26880
    v_mfma_f32_16x16x32_bf16 v[164:167], a[232:235], v[116:119], v[164:167]
    v_or_b32_e64 v9, s3, 4
    s_waitcnt vmcnt(24)
    buffer_store_dword v9, v6, s[4:7], s54 offen offset:512 sc1
    buffer_load_dwordx4 a[48:51], v4, s[4:7], s68 offen offset:1280
    v_mfma_f32_16x16x32_bf16 v[172:175], a[236:239], v[116:119], v[172:175]
    ds_read_b128 a[232:235], v29 offset:34816
    buffer_load_dwordx4 v[72:75], v5, s[4:7], s89 offen offset:1024 sc1
    v_mfma_f32_16x16x32_bf16 v[168:171], a[236:239], v[112:115], v[168:171]
    v_rcp_f32 v230, v230
    v_rcp_f32 v231, v231
    v_pk_mul_f32 v[144:145], v[144:145], v[224:225]
    v_pk_mul_f32 v[146:147], v[146:147], v[226:227]
    v_pk_mul_f32 v[148:149], v[148:149], v[228:229]
    v_pk_mul_f32 v[150:151], v[150:151], v[230:231]
    v_mfma_f32_16x16x32_bf16 v[160:163], a[240:243], v[120:123], v[160:163]
    v_cvt_pk_bf16_f32 v236, v144, v145
    v_cvt_pk_bf16_f32 v238, v148, v149
    v_cvt_pk_bf16_f32 v237, v146, v147
    v_mfma_f32_16x16x32_bf16 v[164:167], a[240:243], v[124:127], v[164:167]
    v_cvt_pk_bf16_f32 v239, v150, v151
    v_permlane16_swap_b32 v236, v238
    v_mfma_f32_16x16x32_bf16 v[172:175], a[244:247], v[124:127], v[172:175]
    s_waitcnt lgkmcnt(1)
    buffer_load_dwordx4 v[76:79], v5, s[4:7], s89 offen offset:1280 sc1
    v_mfma_f32_16x16x32_bf16 v[168:171], a[244:247], v[120:123], v[168:171]
    s_add_u32 s68, s48, 0x4000
    buffer_load_dwordx4 a[76:79], v4, s[4:7], s68 offen offset:3072
    v_mfma_f32_16x16x32_bf16 v[160:163], a[248:251], v[128:131], v[160:163]
    v_permlane16_swap_b32 v237, v239
    buffer_store_dwordx4 v[236:239], v0, s[4:7], s57 offen offset:1024 sc1
    v_mfma_f32_16x16x32_bf16 v[164:167], a[248:251], v[132:135], v[164:167]
    v_mfma_f32_16x16x32_bf16 v[172:175], a[252:255], v[132:135], v[172:175]
    v_mfma_f32_16x16x32_bf16 v[168:171], a[252:255], v[128:131], v[168:171]
    v_mfma_f32_16x16x32_bf16 v[160:163], a[224:227], v[136:139], v[160:163]
    buffer_load_dwordx4 a[104:107], v4, s[4:7], s68 offen offset:3328
    v_mfma_f32_16x16x32_bf16 v[164:167], a[224:227], v[140:143], v[164:167]
    s_waitcnt vmcnt(11)
    v_subrev_u32 v8, s44, v8
    v_cmp_le_u32 vcc, 16, v8
    s_cbranch_vccnz Lfs_289
Lc_290:
    v_mfma_f32_16x16x32_bf16 v[172:175], a[228:231], v[140:143], v[172:175]
    s_waitcnt lgkmcnt(0)
    buffer_load_dwordx4 v[80:83], v5, s[4:7], s84 offen offset:2048 sc1
    v_mfma_f32_16x16x32_bf16 v[168:171], a[228:231], v[136:139], v[168:171]
    buffer_load_dwordx4 v[84:87], v5, s[4:7], s84 offen offset:2304 sc1
    v_mfma_f32_16x16x16_bf16 v[160:163], a[232:233], v[20:21], v[160:163]
    v_mfma_f32_16x16x16_bf16 v[164:167], a[232:233], v[22:23], v[164:167]
    v_mfma_f32_16x16x16_bf16 v[168:171], a[234:235], v[20:21], v[168:171]
    buffer_load_dwordx4 v[88:91], v5, s[4:7], s88 offen offset:2048 sc1
    v_mfma_f32_16x16x16_bf16 v[172:175], a[234:235], v[22:23], v[172:175]
    s_add_u32 s68, s58, 0x1000
    buffer_load_dwordx4 a[136:139], v4, s[4:7], s68 offen offset:2048
LstS4_0s:
    s_cmp_ge_u32 s25, 14
    s_cbranch_scc1 Lidle_291
    v_mfma_f32_16x16x32_bf16 v[176:179], a[0:3], v[240:243], v[176:179]
    buffer_load_dwordx4 v[92:95], v5, s[4:7], s88 offen offset:2304 sc1
    v_mfma_f32_16x16x32_bf16 v[184:187], a[28:31], v[240:243], v[184:187]
    v_mfma_f32_16x16x32_bf16 v[192:195], a[112:115], v[240:243], 0
    v_pk_mul_f32 v[224:225], v[160:161], v[26:27] op_sel:[0,0] op_sel_hi:[1,0]
    v_pk_mul_f32 v[226:227], v[162:163], v[26:27] op_sel:[0,0] op_sel_hi:[1,0]
    v_pk_mul_f32 v[228:229], v[164:165], v[26:27] op_sel:[0,1] op_sel_hi:[1,1]
    v_pk_mul_f32 v[230:231], v[166:167], v[26:27] op_sel:[0,1] op_sel_hi:[1,1]
    v_pk_mul_f32 v[160:161], v[160:161], v[168:169]
    v_pk_mul_f32 v[162:163], v[162:163], v[170:171]
    v_pk_mul_f32 v[164:165], v[164:165], v[172:173]
    v_pk_mul_f32 v[166:167], v[166:167], v[174:175]
    v_mfma_f32_16x16x32_bf16 v[200:203], a[140:143], v[240:243], 0
    v_exp_f32 v224, v224
    v_mfma_f32_16x16x32_bf16 v[204:207], a[140:143], v[244:247], 0
    buffer_load_dwordx4 v[96:99], v5, s[4:7], s85 offen offset:2048 sc1
    v_mfma_f32_16x16x32_bf16 v[196:199], a[112:115], v[244:247], 0
    buffer_load_dwordx4 a[164:167], v4, s[4:7], s68 offen offset:2304
    v_mfma_f32_16x16x32_bf16 v[188:191], a[28:31], v[244:247], v[188:191]
    v_exp_f32 v225, v225
    v_mfma_f32_16x16x32_bf16 v[180:183], a[0:3], v[244:247], v[180:183]
    v_exp_f32 v226, v226
    v_mfma_f32_16x16x32_bf16 v[176:179], a[56:59], v[248:251], v[176:179]
    buffer_load_dwordx4 v[100:103], v5, s[4:7], s85 offen offset:2304 sc1
    v_mfma_f32_16x16x32_bf16 v[184:187], a[84:87], v[248:251], v[184:187]
    v_exp_f32 v227, v227
    v_mfma_f32_16x16x32_bf16 v[192:195], a[168:171], v[248:251], v[192:195]
    s_add_u32 s68, s58, 0x5000
    buffer_load_dwordx4 a[192:195], v4, s[4:7], s68 offen
    v_mfma_f32_16x16x32_bf16 v[200:203], a[196:199], v[248:251], v[200:203]
    v_exp_f32 v228, v228
    v_mfma_f32_16x16x32_bf16 v[204:207], a[196:199], v[252:255], v[204:207]
    buffer_load_dwordx4 v[104:107], v5, s[4:7], s89 offen offset:2048 sc1
    v_mfma_f32_16x16x32_bf16 v[196:199], a[168:171], v[252:255], v[196:199]
    v_exp_f32 v229, v229
    v_mfma_f32_16x16x32_bf16 v[188:191], a[84:87], v[252:255], v[188:191]
    v_exp_f32 v230, v230
    v_exp_f32 v231, v231
    v_pk_fma_f32 v[224:225], v[224:225], v[24:25], v[24:25] op_sel:[0,1,1] op_sel_hi:[1,1,1]
    v_pk_fma_f32 v[226:227], v[226:227], v[24:25], v[24:25] op_sel:[0,1,1] op_sel_hi:[1,1,1]
    v_pk_fma_f32 v[228:229], v[228:229], v[24:25], v[24:25] op_sel:[0,0,0] op_sel_hi:[1,0,0]
    v_pk_fma_f32 v[230:231], v[230:231], v[24:25], v[24:25] op_sel:[0,0,0] op_sel_hi:[1,0,0]
    v_mfma_f32_16x16x32_bf16 v[180:183], a[56:59], v[252:255], v[180:183]
    v_rcp_f32 v224, v224
    v_mfma_f32_16x16x32_bf16 v[176:179], a[4:7], v[32:35], v[176:179]
    buffer_load_dwordx4 v[108:111], v5, s[4:7], s89 offen offset:2304 sc1
    v_mfma_f32_16x16x32_bf16 v[184:187], a[32:35], v[32:35], v[184:187]
    buffer_load_dwordx4 a[220:223], v4, s[4:7], s68 offen offset:256
    v_mfma_f32_16x16x32_bf16 v[192:195], a[116:119], v[32:35], v[192:195]
    v_rcp_f32 v225, v225
    v_mfma_f32_16x16x32_bf16 v[200:203], a[144:147], v[32:35], v[200:203]
    v_rcp_f32 v226, v226
    v_mfma_f32_16x16x32_bf16 v[204:207], a[144:147], v[36:39], v[204:207]
    v_or_b32_e64 v9, s3, 5
    s_waitcnt vmcnt(13)
    buffer_store_dword v9, v6, s[4:7], s54 offen offset:512 sc1
    v_mfma_f32_16x16x32_bf16 v[196:199], a[116:119], v[36:39], v[196:199]
    buffer_load_dwordx4 v[112:115], v5, s[4:7], s84 offen offset:3072 sc1
    v_mfma_f32_16x16x32_bf16 v[188:191], a[32:35], v[36:39], v[188:191]
    s_add_u32 s68, s48, 0x1000
    buffer_load_dwordx4 a[24:27], v4, s[4:7], s68 offen offset:2048
    v_mfma_f32_16x16x32_bf16 v[180:183], a[4:7], v[36:39], v[180:183]
    v_rcp_f32 v227, v227
    v_mfma_f32_16x16x32_bf16 v[176:179], a[60:63], v[40:43], v[176:179]
    buffer_load_dwordx4 v[116:119], v5, s[4:7], s84 offen offset:3328 sc1
    v_mfma_f32_16x16x32_bf16 v[184:187], a[88:91], v[40:43], v[184:187]
    v_rcp_f32 v228, v228
    v_mfma_f32_16x16x32_bf16 v[192:195], a[172:175], v[40:43], v[192:195]
    v_rcp_f32 v229, v229
    v_mfma_f32_16x16x32_bf16 v[200:203], a[200:203], v[40:43], v[200:203]
    v_rcp_f32 v230, v230
    v_rcp_f32 v231, v231
    v_pk_mul_f32 v[160:161], v[160:161], v[224:225]
    v_pk_mul_f32 v[162:163], v[162:163], v[226:227]
    v_pk_mul_f32 v[164:165], v[164:165], v[228:229]
    v_pk_mul_f32 v[166:167], v[166:167], v[230:231]
    v_mfma_f32_16x16x32_bf16 v[204:207], a[200:203], v[44:47], v[204:207]
    buffer_load_dword v8, v10, s[4:7], s56 offen offset:512 sc1
    v_mfma_f32_16x16x32_bf16 v[196:199], a[172:175], v[44:47], v[196:199]
    s_add_u32 s44, s3, 4
    buffer_load_dwordx4 v[120:123], v5, s[4:7], s88 offen offset:3072 sc1
    buffer_load_dwordx4 a[52:55], v4, s[4:7], s68 offen offset:2304
    v_mfma_f32_16x16x32_bf16 v[188:191], a[88:91], v[44:47], v[188:191]
    v_cvt_pk_bf16_f32 v232, v160, v161
    v_cvt_pk_bf16_f32 v234, v164, v165
    v_mfma_f32_16x16x32_bf16 v[180:183], a[60:63], v[44:47], v[180:183]
    v_cvt_pk_bf16_f32 v233, v162, v163
    v_cvt_pk_bf16_f32 v235, v166, v167
    v_mfma_f32_16x16x32_bf16 v[208:211], a[0:3], v[48:51], 0
    buffer_load_dwordx4 v[124:127], v5, s[4:7], s88 offen offset:3328 sc1
    v_mfma_f32_16x16x32_bf16 v[216:219], a[28:31], v[48:51], 0
    v_permlane16_swap_b32 v232, v234
    v_permlane16_swap_b32 v233, v235
    buffer_store_dwordx4 v[232:235], v0, s[4:7], s57 offen offset:2048 sc1
    v_mfma_f32_16x16x32_bf16 v[144:147], a[112:115], v[48:51], 0
    s_add_u32 s68, s48, 0x5000
    buffer_load_dwordx4 a[80:83], v4, s[4:7], s68 offen
    v_mfma_f32_16x16x32_bf16 v[152:155], a[140:143], v[48:51], 0
    v_mfma_f32_16x16x32_bf16 v[156:159], a[140:143], v[52:55], 0
    buffer_load_dwordx4 v[128:131], v5, s[4:7], s85 offen offset:3072 sc1
    v_mfma_f32_16x16x32_bf16 v[148:151], a[112:115], v[52:55], 0
    v_mfma_f32_16x16x32_bf16 v[220:223], a[28:31], v[52:55], 0
    v_mfma_f32_16x16x32_bf16 v[212:215], a[0:3], v[52:55], 0
    v_mfma_f32_16x16x32_bf16 v[208:211], a[56:59], v[56:59], v[208:211]
    buffer_load_dwordx4 v[132:135], v5, s[4:7], s85 offen offset:3328 sc1
    v_mfma_f32_16x16x32_bf16 v[216:219], a[84:87], v[56:59], v[216:219]
    buffer_load_dwordx4 a[108:111], v4, s[4:7], s68 offen offset:256
    v_mfma_f32_16x16x32_bf16 v[144:147], a[168:171], v[56:59], v[144:147]
    v_mfma_f32_16x16x32_bf16 v[152:155], a[196:199], v[56:59], v[152:155]
    v_mfma_f32_16x16x32_bf16 v[156:159], a[196:199], v[60:63], v[156:159]
    buffer_load_dwordx4 v[136:139], v5, s[4:7], s89 offen offset:3072 sc1
    v_mfma_f32_16x16x32_bf16 v[148:151], a[168:171], v[60:63], v[148:151]
    v_mfma_f32_16x16x32_bf16 v[220:223], a[84:87], v[60:63], v[220:223]
    v_mfma_f32_16x16x32_bf16 v[212:215], a[56:59], v[60:63], v[212:215]
    v_mfma_f32_16x16x32_bf16 v[208:211], a[4:7], v[64:67], v[208:211]
    buffer_load_dwordx4 v[140:143], v5, s[4:7], s89 offen offset:3328 sc1
    v_mfma_f32_16x16x32_bf16 v[216:219], a[32:35], v[64:67], v[216:219]
    v_add_u32 v28, s32, v1
    v_add_u32 v29, s33, v1
    v_mfma_f32_16x16x32_bf16 v[144:147], a[116:119], v[64:67], v[144:147]
    v_add_u32 v30, s34, v1
    v_add_u32 v31, s35, v1
    v_mfma_f32_16x16x32_bf16 v[152:155], a[144:147], v[64:67], v[152:155]
    s_waitcnt vmcnt(10)
    v_subrev_u32 v8, s44, v8
    v_cmp_le_u32 vcc, 16, v8
    s_cbranch_vccnz Lfs_292
Lc_293:
    v_mfma_f32_16x16x32_bf16 v[156:159], a[144:147], v[68:71], v[156:159]
    buffer_load_dword v8, v10, s[4:7], s56 offen offset:512 sc1
    v_mfma_f32_16x16x32_bf16 v[148:151], a[116:119], v[68:71], v[148:151]
    s_add_u32 s44, s3, 5
    buffer_load_dwordx4 v[240:243], v5, s[4:7], s86 offen sc1
    v_mfma_f32_16x16x32_bf16 v[220:223], a[32:35], v[68:71], v[220:223]
    v_mfma_f32_16x16x32_bf16 v[212:215], a[4:7], v[68:71], v[212:215]
    v_mfma_f32_16x16x32_bf16 v[208:211], a[60:63], v[72:75], v[208:211]
    buffer_load_dwordx4 v[244:247], v5, s[4:7], s86 offen offset:256 sc1
    v_mfma_f32_16x16x32_bf16 v[216:219], a[88:91], v[72:75], v[216:219]
    v_mfma_f32_16x16x32_bf16 v[144:147], a[172:175], v[72:75], v[144:147]
    v_mfma_f32_16x16x32_bf16 v[152:155], a[200:203], v[72:75], v[152:155]
    v_mfma_f32_16x16x32_bf16 v[156:159], a[200:203], v[76:79], v[156:159]
    buffer_load_dwordx4 v[248:251], v5, s[4:7], s90 offen sc1
    v_mfma_f32_16x16x32_bf16 v[148:151], a[172:175], v[76:79], v[148:151]
    v_mfma_f32_16x16x32_bf16 v[220:223], a[88:91], v[76:79], v[220:223]
    v_mfma_f32_16x16x32_bf16 v[212:215], a[60:63], v[76:79], v[212:215]
    s_barrier
    v_mfma_f32_16x16x32_bf16 v[176:179], a[8:11], v[80:83], v[176:179]
    buffer_load_dwordx4 v[252:255], v5, s[4:7], s90 offen offset:256 sc1
    v_mfma_f32_16x16x32_bf16 v[184:187], a[36:39], v[80:83], v[184:187]
    v_mfma_f32_16x16x32_bf16 v[192:195], a[120:123], v[80:83], v[192:195]
    v_or_b32_e64 v9, s3, 6
    s_waitcnt vmcnt(11)
    buffer_store_dword v9, v6, s[4:7], s54 offen offset:512 sc1
    v_mfma_f32_16x16x32_bf16 v[200:203], a[148:151], v[80:83], v[200:203]
    v_mfma_f32_16x16x32_bf16 v[204:207], a[148:151], v[84:87], v[204:207]
    buffer_load_dwordx4 v[32:35], v5, s[4:7], s87 offen sc1
    v_mfma_f32_16x16x32_bf16 v[196:199], a[120:123], v[84:87], v[196:199]
    v_mfma_f32_16x16x32_bf16 v[188:191], a[36:39], v[84:87], v[188:191]
    v_mfma_f32_16x16x32_bf16 v[180:183], a[8:11], v[84:87], v[180:183]
    v_mfma_f32_16x16x32_bf16 v[176:179], a[64:67], v[88:91], v[176:179]
    buffer_load_dwordx4 v[36:39], v5, s[4:7], s87 offen offset:256 sc1
    v_mfma_f32_16x16x32_bf16 v[184:187], a[92:95], v[88:91], v[184:187]
    v_mfma_f32_16x16x32_bf16 v[192:195], a[176:179], v[88:91], v[192:195]
    v_mfma_f32_16x16x32_bf16 v[200:203], a[204:207], v[88:91], v[200:203]
    s_waitcnt vmcnt(7)
    v_subrev_u32 v8, s44, v8
    v_cmp_le_u32 vcc, 16, v8
    s_cbranch_vccnz Lfs_294
Lc_295:
    v_mfma_f32_16x16x32_bf16 v[204:207], a[204:207], v[92:95], v[204:207]
    buffer_load_dwordx4 v[40:43], v5, s[4:7], s91 offen sc1
    v_mfma_f32_16x16x32_bf16 v[196:199], a[176:179], v[92:95], v[196:199]
    v_mfma_f32_16x16x32_bf16 v[188:191], a[92:95], v[92:95], v[188:191]
    v_mfma_f32_16x16x32_bf16 v[180:183], a[64:67], v[92:95], v[180:183]
    v_mfma_f32_16x16x32_bf16 v[208:211], a[8:11], v[96:99], v[208:211]
    buffer_load_dwordx4 v[44:47], v5, s[4:7], s91 offen offset:256 sc1
    v_mfma_f32_16x16x32_bf16 v[216:219], a[36:39], v[96:99], v[216:219]
    v_mfma_f32_16x16x32_bf16 v[144:147], a[120:123], v[96:99], v[144:147]
    v_mfma_f32_16x16x32_bf16 v[152:155], a[148:151], v[96:99], v[152:155]
    v_mfma_f32_16x16x32_bf16 v[156:159], a[148:151], v[100:103], v[156:159]
    buffer_load_dwordx4 v[48:51], v5, s[4:7], s86 offen offset:1024 sc1
    v_mfma_f32_16x16x32_bf16 v[148:151], a[120:123], v[100:103], v[148:151]
    v_mov_b32 v224, -1
    v_lshlrev_b32 v225, 1, v1
    v_mfma_f32_16x16x32_bf16 v[220:223], a[36:39], v[100:103], v[220:223]
    s_add_u32 s92, s57, 0x0
    s_add_u32 s93, s49, 0x4000
    v_mfma_f32_16x16x32_bf16 v[212:215], a[8:11], v[100:103], v[212:215]
    v_or_b32_e64 v162, s3, 1
    v_lshrrev_b32 v166, 4, v1
    v_mfma_f32_16x16x32_bf16 v[208:211], a[64:67], v[104:107], v[208:211]
    buffer_load_dwordx4 v[52:55], v5, s[4:7], s86 offen offset:1280 sc1
    v_mfma_f32_16x16x32_bf16 v[216:219], a[92:95], v[104:107], v[216:219]
    v_and_b32 v166, 32, v166
    v_add_u32 v166, v166, v10
    v_mfma_f32_16x16x32_bf16 v[144:147], a[176:179], v[104:107], v[144:147]
    v_mov_b32 v164, 0x10000000
    v_mfma_f32_16x16x32_bf16 v[152:155], a[204:207], v[104:107], v[152:155]
    s_mov_b32 s20, 0xff000000
    s_mov_b32 s21, 0xff000000
    v_cndmask_b32_e64 v165, v164, v1, s[20:21]
    v_cndmask_b32_e64 v164, v164, v166, s[20:21]
    v_mfma_f32_16x16x32_bf16 v[156:159], a[204:207], v[108:111], v[156:159]
    buffer_load_dwordx4 v[56:59], v5, s[4:7], s90 offen offset:1024 sc1
    v_mfma_f32_16x16x32_bf16 v[148:151], a[176:179], v[108:111], v[148:151]
    v_mfma_f32_16x16x32_bf16 v[220:223], a[92:95], v[108:111], v[220:223]
    v_mfma_f32_16x16x32_bf16 v[212:215], a[64:67], v[108:111], v[212:215]
    v_mfma_f32_16x16x32_bf16 v[192:195], a[124:127], v[112:115], v[192:195]
    buffer_load_dwordx4 v[60:63], v5, s[4:7], s90 offen offset:1280 sc1
    v_mfma_f32_16x16x32_bf16 v[200:203], a[152:155], v[112:115], v[200:203]
    v_mfma_f32_16x16x32_bf16 v[204:207], a[152:155], v[116:119], v[204:207]
    v_mfma_f32_16x16x32_bf16 v[196:199], a[124:127], v[116:119], v[196:199]
    v_mfma_f32_16x16x32_bf16 v[192:195], a[180:183], v[120:123], v[192:195]
    buffer_load_dwordx4 v[64:67], v5, s[4:7], s87 offen offset:1024 sc1
    v_mfma_f32_16x16x32_bf16 v[200:203], a[208:211], v[120:123], v[200:203]
    v_mfma_f32_16x16x32_bf16 v[204:207], a[208:211], v[124:127], v[204:207]
    v_mfma_f32_16x16x32_bf16 v[196:199], a[180:183], v[124:127], v[196:199]
    v_mfma_f32_16x16x32_bf16 v[208:211], a[12:15], v[128:131], v[208:211]
    buffer_load_dwordx4 v[68:71], v5, s[4:7], s87 offen offset:1280 sc1
    v_mfma_f32_16x16x32_bf16 v[216:219], a[40:43], v[128:131], v[216:219]
    v_mfma_f32_16x16x32_bf16 v[144:147], a[124:127], v[128:131], v[144:147]
    v_mfma_f32_16x16x32_bf16 v[152:155], a[152:155], v[128:131], v[152:155]
    v_mfma_f32_16x16x32_bf16 v[156:159], a[152:155], v[132:135], v[156:159]
    buffer_load_dword v8, v10, s[4:7], s56 offen offset:512 sc1
    v_mfma_f32_16x16x32_bf16 v[148:151], a[124:127], v[132:135], v[148:151]
    s_add_u32 s44, s3, 6
    buffer_load_dwordx4 v[72:75], v5, s[4:7], s91 offen offset:1024 sc1
    v_mfma_f32_16x16x32_bf16 v[220:223], a[40:43], v[132:135], v[220:223]
    v_mfma_f32_16x16x32_bf16 v[212:215], a[12:15], v[132:135], v[212:215]
    v_mfma_f32_16x16x32_bf16 v[208:211], a[68:71], v[136:139], v[208:211]
    buffer_load_dwordx4 v[76:79], v5, s[4:7], s91 offen offset:1280 sc1
    v_mfma_f32_16x16x32_bf16 v[216:219], a[96:99], v[136:139], v[216:219]
    v_mfma_f32_16x16x32_bf16 v[144:147], a[180:183], v[136:139], v[144:147]
    v_mfma_f32_16x16x32_bf16 v[152:155], a[208:211], v[136:139], v[152:155]
    v_mfma_f32_16x16x32_bf16 v[156:159], a[208:211], v[140:143], v[156:159]
    v_mfma_f32_16x16x32_bf16 v[148:151], a[180:183], v[140:143], v[148:151]
    v_mfma_f32_16x16x32_bf16 v[220:223], a[96:99], v[140:143], v[220:223]
    v_mfma_f32_16x16x32_bf16 v[212:215], a[68:71], v[140:143], v[212:215]
    s_waitcnt vmcnt(17)
    v_mfma_f32_16x16x32_bf16 v[192:195], a[128:131], v[240:243], v[192:195]
    v_mfma_f32_16x16x32_bf16 v[200:203], a[156:159], v[240:243], v[200:203]
    s_waitcnt vmcnt(16)
    v_mfma_f32_16x16x32_bf16 v[204:207], a[156:159], v[244:247], v[204:207]
    v_mfma_f32_16x16x32_bf16 v[196:199], a[128:131], v[244:247], v[196:199]
    s_waitcnt vmcnt(15)
    v_mfma_f32_16x16x32_bf16 v[192:195], a[184:187], v[248:251], v[192:195]
    s_add_u32 m0, s55, 0x7000
    s_add_u32 s76, s96, 0x7000
    buffer_load_dwordx4 v7, s[4:7], s76 offen lds
    v_mfma_f32_16x16x32_bf16 v[200:203], a[212:215], v[248:251], v[200:203]
    s_waitcnt vmcnt(15)
    v_mfma_f32_16x16x32_bf16 v[204:207], a[212:215], v[252:255], v[204:207]
    v_mfma_f32_16x16x32_bf16 v[196:199], a[184:187], v[252:255], v[196:199]
    s_waitcnt vmcnt(13)
    v_mfma_f32_16x16x32_bf16 v[208:211], a[16:19], v[32:35], v[208:211]
    buffer_load_dwordx4 v7, s[4:7], s76 offen offset:1024 lds
    v_mfma_f32_16x16x32_bf16 v[216:219], a[44:47], v[32:35], v[216:219]
    v_mfma_f32_16x16x32_bf16 v[144:147], a[128:131], v[32:35], v[144:147]
    v_mfma_f32_16x16x32_bf16 v[152:155], a[156:159], v[32:35], v[152:155]
    s_waitcnt vmcnt(4)
    v_subrev_u32 v8, s44, v8
    v_cmp_le_u32 vcc, 16, v8
    s_cbranch_vccnz Lfs_296
Lc_297:
    s_barrier
    v_mfma_f32_16x16x32_bf16 v[156:159], a[156:159], v[36:39], v[156:159]
    buffer_load_dwordx4 v[80:83], v5, s[4:7], s86 offen offset:2048 sc1
    v_mfma_f32_16x16x32_bf16 v[148:151], a[128:131], v[36:39], v[148:151]
    buffer_load_dwordx4 v[84:87], v5, s[4:7], s86 offen offset:2304 sc1
    buffer_load_dwordx4 v[88:91], v5, s[4:7], s90 offen offset:2048 sc1
    buffer_load_dwordx4 v[92:95], v5, s[4:7], s90 offen offset:2304 sc1
    buffer_load_dwordx4 v[96:99], v5, s[4:7], s87 offen offset:2048 sc1
    buffer_load_dwordx4 v7, s[4:7], s76 offen offset:2048 lds
    v_mfma_f32_16x16x32_bf16 v[220:223], a[44:47], v[36:39], v[220:223]
    v_mfma_f32_16x16x32_bf16 v[212:215], a[16:19], v[36:39], v[212:215]
    v_mfma_f32_16x16x32_bf16 v[208:211], a[72:75], v[40:43], v[208:211]
    buffer_load_dwordx4 v[100:103], v5, s[4:7], s87 offen offset:2304 sc1
    v_mfma_f32_16x16x32_bf16 v[216:219], a[100:103], v[40:43], v[216:219]
    buffer_load_dwordx4 v7, s[4:7], s76 offen offset:3072 lds
    s_add_u32 m0, s55, 0x8000
    s_add_u32 s76, s76, 4096
    v_mfma_f32_16x16x32_bf16 v[144:147], a[184:187], v[40:43], v[144:147]
    v_mfma_f32_16x16x32_bf16 v[152:155], a[212:215], v[40:43], v[152:155]
    v_mfma_f32_16x16x32_bf16 v[156:159], a[212:215], v[44:47], v[156:159]
    buffer_load_dwordx4 v[104:107], v5, s[4:7], s91 offen offset:2048 sc1
    v_mfma_f32_16x16x32_bf16 v[148:151], a[184:187], v[44:47], v[148:151]
    v_mfma_f32_16x16x32_bf16 v[220:223], a[100:103], v[44:47], v[220:223]
    buffer_load_dwordx4 v7, s[4:7], s76 offen lds
    buffer_load_dwordx4 v[108:111], v5, s[4:7], s91 offen offset:2304 sc1
    v_mfma_f32_16x16x32_bf16 v[212:215], a[72:75], v[44:47], v[212:215]
    v_mfma_f32_16x16x32_bf16 v[192:195], a[132:135], v[48:51], v[192:195]
    v_mfma_f32_16x16x32_bf16 v[200:203], a[160:163], v[48:51], v[200:203]
    v_mfma_f32_16x16x32_bf16 v[204:207], a[160:163], v[52:55], v[204:207]
    buffer_load_dwordx4 v7, s[4:7], s76 offen offset:1024 lds
    v_mfma_f32_16x16x32_bf16 v[196:199], a[132:135], v[52:55], v[196:199]
    v_mfma_f32_16x16x32_bf16 v[192:195], a[188:191], v[56:59], v[192:195]
    v_mfma_f32_16x16x32_bf16 v[200:203], a[216:219], v[56:59], v[200:203]
    v_mfma_f32_16x16x32_bf16 v[204:207], a[216:219], v[60:63], v[204:207]
    buffer_load_dwordx4 v7, s[4:7], s76 offen offset:2048 lds
    v_mfma_f32_16x16x32_bf16 v[196:199], a[188:191], v[60:63], v[196:199]
    v_mfma_f32_16x16x32_bf16 v[208:211], a[20:23], v[64:67], v[208:211]
    v_mfma_f32_16x16x32_bf16 v[216:219], a[48:51], v[64:67], v[216:219]
    v_mfma_f32_16x16x32_bf16 v[144:147], a[132:135], v[64:67], v[144:147]
    s_add_u32 m0, s55, 0x0
    s_add_u32 s75, s96, 0x0
    buffer_load_dwordx4 v7, s[4:7], s75 offen lds
    v_mfma_f32_16x16x32_bf16 v[152:155], a[160:163], v[64:67], v[152:155]
    v_mfma_f32_16x16x32_bf16 v[156:159], a[160:163], v[68:71], v[156:159]
    v_mfma_f32_16x16x32_bf16 v[148:151], a[132:135], v[68:71], v[148:151]
    v_mfma_f32_16x16x32_bf16 v[220:223], a[48:51], v[68:71], v[220:223]
    buffer_load_dwordx4 v7, s[4:7], s75 offen offset:1024 lds
    v_mfma_f32_16x16x32_bf16 v[212:215], a[20:23], v[68:71], v[212:215]
    s_waitcnt vmcnt(18)
    v_mfma_f32_16x16x32_bf16 v[208:211], a[76:79], v[72:75], v[208:211]
    v_mfma_f32_16x16x32_bf16 v[216:219], a[104:107], v[72:75], v[216:219]
    v_mfma_f32_16x16x32_bf16 v[144:147], a[188:191], v[72:75], v[144:147]
    v_mfma_f32_16x16x32_bf16 v[152:155], a[216:219], v[72:75], v[152:155]
    s_waitcnt vmcnt(17)
    v_mfma_f32_16x16x32_bf16 v[156:159], a[216:219], v[76:79], v[156:159]
    buffer_load_dwordx4 v7, s[4:7], s75 offen offset:2048 lds
    v_mfma_f32_16x16x32_bf16 v[148:151], a[188:191], v[76:79], v[148:151]
    v_mfma_f32_16x16x32_bf16 v[220:223], a[104:107], v[76:79], v[220:223]
    v_mfma_f32_16x16x32_bf16 v[212:215], a[76:79], v[76:79], v[212:215]
    s_waitcnt vmcnt(15)
    v_mfma_f32_16x16x32_bf16 v[192:195], a[136:139], v[80:83], v[192:195]
    buffer_load_dwordx4 v7, s[4:7], s75 offen offset:3072 lds
    s_add_u32 m0, s55, 0x1000
    s_add_u32 s75, s75, 4096
    v_mfma_f32_16x16x32_bf16 v[200:203], a[164:167], v[80:83], v[200:203]
    s_waitcnt vmcnt(15)
    v_mfma_f32_16x16x32_bf16 v[204:207], a[164:167], v[84:87], v[204:207]
    v_mfma_f32_16x16x32_bf16 v[196:199], a[136:139], v[84:87], v[196:199]
    s_waitcnt vmcnt(14)
    v_mfma_f32_16x16x32_bf16 v[192:195], a[192:195], v[88:91], v[192:195]
    buffer_load_dwordx4 v7, s[4:7], s75 offen lds
    v_mfma_f32_16x16x32_bf16 v[200:203], a[220:223], v[88:91], v[200:203]
    s_waitcnt vmcnt(14)
    v_mfma_f32_16x16x32_bf16 v[204:207], a[220:223], v[92:95], v[204:207]
    v_mfma_f32_16x16x32_bf16 v[196:199], a[192:195], v[92:95], v[196:199]
    s_waitcnt vmcnt(13)
    v_mfma_f32_16x16x32_bf16 v[208:211], a[24:27], v[96:99], v[208:211]
    buffer_load_dwordx4 v7, s[4:7], s75 offen offset:1024 lds
    v_mfma_f32_16x16x32_bf16 v[216:219], a[52:55], v[96:99], v[216:219]
    s_waitcnt vmcnt(12)
    v_mfma_f32_16x16x32_bf16 v[220:223], a[52:55], v[100:103], v[220:223]
    ds_write_b128 v28, v[192:195] offset:0
    v_mfma_f32_16x16x32_bf16 v[212:215], a[24:27], v[100:103], v[212:215]
    ds_write_b128 v28, v[196:199] offset:1024
    s_waitcnt vmcnt(10)
    v_mfma_f32_16x16x32_bf16 v[208:211], a[80:83], v[104:107], v[208:211]
    buffer_load_dwordx4 v7, s[4:7], s75 offen offset:2048 lds
    buffer_store_dword v224, v225, s[4:7], s57 offen
    v_mfma_f32_16x16x32_bf16 v[216:219], a[108:111], v[104:107], v[216:219]
    ds_write_b128 v28, v[200:203] offset:2048
    s_waitcnt vmcnt(10)
    v_mfma_f32_16x16x32_bf16 v[220:223], a[108:111], v[108:111], v[220:223]
    ds_write_b128 v28, v[204:207] offset:3072
    v_mfma_f32_16x16x32_bf16 v[212:215], a[80:83], v[108:111], v[212:215]
    v_mfma_f32_16x16x32_bf16 v[144:147], a[136:139], v[96:99], v[144:147]
    v_mfma_f32_16x16x32_bf16 v[152:155], a[164:167], v[96:99], v[152:155]
    v_mfma_f32_16x16x32_bf16 v[156:159], a[164:167], v[100:103], v[156:159]
    ds_write_b128 v29, v[208:211] offset:0
    v_mfma_f32_16x16x32_bf16 v[148:151], a[136:139], v[100:103], v[148:151]
    s_nop 2
    ds_write_b128 v29, v[212:215] offset:1024
    v_mfma_f32_16x16x32_bf16 v[144:147], a[192:195], v[104:107], v[144:147]
    ds_write_b128 v29, v[216:219] offset:2048
    v_mfma_f32_16x16x32_bf16 v[152:155], a[220:223], v[104:107], v[152:155]
    ds_write_b128 v29, v[220:223] offset:3072
    v_mfma_f32_16x16x32_bf16 v[156:159], a[220:223], v[108:111], v[156:159]
    v_mfma_f32_16x16x32_bf16 v[148:151], a[192:195], v[108:111], v[148:151]
    v_mfma_f32_16x16x32_bf16 v[176:179], a[12:15], v[112:115], v[176:179]
    v_mfma_f32_16x16x32_bf16 v[184:187], a[40:43], v[112:115], v[184:187]
    v_mfma_f32_16x16x32_bf16 v[188:191], a[40:43], v[116:119], v[188:191]
    ds_write_b128 v30, v[144:147] offset:0
    v_mfma_f32_16x16x32_bf16 v[180:183], a[12:15], v[116:119], v[180:183]
    s_nop 2
    ds_write_b128 v30, v[148:151] offset:1024
    v_mfma_f32_16x16x32_bf16 v[176:179], a[68:71], v[120:123], v[176:179]
    ds_write_b128 v30, v[152:155] offset:2048
    v_mfma_f32_16x16x32_bf16 v[184:187], a[96:99], v[120:123], v[184:187]
    ds_write_b128 v30, v[156:159] offset:3072
    v_mfma_f32_16x16x32_bf16 v[188:191], a[96:99], v[124:127], v[188:191]
    v_mfma_f32_16x16x32_bf16 v[180:183], a[68:71], v[124:127], v[180:183]
    v_mfma_f32_16x16x32_bf16 v[176:179], a[16:19], v[240:243], v[176:179]
    v_mfma_f32_16x16x32_bf16 v[184:187], a[44:47], v[240:243], v[184:187]
    s_waitcnt lgkmcnt(0)
    s_barrier
    v_mfma_f32_16x16x32_bf16 v[188:191], a[44:47], v[244:247], v[188:191]
    ds_read_b128 v[192:195], v31 offset:0
    ds_read_b128 v[208:211], v31 offset:4096
    v_mfma_f32_16x16x32_bf16 v[180:183], a[16:19], v[244:247], v[180:183]
    ds_read_b128 v[144:147], v31 offset:8192
    ds_read_b128 v[196:199], v31 offset:1024
    v_mfma_f32_16x16x32_bf16 v[176:179], a[72:75], v[248:251], v[176:179]
    ds_read_b128 v[212:215], v31 offset:5120
    ds_read_b128 v[148:151], v31 offset:9216
    v_mfma_f32_16x16x32_bf16 v[184:187], a[100:103], v[248:251], v[184:187]
    ds_read_b128 v[200:203], v31 offset:2048
    ds_read_b128 v[216:219], v31 offset:6144
    v_mfma_f32_16x16x32_bf16 v[188:191], a[100:103], v[252:255], v[188:191]
    ds_read_b128 v[152:155], v31 offset:10240
    ds_read_b128 v[204:207], v31 offset:3072
    v_mfma_f32_16x16x32_bf16 v[180:183], a[72:75], v[252:255], v[180:183]
    ds_read_b128 v[220:223], v31 offset:7168
    ds_read_b128 v[156:159], v31 offset:11264
    v_mfma_f32_16x16x32_bf16 v[176:179], a[20:23], v[48:51], v[176:179]
    s_waitcnt lgkmcnt(10)
    v_add_f32 v192, v192, v208
    v_add_f32 v193, v193, v209
    v_mfma_f32_16x16x32_bf16 v[184:187], a[48:51], v[48:51], v[184:187]
    v_add_f32 v194, v194, v210
    v_add_f32 v195, v195, v211
    v_mfma_f32_16x16x32_bf16 v[188:191], a[48:51], v[52:55], v[188:191]
    s_waitcnt lgkmcnt(9)
    v_add_f32 v192, v192, v144
    v_add_f32 v193, v193, v145
    v_mfma_f32_16x16x32_bf16 v[180:183], a[20:23], v[52:55], v[180:183]
    v_add_f32 v194, v194, v146
    v_add_f32 v195, v195, v147
    v_mfma_f32_16x16x32_bf16 v[176:179], a[76:79], v[56:59], v[176:179]
    s_waitcnt lgkmcnt(7)
    v_add_f32 v196, v196, v212
    v_add_f32 v197, v197, v213
    v_mfma_f32_16x16x32_bf16 v[184:187], a[104:107], v[56:59], v[184:187]
    v_add_f32 v198, v198, v214
    v_add_f32 v199, v199, v215
    v_mfma_f32_16x16x32_bf16 v[188:191], a[104:107], v[60:63], v[188:191]
    s_waitcnt lgkmcnt(6)
    v_add_f32 v196, v196, v148
    v_add_f32 v197, v197, v149
    v_mfma_f32_16x16x32_bf16 v[180:183], a[76:79], v[60:63], v[180:183]
    v_add_f32 v198, v198, v150
    v_add_f32 v199, v199, v151
    v_mfma_f32_16x16x32_bf16 v[176:179], a[24:27], v[80:83], v[176:179]
    s_waitcnt lgkmcnt(4)
    v_add_f32 v200, v200, v216
    v_add_f32 v201, v201, v217
    v_mfma_f32_16x16x32_bf16 v[184:187], a[52:55], v[80:83], v[184:187]
    v_add_f32 v202, v202, v218
    v_add_f32 v203, v203, v219
    v_mfma_f32_16x16x32_bf16 v[188:191], a[52:55], v[84:87], v[188:191]
    s_waitcnt lgkmcnt(3)
    v_add_f32 v200, v200, v152
    v_add_f32 v201, v201, v153
    v_mfma_f32_16x16x32_bf16 v[180:183], a[24:27], v[84:87], v[180:183]
    v_add_f32 v202, v202, v154
    v_add_f32 v203, v203, v155
    v_mfma_f32_16x16x32_bf16 v[176:179], a[80:83], v[88:91], v[176:179]
    s_waitcnt lgkmcnt(1)
    v_add_f32 v204, v204, v220
    v_add_f32 v205, v205, v221
    v_mfma_f32_16x16x32_bf16 v[184:187], a[108:111], v[88:91], v[184:187]
    v_add_f32 v206, v206, v222
    v_add_f32 v207, v207, v223
    v_mfma_f32_16x16x32_bf16 v[188:191], a[108:111], v[92:95], v[188:191]
    s_waitcnt lgkmcnt(0)
    v_add_f32 v204, v204, v156
    v_add_f32 v205, v205, v157
    v_mfma_f32_16x16x32_bf16 v[180:183], a[80:83], v[92:95], v[180:183]
    v_add_f32 v206, v206, v158
    v_add_f32 v207, v207, v159
    v_pk_add_f32 v[176:177], v[176:177], v[192:193]
    v_pk_add_f32 v[178:179], v[178:179], v[194:195]
    v_cvt_pk_bf16_f32 v12, v176, v177
    v_cvt_pk_bf16_f32 v13, v178, v179
    s_nop 1
    v_pk_add_f32 v[180:181], v[180:181], v[196:197]
    v_pk_add_f32 v[182:183], v[182:183], v[198:199]
    v_cvt_pk_bf16_f32 v14, v180, v181
    v_cvt_pk_bf16_f32 v15, v182, v183
    s_nop 0
    v_permlane16_swap_b32 v12, v14
    v_permlane16_swap_b32 v13, v15
    s_waitcnt vmcnt(0)
    buffer_store_dwordx4 v[12:15], v1, s[4:7], s92 offen sc1
    v_pk_add_f32 v[184:185], v[184:185], v[200:201]
    v_pk_add_f32 v[186:187], v[186:187], v[202:203]
    v_cvt_pk_bf16_f32 v16, v184, v185
    v_cvt_pk_bf16_f32 v17, v186, v187
    v_pk_add_f32 v[188:189], v[188:189], v[204:205]
    v_pk_add_f32 v[190:191], v[190:191], v[206:207]
    v_cvt_pk_bf16_f32 v18, v188, v189
    v_cvt_pk_bf16_f32 v19, v190, v191
    s_nop 0
    v_permlane16_swap_b32 v16, v18
    v_permlane16_swap_b32 v17, v19
    buffer_store_dwordx4 v[16:19], v1, s[4:7], s92 offen offset:1024 sc1
    v_dot2_f32_bf16 v160, v12, s23, 0
    v_dot2_f32_bf16 v161, v12, v12, 0
    v_dot2_f32_bf16 v160, v13, s23, v160
    v_dot2_f32_bf16 v161, v13, v13, v161
    buffer_store_dwordx4 v[12:15], v165, s[4:7], s50 offen sc1
    v_dot2_f32_bf16 v160, v14, s23, v160
    v_dot2_f32_bf16 v161, v14, v14, v161
    v_dot2_f32_bf16 v160, v15, s23, v160
    v_dot2_f32_bf16 v161, v15, v15, v161
    buffer_store_dwordx4 v[16:19], v165, s[4:7], s50 offen offset:1024 sc1
    v_dot2_f32_bf16 v160, v16, s23, v160
    v_dot2_f32_bf16 v161, v16, v16, v161
    v_dot2_f32_bf16 v160, v17, s23, v160
    v_dot2_f32_bf16 v161, v17, v17, v161
    v_dot2_f32_bf16 v160, v18, s23, v160
    v_dot2_f32_bf16 v161, v18, v18, v161
    v_dot2_f32_bf16 v160, v19, s23, v160
    v_dot2_f32_bf16 v161, v19, v19, v161
    s_nop 2
    v_permlane32_swap_b32 v160, v161
    v_add_f32 v160, v160, v161
    buffer_store_dword v160, v2, s[4:7], s93 offen sc1
    buffer_store_dword v160, v164, s[4:7], s51 offen sc1
    s_waitcnt vmcnt(0)
    buffer_store_dword v162, v6, s[4:7], s100 offen offset:256 sc1
LstS1_1s:
    s_add_u32 s88, s37, 0x4000
    s_waitcnt lgkmcnt(0)
    s_barrier
    s_add_u32 s96, s38, s55
    s_min_u32 s92, s24, 2
    s_lshl_b32 s92, s92, 10
    s_add_u32 m0, s92, 86016
    s_lshl_b32 s22, s25, 12
    s_add_u32 s92, s92, s22
    s_add_u32 s92, s92, 0x120000
    s_add_u32 s92, s92, s26
    buffer_load_dwordx4 v1, s[4:7], s92 offen lds
    s_add_u32 m0, s55, 0xe000
    s_add_u32 s61, s96, 0xe000
    buffer_load_dwordx4 v7, s[4:7], s61 offen lds
    buffer_load_dwordx4 v7, s[4:7], s61 offen offset:1024 lds
    buffer_load_dwordx4 v7, s[4:7], s61 offen offset:2048 lds
    buffer_load_dwordx4 v7, s[4:7], s61 offen offset:3072 lds
    s_add_u32 m0, s55, 0xf000
    s_add_u32 s61, s61, 4096
    buffer_load_dwordx4 v7, s[4:7], s61 offen lds
    buffer_load_dwordx4 v7, s[4:7], s61 offen offset:1024 lds
    buffer_load_dwordx4 v7, s[4:7], s61 offen offset:2048 lds
    buffer_load_dword v8, v11, s[4:7], s101 offen offset:256 sc1
    s_add_u32 s63, s3, 1
    s_lshl_b32 s92, s55, 1
    v_add_u32 v31, s92, v1
    v_add_u32 v29, 57344, v1
    s_lshl_b32 s84, s24, 12
    s_add_u32 s84, s84, 90112
    v_add_u32 v28, s84, v1
    v_mov_b32 v252, 0
    v_mov_b32 v253, 0
    v_mov_b32 v254, 0
    v_mov_b32 v255, 0
    ds_write_b128 v28, v[252:255] offset:0
    ds_write_b128 v28, v[252:255] offset:1024
    ds_read_b128 a[224:227], v1 offset:0
    ds_read_b128 a[228:231], v1 offset:1024
    ds_read_b128 a[232:235], v1 offset:2048
    ds_read_b128 a[236:239], v1 offset:3072
    ds_read_b128 a[240:243], v1 offset:4096
    ds_read_b128 a[244:247], v1 offset:5120
    ds_read_b128 a[248:251], v1 offset:6144
    buffer_load_dword v9, v11, s[4:7], s101 offen offset:256 sc1
Lp_299:
    s_waitcnt vmcnt(1)
    v_subrev_u32 v8, s63, v8
    v_cmp_le_u32 vcc, 16, v8
    s_cbranch_vccz Lo_300
    buffer_load_dword v8, v11, s[4:7], s101 offen offset:256 sc1
    s_waitcnt vmcnt(1)
    v_subrev_u32 v9, s63, v9
    v_cmp_le_u32 vcc, 16, v9
    s_cbranch_vccz Lo_300
    buffer_load_dword v9, v11, s[4:7], s101 offen offset:256 sc1
    s_sub_u32 s30, s30, 1
    s_cbranch_scc0 Lp_299
    s_mov_b32 s30, 0
Lo_300:
    buffer_load_dwordx4 v[32:35], v1, s[4:7], s36 offen sc1
    buffer_load_dwordx4 v[36:39], v1, s[4:7], s36 offen offset:1024 sc1
    buffer_load_dwordx4 v[40:43], v0, s[4:7], s36 offen offset:3072 sc1
    s_add_u32 s62, s36, 0x2000
    buffer_load_dwordx4 v[44:47], v1, s[4:7], s62 offen sc1
    s_add_u32 s62, s36, 0xe000
    buffer_load_dwordx4 v[48:51], v1, s[4:7], s62 offen sc1
    buffer_load_dwordx4 v[52:55], v1, s[4:7], s62 offen offset:1024 sc1
    buffer_load_dwordx4 v[56:59], v0, s[4:7], s62 offen offset:3072 sc1
    s_add_u32 s62, s36, 0x10000
    buffer_load_dwordx4 v[60:63], v1, s[4:7], s62 offen sc1
    s_waitcnt lgkmcnt(3)
    s_barrier
    s_waitcnt vmcnt(7)
    v_mfma_f32_32x32x16_bf16 v[144:159], a[224:227], v[32:35], 0
    ds_read_b128 a[252:255], v1 offset:7168
    s_add_u32 s62, s36, 0x1c000
    buffer_load_dwordx4 v[64:67], v1, s[4:7], s62 offen sc1
    v_mfma_f32_32x32x16_bf16 v[160:175], a[228:231], v[32:35], 0
    ds_read_b128 a[224:227], v29 offset:3072
    s_add_u32 s89, s26, 0x10000
    s_add_u32 s90, s26, 0x17000
    s_add_u32 s89, s89, s55
    v_and_b32 v25, 0x380, v1
    v_add_u32 v25, v25, v10
    s_waitcnt vmcnt(7)
    v_mfma_f32_32x32x16_bf16 v[144:159], a[232:235], v[36:39], v[144:159]
    ds_read_b128 a[228:231], v1 offset:8192
    buffer_load_dwordx4 v[68:71], v1, s[4:7], s62 offen offset:1024 sc1
    v_lshlrev_b32 v25, 2, v25
    v_add_u32 v25, 384, v25
    v_lshrrev_b32 v30, 2, v1
    v_mfma_f32_32x32x16_bf16 v[160:175], a[236:239], v[36:39], v[160:175]
    ds_read_b128 a[232:235], v1 offset:9216
    v_and_b32 v30, 0x80, v30
    v_lshl_add_u32 v30, v10, 2, v30
    v_add_u32 v30, s84, v30
    s_waitcnt lgkmcnt(3)
    s_waitcnt vmcnt(7)
    v_mfma_f32_32x32x16_bf16 v[144:159], a[240:243], v[40:43], v[144:159]
    ds_read_b128 a[236:239], v29 offset:4096
    buffer_load_dword v192, v2, s[4:7], s88 offen sc1
    buffer_load_dwordx4 v[72:75], v0, s[4:7], s62 offen offset:3072 sc1
    v_mfma_f32_32x32x16_bf16 v[160:175], a[244:247], v[40:43], v[160:175]
    ds_read_b128 a[240:243], v1 offset:10240
    buffer_load_dword v193, v2, s[4:7], s88 offen offset:256 sc1
    s_waitcnt vmcnt(9)
    v_mfma_f32_32x32x16_bf16 v[144:159], a[248:251], v[44:47], v[144:159]
    ds_read_b128 a[244:247], v1 offset:11264
    buffer_load_dword v194, v2, s[4:7], s88 offen offset:512 sc1
    buffer_load_dword v195, v2, s[4:7], s88 offen offset:768 sc1
    s_add_u32 s62, s36, 0x1e000
    buffer_load_dwordx4 v[76:79], v1, s[4:7], s62 offen sc1
    v_mfma_f32_32x32x16_bf16 v[160:175], a[252:255], v[44:47], v[160:175]
    ds_read_b128 a[248:251], v29 offset:5120
    buffer_load_dword v196, v2, s[4:7], s88 offen offset:1024 sc1
    s_waitcnt lgkmcnt(3)
    v_mfma_f32_32x32x16_bf16 v[176:191], v[44:47], a[224:227], 0
    ds_read_b128 a[252:255], v1 offset:12288
    buffer_load_dword v197, v2, s[4:7], s88 offen offset:1280 sc1
    s_waitcnt vmcnt(13)
    v_mfma_f32_32x32x16_bf16 v[144:159], a[228:231], v[48:51], v[144:159]
    ds_read_b128 a[224:227], v1 offset:13312
    buffer_load_dword v198, v2, s[4:7], s88 offen offset:1536 sc1
    s_add_u32 s62, s36, 0x2a000
    buffer_load_dwordx4 v[80:83], v1, s[4:7], s62 offen sc1
    v_mfma_f32_32x32x16_bf16 v[160:175], a[232:235], v[48:51], v[160:175]
    ds_read_b128 a[228:231], v29 offset:6144
    buffer_load_dword v199, v2, s[4:7], s88 offen offset:1792 sc1
    buffer_load_dword v200, v2, s[4:7], s88 offen offset:2048 sc1
    v_mfma_f32_32x32x16_bf16 v[176:191], v[48:51], a[236:239], v[176:191]
    ds_read_b128 a[232:235], v1 offset:14336
    buffer_load_dword v201, v2, s[4:7], s88 offen offset:2304 sc1
    s_waitcnt lgkmcnt(3)
    s_waitcnt vmcnt(17)
    v_mfma_f32_32x32x16_bf16 v[144:159], a[240:243], v[52:55], v[144:159]
    ds_read_b128 a[236:239], v1 offset:15360
    buffer_load_dword v202, v2, s[4:7], s88 offen offset:2560 sc1
    buffer_load_dwordx4 v[84:87], v1, s[4:7], s62 offen offset:1024 sc1
    v_mfma_f32_32x32x16_bf16 v[160:175], a[244:247], v[52:55], v[160:175]
    ds_read_b128 a[240:243], v29 offset:7168
    buffer_load_dword v203, v2, s[4:7], s88 offen offset:2816 sc1
    v_mfma_f32_32x32x16_bf16 v[176:191], v[52:55], a[248:251], v[176:191]
    ds_read_b128 a[244:247], v1 offset:16384
    s_add_u32 m0, s84, 2048
    s_nop 0
    buffer_load_dwordx4 v25, s[4:7], s89 offen sc1 lds
    buffer_load_dword v204, v2, s[4:7], s88 offen offset:3072 sc1
    buffer_load_dword v205, v2, s[4:7], s88 offen offset:3328 sc1
    s_waitcnt vmcnt(22)
    v_mfma_f32_32x32x16_bf16 v[144:159], a[252:255], v[56:59], v[144:159]
    ds_read_b128 a[248:251], v1 offset:17408
    s_sub_u32 m0, s84, 256
    s_nop 0
    buffer_load_dwordx4 v25, s[4:7], s89 offen offset:3072 sc1 lds
    buffer_load_dwordx4 v[88:91], v0, s[4:7], s62 offen offset:3072 sc1
    s_waitcnt lgkmcnt(3)
    v_mfma_f32_32x32x16_bf16 v[160:175], a[224:227], v[56:59], v[160:175]
    ds_read_b128 a[252:255], v29 offset:8192
    buffer_load_dword v208, v2, s[4:7], s90 offen sc1
    v_mfma_f32_32x32x16_bf16 v[176:191], v[56:59], a[228:231], v[176:191]
    ds_read_b128 a[224:227], v1 offset:18432
    buffer_load_dword v209, v2, s[4:7], s90 offen offset:256 sc1
    v_lshrrev_b32 v59, 2, v2
    v_not_b32 v59, v59
    v_mov_b32 v58, 0xff000000
    s_waitcnt vmcnt(25)
    v_mfma_f32_32x32x16_bf16 v[144:159], a[232:235], v[60:63], v[144:159]
    ds_read_b128 a[228:231], v1 offset:19456
    buffer_load_dword v210, v2, s[4:7], s90 offen offset:512 sc1
    s_add_u32 s62, s36, 0x2c000
    buffer_load_dwordx4 v[92:95], v1, s[4:7], s62 offen sc1
    buffer_load_dword v211, v2, s[4:7], s90 offen offset:640 sc1
    v_mfma_f32_32x32x16_bf16 v[160:175], a[236:239], v[60:63], v[160:175]
    ds_read_b128 a[232:235], v29 offset:9216
    s_lshr_b32 s22, s24, 1
    s_lshl_b32 s87, s22, 10
    s_sub_u32 s20, s22, 1
    s_sub_u32 s21, 0, s22
    s_and_b32 s22, s24, 1
    s_lshl3_add_u32 s87, s22, s87
    s_sub_u32 s18, 0, s22
    s_mov_b32 s19, s18
    s_andn2_b64 s[16:17], s[20:21], s[18:19]
    s_and_b64 s[18:19], s[20:21], s[18:19]
    s_waitcnt lgkmcnt(3)
    v_mfma_f32_32x32x16_bf16 v[176:191], v[60:63], a[240:243], v[176:191]
    ds_read_b128 a[236:239], v1 offset:20480
    v_and_b32 v9, 0x70, v1
    v_and_b32 v5, 64, v2
    v_xor_b32 v9, v9, v5
    v_lshrrev_b32 v5, 7, v1
    v_mul_u32_u24 v5, 896, v5
    s_waitcnt vmcnt(27)
    v_mfma_f32_32x32x16_bf16 v[144:159], a[244:247], v[64:67], v[144:159]
    ds_read_b128 a[240:243], v1 offset:21504
    s_add_u32 s62, s36, 0x38000
    buffer_load_dwordx4 v[96:99], v1, s[4:7], s62 offen sc1
    v_add_u32 v9, v9, v5
    v_add_u32 v5, 6144, v9
    v_mfma_f32_32x32x16_bf16 v[160:175], a[248:251], v[64:67], v[160:175]
    ds_read_b128 a[244:247], v29 offset:10240
    s_lshr_b32 s64, s25, 1
    s_lshl_b32 s64, s64, 7
    s_mul_i32 s22, s24, 100352
    s_add_u32 s64, s64, s22
    s_cmp_ge_u32 s25, 14
    s_cselect_b32 s64, 0x10000000, s64
    s_lshl_b32 s59, s55, 1
    v_mfma_f32_32x32x16_bf16 v[176:191], v[64:67], a[252:255], v[176:191]
    ds_read_b128 a[248:251], v1 offset:22528
    s_add_u32 s87, s87, 104448
    s_lshl_b32 s86, s24, 12
    s_add_u32 s84, s86, 90112
    s_sub_u32 s86, s86, 4096
    s_waitcnt lgkmcnt(3)
    s_waitcnt vmcnt(27)
    v_mfma_f32_32x32x16_bf16 v[144:159], a[224:227], v[68:71], v[144:159]
    ds_read_b128 a[252:255], v1 offset:23552
    buffer_load_dwordx4 v[100:103], v1, s[4:7], s62 offen offset:1024 sc1
    s_and_b32 s86, s86, 0x3000
    s_add_u32 s86, s86, 90112
    s_lshl_b32 s93, s24, 7
    v_mfma_f32_32x32x16_bf16 v[160:175], a[228:231], v[68:71], v[160:175]
    ds_read_b128 a[224:227], v29 offset:11264
    s_add_u32 s85, s93, 102016
    s_add_u32 s93, s93, 89216
    s_mov_b32 s94, 0xff000000
    s_mov_b32 s95, 0xff000000
    s_and_b32 s70, s31, 0xff
    v_mfma_f32_32x32x16_bf16 v[176:191], v[68:71], a[232:235], v[176:191]
    ds_read_b128 a[228:231], v1 offset:24576
    s_mov_b32 s71, s70
    v_lshrrev_b32 v59, v59, v58
    v_bfe_u32 v58, v1, 9, 1
    v_lshlrev_b32 v58, 2, v58
    v_lshrrev_b32 v59, v58, v59
    s_waitcnt vmcnt(26)
    v_mfma_f32_32x32x16_bf16 v[144:159], a[236:239], v[72:75], v[144:159]
    ds_read_b128 a[232:235], v1 offset:25600
    buffer_load_dwordx4 v[104:107], v0, s[4:7], s62 offen offset:3072 sc1
    v_not_b32 v59, v59
    v_bfe_i32 v44, v59, 0, 1
    s_waitcnt lgkmcnt(3)
    v_mfma_f32_32x32x16_bf16 v[160:175], a[240:243], v[72:75], v[160:175]
    ds_read_b128 a[236:239], v29 offset:12288
    v_bfe_i32 v45, v59, 1, 1
    v_bfe_i32 v46, v59, 2, 1
    v_bfe_i32 v47, v59, 3, 1
    v_bfe_i32 v48, v59, 8, 1
    v_bfe_i32 v49, v59, 9, 1
    v_mfma_f32_32x32x16_bf16 v[176:191], v[72:75], a[244:247], v[176:191]
    ds_read_b128 a[240:243], v1 offset:26624
    v_bfe_i32 v50, v59, 10, 1
    v_bfe_i32 v51, v59, 11, 1
    v_bfe_i32 v52, v59, 16, 1
    v_bfe_i32 v53, v59, 17, 1
    v_bfe_i32 v54, v59, 18, 1
    s_waitcnt vmcnt(23)
    v_mfma_f32_32x32x16_bf16 v[144:159], a[248:251], v[76:79], v[144:159]
    ds_read_b128 a[244:247], v1 offset:27648
    s_add_u32 s62, s36, 0x3a000
    buffer_load_dwordx4 v[108:111], v1, s[4:7], s62 offen sc1
    v_bfe_i32 v55, v59, 19, 1
    v_bfe_i32 v56, v59, 24, 1
    v_mfma_f32_32x32x16_bf16 v[160:175], a[252:255], v[76:79], v[160:175]
    ds_read_b128 a[248:251], v1 offset:28672
    v_bfe_i32 v57, v59, 25, 1
    v_bfe_i32 v58, v59, 26, 1
    v_bfe_i32 v59, v59, 27, 1
    s_waitcnt lgkmcnt(3)
    v_mfma_f32_32x32x16_bf16 v[176:191], v[76:79], a[224:227], v[176:191]
    ds_read_b128 a[252:255], v1 offset:29696
    s_waitcnt vmcnt(20)
    v_mfma_f32_32x32x16_bf16 v[144:159], a[228:231], v[80:83], v[144:159]
    ds_read_b128 a[224:227], v1 offset:30720
    s_add_u32 s62, s36, 0x46000
    buffer_load_dwordx4 v[112:115], v1, s[4:7], s62 offen sc1
    v_add_f32 v192, v192, v193
    v_add_f32 v194, v194, v195
    v_mfma_f32_32x32x16_bf16 v[160:175], a[232:235], v[80:83], v[160:175]
    ds_read_b128 a[228:231], v1 offset:31744
    v_add_f32 v196, v196, v197
    s_waitcnt vmcnt(20)
    v_add_f32 v198, v198, v199
    s_waitcnt vmcnt(18)
    v_add_f32 v200, v200, v201
    s_waitcnt vmcnt(15)
    v_add_f32 v202, v202, v203
    s_waitcnt vmcnt(12)
    v_add_f32 v204, v204, v205
    v_mfma_f32_32x32x16_bf16 v[176:191], v[80:83], a[236:239], v[176:191]
    ds_read_b128 a[232:235], v1 offset:32768
    v_add_f32 v192, v192, v194
    v_add_f32 v196, v196, v198
    v_add_f32 v200, v200, v202
    v_add_f32 v192, v192, v196
    s_waitcnt lgkmcnt(3)
    v_mfma_f32_32x32x16_bf16 v[144:159], a[240:243], v[84:87], v[144:159]
    ds_read_b128 a[236:239], v1 offset:33792
    buffer_load_dwordx4 v[116:119], v1, s[4:7], s62 offen offset:1024 sc1
    s_waitcnt vmcnt(6)
    ds_read_b128 v[224:227], v30 offset:2048
    ds_read_b128 v[228:231], v30 offset:2304
    v_mfma_f32_32x32x16_bf16 v[160:175], a[244:247], v[84:87], v[160:175]
    ds_read_b128 a[240:243], v1 offset:34816
    ds_read_b128 v[232:235], v30 offset:2560
    ds_read_b128 v[236:239], v30 offset:2816
    ds_read_b128 v[240:243], v30 offset:3072
    ds_read_b128 v[244:247], v30 offset:3328
    v_add_f32 v200, v200, v204
    v_add_f32 v192, v192, v200
    v_mov_b32 v216, v192
    v_mfma_f32_32x32x16_bf16 v[144:159], a[248:251], v[88:91], v[144:159]
    ds_read_b128 a[244:247], v31 offset:0
    buffer_load_dwordx4 v[120:123], v0, s[4:7], s62 offen offset:3072 sc1
    ds_read_b128 v[248:251], v30 offset:3584
    v_mov_b32 v217, v216
    s_nop 0
    v_mfma_f32_32x32x16_bf16 v[160:175], a[252:255], v[88:91], v[160:175]
    ds_read_b128 a[248:251], v1 offset:35840
    v_permlane32_swap_b32 v216, v217
    v_mul_f32 v216, 0xbb124925, v216
    v_mov_b32 v218, 0x3727c5ac
    v_fmac_f32 v218, 0x3b124925, v217
    s_waitcnt lgkmcnt(10)
    v_mfma_f32_32x32x16_bf16 v[144:159], a[224:227], v[92:95], v[144:159]
    ds_read_b128 a[252:255], v31 offset:2048
    s_add_u32 s62, s36, 0x48000
    buffer_load_dwordx4 v[124:127], v1, s[4:7], s62 offen sc1
    v_max3_u32 v27, v208, v209, v210
    s_waitcnt lgkmcnt(10)
    v_max3_u32 v27, v27, v211, v224
    v_mfma_f32_32x32x16_bf16 v[160:175], a[228:231], v[92:95], v[160:175]
    ds_read_b128 a[224:227], v1 offset:36864
    s_waitcnt lgkmcnt(8)
    v_max3_u32 v27, v27, v228, v232
    s_waitcnt lgkmcnt(6)
    v_max3_u32 v27, v27, v236, v240
    s_waitcnt lgkmcnt(3)
    v_max3_u32 v27, v27, v244, v248
    v_cmp_eq_u32 vcc, -1, v27
    s_cbranch_vccnz Lre_301
Lc_302:
    s_waitcnt vmcnt(7)
    v_mfma_f32_32x32x16_bf16 v[144:159], a[232:235], v[96:99], v[144:159]
    ds_read_b128 a[228:231], v31 offset:4096
    s_add_u32 s62, s36, 0x54000
    buffer_load_dwordx4 v[128:131], v1, s[4:7], s62 offen sc1
    ds_write_b128 v28, v[252:255] offset:2048
    v_mfma_f32_32x32x16_bf16 v[160:175], a[236:239], v[96:99], v[160:175]
    ds_read_b128 a[232:235], v1 offset:37888
    v_fma_f32 v219, -v216, v216, v218
    v_max_f32 v219, 0x3727c5ac, v219
    v_cvt_pk_bf16_f32 v20, v216, v216
    v_add_u32 v30, s85, v1
    s_waitcnt lgkmcnt(4)
    s_waitcnt vmcnt(7)
    v_mfma_f32_32x32x16_bf16 v[144:159], a[240:243], v[100:103], v[144:159]
    ds_read_b128 a[236:239], v31 offset:6144
    buffer_load_dwordx4 v[132:135], v1, s[4:7], s62 offen offset:1024 sc1
    ds_write_b128 v28, v[252:255] offset:3072
    v_mfma_f32_32x32x16_bf16 v[192:207], a[244:247], v[224:227], 0
    ds_read_b128 a[240:243], v1 offset:38912
    v_rsq_f32 v24, v219
    v_and_b32 v220, 0xffff0000, v20
    v_sub_f32 v220, v216, v220
    v_cvt_pk_bf16_f32 v21, v220, v220
    v_mfma_f32_32x32x16_bf16 v[160:175], a[248:251], v[100:103], v[160:175]
    ds_read_b128 a[244:247], v31 offset:8192
    v_mov_b32 v22, v20
    v_mov_b32 v23, v21
    v_mul_f32 v26, 0x3e8b97f6, v24
    v_lshrrev_b32 v25, 1, v3
    v_add_u32 v25, s93, v25
    v_mfma_f32_32x32x16_bf16 v[192:207], a[252:255], v[228:231], v[192:207]
    ds_read_b128 a[248:251], v1 offset:39936
    ds_write_b32 v25, v24
    s_waitcnt lgkmcnt(5)
    s_waitcnt vmcnt(7)
    v_mfma_f32_32x32x16_bf16 v[144:159], a[224:227], v[104:107], v[144:159]
    ds_read_b128 a[252:255], v31 offset:10240
    buffer_load_dwordx4 v[136:139], v0, s[4:7], s62 offen offset:3072 sc1
    s_mov_b32 s20, 0
    s_mov_b32 s21, -1
    v_cndmask_b32_e64 v211, 0, v211, s[20:21]
    v_mfma_f32_32x32x16_bf16 v[192:207], a[228:231], v[232:235], v[192:207]
    ds_read_b128 a[224:227], v1 offset:40960
    v_add_f32 v208, v208, v209
    v_add_f32 v210, v210, v211
    v_add_f32 v208, v208, v210
    v_mov_b32 v209, v208
    s_nop 0
    v_mfma_f32_32x32x16_bf16 v[160:175], a[232:235], v[104:107], v[160:175]
    ds_read_b128 a[228:231], v31 offset:12288
    v_permlane32_swap_b32 v208, v209
    v_add_f32 v208, v208, v209
    v_mov_b32 v209, v208
    s_nop 0
    s_nop 0
    v_permlane16_swap_b32 v208, v209
    v_mfma_f32_32x32x16_bf16 v[192:207], a[236:239], v[236:239], v[192:207]
    ds_read_b128 a[232:235], v1 offset:41984
    v_add_f32 v208, v208, v209
    s_nop 0
    s_nop 0
    v_mov_b32_dpp v210, v208 row_ror:8 row_mask:0xf bank_mask:0xf
    s_waitcnt lgkmcnt(3)
    s_waitcnt vmcnt(7)
    v_mfma_f32_32x32x16_bf16 v[144:159], a[240:243], v[108:111], v[144:159]
    ds_read_b128 a[236:239], v29 offset:29696
    s_add_u32 s62, s36, 0x56000
    buffer_load_dwordx4 v[140:143], v1, s[4:7], s62 offen sc1
    v_mfma_f32_32x32x16_bf16 v[192:207], a[244:247], v[240:243], v[192:207]
    ds_read_b128 a[240:243], v1 offset:43008
    s_mov_b32 s20, 0xff00ff00
    s_mov_b32 s21, 0xff00ff00
    v_cndmask_b32_e64 v209, v210, v208, s[20:21]
    v_cndmask_b32_e64 v208, v208, v210, s[20:21]
    v_mul_f32 v208, 0xbb124925, v208
    v_mfma_f32_32x32x16_bf16 v[160:175], a[248:251], v[108:111], v[160:175]
    ds_read_b128 a[244:247], v29 offset:29696
    v_mov_b32 v210, 0x3727c5ac
    v_fmac_f32 v210, 0x3b124925, v209
    v_fma_f32 v211, -v208, v208, v210
    v_max_f32 v211, 0x3727c5ac, v211
    v_cvt_pk_bf16_f32 v252, v208, v208
    v_mfma_f32_32x32x16_bf16 v[192:207], a[252:255], v[244:247], v[192:207]
    ds_read_b128 a[248:251], v1 offset:44032
    v_rsq_f32 v213, v211
    v_and_b32 v212, 0xffff0000, v252
    v_sub_f32 v212, v208, v212
    s_waitcnt lgkmcnt(3)
    s_waitcnt vmcnt(7)
    v_mfma_f32_32x32x16_bf16 v[144:159], a[224:227], v[112:115], v[144:159]
    ds_read_b128 a[252:255], v29 offset:28672
    v_cvt_pk_bf16_f32 v253, v212, v212
    v_cndmask_b32_e64 v254, 0, v252, s[18:19]
    v_cndmask_b32_e64 v255, 0, v253, s[18:19]
    v_cndmask_b32_e64 v252, 0, v252, s[16:17]
    v_cndmask_b32_e64 v253, 0, v253, s[16:17]
    v_mfma_f32_32x32x16_bf16 v[192:207], a[228:231], v[248:251], v[192:207]
    ds_read_b128 a[224:227], v1 offset:45056
    v_add_u32 v214, 89184, v10
    ds_write_b32 v214, v213
    v_mfma_f32_32x32x16_bf16 v[160:175], a[232:235], v[112:115], v[160:175]
    v_add_u32 v31, s55, v29
    ds_read_b128 a[228:231], v31 offset:0
    v_mfma_f32_32x32x16_bf16 v[144:159], a[236:239], v[20:23], v[144:159]
    ds_read_b128 a[232:235], v1 offset:46080
    s_waitcnt lgkmcnt(4)
    s_waitcnt vmcnt(6)
    v_mfma_f32_32x32x16_bf16 v[144:159], a[240:243], v[116:119], v[144:159]
    ds_read_b128 a[236:239], v31 offset:1024
    v_mfma_f32_32x32x16_bf16 v[192:207], a[244:247], v[252:255], v[192:207]
    ds_read_b128 a[240:243], v1 offset:47104
    v_mfma_f32_32x32x16_bf16 v[160:175], a[248:251], v[116:119], v[160:175]
    s_lshl_b32 s22, s24, 12
    s_add_u32 s22, s22, LstS2_1s-Lpc_3
    v_lshlrev_b32 v27, 2, v1
    buffer_load_dword v8, v27, s[12:15], s22 offen
    ds_read_b128 a[244:247], v31 offset:2048
    v_mfma_f32_32x32x16_bf16 v[160:175], a[252:255], v[20:23], v[160:175]
    ds_read_b128 a[248:251], v1 offset:48128
    s_nop 2
    v_cvt_pk_bf16_f32 v192, v192, v193
    v_cvt_pk_bf16_f32 v193, v194, v195
    v_cvt_pk_bf16_f32 v194, v196, v197
    v_cvt_pk_bf16_f32 v195, v198, v199
    s_waitcnt lgkmcnt(3)
    s_waitcnt vmcnt(6)
    v_mfma_f32_32x32x16_bf16 v[144:159], a[224:227], v[120:123], v[144:159]
    ds_read_b128 a[252:255], v31 offset:3072
    v_cvt_pk_bf16_f32 v196, v200, v201
    v_cvt_pk_bf16_f32 v197, v202, v203
    v_cvt_pk_bf16_f32 v198, v204, v205
    v_cvt_pk_bf16_f32 v199, v206, v207
    v_mfma_f32_32x32x16_bf16 v[208:223], v[224:227], a[228:231], 0
    ds_read_b128 a[224:227], v1 offset:49152
    s_mov_b64 exec, s[94:95]
    ds_write_b128 v30, v[192:195]
    ds_write_b128 v30, v[196:199] offset:1024
    s_mov_b64 exec, -1
    v_mfma_f32_32x32x16_bf16 v[160:175], a[232:235], v[120:123], v[160:175]
    ds_read_b128 a[228:231], v31 offset:4096
    v_add_u32 v224, s86, v1
    v_lshrrev_b32 v226, 5, v1
    v_and_b32 v226, 16, v226
    v_sub_u32 v25, v25, v226
    v_mfma_f32_32x32x16_bf16 v[208:223], v[228:231], a[236:239], v[208:223]
    ds_read_b128 a[232:235], v1 offset:50176
    s_waitcnt lgkmcnt(5)
    s_waitcnt vmcnt(5)
    v_mfma_f32_32x32x16_bf16 v[144:159], a[240:243], v[124:127], v[144:159]
    ds_read_b128 a[236:239], v31 offset:5120
    v_mfma_f32_32x32x16_bf16 v[208:223], v[232:235], a[244:247], v[208:223]
    ds_read_b128 a[240:243], v1 offset:51200
    v_bfi_b32 v228, 31, v226, v25
    v_subrev_u32 v229, 4, v25
    v_bfi_b32 v229, 31, v226, v229
    v_subrev_u32 v230, 8, v25
    v_bfi_b32 v230, 31, v226, v230
    v_mfma_f32_32x32x16_bf16 v[160:175], a[248:251], v[124:127], v[160:175]
    ds_read_b128 a[244:247], v31 offset:6144
    v_subrev_u32 v231, 12, v25
    v_bfi_b32 v231, 31, v226, v231
    v_cndmask_b32_e64 v232, 0, v44, s[70:71]
    v_cndmask_b32_e64 v233, 0, v45, s[70:71]
    v_cndmask_b32_e64 v234, 0, v46, s[70:71]
    v_mfma_f32_32x32x16_bf16 v[208:223], v[236:239], a[252:255], v[208:223]
    ds_read_b128 a[248:251], v1 offset:52224
    v_cndmask_b32_e64 v235, 0, v47, s[70:71]
    v_perm_b32 v236, v45, v44, s53
    v_perm_b32 v237, v47, v46, s53
    v_perm_b32 v238, v49, v48, s53
    s_waitcnt lgkmcnt(3)
    s_waitcnt vmcnt(4)
    v_mfma_f32_32x32x16_bf16 v[144:159], a[224:227], v[128:131], v[144:159]
    ds_read_b128 a[252:255], v29 offset:30720
    v_perm_b32 v239, v51, v50, s53
    v_mfma_f32_32x32x16_bf16 v[208:223], v[240:243], a[228:231], v[208:223]
    ds_read_b128 a[224:227], v1 offset:53248
    v_perm_b32 v240, v53, v52, s53
    v_perm_b32 v241, v55, v54, s53
    v_perm_b32 v242, v57, v56, s53
    v_perm_b32 v243, v59, v58, s53
    v_mfma_f32_32x32x16_bf16 v[160:175], a[232:235], v[128:131], v[160:175]
    ds_read_b128 a[228:231], v1 offset:54272
    v_mfma_f32_32x32x16_bf16 v[208:223], v[244:247], a[236:239], v[208:223]
    ds_read_b128 a[232:235], v1 offset:55296
    v_cndmask_b32_e64 v244, 0, v236, s[70:71]
    v_cndmask_b32_e64 v245, 0, v237, s[70:71]
    v_add_u32 v225, s87, v1
    s_lshl2_add_u32 s93, s25, s101
    s_waitcnt lgkmcnt(3)
    s_waitcnt vmcnt(3)
    v_mfma_f32_32x32x16_bf16 v[144:159], a[240:243], v[132:135], v[144:159]
    ds_read_b128 a[236:239], v1 offset:56320
    v_mfma_f32_32x32x16_bf16 v[208:223], v[248:251], a[244:247], v[208:223]
    ds_read_b128 a[240:243], v29 offset:0
    v_mov_b32 v248, -1
    v_lshlrev_b32 v249, 1, v1
    v_mfma_f32_32x32x16_bf16 v[160:175], a[248:251], v[132:135], v[160:175]
    ds_read_b128 a[244:247], v29 offset:1024
    v_mfma_f32_32x32x16_bf16 v[208:223], v[252:255], a[252:255], v[208:223]
    ds_read_b128 a[248:251], v29 offset:2048
    s_waitcnt lgkmcnt(3)
    s_waitcnt vmcnt(2)
    v_mfma_f32_32x32x16_bf16 v[144:159], a[224:227], v[136:139], v[144:159]
    ds_read_b128 a[252:255], v29 offset:13312
    v_mfma_f32_32x32x16_bf16 v[160:175], a[228:231], v[136:139], v[160:175]
    ds_read_b128 a[224:227], v29 offset:14336
    buffer_store_dword v248, v249, s[4:7], s57 offen offset:2048
    s_add_u32 s22, s57, 4096
    buffer_store_dword v248, v249, s[4:7], s22 offen offset:1024
    s_waitcnt vmcnt(3)
    v_mfma_f32_32x32x16_bf16 v[144:159], a[232:235], v[140:143], v[144:159]
    ds_read_b128 a[228:231], v29 offset:15360
    v_cvt_pk_bf16_f32 v246, v220, v221
    v_cvt_pk_bf16_f32 v247, v222, v223
    v_mfma_f32_32x32x16_bf16 v[160:175], a[236:239], v[140:143], v[160:175]
    ds_read_b128 a[232:235], v29 offset:16384
    s_waitcnt lgkmcnt(3)
    v_mfma_f32_32x32x16_bf16 v[176:191], v[32:35], a[240:243], v[176:191]
    ds_read_b128 a[236:239], v29 offset:17408
    s_nop 3
    v_cvt_pk_bf16_f32 v144, v144, v145
    v_cvt_pk_bf16_f32 v145, v146, v147
    v_cvt_pk_bf16_f32 v146, v148, v149
    v_cvt_pk_bf16_f32 v147, v150, v151
    v_cvt_pk_bf16_f32 v148, v152, v153
    v_mfma_f32_32x32x16_bf16 v[176:191], v[36:39], a[244:247], v[176:191]
    v_cvt_pk_bf16_f32 v149, v154, v155
    v_cvt_pk_bf16_f32 v150, v156, v157
    v_cvt_pk_bf16_f32 v151, v158, v159
    s_cmp_eq_u32 s24, 3
    s_cbranch_scc1 Lk_303
    s_mov_b64 exec, s[94:95]
    ds_write_b128 v28, v[144:147]
    ds_write_b128 v28, v[148:151] offset:1024
    s_mov_b64 exec, -1
Lk_303:
    v_mfma_f32_32x32x16_bf16 v[176:191], v[40:43], a[248:251], v[176:191]
    v_cvt_pk_bf16_f32 v160, v160, v161
    v_cvt_pk_bf16_f32 v161, v162, v163
    s_waitcnt lgkmcnt(0)
    s_barrier
    ds_read_b128 v[152:155], v224
    ds_read_b128 v[156:159], v224 offset:1024
    v_mfma_f32_32x32x16_bf16 v[176:191], v[84:87], a[252:255], v[176:191]
    s_add_u32 m0, s59, 0x0
    s_nop 0
    buffer_load_dwordx4 v9, s[40:43], s64 offen lds
    v_mfma_f32_32x32x16_bf16 v[176:191], v[88:91], a[224:227], v[176:191]
    buffer_load_dwordx4 v5, s[40:43], s64 offen offset:1024 lds
    v_cvt_pk_bf16_f32 v162, v164, v165
    v_cvt_pk_bf16_f32 v163, v166, v167
    v_mfma_f32_32x32x16_bf16 v[176:191], v[92:95], a[228:231], v[176:191]
    ds_read_b128 a[240:243], v29 offset:18432
    s_add_u32 m0, s59, 0x800
    s_add_u32 s64, s64, 14336
    buffer_load_dwordx4 v9, s[40:43], s64 offen lds
    v_mfma_f32_32x32x16_bf16 v[176:191], v[96:99], a[232:235], v[176:191]
    ds_read_b128 a[244:247], v29 offset:19456
    buffer_load_dwordx4 v5, s[40:43], s64 offen offset:1024 lds
    v_cvt_pk_bf16_f32 v164, v168, v169
    v_cvt_pk_bf16_f32 v165, v170, v171
    v_cvt_pk_bf16_f32 v166, v172, v173
    v_cvt_pk_bf16_f32 v167, v174, v175
    v_mfma_f32_32x32x16_bf16 v[176:191], v[100:103], a[236:239], v[176:191]
    ds_read_b128 a[248:251], v29 offset:20480
    ds_read_b32 v228, v228 offset:0
    ds_read_b32 v229, v229 offset:4
    ds_read_b32 v230, v230 offset:8
    ds_read_b32 v231, v231 offset:12
    s_waitcnt lgkmcnt(8)
    v_mfma_f32_32x32x16_bf16 v[208:223], v[152:155], v[160:163], 0
    ds_read_b128 a[252:255], v29 offset:21504
    s_add_u32 m0, s59, 0x1000
    s_add_u32 s64, s64, 14336
    buffer_load_dwordx4 v9, s[40:43], s64 offen lds
    v_mfma_f32_32x32x16_bf16 v[60:75], v[144:147], v[160:163], v[44:59]
    ds_read_b128 a[224:227], v29 offset:22528
    buffer_load_dwordx4 v5, s[40:43], s64 offen offset:1024 lds
    s_waitcnt lgkmcnt(9)
    v_mfma_f32_32x32x16_bf16 v[208:223], v[156:159], v[164:167], v[208:223]
    ds_read_b128 a[228:231], v29 offset:23552
    s_add_u32 m0, s59, 0x1800
    s_add_u32 s64, s64, 14336
    buffer_load_dwordx4 v9, s[40:43], s64 offen lds
    v_mfma_f32_32x32x16_bf16 v[60:75], v[148:151], v[164:167], v[60:75]
    ds_read_b128 a[232:235], v29 offset:24576
    buffer_load_dwordx4 v5, s[40:43], s64 offen offset:1024 lds
    s_waitcnt lgkmcnt(3)
    v_mfma_f32_32x32x16_bf16 v[176:191], v[104:107], a[240:243], v[176:191]
    ds_read_b128 a[236:239], v29 offset:25600
    s_nop 1
    v_add_f32 v208, v208, v212
    v_add_f32 v209, v209, v213
    v_add_f32 v210, v210, v214
    v_add_f32 v211, v211, v215
    v_add_f32 v216, v216, v220
    v_mfma_f32_32x32x16_bf16 v[176:191], v[108:111], a[244:247], v[176:191]
    ds_read_b128 a[240:243], v29 offset:26624
    s_add_u32 m0, s59, 0x2000
    s_add_u32 s64, s64, 14336
    buffer_load_dwordx4 v9, s[40:43], s64 offen lds
    v_mfma_f32_32x32x16_bf16 v[176:191], v[112:115], a[248:251], v[176:191]
    ds_read_b128 a[244:247], v29 offset:27648
    buffer_load_dwordx4 v5, s[40:43], s64 offen offset:1024 lds
    v_add_f32 v217, v217, v221
    v_mfma_f32_32x32x16_bf16 v[176:191], v[116:119], a[252:255], v[176:191]
    ds_read_b128 a[248:251], v29 offset:30720
    s_add_u32 m0, s59, 0x2800
    s_add_u32 s64, s64, 14336
    buffer_load_dwordx4 v9, s[40:43], s64 offen lds
    s_waitcnt lgkmcnt(3)
    v_mfma_f32_32x32x16_bf16 v[176:191], v[120:123], a[224:227], v[176:191]
    buffer_load_dwordx4 v5, s[40:43], s64 offen offset:1024 lds
    v_add_f32 v218, v218, v222
    v_add_f32 v219, v219, v223
    v_mfma_f32_32x32x16_bf16 v[176:191], v[124:127], a[228:231], v[176:191]
    v_add_f32 v208, v208, v216
    v_add_f32 v209, v209, v217
    v_add_f32 v210, v210, v218
    v_add_f32 v211, v211, v219
    v_max3_f32 v60, v60, v64, v68
    v_max3_f32 v61, v61, v65, v69
    v_mfma_f32_32x32x16_bf16 v[176:191], v[128:131], a[232:235], v[176:191]
    s_add_u32 m0, s59, 0x3000
    s_add_u32 s64, s64, 14336
    buffer_load_dwordx4 v9, s[40:43], s64 offen lds
    v_mfma_f32_32x32x16_bf16 v[176:191], v[132:135], a[236:239], v[176:191]
    v_max3_f32 v62, v62, v66, v70
    v_max3_f32 v63, v63, v67, v71
    v_bfi_b32 v208, v232, v208, -1
    v_bfi_b32 v209, v233, v209, -1
    v_bfi_b32 v210, v234, v210, -1
    s_waitcnt lgkmcnt(0)
    v_mfma_f32_32x32x16_bf16 v[176:191], v[136:139], a[240:243], v[176:191]
    buffer_load_dwordx4 v5, s[40:43], s64 offen offset:1024 lds
    v_bfi_b32 v211, v235, v211, -1
    v_max3_f32 v208, v208, v60, v72
    v_mfma_f32_32x32x16_bf16 v[176:191], v[140:143], a[244:247], v[176:191]
    v_max3_f32 v209, v209, v61, v73
    v_max3_f32 v210, v210, v62, v74
    v_max3_f32 v211, v211, v63, v75
    v_mul_f32 v208, v208, v228
    v_mul_f32 v209, v209, v229
    v_mul_f32 v210, v210, v230
    v_mfma_f32_32x32x16_bf16 v[176:191], v[20:23], a[248:251], v[176:191]
    v_mul_f32 v211, v211, v231
    v_max_f32 v212, v208, v209
    v_max3_f32 v212, v212, v210, v211
    v_mov_b32 v213, v212
    s_nop 1
    v_permlane32_swap_b32 v212, v213
    v_max_f32 v212, v212, v213
    v_mul_f32 v212, v212, v26
    v_fma_f32 v208, v208, v26, -v212
    v_fma_f32 v209, v209, v26, -v212
    v_fma_f32 v210, v210, v26, -v212
    v_fma_f32 v211, v211, v26, -v212
    v_exp_f32_e64 v208, v208 clamp
    v_exp_f32_e64 v209, v209 clamp
    v_exp_f32_e64 v210, v210 clamp
    v_exp_f32_e64 v211, v211 clamp
    v_add_f32 v212, v208, v209
    v_add_f32 v213, v210, v211
    v_add_f32 v212, v212, v213
    v_mov_b32 v213, v212
    v_mul_f32 v208, v208, v228
    v_mul_f32 v209, v209, v229
    v_permlane32_swap_b32 v212, v213
    v_add_f32 v212, v212, v213
    v_rcp_f32 v212, v212
    v_mul_f32 v210, v210, v230
    v_mul_f32 v211, v211, v231
    v_mul_f32 v208, v208, v212
    v_mul_f32 v209, v209, v212
    v_mul_f32 v210, v210, v212
    v_mul_f32 v211, v211, v212
    v_cvt_pk_bf16_f32 v212, v208, v209
    v_cvt_pk_bf16_f32 v213, v210, v211
    v_bfi_b32 v192, v236, 0, v212
    v_bfi_b32 v193, v237, 0, v213
    v_bfi_b32 v194, v238, 0, v212
    v_bfi_b32 v195, v239, 0, v213
    v_bfi_b32 v196, v240, 0, v212
    v_bfi_b32 v197, v241, 0, v213
    v_bfi_b32 v198, v242, 0, v212
    v_bfi_b32 v199, v243, 0, v213
    v_and_b32 v200, v244, v212
    v_and_b32 v201, v245, v213
    v_and_b32 v202, v244, v212
    v_and_b32 v203, v245, v213
    v_cvt_pk_bf16_f32 v66, v188, v189
    v_cvt_pk_bf16_f32 v67, v190, v191
    ds_write_b64 v28, v[66:67] offset:3080
    ds_write_b64 v225, v[246:247]
    v_cvt_pk_bf16_f32 v60, v176, v177
    v_cvt_pk_bf16_f32 v61, v178, v179
    v_cvt_pk_bf16_f32 v62, v180, v181
    v_cvt_pk_bf16_f32 v63, v182, v183
    v_cvt_pk_bf16_f32 v64, v184, v185
    v_cvt_pk_bf16_f32 v65, v186, v187
    v_mfma_f32_32x32x16_bf16 v[44:59], v[60:63], v[192:195], 0
    s_waitcnt lgkmcnt(0)
    s_barrier
    ds_read_b128 v[168:171], v224 offset:2048
    ds_read_b128 v[172:175], v224 offset:3072
    v_mfma_f32_32x32x16_bf16 v[44:59], v[64:67], v[196:199], v[44:59]
    s_waitcnt lgkmcnt(1)
    v_mfma_f32_32x32x16_bf16 v[44:59], v[168:171], v[200:203], v[44:59]
    s_waitcnt lgkmcnt(0)
    v_mfma_f32_32x32x16_bf16 v[44:59], v[172:175], v[200:203], v[44:59]
    v_or_b32_e64 v27, s3, 1
    s_nop 10
    v_cvt_pk_bf16_f32 v44, v44, v45
    v_cvt_pk_bf16_f32 v45, v46, v47
    v_cvt_pk_bf16_f32 v46, v48, v49
    v_cvt_pk_bf16_f32 v47, v50, v51
    s_waitcnt vmcnt(14)
    buffer_store_dwordx4 v[44:47], v1, s[4:7], s57 offen offset:2048 sc1
    v_cvt_pk_bf16_f32 v48, v52, v53
    v_cvt_pk_bf16_f32 v49, v54, v55
    v_cvt_pk_bf16_f32 v50, v56, v57
    v_cvt_pk_bf16_f32 v51, v58, v59
    buffer_store_dwordx4 v[48:51], v1, s[4:7], s57 offen offset:3072 sc1
    s_waitcnt vmcnt(0)
    buffer_store_dword v27, v6, s[4:7], s93 offen sc1
LstS2_1s:
    s_add_u32 m0, s55, 0xe000
    s_add_u32 s65, s39, 0x2a000
    buffer_load_dwordx4 v1, s[4:7], s65 offen lds
    buffer_load_dwordx4 v1, s[4:7], s65 offen offset:1024 lds
    buffer_load_dwordx4 v1, s[4:7], s65 offen offset:2048 lds
    buffer_load_dwordx4 v1, s[4:7], s65 offen offset:3072 lds
    s_add_u32 m0, s55, 0xf000
    s_nop 0
    buffer_load_dwordx4 v0, s[4:7], s65 offen lds
    buffer_load_dwordx4 v0, s[4:7], s65 offen offset:1024 lds
    buffer_load_dwordx4 v0, s[4:7], s65 offen offset:2048 lds
    s_cmp_ge_u32 s25, 14
    s_cbranch_scc1 Lidle_304
    s_and_b32 s86, s24, 1
    s_lshl_b32 s87, s86, 5
    s_andn2_b32 s85, s100, 63
    s_add_u32 s85, s85, s87
    buffer_load_dword v8, v10, s[4:7], s85 offen sc1
    s_add_u32 s68, s3, 1
    s_lshl_b32 s87, s86, 1
    s_sub_u32 s87, s87, s24
    s_mul_i32 s87, s87, 114688
    s_add_u32 s84, s87, s46
    s_mul_i32 s87, s86, 28736
    s_add_u32 s87, s87, 0
    v_and_b32 v146, 0x58, v3
    v_and_b32 v147, 0x60, v3
    v_lshl_add_u32 v146, v147, 2, v146
    v_bfe_u32 v147, v3, 7, 1
    v_lshl_add_u32 v146, v147, 5, v146
    v_xor_b32 v146, s87, v146
    v_xor_b32 v147, 64, v146
    v_and_b32 v145, 0x200, v1
    v_add_u32 v144, v145, v146
    v_add_u32 v145, v145, v147
    s_lshl_b32 s87, s24, 12
    s_add_u32 s87, s87, 90112
    v_add_u32 v31, s87, v1
    v_xor_b32 v28, 0x1000, v31
    v_lshlrev_b32 v176, 16, v12
    v_and_b32 v177, 0xffff0000, v12
    v_lshlrev_b32 v178, 16, v13
    v_and_b32 v179, 0xffff0000, v13
    v_lshlrev_b32 v180, 16, v14
    v_and_b32 v181, 0xffff0000, v14
    v_lshlrev_b32 v182, 16, v15
    v_and_b32 v183, 0xffff0000, v15
    v_lshlrev_b32 v184, 16, v16
    v_and_b32 v185, 0xffff0000, v16
    v_lshlrev_b32 v186, 16, v17
    v_and_b32 v187, 0xffff0000, v17
    v_lshlrev_b32 v188, 16, v18
    v_and_b32 v189, 0xffff0000, v18
    v_lshlrev_b32 v190, 16, v19
    v_and_b32 v191, 0xffff0000, v19
    s_add_u32 s92, s57, 0x1400
    s_add_u32 s93, s49, 0x8000
    v_or_b32_e64 v162, s3, 2
    s_barrier
    ds_read_b64_tr_b16 v[96:97], v145 offset:0
    ds_read_b64_tr_b16 v[98:99], v145 offset:1024
    ds_read_b64_tr_b16 v[100:101], v144 offset:0
    ds_read_b64_tr_b16 v[102:103], v144 offset:1024
    ds_read_b64_tr_b16 v[104:105], v145 offset:2048
    ds_read_b64_tr_b16 v[106:107], v147 offset:3072
    ds_read_b64_tr_b16 v[108:109], v144 offset:2048
    ds_read_b64_tr_b16 v[110:111], v146 offset:3072
    ds_read_b64_tr_b16 v[112:113], v145 offset:3584
    ds_read_b64_tr_b16 v[114:115], v145 offset:4608
    ds_read_b64_tr_b16 v[116:117], v144 offset:3584
    ds_read_b64_tr_b16 v[118:119], v144 offset:4608
    ds_read_b64_tr_b16 v[120:121], v145 offset:5632
    ds_read_b64_tr_b16 v[122:123], v147 offset:6656
    ds_read_b64_tr_b16 v[124:125], v144 offset:5632
    ds_read_b64_tr_b16 v[126:127], v146 offset:6656
    ds_read_b64_tr_b16 v[128:129], v145 offset:7168
    ds_read_b64_tr_b16 v[130:131], v145 offset:8192
    ds_read_b64_tr_b16 v[132:133], v144 offset:7168
    ds_read_b64_tr_b16 v[134:135], v144 offset:8192
    ds_read_b64_tr_b16 v[136:137], v145 offset:9216
    ds_read_b64_tr_b16 v[138:139], v147 offset:10240
    ds_read_b64_tr_b16 v[140:141], v144 offset:9216
    ds_read_b64_tr_b16 v[142:143], v146 offset:10240
    ds_read_b64_tr_b16 v[224:225], v145 offset:10752
    ds_read_b64_tr_b16 v[226:227], v145 offset:11776
    ds_read_b64_tr_b16 v[228:229], v144 offset:10752
    ds_read_b64_tr_b16 v[230:231], v144 offset:11776
    ds_read_b64_tr_b16 v[232:233], v145 offset:12800
    ds_read_b64_tr_b16 v[234:235], v147 offset:13824
    ds_read_b64_tr_b16 v[236:237], v144 offset:12800
    ds_read_b64_tr_b16 v[238:239], v146 offset:13824
    ds_read_b64_tr_b16 v[240:241], v145 offset:14336
    ds_read_b64_tr_b16 v[242:243], v145 offset:15360
    ds_read_b64_tr_b16 v[244:245], v145 offset:16384
    ds_read_b64_tr_b16 v[246:247], v147 offset:17408
    ds_read_b64_tr_b16 v[248:249], v145 offset:17920
    ds_read_b64_tr_b16 v[250:251], v145 offset:18944
    ds_read_b64_tr_b16 v[252:253], v145 offset:19968
    ds_read_b64_tr_b16 v[254:255], v147 offset:20992
    ds_read_b64_tr_b16 a[224:225], v145 offset:21504
    ds_read_b64_tr_b16 a[226:227], v145 offset:22528
    ds_read_b64_tr_b16 a[228:229], v145 offset:23552
    ds_read_b64_tr_b16 a[230:231], v147 offset:24576
    ds_read_b64_tr_b16 a[232:233], v145 offset:25088
    ds_read_b64_tr_b16 a[234:235], v145 offset:26112
    ds_read_b64_tr_b16 a[236:237], v145 offset:27136
    ds_read_b64_tr_b16 a[238:239], v147 offset:28160
    ds_read_b64_tr_b16 a[240:241], v144 offset:14336
    ds_read_b64_tr_b16 a[242:243], v144 offset:15360
    ds_read_b64_tr_b16 a[244:245], v144 offset:16384
    ds_read_b64_tr_b16 a[246:247], v146 offset:17408
    ds_read_b64_tr_b16 a[248:249], v144 offset:17920
    ds_read_b64_tr_b16 a[250:251], v144 offset:18944
    ds_read_b64_tr_b16 a[252:253], v144 offset:19968
    ds_read_b64_tr_b16 a[254:255], v146 offset:20992
    ds_read_b64_tr_b16 v[208:209], v144 offset:21504
    ds_read_b64_tr_b16 v[210:211], v144 offset:22528
    ds_read_b64_tr_b16 v[212:213], v144 offset:23552
    ds_read_b64_tr_b16 v[214:215], v146 offset:24576
    ds_read_b64_tr_b16 v[216:217], v144 offset:25088
    ds_read_b64_tr_b16 v[218:219], v144 offset:26112
    ds_read_b64_tr_b16 v[220:221], v144 offset:27136
    ds_read_b64_tr_b16 v[222:223], v146 offset:28160
    buffer_load_dword v9, v10, s[4:7], s85 offen sc1
Lp_305:
    s_waitcnt vmcnt(1)
    v_subrev_u32 v8, s68, v8
    v_cmp_le_u32 vcc, 16, v8
    s_cbranch_vccz Lo_306
    buffer_load_dword v8, v10, s[4:7], s85 offen sc1
    s_waitcnt vmcnt(1)
    v_subrev_u32 v9, s68, v9
    v_cmp_le_u32 vcc, 16, v9
    s_cbranch_vccz Lo_306
    buffer_load_dword v9, v10, s[4:7], s85 offen sc1
    s_sub_u32 s30, s30, 1
    s_cbranch_scc0 Lp_305
    s_mov_b32 s30, 0
Lo_306:
    buffer_load_dwordx4 v[32:35], v1, s[4:7], s84 offen offset:2048 sc1
    buffer_load_dwordx4 v[36:39], v1, s[4:7], s84 offen offset:3072 sc1
    s_add_u32 s67, s84, 0x6000
    buffer_load_dwordx4 v[40:43], v0, s[4:7], s67 offen offset:2048 sc1
    buffer_load_dwordx4 v[44:47], v0, s[4:7], s67 offen offset:3072 sc1
    s_add_u32 s67, s84, 0xe000
    buffer_load_dwordx4 v[48:51], v1, s[4:7], s67 offen offset:2048 sc1
    buffer_load_dwordx4 v[52:55], v1, s[4:7], s67 offen offset:3072 sc1
    s_add_u32 s67, s84, 0x14000
    buffer_load_dwordx4 v[56:59], v0, s[4:7], s67 offen offset:2048 sc1
    buffer_load_dwordx4 v[60:63], v0, s[4:7], s67 offen offset:3072 sc1
    s_waitcnt vmcnt(7) lgkmcnt(15)
    v_mfma_f32_32x32x16_bf16 v[192:207], v[96:99], v[32:35], 0
    s_add_u32 s67, s84, 0x1c000
    buffer_load_dwordx4 v[64:67], v1, s[4:7], s67 offen offset:2048 sc1
    v_mfma_f32_32x32x16_bf16 v[176:191], v[100:103], v[32:35], v[176:191]
    buffer_load_dwordx4 v[68:71], v1, s[4:7], s67 offen offset:3072 sc1
    s_waitcnt vmcnt(8)
    v_mfma_f32_32x32x16_bf16 v[192:207], v[104:107], v[36:39], v[192:207]
    s_add_u32 s67, s84, 0x22000
    buffer_load_dwordx4 v[72:75], v0, s[4:7], s67 offen offset:2048 sc1
    v_mfma_f32_32x32x16_bf16 v[176:191], v[108:111], v[36:39], v[176:191]
    buffer_load_dwordx4 v[76:79], v0, s[4:7], s67 offen offset:3072 sc1
    s_waitcnt vmcnt(9)
    v_mfma_f32_32x32x16_bf16 v[192:207], v[112:115], v[40:43], v[192:207]
    s_add_u32 s67, s84, 0x2a000
    buffer_load_dwordx4 v[80:83], v1, s[4:7], s67 offen offset:2048 sc1
    v_mfma_f32_32x32x16_bf16 v[176:191], v[116:119], v[40:43], v[176:191]
    buffer_load_dwordx4 v[84:87], v1, s[4:7], s67 offen offset:3072 sc1
    s_waitcnt vmcnt(10)
    v_mfma_f32_32x32x16_bf16 v[192:207], v[120:123], v[44:47], v[192:207]
    s_add_u32 s67, s84, 0x30000
    buffer_load_dwordx4 v[88:91], v0, s[4:7], s67 offen offset:2048 sc1
    v_mfma_f32_32x32x16_bf16 v[176:191], v[124:127], v[44:47], v[176:191]
    buffer_load_dwordx4 v[92:95], v0, s[4:7], s67 offen offset:3072 sc1
    s_waitcnt vmcnt(11)
    v_mfma_f32_32x32x16_bf16 v[192:207], v[128:131], v[48:51], v[192:207]
    v_mfma_f32_32x32x16_bf16 v[176:191], v[132:135], v[48:51], v[176:191]
    s_waitcnt vmcnt(10)
    v_mfma_f32_32x32x16_bf16 v[192:207], v[136:139], v[52:55], v[192:207]
    s_lshl_b32 s22, s24, 12
    s_add_u32 s22, s22, LstS3_1s-Lpc_3
    v_lshlrev_b32 v27, 2, v1
    buffer_load_dword v8, v27, s[12:15], s22 offen
    v_mfma_f32_32x32x16_bf16 v[176:191], v[140:143], v[52:55], v[176:191]
    s_waitcnt vmcnt(10)
    v_mfma_f32_32x32x16_bf16 v[192:207], v[224:227], v[56:59], v[192:207]
    v_mfma_f32_32x32x16_bf16 v[176:191], v[228:231], v[56:59], v[176:191]
    s_waitcnt vmcnt(9)
    v_mfma_f32_32x32x16_bf16 v[192:207], v[232:235], v[60:63], v[192:207]
    s_waitcnt lgkmcnt(0)
    s_barrier
    v_mfma_f32_32x32x16_bf16 v[176:191], v[236:239], v[60:63], v[176:191]
    s_waitcnt vmcnt(8)
    v_mfma_f32_32x32x16_bf16 v[192:207], v[240:243], v[64:67], v[192:207]
    s_waitcnt vmcnt(7)
    v_mfma_f32_32x32x16_bf16 v[192:207], v[244:247], v[68:71], v[192:207]
    s_waitcnt vmcnt(6)
    v_mfma_f32_32x32x16_bf16 v[192:207], v[248:251], v[72:75], v[192:207]
    s_add_u32 m0, s55, 0x0
    s_add_u32 s69, s39, 0x23000
    buffer_load_dwordx4 v1, s[4:7], s69 offen lds
    s_waitcnt vmcnt(6)
    v_mfma_f32_32x32x16_bf16 v[192:207], v[252:255], v[76:79], v[192:207]
    s_waitcnt vmcnt(5)
    v_mfma_f32_32x32x16_bf16 v[192:207], a[224:227], v[80:83], v[192:207]
    s_waitcnt vmcnt(4)
    v_mfma_f32_32x32x16_bf16 v[192:207], a[228:231], v[84:87], v[192:207]
    buffer_load_dwordx4 v1, s[4:7], s69 offen offset:1024 lds
    s_waitcnt vmcnt(4)
    v_mfma_f32_32x32x16_bf16 v[192:207], a[232:235], v[88:91], v[192:207]
    s_waitcnt vmcnt(3)
    v_mfma_f32_32x32x16_bf16 v[192:207], a[236:239], v[92:95], v[192:207]
    buffer_load_dwordx4 v1, s[4:7], s69 offen offset:2048 lds
    v_mfma_f32_32x32x16_bf16 v[176:191], a[240:243], v[64:67], v[176:191]
    v_mfma_f32_32x32x16_bf16 v[176:191], a[244:247], v[68:71], v[176:191]
    s_nop 8
    ds_write_b128 v28, v[192:195] offset:0
    buffer_load_dwordx4 v1, s[4:7], s69 offen offset:3072 lds
    s_add_u32 m0, s55, 0x1000
    v_mfma_f32_32x32x16_bf16 v[176:191], a[248:251], v[72:75], v[176:191]
    ds_write_b128 v28, v[196:199] offset:1024
    v_mfma_f32_32x32x16_bf16 v[176:191], a[252:255], v[76:79], v[176:191]
    ds_write_b128 v28, v[200:203] offset:2048
    buffer_load_dwordx4 v0, s[4:7], s69 offen lds
    v_mfma_f32_32x32x16_bf16 v[176:191], v[208:211], v[80:83], v[176:191]
    ds_write_b128 v28, v[204:207] offset:3072
    v_mfma_f32_32x32x16_bf16 v[176:191], v[212:215], v[84:87], v[176:191]
    buffer_load_dwordx4 v0, s[4:7], s69 offen offset:1024 lds
    v_mfma_f32_32x32x16_bf16 v[176:191], v[216:219], v[88:91], v[176:191]
    v_mfma_f32_32x32x16_bf16 v[176:191], v[220:223], v[92:95], v[176:191]
    buffer_load_dwordx4 v0, s[4:7], s69 offen offset:2048 lds
    s_waitcnt lgkmcnt(0)
    s_barrier
    ds_read_b128 v[192:195], v31 offset:0
    ds_read_b128 v[196:199], v31 offset:1024
    ds_read_b128 v[200:203], v31 offset:2048
    ds_read_b128 v[204:207], v31 offset:3072
    s_waitcnt lgkmcnt(3)
    s_nop 3
    v_pk_add_f32 v[176:177], v[176:177], v[192:193]
    v_pk_add_f32 v[178:179], v[178:179], v[194:195]
    v_cvt_pk_bf16_f32 v12, v176, v177
    v_cvt_pk_bf16_f32 v13, v178, v179
    s_waitcnt lgkmcnt(2)
    v_pk_add_f32 v[180:181], v[180:181], v[196:197]
    v_pk_add_f32 v[182:183], v[182:183], v[198:199]
    v_cvt_pk_bf16_f32 v14, v180, v181
    v_cvt_pk_bf16_f32 v15, v182, v183
    buffer_store_dwordx4 v[12:15], v1, s[4:7], s92 offen sc1
    s_waitcnt lgkmcnt(1)
    v_pk_add_f32 v[184:185], v[184:185], v[200:201]
    v_pk_add_f32 v[186:187], v[186:187], v[202:203]
    v_cvt_pk_bf16_f32 v16, v184, v185
    v_cvt_pk_bf16_f32 v17, v186, v187
    s_waitcnt lgkmcnt(0)
    v_pk_add_f32 v[188:189], v[188:189], v[204:205]
    v_pk_add_f32 v[190:191], v[190:191], v[206:207]
    v_cvt_pk_bf16_f32 v18, v188, v189
    v_cvt_pk_bf16_f32 v19, v190, v191
    buffer_store_dwordx4 v[16:19], v1, s[4:7], s92 offen offset:1024 sc1
    v_dot2_f32_bf16 v160, v12, s23, 0
    v_dot2_f32_bf16 v161, v12, v12, 0
    v_dot2_f32_bf16 v160, v13, s23, v160
    v_dot2_f32_bf16 v161, v13, v13, v161
    v_dot2_f32_bf16 v160, v14, s23, v160
    v_dot2_f32_bf16 v161, v14, v14, v161
    v_dot2_f32_bf16 v160, v15, s23, v160
    v_dot2_f32_bf16 v161, v15, v15, v161
    v_dot2_f32_bf16 v160, v16, s23, v160
    v_dot2_f32_bf16 v161, v16, v16, v161
    v_dot2_f32_bf16 v160, v17, s23, v160
    v_dot2_f32_bf16 v161, v17, v17, v161
    v_dot2_f32_bf16 v160, v18, s23, v160
    v_dot2_f32_bf16 v161, v18, v18, v161
    v_dot2_f32_bf16 v160, v19, s23, v160
    v_dot2_f32_bf16 v161, v19, v19, v161
    s_nop 2
    v_permlane32_swap_b32 v160, v161
    v_add_f32 v160, v160, v161
    buffer_store_dword v160, v2, s[4:7], s93 offen sc1
    s_waitcnt vmcnt(0)
    buffer_store_dword v162, v6, s[4:7], s100 offen offset:256 sc1
LstS3_1s:
    s_waitcnt lgkmcnt(0)
    s_barrier
    s_lshl_b32 s22, s24, 12
    s_add_u32 s22, s22, LstS4_1s-Lpc_3
    v_lshlrev_b32 v27, 2, v1
    buffer_load_dword v9, v27, s[12:15], s22 offen
    buffer_load_dword v8, v11, s[4:7], s101 offen offset:256 sc1
    s_add_u32 s71, s3, 2
    s_add_u32 s93, s37, 0x8000
    v_lshrrev_b32 v30, 1, v1
    v_xor_b32 v30, v30, v1
    v_and_b32 v30, 64, v30
    v_mul_u32_u24 v30, 3, v30
    v_and_b32 v29, 0x100, v1
    v_mul_u32_u24 v5, 111, v29
    v_add_u32 v5, v5, v1
    v_mad_u32_u24 v31, v29, 3, v1
    v_xor_b32 v28, v31, v30
    v_add_u32 v29, 57344, v28
    v_add_u32 v30, 106496, v28
    ds_read_b128 a[224:227], v30 offset:0
    ds_read_b128 a[228:231], v30 offset:28672
    ds_read_b128 a[232:235], v29 offset:0
    ds_read_b128 a[236:239], v30 offset:256
    ds_read_b128 a[240:243], v30 offset:28928
    ds_read_b128 a[244:247], v29 offset:256
    ds_read_b128 a[248:251], v30 offset:2048
    buffer_load_dword v9, v11, s[4:7], s101 offen offset:256 sc1
Lp_308:
    s_waitcnt vmcnt(1)
    v_subrev_u32 v8, s71, v8
    v_cmp_le_u32 vcc, 16, v8
    s_cbranch_vccz Lo_309
    buffer_load_dword v8, v11, s[4:7], s101 offen offset:256 sc1
    s_waitcnt vmcnt(1)
    v_subrev_u32 v9, s71, v9
    v_cmp_le_u32 vcc, 16, v9
    s_cbranch_vccz Lo_309
    buffer_load_dword v9, v11, s[4:7], s101 offen offset:256 sc1
    s_sub_u32 s30, s30, 1
    s_cbranch_scc0 Lp_308
    s_mov_b32 s30, 0
Lo_309:
    s_add_u32 s70, s36, 0x1000
    buffer_load_dwordx4 v[32:35], v31, s[4:7], s70 offen offset:1024 sc1
    buffer_load_dwordx4 v[36:39], v31, s[4:7], s70 offen offset:1280 sc1
    s_add_u32 s70, s36, 0x3000
    buffer_load_dwordx4 v[40:43], v31, s[4:7], s70 offen sc1
    buffer_load_dwordx4 v[44:47], v31, s[4:7], s70 offen offset:256 sc1
    s_add_u32 s70, s36, 0xf000
    buffer_load_dwordx4 v[48:51], v31, s[4:7], s70 offen offset:1024 sc1
    buffer_load_dwordx4 v[52:55], v31, s[4:7], s70 offen offset:1280 sc1
    s_add_u32 s70, s36, 0x11000
    buffer_load_dwordx4 v[56:59], v31, s[4:7], s70 offen sc1
    buffer_load_dwordx4 v[60:63], v31, s[4:7], s70 offen offset:256 sc1
    s_add_u32 s70, s36, 0x1d000
    buffer_load_dwordx4 v[64:67], v31, s[4:7], s70 offen offset:1024 sc1
    buffer_load_dwordx4 v[68:71], v31, s[4:7], s70 offen offset:1280 sc1
    s_add_u32 s70, s36, 0x1f000
    buffer_load_dwordx4 v[72:75], v31, s[4:7], s70 offen sc1
    buffer_load_dwordx4 v[76:79], v31, s[4:7], s70 offen offset:256 sc1
    s_waitcnt lgkmcnt(3)
    s_waitcnt vmcnt(10)
    v_mfma_f32_16x16x32_bf16 v[148:151], a[224:227], v[36:39], 0
    ds_read_b128 a[252:255], v30 offset:30720
    v_mfma_f32_16x16x32_bf16 v[144:147], a[224:227], v[32:35], 0
    s_add_u32 s70, s36, 0x2b000
    buffer_load_dwordx4 v[80:83], v31, s[4:7], s70 offen offset:1024 sc1
    v_mfma_f32_16x16x32_bf16 v[160:163], a[228:231], v[32:35], 0
    ds_read_b128 a[224:227], v29 offset:2048
    v_mfma_f32_16x16x32_bf16 v[164:167], a[228:231], v[36:39], 0
    v_mfma_f32_16x16x32_bf16 v[180:183], a[232:235], v[36:39], 0
    ds_read_b128 a[228:231], v30 offset:2304
    buffer_load_dwordx4 v[84:87], v31, s[4:7], s70 offen offset:1280 sc1
    v_mfma_f32_16x16x32_bf16 v[176:179], a[232:235], v[32:35], 0
    v_mfma_f32_16x16x32_bf16 v[152:155], a[236:239], v[32:35], 0
    ds_read_b128 a[232:235], v30 offset:30976
    s_waitcnt lgkmcnt(3)
    v_mfma_f32_16x16x32_bf16 v[156:159], a[236:239], v[36:39], 0
    v_mfma_f32_16x16x32_bf16 v[172:175], a[240:243], v[36:39], 0
    ds_read_b128 a[236:239], v29 offset:2304
    v_mfma_f32_16x16x32_bf16 v[168:171], a[240:243], v[32:35], 0
    s_add_u32 s70, s36, 0x2d000
    buffer_load_dwordx4 v[88:91], v31, s[4:7], s70 offen sc1
    v_mfma_f32_16x16x32_bf16 v[184:187], a[244:247], v[32:35], 0
    ds_read_b128 a[240:243], v30 offset:4096
    v_mfma_f32_16x16x32_bf16 v[188:191], a[244:247], v[36:39], 0
    s_waitcnt vmcnt(11)
    v_mfma_f32_16x16x32_bf16 v[148:151], a[248:251], v[44:47], v[148:151]
    ds_read_b128 a[244:247], v30 offset:32768
    buffer_load_dwordx4 v[92:95], v31, s[4:7], s70 offen offset:256 sc1
    v_mfma_f32_16x16x32_bf16 v[144:147], a[248:251], v[40:43], v[144:147]
    v_mfma_f32_16x16x32_bf16 v[160:163], a[252:255], v[40:43], v[160:163]
    ds_read_b128 a[248:251], v29 offset:4096
    s_waitcnt lgkmcnt(3)
    v_mfma_f32_16x16x32_bf16 v[164:167], a[252:255], v[44:47], v[164:167]
    v_mfma_f32_16x16x32_bf16 v[180:183], a[224:227], v[44:47], v[180:183]
    ds_read_b128 a[252:255], v30 offset:4352
    v_mfma_f32_16x16x32_bf16 v[176:179], a[224:227], v[40:43], v[176:179]
    s_add_u32 s70, s36, 0x39000
    buffer_load_dwordx4 v[96:99], v31, s[4:7], s70 offen offset:1024 sc1
    v_mfma_f32_16x16x32_bf16 v[152:155], a[228:231], v[40:43], v[152:155]
    ds_read_b128 a[224:227], v30 offset:33024
    v_mfma_f32_16x16x32_bf16 v[156:159], a[228:231], v[44:47], v[156:159]
    v_mfma_f32_16x16x32_bf16 v[172:175], a[232:235], v[44:47], v[172:175]
    ds_read_b128 a[228:231], v29 offset:4352
    buffer_load_dwordx4 v[100:103], v31, s[4:7], s70 offen offset:1280 sc1
    v_mfma_f32_16x16x32_bf16 v[168:171], a[232:235], v[40:43], v[168:171]
    v_mfma_f32_16x16x32_bf16 v[184:187], a[236:239], v[40:43], v[184:187]
    ds_read_b128 a[232:235], v30 offset:6144
    s_waitcnt lgkmcnt(3)
    v_mfma_f32_16x16x32_bf16 v[188:191], a[236:239], v[44:47], v[188:191]
    s_waitcnt vmcnt(12)
    v_mfma_f32_16x16x32_bf16 v[148:151], a[240:243], v[52:55], v[148:151]
    ds_read_b128 a[236:239], v30 offset:34816
    v_mfma_f32_16x16x32_bf16 v[144:147], a[240:243], v[48:51], v[144:147]
    s_add_u32 s70, s36, 0x3b000
    buffer_load_dwordx4 v[104:107], v31, s[4:7], s70 offen sc1
    v_mfma_f32_16x16x32_bf16 v[160:163], a[244:247], v[48:51], v[160:163]
    ds_read_b128 a[240:243], v29 offset:6144
    v_mfma_f32_16x16x32_bf16 v[164:167], a[244:247], v[52:55], v[164:167]
    v_mfma_f32_16x16x32_bf16 v[180:183], a[248:251], v[52:55], v[180:183]
    ds_read_b128 a[244:247], v30 offset:6400
    buffer_load_dwordx4 v[108:111], v31, s[4:7], s70 offen offset:256 sc1
    v_mfma_f32_16x16x32_bf16 v[176:179], a[248:251], v[48:51], v[176:179]
    v_mfma_f32_16x16x32_bf16 v[152:155], a[252:255], v[48:51], v[152:155]
    ds_read_b128 a[248:251], v30 offset:35072
    s_waitcnt lgkmcnt(3)
    v_mfma_f32_16x16x32_bf16 v[156:159], a[252:255], v[52:55], v[156:159]
    v_mfma_f32_16x16x32_bf16 v[172:175], a[224:227], v[52:55], v[172:175]
    ds_read_b128 a[252:255], v29 offset:6400
    v_mfma_f32_16x16x32_bf16 v[168:171], a[224:227], v[48:51], v[168:171]
    s_add_u32 s70, s36, 0x47000
    buffer_load_dwordx4 v[112:115], v31, s[4:7], s70 offen offset:1024 sc1
    v_mfma_f32_16x16x32_bf16 v[184:187], a[228:231], v[48:51], v[184:187]
    ds_read_b128 a[224:227], v30 offset:8192
    v_mfma_f32_16x16x32_bf16 v[188:191], a[228:231], v[52:55], v[188:191]
    s_waitcnt vmcnt(13)
    v_mfma_f32_16x16x32_bf16 v[148:151], a[232:235], v[60:63], v[148:151]
    ds_read_b128 a[228:231], v30 offset:36864
    v_mfma_f32_16x16x32_bf16 v[144:147], a[232:235], v[56:59], v[144:147]
    v_mfma_f32_16x16x32_bf16 v[160:163], a[236:239], v[56:59], v[160:163]
    ds_read_b128 a[232:235], v29 offset:8192
    s_waitcnt lgkmcnt(3)
    v_mfma_f32_16x16x32_bf16 v[164:167], a[236:239], v[60:63], v[164:167]
    buffer_load_dwordx4 v[116:119], v31, s[4:7], s70 offen offset:1280 sc1
    v_mfma_f32_16x16x32_bf16 v[180:183], a[240:243], v[60:63], v[180:183]
    ds_read_b128 a[236:239], v30 offset:8448
    v_mfma_f32_16x16x32_bf16 v[176:179], a[240:243], v[56:59], v[176:179]
    v_mfma_f32_16x16x32_bf16 v[152:155], a[244:247], v[56:59], v[152:155]
    ds_read_b128 a[240:243], v30 offset:37120
    v_mfma_f32_16x16x32_bf16 v[156:159], a[244:247], v[60:63], v[156:159]
    s_add_u32 s70, s36, 0x49000
    buffer_load_dwordx4 v[120:123], v31, s[4:7], s70 offen sc1
    v_mfma_f32_16x16x32_bf16 v[172:175], a[248:251], v[60:63], v[172:175]
    ds_read_b128 a[244:247], v29 offset:8448
    v_mfma_f32_16x16x32_bf16 v[168:171], a[248:251], v[56:59], v[168:171]
    v_mfma_f32_16x16x32_bf16 v[184:187], a[252:255], v[56:59], v[184:187]
    ds_read_b128 a[248:251], v30 offset:10240
    s_waitcnt lgkmcnt(3)
    v_mfma_f32_16x16x32_bf16 v[188:191], a[252:255], v[60:63], v[188:191]
    buffer_load_dwordx4 v[124:127], v31, s[4:7], s70 offen offset:256 sc1
    s_waitcnt vmcnt(14)
    v_mfma_f32_16x16x32_bf16 v[148:151], a[224:227], v[68:71], v[148:151]
    ds_read_b128 a[252:255], v30 offset:38912
    v_mfma_f32_16x16x32_bf16 v[144:147], a[224:227], v[64:67], v[144:147]
    v_mfma_f32_16x16x32_bf16 v[160:163], a[228:231], v[64:67], v[160:163]
    ds_read_b128 a[224:227], v29 offset:10240
    v_mfma_f32_16x16x32_bf16 v[164:167], a[228:231], v[68:71], v[164:167]
    s_add_u32 s70, s36, 0x55000
    buffer_load_dwordx4 v[128:131], v31, s[4:7], s70 offen offset:1024 sc1
    v_mfma_f32_16x16x32_bf16 v[180:183], a[232:235], v[68:71], v[180:183]
    ds_read_b128 a[228:231], v30 offset:10496
    v_mfma_f32_16x16x32_bf16 v[176:179], a[232:235], v[64:67], v[176:179]
    v_mfma_f32_16x16x32_bf16 v[152:155], a[236:239], v[64:67], v[152:155]
    ds_read_b128 a[232:235], v30 offset:39168
    s_waitcnt lgkmcnt(3)
    v_mfma_f32_16x16x32_bf16 v[156:159], a[236:239], v[68:71], v[156:159]
    s_lshl_b32 s94, s24, 11
    s_add_u32 m0, s94, 86016
    s_lshl_b32 s95, s25, 13
    s_add_u32 s94, s94, s95
    s_add_u32 s94, s94, 0x1d0000
    buffer_load_dwordx4 v1, s[4:7], s94 offen lds
    v_mfma_f32_16x16x32_bf16 v[172:175], a[240:243], v[68:71], v[172:175]
    ds_read_b128 a[236:239], v29 offset:10496
    v_mfma_f32_16x16x32_bf16 v[168:171], a[240:243], v[64:67], v[168:171]
    v_mfma_f32_16x16x32_bf16 v[184:187], a[244:247], v[64:67], v[184:187]
    ds_read_b128 a[240:243], v30 offset:12288
    buffer_load_dword v208, v2, s[4:7], s93 offen sc1
    v_mfma_f32_16x16x32_bf16 v[188:191], a[244:247], v[68:71], v[188:191]
    s_waitcnt vmcnt(15)
    v_mfma_f32_16x16x32_bf16 v[148:151], a[248:251], v[76:79], v[148:151]
    ds_read_b128 a[244:247], v30 offset:40960
    buffer_load_dwordx4 v[132:135], v31, s[4:7], s70 offen offset:1280 sc1
    v_mfma_f32_16x16x32_bf16 v[144:147], a[248:251], v[72:75], v[144:147]
    v_mfma_f32_16x16x32_bf16 v[160:163], a[252:255], v[72:75], v[160:163]
    ds_read_b128 a[248:251], v29 offset:12288
    s_waitcnt lgkmcnt(3)
    v_mfma_f32_16x16x32_bf16 v[164:167], a[252:255], v[76:79], v[164:167]
    v_mfma_f32_16x16x32_bf16 v[180:183], a[224:227], v[76:79], v[180:183]
    ds_read_b128 a[252:255], v30 offset:12544
    buffer_load_dword v209, v2, s[4:7], s93 offen offset:256 sc1
    v_mfma_f32_16x16x32_bf16 v[176:179], a[224:227], v[72:75], v[176:179]
    v_mfma_f32_16x16x32_bf16 v[152:155], a[228:231], v[72:75], v[152:155]
    ds_read_b128 a[224:227], v30 offset:41216
    buffer_load_dwordx4 v1, s[4:7], s94 offen offset:1024 lds
    v_mfma_f32_16x16x32_bf16 v[156:159], a[228:231], v[76:79], v[156:159]
    v_mfma_f32_16x16x32_bf16 v[172:175], a[232:235], v[76:79], v[172:175]
    ds_read_b128 a[228:231], v29 offset:12544
    v_mfma_f32_16x16x32_bf16 v[168:171], a[232:235], v[72:75], v[168:171]
    v_mfma_f32_16x16x32_bf16 v[184:187], a[236:239], v[72:75], v[184:187]
    ds_read_b128 a[232:235], v30 offset:14336
    s_waitcnt lgkmcnt(3)
    v_mfma_f32_16x16x32_bf16 v[188:191], a[236:239], v[76:79], v[188:191]
    buffer_load_dword v210, v2, s[4:7], s93 offen offset:512 sc1
    s_waitcnt vmcnt(17)
    v_mfma_f32_16x16x32_bf16 v[148:151], a[240:243], v[84:87], v[148:151]
    ds_read_b128 a[236:239], v30 offset:43008
    buffer_load_dword v211, v2, s[4:7], s93 offen offset:768 sc1
    v_mfma_f32_16x16x32_bf16 v[144:147], a[240:243], v[80:83], v[144:147]
    v_mfma_f32_16x16x32_bf16 v[160:163], a[244:247], v[80:83], v[160:163]
    ds_read_b128 a[240:243], v29 offset:14336
    buffer_load_dword v212, v2, s[4:7], s93 offen offset:1024 sc1
    v_mfma_f32_16x16x32_bf16 v[164:167], a[244:247], v[84:87], v[164:167]
    v_mfma_f32_16x16x32_bf16 v[180:183], a[248:251], v[84:87], v[180:183]
    ds_read_b128 a[244:247], v30 offset:14592
    buffer_load_dword v213, v2, s[4:7], s93 offen offset:1280 sc1
    v_mfma_f32_16x16x32_bf16 v[176:179], a[248:251], v[80:83], v[176:179]
    v_mfma_f32_16x16x32_bf16 v[152:155], a[252:255], v[80:83], v[152:155]
    ds_read_b128 a[248:251], v30 offset:43264
    s_waitcnt lgkmcnt(3)
    v_mfma_f32_16x16x32_bf16 v[156:159], a[252:255], v[84:87], v[156:159]
    s_add_u32 s70, s36, 0x57000
    buffer_load_dwordx4 v[136:139], v31, s[4:7], s70 offen sc1
    v_mfma_f32_16x16x32_bf16 v[172:175], a[224:227], v[84:87], v[172:175]
    ds_read_b128 a[252:255], v29 offset:14592
    v_mfma_f32_16x16x32_bf16 v[168:171], a[224:227], v[80:83], v[168:171]
    v_mfma_f32_16x16x32_bf16 v[184:187], a[228:231], v[80:83], v[184:187]
    ds_read_b128 a[224:227], v30 offset:16384
    buffer_load_dword v214, v2, s[4:7], s93 offen offset:1536 sc1
    v_mfma_f32_16x16x32_bf16 v[188:191], a[228:231], v[84:87], v[188:191]
    s_waitcnt vmcnt(20)
    v_mfma_f32_16x16x32_bf16 v[148:151], a[232:235], v[92:95], v[148:151]
    ds_read_b128 a[228:231], v30 offset:45056
    buffer_load_dword v215, v2, s[4:7], s93 offen offset:1792 sc1
    v_mfma_f32_16x16x32_bf16 v[144:147], a[232:235], v[88:91], v[144:147]
    v_mfma_f32_16x16x32_bf16 v[160:163], a[236:239], v[88:91], v[160:163]
    ds_read_b128 a[232:235], v29 offset:16384
    s_waitcnt lgkmcnt(3)
    v_mfma_f32_16x16x32_bf16 v[164:167], a[236:239], v[92:95], v[164:167]
    buffer_load_dword v216, v2, s[4:7], s93 offen offset:2048 sc1
    v_mfma_f32_16x16x32_bf16 v[180:183], a[240:243], v[92:95], v[180:183]
    ds_read_b128 a[236:239], v30 offset:16640
    buffer_load_dwordx4 v[140:143], v31, s[4:7], s70 offen offset:256 sc1
    v_mfma_f32_16x16x32_bf16 v[176:179], a[240:243], v[88:91], v[176:179]
    v_mfma_f32_16x16x32_bf16 v[152:155], a[244:247], v[88:91], v[152:155]
    ds_read_b128 a[240:243], v30 offset:45312
    v_mfma_f32_16x16x32_bf16 v[156:159], a[244:247], v[92:95], v[156:159]
    v_mfma_f32_16x16x32_bf16 v[172:175], a[248:251], v[92:95], v[172:175]
    ds_read_b128 a[244:247], v29 offset:16640
    buffer_load_dword v217, v2, s[4:7], s93 offen offset:2304 sc1
    v_mfma_f32_16x16x32_bf16 v[168:171], a[248:251], v[88:91], v[168:171]
    v_mfma_f32_16x16x32_bf16 v[184:187], a[252:255], v[88:91], v[184:187]
    ds_read_b128 a[248:251], v30 offset:18432
    s_waitcnt lgkmcnt(3)
    v_mfma_f32_16x16x32_bf16 v[188:191], a[252:255], v[92:95], v[188:191]
    buffer_load_dword v218, v2, s[4:7], s93 offen offset:2560 sc1
    s_waitcnt vmcnt(23)
    v_mfma_f32_16x16x32_bf16 v[148:151], a[224:227], v[100:103], v[148:151]
    ds_read_b128 a[252:255], v30 offset:47104
    buffer_load_dword v219, v2, s[4:7], s93 offen offset:2816 sc1
    v_mfma_f32_16x16x32_bf16 v[144:147], a[224:227], v[96:99], v[144:147]
    v_mfma_f32_16x16x32_bf16 v[160:163], a[228:231], v[96:99], v[160:163]
    ds_read_b128 a[224:227], v29 offset:18432
    buffer_load_dword v220, v2, s[4:7], s93 offen offset:3072 sc1
    v_mfma_f32_16x16x32_bf16 v[164:167], a[228:231], v[100:103], v[164:167]
    v_mfma_f32_16x16x32_bf16 v[180:183], a[232:235], v[100:103], v[180:183]
    ds_read_b128 a[228:231], v30 offset:18688
    buffer_load_dword v221, v2, s[4:7], s93 offen offset:3328 sc1
    v_mfma_f32_16x16x32_bf16 v[176:179], a[232:235], v[96:99], v[176:179]
    v_mfma_f32_16x16x32_bf16 v[152:155], a[236:239], v[96:99], v[152:155]
    ds_read_b128 a[232:235], v30 offset:47360
    s_waitcnt lgkmcnt(3)
    v_mfma_f32_16x16x32_bf16 v[156:159], a[236:239], v[100:103], v[156:159]
    s_add_u32 m0, s55, 0x7000
    s_add_u32 s72, s39, 0xe000
    buffer_load_dwordx4 v1, s[4:7], s72 offen lds
    v_mfma_f32_16x16x32_bf16 v[172:175], a[240:243], v[100:103], v[172:175]
    ds_read_b128 a[236:239], v29 offset:18688
    v_mfma_f32_16x16x32_bf16 v[168:171], a[240:243], v[96:99], v[168:171]
    v_mfma_f32_16x16x32_bf16 v[184:187], a[244:247], v[96:99], v[184:187]
    ds_read_b128 a[240:243], v30 offset:20480
    buffer_load_dwordx4 v1, s[4:7], s72 offen offset:1024 lds
    v_mfma_f32_16x16x32_bf16 v[188:191], a[244:247], v[100:103], v[188:191]
    s_waitcnt vmcnt(26)
    v_mfma_f32_16x16x32_bf16 v[148:151], a[248:251], v[108:111], v[148:151]
    ds_read_b128 a[244:247], v30 offset:49152
    v_mfma_f32_16x16x32_bf16 v[144:147], a[248:251], v[104:107], v[144:147]
    v_mfma_f32_16x16x32_bf16 v[160:163], a[252:255], v[104:107], v[160:163]
    ds_read_b128 a[248:251], v29 offset:20480
    s_waitcnt lgkmcnt(3)
    buffer_load_dwordx4 v1, s[4:7], s72 offen offset:2048 lds
    v_mfma_f32_16x16x32_bf16 v[164:167], a[252:255], v[108:111], v[164:167]
    v_mfma_f32_16x16x32_bf16 v[180:183], a[224:227], v[108:111], v[180:183]
    ds_read_b128 a[252:255], v30 offset:20736
    v_mfma_f32_16x16x32_bf16 v[176:179], a[224:227], v[104:107], v[176:179]
    v_mfma_f32_16x16x32_bf16 v[152:155], a[228:231], v[104:107], v[152:155]
    ds_read_b128 a[224:227], v30 offset:49408
    buffer_load_dwordx4 v1, s[4:7], s72 offen offset:3072 lds
    s_add_u32 m0, s55, 0x8000
    v_mfma_f32_16x16x32_bf16 v[156:159], a[228:231], v[108:111], v[156:159]
    v_mfma_f32_16x16x32_bf16 v[172:175], a[232:235], v[108:111], v[172:175]
    ds_read_b128 a[228:231], v29 offset:20736
    v_mfma_f32_16x16x32_bf16 v[168:171], a[232:235], v[104:107], v[168:171]
    v_mfma_f32_16x16x32_bf16 v[184:187], a[236:239], v[104:107], v[184:187]
    ds_read_b128 a[232:235], v30 offset:22528
    s_waitcnt lgkmcnt(3)
    buffer_load_dwordx4 v0, s[4:7], s72 offen lds
    v_mfma_f32_16x16x32_bf16 v[188:191], a[236:239], v[108:111], v[188:191]
    s_waitcnt vmcnt(27)
    v_mfma_f32_16x16x32_bf16 v[148:151], a[240:243], v[116:119], v[148:151]
    ds_read_b128 a[236:239], v30 offset:51200
    v_mfma_f32_16x16x32_bf16 v[144:147], a[240:243], v[112:115], v[144:147]
    v_mfma_f32_16x16x32_bf16 v[160:163], a[244:247], v[112:115], v[160:163]
    ds_read_b128 a[240:243], v29 offset:22528
    buffer_load_dwordx4 v0, s[4:7], s72 offen offset:1024 lds
    v_mfma_f32_16x16x32_bf16 v[164:167], a[244:247], v[116:119], v[164:167]
    v_mfma_f32_16x16x32_bf16 v[180:183], a[248:251], v[116:119], v[180:183]
    ds_read_b128 a[244:247], v30 offset:22784
    v_mfma_f32_16x16x32_bf16 v[176:179], a[248:251], v[112:115], v[176:179]
    v_mfma_f32_16x16x32_bf16 v[152:155], a[252:255], v[112:115], v[152:155]
    ds_read_b128 a[248:251], v30 offset:51456
    s_waitcnt lgkmcnt(3)
    v_mfma_f32_16x16x32_bf16 v[156:159], a[252:255], v[116:119], v[156:159]
    v_mfma_f32_16x16x32_bf16 v[172:175], a[224:227], v[116:119], v[172:175]
    ds_read_b128 a[252:255], v29 offset:22784
    buffer_load_dwordx4 v0, s[4:7], s72 offen offset:2048 lds
    v_mfma_f32_16x16x32_bf16 v[168:171], a[224:227], v[112:115], v[168:171]
    v_mfma_f32_16x16x32_bf16 v[184:187], a[228:231], v[112:115], v[184:187]
    ds_read_b128 a[224:227], v30 offset:24576
    v_mfma_f32_16x16x32_bf16 v[188:191], a[228:231], v[116:119], v[188:191]
    s_waitcnt vmcnt(27)
    v_mfma_f32_16x16x32_bf16 v[148:151], a[232:235], v[124:127], v[148:151]
    ds_read_b128 a[228:231], v30 offset:53248
    v_mfma_f32_16x16x32_bf16 v[144:147], a[232:235], v[120:123], v[144:147]
    v_mfma_f32_16x16x32_bf16 v[160:163], a[236:239], v[120:123], v[160:163]
    ds_read_b128 a[232:235], v29 offset:24576
    s_waitcnt lgkmcnt(3)
    v_mfma_f32_16x16x32_bf16 v[164:167], a[236:239], v[124:127], v[164:167]
    v_mfma_f32_16x16x32_bf16 v[180:183], a[240:243], v[124:127], v[180:183]
    ds_read_b128 a[236:239], v30 offset:24832
    v_mfma_f32_16x16x32_bf16 v[176:179], a[240:243], v[120:123], v[176:179]
    v_mfma_f32_16x16x32_bf16 v[152:155], a[244:247], v[120:123], v[152:155]
    ds_read_b128 a[240:243], v30 offset:53504
    v_mfma_f32_16x16x32_bf16 v[156:159], a[244:247], v[124:127], v[156:159]
    v_mfma_f32_16x16x32_bf16 v[172:175], a[248:251], v[124:127], v[172:175]
    ds_read_b128 a[244:247], v29 offset:24832
    v_mfma_f32_16x16x32_bf16 v[168:171], a[248:251], v[120:123], v[168:171]
    v_mfma_f32_16x16x32_bf16 v[184:187], a[252:255], v[120:123], v[184:187]
    ds_read_b128 a[248:251], v30 offset:26624
    s_waitcnt lgkmcnt(3)
    v_mfma_f32_16x16x32_bf16 v[188:191], a[252:255], v[124:127], v[188:191]
    s_waitcnt vmcnt(23)
    v_mfma_f32_16x16x32_bf16 v[148:151], a[224:227], v[132:135], v[148:151]
    ds_read_b128 a[252:255], v30 offset:55296
    v_mfma_f32_16x16x32_bf16 v[144:147], a[224:227], v[128:131], v[144:147]
    v_mfma_f32_16x16x32_bf16 v[160:163], a[228:231], v[128:131], v[160:163]
    ds_read_b128 a[224:227], v29 offset:26624
    v_mfma_f32_16x16x32_bf16 v[164:167], a[228:231], v[132:135], v[164:167]
    v_mfma_f32_16x16x32_bf16 v[180:183], a[232:235], v[132:135], v[180:183]
    ds_read_b128 a[228:231], v30 offset:26880
    v_mfma_f32_16x16x32_bf16 v[176:179], a[232:235], v[128:131], v[176:179]
    v_mfma_f32_16x16x32_bf16 v[152:155], a[236:239], v[128:131], v[152:155]
    ds_read_b128 a[232:235], v30 offset:55552
    s_waitcnt lgkmcnt(3)
    v_mfma_f32_16x16x32_bf16 v[156:159], a[236:239], v[132:135], v[156:159]
    v_mfma_f32_16x16x32_bf16 v[172:175], a[240:243], v[132:135], v[172:175]
    ds_read_b128 a[236:239], v29 offset:26880
    v_mfma_f32_16x16x32_bf16 v[168:171], a[240:243], v[128:131], v[168:171]
    v_mfma_f32_16x16x32_bf16 v[184:187], a[244:247], v[128:131], v[184:187]
    s_waitcnt vmcnt(21)
    s_barrier
    ds_read_b128 a[240:243], v28 offset:0
    v_mfma_f32_16x16x32_bf16 v[188:191], a[244:247], v[132:135], v[188:191]
    s_waitcnt vmcnt(12)
    v_mfma_f32_16x16x32_bf16 v[148:151], a[248:251], v[140:143], v[148:151]
    ds_read_b128 a[244:247], v28 offset:256
    v_mfma_f32_16x16x32_bf16 v[144:147], a[248:251], v[136:139], v[144:147]
    v_mfma_f32_16x16x32_bf16 v[160:163], a[252:255], v[136:139], v[160:163]
    ds_read_b128 a[248:251], v28 offset:2048
    s_waitcnt lgkmcnt(3)
    v_add_f32 v208, v208, v209
    v_mfma_f32_16x16x32_bf16 v[164:167], a[252:255], v[140:143], v[164:167]
    v_add_f32 v210, v210, v211
    v_add_f32 v212, v212, v213
    v_add_f32 v214, v214, v215
    v_mfma_f32_16x16x32_bf16 v[180:183], a[224:227], v[140:143], v[180:183]
    ds_read_b128 a[252:255], v28 offset:2304
    s_waitcnt vmcnt(11)
    v_add_f32 v216, v216, v217
    s_waitcnt vmcnt(9)
    v_add_f32 v218, v218, v219
    v_mfma_f32_16x16x32_bf16 v[176:179], a[224:227], v[136:139], v[176:179]
    s_waitcnt vmcnt(7)
    v_add_f32 v220, v220, v221
    v_add_f32 v208, v208, v210
    v_add_f32 v212, v212, v214
    v_mfma_f32_16x16x32_bf16 v[152:155], a[228:231], v[136:139], v[152:155]
    ds_read_b128 a[224:227], v28 offset:4096
    v_add_f32 v216, v216, v218
    v_add_f32 v208, v208, v212
    v_mfma_f32_16x16x32_bf16 v[156:159], a[228:231], v[140:143], v[156:159]
    v_add_f32 v216, v216, v220
    v_add_f32 v208, v208, v216
    v_mfma_f32_16x16x32_bf16 v[172:175], a[232:235], v[140:143], v[172:175]
    ds_read_b128 a[228:231], v28 offset:4352
    v_mfma_f32_16x16x32_bf16 v[168:171], a[232:235], v[136:139], v[168:171]
    v_mfma_f32_16x16x32_bf16 v[184:187], a[236:239], v[136:139], v[184:187]
    ds_read_b128 a[232:235], v29 offset:30976
    s_waitcnt lgkmcnt(3)
    v_mfma_f32_16x16x32_bf16 v[188:191], a[236:239], v[140:143], v[188:191]
    v_mfma_f32_16x16x32_bf16 v[192:195], a[240:243], v[32:35], 0
    v_mov_b32 v209, v208
    s_nop 0
    v_mfma_f32_16x16x32_bf16 v[196:199], a[240:243], v[36:39], 0
    v_permlane32_swap_b32 v208, v209
    s_barrier
    v_mfma_f32_16x16x32_bf16 v[204:207], a[244:247], v[36:39], 0
    ds_read_b128 a[236:239], v29 offset:32768
    v_mul_f32 v208, 0xbb124925, v208
    v_mov_b32 v210, 0x3727c5ac
    v_mfma_f32_16x16x32_bf16 v[200:203], a[244:247], v[32:35], 0
    s_add_u32 m0, s55, 0x1a000
    s_add_u32 s73, s39, 0x7000
    buffer_load_dwordx4 v1, s[4:7], s73 offen lds
    v_mfma_f32_16x16x32_bf16 v[192:195], a[248:251], v[40:43], v[192:195]
    v_fmac_f32 v210, 0x3b124925, v209
    v_fma_f32 v25, -v208, v208, v210
    v_max_f32 v25, 0x3727c5ac, v25
    v_mfma_f32_16x16x32_bf16 v[196:199], a[248:251], v[44:47], v[196:199]
    v_cvt_pk_bf16_f32 v20, v208, v208
    v_rsq_f32 v24, v25
    v_mfma_f32_16x16x32_bf16 v[204:207], a[252:255], v[44:47], v[204:207]
    ds_read_b128 a[240:243], v29 offset:34816
    s_waitcnt lgkmcnt(2)
    buffer_load_dwordx4 v1, s[4:7], s73 offen offset:1024 lds
    v_mfma_f32_16x16x32_bf16 v[200:203], a[252:255], v[40:43], v[200:203]
    v_and_b32 v212, 0xffff0000, v20
    v_sub_f32 v212, v208, v212
    v_cvt_pk_bf16_f32 v21, v212, v212
    v_mfma_f32_16x16x32_bf16 v[192:195], a[224:227], v[48:51], v[192:195]
    v_mov_b32 v22, v20
    v_mov_b32 v23, v21
    v_mul_f32 v26, 0xbfb8aa3b, v24
    v_mfma_f32_16x16x32_bf16 v[196:199], a[224:227], v[52:55], v[196:199]
    v_permlane16_swap_b32 v20, v22
    v_mfma_f32_16x16x32_bf16 v[204:207], a[228:231], v[52:55], v[204:207]
    ds_read_b128 a[244:247], v28 offset:6144
    buffer_load_dwordx4 v1, s[4:7], s73 offen offset:2048 lds
    v_mfma_f32_16x16x32_bf16 v[200:203], a[228:231], v[48:51], v[200:203]
    v_permlane16_swap_b32 v21, v23
    v_mov_b32 v27, v26
    s_nop 0
    v_mfma_f32_16x16x16_bf16 v[144:147], a[232:233], v[20:21], v[144:147]
    ds_read_b128 a[248:251], v28 offset:6400
    v_mov_b32 v24, v25
    v_mfma_f32_16x16x16_bf16 v[148:151], a[232:233], v[22:23], v[148:151]
    v_permlane16_swap_b32 v26, v27
    v_mfma_f32_16x16x16_bf16 v[152:155], a[234:235], v[20:21], v[152:155]
    ds_read_b128 a[252:255], v28 offset:8192
    s_waitcnt lgkmcnt(3)
    v_mfma_f32_16x16x16_bf16 v[156:159], a[234:235], v[22:23], v[156:159]
    buffer_load_dwordx4 v1, s[4:7], s73 offen offset:3072 lds
    s_add_u32 m0, s55, 0x1b000
    v_mfma_f32_16x16x16_bf16 v[160:163], a[236:237], v[20:21], v[160:163]
    ds_read_b128 a[224:227], v28 offset:8448
    v_permlane16_swap_b32 v25, v24
    v_mfma_f32_16x16x16_bf16 v[164:167], a[236:237], v[22:23], v[164:167]
    v_mfma_f32_16x16x16_bf16 v[168:171], a[238:239], v[20:21], v[168:171]
    ds_read_b128 a[228:231], v28 offset:10240
    buffer_load_dwordx4 v0, s[4:7], s73 offen lds
    v_mfma_f32_16x16x16_bf16 v[172:175], a[238:239], v[22:23], v[172:175]
    v_mfma_f32_16x16x16_bf16 v[176:179], a[240:241], v[20:21], v[176:179]
    ds_read_b128 a[232:235], v28 offset:10496
    v_mfma_f32_16x16x16_bf16 v[180:183], a[240:241], v[22:23], v[180:183]
    v_pk_mul_f32 v[224:225], v[144:145], v[26:27] op_sel:[0,0] op_sel_hi:[1,0]
    v_pk_mul_f32 v[226:227], v[146:147], v[26:27] op_sel:[0,0] op_sel_hi:[1,0]
    v_pk_mul_f32 v[228:229], v[148:149], v[26:27] op_sel:[0,1] op_sel_hi:[1,1]
    v_pk_mul_f32 v[230:231], v[150:151], v[26:27] op_sel:[0,1] op_sel_hi:[1,1]
    v_pk_mul_f32 v[144:145], v[144:145], v[152:153]
    v_pk_mul_f32 v[146:147], v[146:147], v[154:155]
    v_pk_mul_f32 v[148:149], v[148:149], v[156:157]
    v_pk_mul_f32 v[150:151], v[150:151], v[158:159]
    v_mfma_f32_16x16x16_bf16 v[184:187], a[242:243], v[20:21], v[184:187]
    ds_read_b128 a[236:239], v28 offset:12288
    s_waitcnt lgkmcnt(3)
    buffer_load_dwordx4 v0, s[4:7], s73 offen offset:1024 lds
    v_mfma_f32_16x16x16_bf16 v[188:191], a[242:243], v[22:23], v[188:191]
    v_exp_f32 v224, v224
    v_mfma_f32_16x16x32_bf16 v[192:195], a[244:247], v[56:59], v[192:195]
    ds_read_b128 a[240:243], v28 offset:12544
    v_exp_f32 v225, v225
    v_mfma_f32_16x16x32_bf16 v[196:199], a[244:247], v[60:63], v[196:199]
    v_exp_f32 v226, v226
    v_mfma_f32_16x16x32_bf16 v[204:207], a[248:251], v[60:63], v[204:207]
    ds_read_b128 a[244:247], v28 offset:14336
    buffer_load_dwordx4 v0, s[4:7], s73 offen offset:2048 lds
    v_mfma_f32_16x16x32_bf16 v[200:203], a[248:251], v[56:59], v[200:203]
    v_exp_f32 v227, v227
    v_mfma_f32_16x16x32_bf16 v[192:195], a[252:255], v[64:67], v[192:195]
    ds_read_b128 a[248:251], v28 offset:14592
    v_exp_f32 v228, v228
    v_mfma_f32_16x16x32_bf16 v[196:199], a[252:255], v[68:71], v[196:199]
    v_exp_f32 v229, v229
    v_mfma_f32_16x16x32_bf16 v[204:207], a[224:227], v[68:71], v[204:207]
    ds_read_b128 a[252:255], v28 offset:16384
    s_waitcnt lgkmcnt(3)
    v_mfma_f32_16x16x32_bf16 v[200:203], a[224:227], v[64:67], v[200:203]
    s_add_u32 m0, s55, 0x21000
    s_add_u32 s74, s39, 0x0
    buffer_load_dwordx4 v1, s[4:7], s74 offen lds
    v_mfma_f32_16x16x32_bf16 v[192:195], a[228:231], v[72:75], v[192:195]
    ds_read_b128 a[224:227], v28 offset:16640
    v_mfma_f32_16x16x32_bf16 v[196:199], a[228:231], v[76:79], v[196:199]
    v_exp_f32 v230, v230
    v_exp_f32 v231, v231
    v_pk_fma_f32 v[224:225], v[224:225], v[24:25], v[24:25] op_sel:[0,1,1] op_sel_hi:[1,1,1]
    v_pk_fma_f32 v[226:227], v[226:227], v[24:25], v[24:25] op_sel:[0,1,1] op_sel_hi:[1,1,1]
    v_pk_fma_f32 v[228:229], v[228:229], v[24:25], v[24:25] op_sel:[0,0,0] op_sel_hi:[1,0,0]
    v_pk_fma_f32 v[230:231], v[230:231], v[24:25], v[24:25] op_sel:[0,0,0] op_sel_hi:[1,0,0]
    v_mfma_f32_16x16x32_bf16 v[204:207], a[232:235], v[76:79], v[204:207]
    ds_read_b128 a[228:231], v28 offset:18432
    buffer_load_dwordx4 v1, s[4:7], s74 offen offset:1024 lds
    v_mfma_f32_16x16x32_bf16 v[200:203], a[232:235], v[72:75], v[200:203]
    v_rcp_f32 v224, v224
    v_mfma_f32_16x16x32_bf16 v[192:195], a[236:239], v[80:83], v[192:195]
    ds_read_b128 a[232:235], v28 offset:18688
    v_rcp_f32 v225, v225
    v_mfma_f32_16x16x32_bf16 v[196:199], a[236:239], v[84:87], v[196:199]
    v_rcp_f32 v226, v226
    v_mfma_f32_16x16x32_bf16 v[204:207], a[240:243], v[84:87], v[204:207]
    ds_read_b128 a[236:239], v28 offset:20480
    s_waitcnt lgkmcnt(3)
    buffer_load_dwordx4 v1, s[4:7], s74 offen offset:2048 lds
    v_mfma_f32_16x16x32_bf16 v[200:203], a[240:243], v[80:83], v[200:203]
    v_rcp_f32 v227, v227
    v_mfma_f32_16x16x32_bf16 v[192:195], a[244:247], v[88:91], v[192:195]
    ds_read_b128 a[240:243], v28 offset:20736
    v_rcp_f32 v228, v228
    v_mfma_f32_16x16x32_bf16 v[196:199], a[244:247], v[92:95], v[196:199]
    v_rcp_f32 v229, v229
    v_mfma_f32_16x16x32_bf16 v[204:207], a[248:251], v[92:95], v[204:207]
    ds_read_b128 a[244:247], v28 offset:22528
    buffer_load_dwordx4 v1, s[4:7], s74 offen offset:3072 lds
    s_add_u32 m0, s55, 0x22000
    v_mfma_f32_16x16x32_bf16 v[200:203], a[248:251], v[88:91], v[200:203]
    v_rcp_f32 v230, v230
    v_rcp_f32 v231, v231
    v_pk_mul_f32 v[144:145], v[144:145], v[224:225]
    v_pk_mul_f32 v[146:147], v[146:147], v[226:227]
    v_pk_mul_f32 v[148:149], v[148:149], v[228:229]
    v_pk_mul_f32 v[150:151], v[150:151], v[230:231]
    v_mfma_f32_16x16x32_bf16 v[192:195], a[252:255], v[96:99], v[192:195]
    ds_read_b128 a[248:251], v28 offset:22784
    buffer_load_dwordx4 v0, s[4:7], s74 offen lds
    v_cvt_pk_bf16_f32 v232, v144, v145
    v_mfma_f32_16x16x32_bf16 v[196:199], a[252:255], v[100:103], v[196:199]
    v_cvt_pk_bf16_f32 v234, v148, v149
    v_cvt_pk_bf16_f32 v233, v146, v147
    v_cvt_pk_bf16_f32 v235, v150, v151
    v_mfma_f32_16x16x32_bf16 v[204:207], a[224:227], v[100:103], v[204:207]
    ds_read_b128 a[252:255], v28 offset:24576
    s_waitcnt lgkmcnt(3)
    v_mfma_f32_16x16x32_bf16 v[200:203], a[224:227], v[96:99], v[200:203]
    v_permlane16_swap_b32 v232, v234
    v_mfma_f32_16x16x32_bf16 v[192:195], a[228:231], v[104:107], v[192:195]
    ds_read_b128 a[224:227], v28 offset:24832
    buffer_load_dwordx4 v0, s[4:7], s74 offen offset:1024 lds
    v_mfma_f32_16x16x32_bf16 v[196:199], a[228:231], v[108:111], v[196:199]
    v_permlane16_swap_b32 v233, v235
    v_mfma_f32_16x16x32_bf16 v[204:207], a[232:235], v[108:111], v[204:207]
    ds_read_b128 a[228:231], v28 offset:26624
    v_mfma_f32_16x16x32_bf16 v[200:203], a[232:235], v[104:107], v[200:203]
    buffer_store_dwordx4 v[232:235], v1, s[4:7], s57 offen sc1
    v_mfma_f32_16x16x32_bf16 v[192:195], a[236:239], v[112:115], v[192:195]
    ds_read_b128 a[232:235], v28 offset:26880
    v_mfma_f32_16x16x32_bf16 v[196:199], a[236:239], v[116:119], v[196:199]
    v_pk_mul_f32 v[224:225], v[160:161], v[26:27] op_sel:[0,0] op_sel_hi:[1,0]
    v_pk_mul_f32 v[226:227], v[162:163], v[26:27] op_sel:[0,0] op_sel_hi:[1,0]
    v_pk_mul_f32 v[228:229], v[164:165], v[26:27] op_sel:[0,1] op_sel_hi:[1,1]
    v_pk_mul_f32 v[230:231], v[166:167], v[26:27] op_sel:[0,1] op_sel_hi:[1,1]
    v_pk_mul_f32 v[160:161], v[160:161], v[168:169]
    v_pk_mul_f32 v[162:163], v[162:163], v[170:171]
    v_pk_mul_f32 v[164:165], v[164:165], v[172:173]
    v_pk_mul_f32 v[166:167], v[166:167], v[174:175]
    v_mfma_f32_16x16x32_bf16 v[204:207], a[240:243], v[116:119], v[204:207]
    ds_read_b128 a[236:239], v29 offset:33024
    s_waitcnt lgkmcnt(3)
    v_mfma_f32_16x16x32_bf16 v[200:203], a[240:243], v[112:115], v[200:203]
    v_exp_f32 v224, v224
    v_mfma_f32_16x16x32_bf16 v[192:195], a[244:247], v[120:123], v[192:195]
    v_exp_f32 v225, v225
    v_mfma_f32_16x16x32_bf16 v[196:199], a[244:247], v[124:127], v[196:199]
    v_exp_f32 v226, v226
    v_mfma_f32_16x16x32_bf16 v[204:207], a[248:251], v[124:127], v[204:207]
    s_waitcnt vmcnt(14)
    s_barrier
    ds_read_b128 a[240:243], v28 offset:28672
    v_mfma_f32_16x16x32_bf16 v[200:203], a[248:251], v[120:123], v[200:203]
    buffer_load_dwordx4 v0, s[4:7], s74 offen offset:2048 lds
    v_exp_f32 v227, v227
    v_mfma_f32_16x16x32_bf16 v[192:195], a[252:255], v[128:131], v[192:195]
    ds_read_b128 a[244:247], v28 offset:28928
    v_exp_f32 v228, v228
    v_mfma_f32_16x16x32_bf16 v[196:199], a[252:255], v[132:135], v[196:199]
    v_exp_f32 v229, v229
    v_mfma_f32_16x16x32_bf16 v[204:207], a[224:227], v[132:135], v[204:207]
    ds_read_b128 a[248:251], v28 offset:30720
    s_waitcnt lgkmcnt(3)
    v_mfma_f32_16x16x32_bf16 v[200:203], a[224:227], v[128:131], v[200:203]
    v_exp_f32 v230, v230
    v_exp_f32 v231, v231
    v_pk_fma_f32 v[224:225], v[224:225], v[24:25], v[24:25] op_sel:[0,1,1] op_sel_hi:[1,1,1]
    v_pk_fma_f32 v[226:227], v[226:227], v[24:25], v[24:25] op_sel:[0,1,1] op_sel_hi:[1,1,1]
    v_pk_fma_f32 v[228:229], v[228:229], v[24:25], v[24:25] op_sel:[0,0,0] op_sel_hi:[1,0,0]
    v_pk_fma_f32 v[230:231], v[230:231], v[24:25], v[24:25] op_sel:[0,0,0] op_sel_hi:[1,0,0]
    v_mfma_f32_16x16x32_bf16 v[192:195], a[228:231], v[136:139], v[192:195]
    ds_read_b128 a[252:255], v28 offset:30976
    v_rcp_f32 v224, v224
    v_mfma_f32_16x16x32_bf16 v[196:199], a[228:231], v[140:143], v[196:199]
    v_rcp_f32 v225, v225
    v_mfma_f32_16x16x32_bf16 v[204:207], a[232:235], v[140:143], v[204:207]
    ds_read_b128 a[224:227], v28 offset:32768
    v_rcp_f32 v226, v226
    v_mfma_f32_16x16x32_bf16 v[200:203], a[232:235], v[136:139], v[200:203]
    v_rcp_f32 v227, v227
    v_mfma_f32_16x16x16_bf16 v[192:195], a[236:237], v[20:21], v[192:195]
    ds_read_b128 a[228:231], v28 offset:33024
    v_rcp_f32 v228, v228
    v_mfma_f32_16x16x16_bf16 v[196:199], a[236:237], v[22:23], v[196:199]
    v_rcp_f32 v229, v229
    v_mfma_f32_16x16x16_bf16 v[200:203], a[238:239], v[20:21], v[200:203]
    ds_read_b128 a[232:235], v28 offset:34816
    s_waitcnt lgkmcnt(3)
    v_mfma_f32_16x16x16_bf16 v[204:207], a[238:239], v[22:23], v[204:207]
    v_rcp_f32 v230, v230
    v_rcp_f32 v231, v231
    v_pk_mul_f32 v[160:161], v[160:161], v[224:225]
    v_pk_mul_f32 v[162:163], v[162:163], v[226:227]
    v_pk_mul_f32 v[164:165], v[164:165], v[228:229]
    v_pk_mul_f32 v[166:167], v[166:167], v[230:231]
    v_mfma_f32_16x16x32_bf16 v[208:211], a[240:243], v[32:35], 0
    ds_read_b128 a[236:239], v28 offset:35072
    v_cvt_pk_bf16_f32 v236, v160, v161
    v_cvt_pk_bf16_f32 v238, v164, v165
    v_mfma_f32_16x16x32_bf16 v[212:215], a[240:243], v[36:39], 0
    v_cvt_pk_bf16_f32 v237, v162, v163
    v_cvt_pk_bf16_f32 v239, v166, v167
    s_add_u32 s84, s46, 0x0
    v_mfma_f32_16x16x32_bf16 v[220:223], a[244:247], v[36:39], 0
    ds_read_b128 a[240:243], v28 offset:36864
    v_permlane16_swap_b32 v236, v238
    v_mfma_f32_16x16x32_bf16 v[216:219], a[244:247], v[32:35], 0
    v_permlane16_swap_b32 v237, v239
    s_add_u32 s85, s47, 0x0
    v_mfma_f32_16x16x32_bf16 v[208:211], a[248:251], v[40:43], v[208:211]
    ds_read_b128 a[244:247], v28 offset:37120
    s_add_u32 s86, s46, 0x1000
    s_add_u32 s87, s47, 0x1000
    v_mfma_f32_16x16x32_bf16 v[212:215], a[248:251], v[44:47], v[212:215]
    buffer_store_dwordx4 v[236:239], v1, s[4:7], s57 offen offset:1024 sc1
    v_mfma_f32_16x16x32_bf16 v[220:223], a[252:255], v[44:47], v[220:223]
    ds_read_b128 a[248:251], v28 offset:38912
    s_waitcnt lgkmcnt(3)
    s_add_u32 s88, s46, 0xe000
    v_mfma_f32_16x16x32_bf16 v[216:219], a[252:255], v[40:43], v[216:219]
    v_pk_mul_f32 v[224:225], v[176:177], v[26:27] op_sel:[0,0] op_sel_hi:[1,0]
    v_pk_mul_f32 v[226:227], v[178:179], v[26:27] op_sel:[0,0] op_sel_hi:[1,0]
    v_pk_mul_f32 v[228:229], v[180:181], v[26:27] op_sel:[0,1] op_sel_hi:[1,1]
    v_pk_mul_f32 v[230:231], v[182:183], v[26:27] op_sel:[0,1] op_sel_hi:[1,1]
    v_pk_mul_f32 v[176:177], v[176:177], v[184:185]
    v_pk_mul_f32 v[178:179], v[178:179], v[186:187]
    v_pk_mul_f32 v[180:181], v[180:181], v[188:189]
    v_pk_mul_f32 v[182:183], v[182:183], v[190:191]
    v_mfma_f32_16x16x32_bf16 v[208:211], a[224:227], v[48:51], v[208:211]
    ds_read_b128 a[252:255], v28 offset:39168
    v_exp_f32 v224, v224
    v_mfma_f32_16x16x32_bf16 v[212:215], a[224:227], v[52:55], v[212:215]
    v_exp_f32 v225, v225
    s_add_u32 s89, s47, 0xe000
    v_mfma_f32_16x16x32_bf16 v[220:223], a[228:231], v[52:55], v[220:223]
    ds_read_b128 a[224:227], v28 offset:40960
    v_exp_f32 v226, v226
    v_mfma_f32_16x16x32_bf16 v[216:219], a[228:231], v[48:51], v[216:219]
    v_exp_f32 v227, v227
    s_add_u32 s90, s46, 0xf000
    v_mfma_f32_16x16x32_bf16 v[208:211], a[232:235], v[56:59], v[208:211]
    ds_read_b128 a[228:231], v28 offset:41216
    v_exp_f32 v228, v228
    v_mfma_f32_16x16x32_bf16 v[212:215], a[232:235], v[60:63], v[212:215]
    v_exp_f32 v229, v229
    s_add_u32 s91, s47, 0xf000
    v_mfma_f32_16x16x32_bf16 v[220:223], a[236:239], v[60:63], v[220:223]
    ds_read_b128 a[232:235], v28 offset:43008
    s_waitcnt lgkmcnt(3)
    v_mfma_f32_16x16x32_bf16 v[216:219], a[236:239], v[56:59], v[216:219]
    v_exp_f32 v230, v230
    v_exp_f32 v231, v231
    v_pk_fma_f32 v[224:225], v[224:225], v[24:25], v[24:25] op_sel:[0,1,1] op_sel_hi:[1,1,1]
    v_pk_fma_f32 v[226:227], v[226:227], v[24:25], v[24:25] op_sel:[0,1,1] op_sel_hi:[1,1,1]
    v_pk_fma_f32 v[228:229], v[228:229], v[24:25], v[24:25] op_sel:[0,0,0] op_sel_hi:[1,0,0]
    v_pk_fma_f32 v[230:231], v[230:231], v[24:25], v[24:25] op_sel:[0,0,0] op_sel_hi:[1,0,0]
    v_mfma_f32_16x16x32_bf16 v[208:211], a[240:243], v[64:67], v[208:211]
    ds_read_b128 a[236:239], v28 offset:43264
    v_rcp_f32 v224, v224
    v_mfma_f32_16x16x32_bf16 v[212:215], a[240:243], v[68:71], v[212:215]
    v_rcp_f32 v225, v225
    v_mfma_f32_16x16x32_bf16 v[220:223], a[244:247], v[68:71], v[220:223]
    ds_read_b128 a[240:243], v28 offset:45056
    v_rcp_f32 v226, v226
    v_mfma_f32_16x16x32_bf16 v[216:219], a[244:247], v[64:67], v[216:219]
    v_rcp_f32 v227, v227
    v_mfma_f32_16x16x32_bf16 v[208:211], a[248:251], v[72:75], v[208:211]
    ds_read_b128 a[244:247], v28 offset:45312
    v_rcp_f32 v228, v228
    v_mfma_f32_16x16x32_bf16 v[212:215], a[248:251], v[76:79], v[212:215]
    v_rcp_f32 v229, v229
    v_mfma_f32_16x16x32_bf16 v[220:223], a[252:255], v[76:79], v[220:223]
    ds_read_b128 a[248:251], v28 offset:47104
    s_waitcnt lgkmcnt(3)
    v_mfma_f32_16x16x32_bf16 v[216:219], a[252:255], v[72:75], v[216:219]
    v_rcp_f32 v230, v230
    v_rcp_f32 v231, v231
    v_pk_mul_f32 v[176:177], v[176:177], v[224:225]
    v_pk_mul_f32 v[178:179], v[178:179], v[226:227]
    v_pk_mul_f32 v[180:181], v[180:181], v[228:229]
    v_pk_mul_f32 v[182:183], v[182:183], v[230:231]
    v_mfma_f32_16x16x32_bf16 v[208:211], a[224:227], v[80:83], v[208:211]
    ds_read_b128 a[252:255], v28 offset:47360
    v_cvt_pk_bf16_f32 v232, v176, v177
    v_cvt_pk_bf16_f32 v234, v180, v181
    v_mfma_f32_16x16x32_bf16 v[212:215], a[224:227], v[84:87], v[212:215]
    v_cvt_pk_bf16_f32 v233, v178, v179
    v_cvt_pk_bf16_f32 v235, v182, v183
    v_mfma_f32_16x16x32_bf16 v[220:223], a[228:231], v[84:87], v[220:223]
    ds_read_b128 a[224:227], v28 offset:49152
    v_permlane16_swap_b32 v232, v234
    v_mfma_f32_16x16x32_bf16 v[216:219], a[228:231], v[80:83], v[216:219]
    v_permlane16_swap_b32 v233, v235
    v_mfma_f32_16x16x32_bf16 v[208:211], a[232:235], v[88:91], v[208:211]
    ds_read_b128 a[228:231], v28 offset:49408
    v_mfma_f32_16x16x32_bf16 v[212:215], a[232:235], v[92:95], v[212:215]
    buffer_store_dwordx4 v[232:235], v1, s[4:7], s57 offen offset:2048 sc1
    v_mfma_f32_16x16x32_bf16 v[220:223], a[236:239], v[92:95], v[220:223]
    ds_read_b128 a[232:235], v28 offset:51200
    s_waitcnt lgkmcnt(3)
    v_mfma_f32_16x16x32_bf16 v[216:219], a[236:239], v[88:91], v[216:219]
    v_pk_mul_f32 v[224:225], v[192:193], v[26:27] op_sel:[0,0] op_sel_hi:[1,0]
    v_pk_mul_f32 v[226:227], v[194:195], v[26:27] op_sel:[0,0] op_sel_hi:[1,0]
    v_pk_mul_f32 v[228:229], v[196:197], v[26:27] op_sel:[0,1] op_sel_hi:[1,1]
    v_pk_mul_f32 v[230:231], v[198:199], v[26:27] op_sel:[0,1] op_sel_hi:[1,1]
    v_pk_mul_f32 v[192:193], v[192:193], v[200:201]
    v_pk_mul_f32 v[194:195], v[194:195], v[202:203]
    v_pk_mul_f32 v[196:197], v[196:197], v[204:205]
    v_pk_mul_f32 v[198:199], v[198:199], v[206:207]
    v_mfma_f32_16x16x32_bf16 v[208:211], a[240:243], v[96:99], v[208:211]
    ds_read_b128 a[236:239], v28 offset:51456
    v_exp_f32 v224, v224
    v_mfma_f32_16x16x32_bf16 v[212:215], a[240:243], v[100:103], v[212:215]
    v_exp_f32 v225, v225
    v_mfma_f32_16x16x32_bf16 v[220:223], a[244:247], v[100:103], v[220:223]
    ds_read_b128 a[240:243], v28 offset:53248
    v_exp_f32 v226, v226
    v_mfma_f32_16x16x32_bf16 v[216:219], a[244:247], v[96:99], v[216:219]
    v_exp_f32 v227, v227
    v_mfma_f32_16x16x32_bf16 v[208:211], a[248:251], v[104:107], v[208:211]
    ds_read_b128 a[244:247], v28 offset:53504
    v_exp_f32 v228, v228
    v_mfma_f32_16x16x32_bf16 v[212:215], a[248:251], v[108:111], v[212:215]
    v_exp_f32 v229, v229
    v_mfma_f32_16x16x32_bf16 v[220:223], a[252:255], v[108:111], v[220:223]
    ds_read_b128 a[248:251], v28 offset:55296
    s_waitcnt lgkmcnt(3)
    v_mfma_f32_16x16x32_bf16 v[216:219], a[252:255], v[104:107], v[216:219]
    v_exp_f32 v230, v230
    v_exp_f32 v231, v231
    v_pk_fma_f32 v[224:225], v[224:225], v[24:25], v[24:25] op_sel:[0,1,1] op_sel_hi:[1,1,1]
    v_pk_fma_f32 v[226:227], v[226:227], v[24:25], v[24:25] op_sel:[0,1,1] op_sel_hi:[1,1,1]
    v_pk_fma_f32 v[228:229], v[228:229], v[24:25], v[24:25] op_sel:[0,0,0] op_sel_hi:[1,0,0]
    v_pk_fma_f32 v[230:231], v[230:231], v[24:25], v[24:25] op_sel:[0,0,0] op_sel_hi:[1,0,0]
    v_mfma_f32_16x16x32_bf16 v[208:211], a[224:227], v[112:115], v[208:211]
    ds_read_b128 a[252:255], v28 offset:55552
    v_rcp_f32 v224, v224
    v_mfma_f32_16x16x32_bf16 v[212:215], a[224:227], v[116:119], v[212:215]
    v_rcp_f32 v225, v225
    v_mfma_f32_16x16x32_bf16 v[220:223], a[228:231], v[116:119], v[220:223]
    ds_read_b128 a[224:227], v29 offset:30720
    v_rcp_f32 v226, v226
    v_mfma_f32_16x16x32_bf16 v[216:219], a[228:231], v[112:115], v[216:219]
    v_rcp_f32 v227, v227
    v_mfma_f32_16x16x32_bf16 v[208:211], a[232:235], v[120:123], v[208:211]
    v_rcp_f32 v228, v228
    v_mfma_f32_16x16x32_bf16 v[212:215], a[232:235], v[124:127], v[212:215]
    v_rcp_f32 v229, v229
    v_mfma_f32_16x16x32_bf16 v[220:223], a[236:239], v[124:127], v[220:223]
    s_waitcnt vmcnt(10)
    s_barrier
    ds_read_b128 a[228:231], v30 offset:0
    v_mfma_f32_16x16x32_bf16 v[216:219], a[236:239], v[120:123], v[216:219]
    s_waitcnt lgkmcnt(2)
    v_mfma_f32_16x16x32_bf16 v[208:211], a[240:243], v[128:131], v[208:211]
    ds_read_b128 a[232:235], v30 offset:256
    v_mfma_f32_16x16x32_bf16 v[212:215], a[240:243], v[132:135], v[212:215]
    v_rcp_f32 v230, v230
    v_rcp_f32 v231, v231
    v_pk_mul_f32 v[192:193], v[192:193], v[224:225]
    v_pk_mul_f32 v[194:195], v[194:195], v[226:227]
    v_pk_mul_f32 v[196:197], v[196:197], v[228:229]
    v_pk_mul_f32 v[198:199], v[198:199], v[230:231]
    v_mfma_f32_16x16x32_bf16 v[220:223], a[244:247], v[132:135], v[220:223]
    ds_read_b128 a[236:239], v30 offset:2048
    v_mfma_f32_16x16x32_bf16 v[216:219], a[244:247], v[128:131], v[216:219]
    v_or_b32_e64 v9, s3, 9
    s_waitcnt vmcnt(1)
    buffer_store_dword v9, v6, s[4:7], s54 offen offset:512 sc1
    v_mfma_f32_16x16x32_bf16 v[208:211], a[248:251], v[136:139], v[208:211]
    ds_read_b128 a[240:243], v30 offset:2304
    v_cvt_pk_bf16_f32 v236, v192, v193
    v_cvt_pk_bf16_f32 v238, v196, v197
    v_mfma_f32_16x16x32_bf16 v[212:215], a[248:251], v[140:143], v[212:215]
    v_cvt_pk_bf16_f32 v237, v194, v195
    v_cvt_pk_bf16_f32 v239, v198, v199
    v_mfma_f32_16x16x32_bf16 v[220:223], a[252:255], v[140:143], v[220:223]
    ds_read_b128 a[244:247], v30 offset:4096
    s_waitcnt lgkmcnt(3)
    v_mfma_f32_16x16x32_bf16 v[216:219], a[252:255], v[136:139], v[216:219]
    v_permlane16_swap_b32 v236, v238
    v_mfma_f32_16x16x16_bf16 v[208:211], a[224:225], v[20:21], v[208:211]
    ds_read_b128 a[248:251], v30 offset:4352
    v_permlane16_swap_b32 v237, v239
    v_mfma_f32_16x16x16_bf16 v[212:215], a[224:225], v[22:23], v[212:215]
    buffer_store_dwordx4 v[236:239], v1, s[4:7], s57 offen offset:3072 sc1
    v_mfma_f32_16x16x16_bf16 v[216:219], a[226:227], v[20:21], v[216:219]
    ds_read_b128 a[252:255], v30 offset:6144
    v_permlane16_swap_b32 v12, v14
    v_mfma_f32_16x16x16_bf16 v[220:223], a[226:227], v[22:23], v[220:223]
    v_permlane16_swap_b32 v13, v15
    v_mfma_f32_16x16x32_bf16 v[144:147], a[228:231], v[32:35], 0
    ds_read_b128 a[224:227], v30 offset:6400
    v_permlane16_swap_b32 v16, v18
    v_mfma_f32_16x16x32_bf16 v[148:151], a[228:231], v[36:39], 0
    v_permlane16_swap_b32 v17, v19
    v_lshlrev_b32 v176, 16, v12
    v_mfma_f32_16x16x32_bf16 v[156:159], a[232:235], v[36:39], 0
    ds_read_b128 a[228:231], v30 offset:8192
    s_waitcnt lgkmcnt(3)
    v_and_b32 v177, 0xffff0000, v12
    v_mfma_f32_16x16x32_bf16 v[152:155], a[232:235], v[32:35], 0
    v_lshlrev_b32 v178, 16, v13
    v_and_b32 v179, 0xffff0000, v13
    v_lshlrev_b32 v180, 16, v14
    v_mfma_f32_16x16x32_bf16 v[144:147], a[236:239], v[40:43], v[144:147]
    ds_read_b128 a[232:235], v30 offset:8448
    v_and_b32 v181, 0xffff0000, v14
    v_lshlrev_b32 v182, 16, v15
    v_mfma_f32_16x16x32_bf16 v[148:151], a[236:239], v[44:47], v[148:151]
    v_and_b32 v183, 0xffff0000, v15
    v_lshlrev_b32 v184, 16, v16
    v_and_b32 v185, 0xffff0000, v16
    v_mfma_f32_16x16x32_bf16 v[156:159], a[240:243], v[44:47], v[156:159]
    ds_read_b128 a[236:239], v30 offset:10240
    v_lshlrev_b32 v186, 16, v17
    v_and_b32 v187, 0xffff0000, v17
    v_mfma_f32_16x16x32_bf16 v[152:155], a[240:243], v[40:43], v[152:155]
    v_lshlrev_b32 v188, 16, v18
    v_and_b32 v189, 0xffff0000, v18
    v_lshlrev_b32 v190, 16, v19
    v_mfma_f32_16x16x32_bf16 v[144:147], a[244:247], v[48:51], v[144:147]
    ds_read_b128 a[240:243], v30 offset:10496
    v_and_b32 v191, 0xffff0000, v19
    v_mfma_f32_16x16x32_bf16 v[148:151], a[244:247], v[52:55], v[148:151]
    v_pk_mul_f32 v[224:225], v[208:209], v[26:27] op_sel:[0,0] op_sel_hi:[1,0]
    v_pk_mul_f32 v[226:227], v[210:211], v[26:27] op_sel:[0,0] op_sel_hi:[1,0]
    v_pk_mul_f32 v[228:229], v[212:213], v[26:27] op_sel:[0,1] op_sel_hi:[1,1]
    v_pk_mul_f32 v[230:231], v[214:215], v[26:27] op_sel:[0,1] op_sel_hi:[1,1]
    v_pk_mul_f32 v[208:209], v[208:209], v[216:217]
    v_pk_mul_f32 v[210:211], v[210:211], v[218:219]
    v_pk_mul_f32 v[212:213], v[212:213], v[220:221]
    v_pk_mul_f32 v[214:215], v[214:215], v[222:223]
    v_mfma_f32_16x16x32_bf16 v[156:159], a[248:251], v[52:55], v[156:159]
    ds_read_b128 a[244:247], v30 offset:12288
    s_waitcnt lgkmcnt(3)
    v_mfma_f32_16x16x32_bf16 v[152:155], a[248:251], v[48:51], v[152:155]
    v_exp_f32 v224, v224
    v_mfma_f32_16x16x32_bf16 v[144:147], a[252:255], v[56:59], v[144:147]
    ds_read_b128 a[248:251], v30 offset:12544
    v_exp_f32 v225, v225
    v_mfma_f32_16x16x32_bf16 v[148:151], a[252:255], v[60:63], v[148:151]
    v_exp_f32 v226, v226
    v_mfma_f32_16x16x32_bf16 v[156:159], a[224:227], v[60:63], v[156:159]
    ds_read_b128 a[252:255], v30 offset:14336
    v_exp_f32 v227, v227
    v_mfma_f32_16x16x32_bf16 v[152:155], a[224:227], v[56:59], v[152:155]
    v_exp_f32 v228, v228
    v_mfma_f32_16x16x32_bf16 v[144:147], a[228:231], v[64:67], v[144:147]
    ds_read_b128 a[224:227], v30 offset:14592
    v_exp_f32 v229, v229
    v_mfma_f32_16x16x32_bf16 v[148:151], a[228:231], v[68:71], v[148:151]
    v_exp_f32 v230, v230
    v_exp_f32 v231, v231
    v_pk_fma_f32 v[224:225], v[224:225], v[24:25], v[24:25] op_sel:[0,1,1] op_sel_hi:[1,1,1]
    v_pk_fma_f32 v[226:227], v[226:227], v[24:25], v[24:25] op_sel:[0,1,1] op_sel_hi:[1,1,1]
    v_pk_fma_f32 v[228:229], v[228:229], v[24:25], v[24:25] op_sel:[0,0,0] op_sel_hi:[1,0,0]
    v_pk_fma_f32 v[230:231], v[230:231], v[24:25], v[24:25] op_sel:[0,0,0] op_sel_hi:[1,0,0]
    v_mfma_f32_16x16x32_bf16 v[156:159], a[232:235], v[68:71], v[156:159]
    ds_read_b128 a[228:231], v30 offset:16384
    s_waitcnt lgkmcnt(3)
    v_mfma_f32_16x16x32_bf16 v[152:155], a[232:235], v[64:67], v[152:155]
    v_rcp_f32 v224, v224
    v_mfma_f32_16x16x32_bf16 v[144:147], a[236:239], v[72:75], v[144:147]
    ds_read_b128 a[232:235], v30 offset:16640
    buffer_load_dword v8, v10, s[4:7], s56 offen offset:512 sc1
    v_mfma_f32_16x16x32_bf16 v[148:151], a[236:239], v[76:79], v[148:151]
    s_add_u32 s44, s3, 9
    v_rcp_f32 v225, v225
    v_mfma_f32_16x16x32_bf16 v[156:159], a[240:243], v[76:79], v[156:159]
    ds_read_b128 a[236:239], v30 offset:18432
    v_rcp_f32 v226, v226
    v_mfma_f32_16x16x32_bf16 v[152:155], a[240:243], v[72:75], v[152:155]
    v_rcp_f32 v227, v227
    v_mfma_f32_16x16x32_bf16 v[144:147], a[244:247], v[80:83], v[144:147]
    ds_read_b128 a[240:243], v30 offset:18688
    v_rcp_f32 v228, v228
    v_mfma_f32_16x16x32_bf16 v[148:151], a[244:247], v[84:87], v[148:151]
    v_rcp_f32 v229, v229
    v_mfma_f32_16x16x32_bf16 v[156:159], a[248:251], v[84:87], v[156:159]
    ds_read_b128 a[244:247], v30 offset:20480
    s_waitcnt lgkmcnt(3)
    v_mfma_f32_16x16x32_bf16 v[152:155], a[248:251], v[80:83], v[152:155]
    v_rcp_f32 v230, v230
    v_rcp_f32 v231, v231
    v_pk_mul_f32 v[208:209], v[208:209], v[224:225]
    v_pk_mul_f32 v[210:211], v[210:211], v[226:227]
    v_pk_mul_f32 v[212:213], v[212:213], v[228:229]
    v_pk_mul_f32 v[214:215], v[214:215], v[230:231]
    v_mfma_f32_16x16x32_bf16 v[144:147], a[252:255], v[88:91], v[144:147]
    ds_read_b128 a[248:251], v30 offset:20736
    v_cvt_pk_bf16_f32 v232, v208, v209
    v_cvt_pk_bf16_f32 v234, v212, v213
    v_mfma_f32_16x16x32_bf16 v[148:151], a[252:255], v[92:95], v[148:151]
    v_cvt_pk_bf16_f32 v233, v210, v211
    v_cvt_pk_bf16_f32 v235, v214, v215
    v_mfma_f32_16x16x32_bf16 v[156:159], a[224:227], v[92:95], v[156:159]
    ds_read_b128 a[252:255], v30 offset:22528
    v_permlane16_swap_b32 v232, v234
    v_mfma_f32_16x16x32_bf16 v[152:155], a[224:227], v[88:91], v[152:155]
    v_permlane16_swap_b32 v233, v235
    v_mfma_f32_16x16x32_bf16 v[144:147], a[228:231], v[96:99], v[144:147]
    ds_read_b128 a[224:227], v30 offset:22784
    v_mfma_f32_16x16x32_bf16 v[148:151], a[228:231], v[100:103], v[148:151]
    buffer_store_dwordx4 v[232:235], v0, s[4:7], s57 offen sc1
    v_mfma_f32_16x16x32_bf16 v[156:159], a[232:235], v[100:103], v[156:159]
    ds_read_b128 a[228:231], v30 offset:24576
    s_waitcnt lgkmcnt(3)
    v_mfma_f32_16x16x32_bf16 v[152:155], a[232:235], v[96:99], v[152:155]
    v_mfma_f32_16x16x32_bf16 v[144:147], a[236:239], v[104:107], v[144:147]
    ds_read_b128 a[232:235], v30 offset:24832
    v_mfma_f32_16x16x32_bf16 v[148:151], a[236:239], v[108:111], v[148:151]
    v_mfma_f32_16x16x32_bf16 v[156:159], a[240:243], v[108:111], v[156:159]
    ds_read_b128 a[236:239], v30 offset:26624
    v_mfma_f32_16x16x32_bf16 v[152:155], a[240:243], v[104:107], v[152:155]
    v_mfma_f32_16x16x32_bf16 v[144:147], a[244:247], v[112:115], v[144:147]
    ds_read_b128 a[240:243], v30 offset:26880
    v_mfma_f32_16x16x32_bf16 v[148:151], a[244:247], v[116:119], v[148:151]
    v_or_b32_e64 v9, s3, 11
    s_waitcnt vmcnt(2)
    buffer_store_dword v9, v6, s[4:7], s54 offen offset:512 sc1
    v_mfma_f32_16x16x32_bf16 v[156:159], a[248:251], v[116:119], v[156:159]
    ds_read_b128 a[244:247], v29 offset:28928
    s_waitcnt lgkmcnt(3)
    v_mfma_f32_16x16x32_bf16 v[152:155], a[248:251], v[112:115], v[152:155]
    s_waitcnt vmcnt(2)
    v_subrev_u32 v8, s44, v8
    v_cmp_le_u32 vcc, 16, v8
    s_cbranch_vccnz Lfs_310
Lc_311:
    v_mfma_f32_16x16x32_bf16 v[144:147], a[252:255], v[120:123], v[144:147]
    buffer_load_dwordx4 v[240:243], v5, s[4:7], s84 offen sc1
    v_mfma_f32_16x16x32_bf16 v[148:151], a[252:255], v[124:127], v[148:151]
    v_mfma_f32_16x16x32_bf16 v[156:159], a[224:227], v[124:127], v[156:159]
    s_barrier
    ds_read_b128 a[248:251], v30 offset:28672
    v_mfma_f32_16x16x32_bf16 v[152:155], a[224:227], v[120:123], v[152:155]
    v_mfma_f32_16x16x32_bf16 v[144:147], a[228:231], v[128:131], v[144:147]
    ds_read_b128 a[252:255], v30 offset:28928
    buffer_load_dwordx4 v[244:247], v5, s[4:7], s84 offen offset:256 sc1
    v_mfma_f32_16x16x32_bf16 v[148:151], a[228:231], v[132:135], v[148:151]
    v_mfma_f32_16x16x32_bf16 v[156:159], a[232:235], v[132:135], v[156:159]
    ds_read_b128 a[224:227], v30 offset:30720
    s_waitcnt lgkmcnt(3)
    v_mfma_f32_16x16x32_bf16 v[152:155], a[232:235], v[128:131], v[152:155]
    v_mfma_f32_16x16x32_bf16 v[144:147], a[236:239], v[136:139], v[144:147]
    ds_read_b128 a[228:231], v30 offset:30976
    buffer_load_dwordx4 v[248:251], v5, s[4:7], s88 offen sc1
    v_mfma_f32_16x16x32_bf16 v[148:151], a[236:239], v[140:143], v[148:151]
    v_mfma_f32_16x16x32_bf16 v[156:159], a[240:243], v[140:143], v[156:159]
    ds_read_b128 a[232:235], v30 offset:32768
    v_mfma_f32_16x16x32_bf16 v[152:155], a[240:243], v[136:139], v[152:155]
    v_mfma_f32_16x16x16_bf16 v[144:147], a[244:245], v[20:21], v[144:147]
    ds_read_b128 a[236:239], v30 offset:33024
    buffer_load_dwordx4 v[252:255], v5, s[4:7], s88 offen offset:256 sc1
    v_mfma_f32_16x16x16_bf16 v[148:151], a[244:245], v[22:23], v[148:151]
    v_mfma_f32_16x16x16_bf16 v[152:155], a[246:247], v[20:21], v[152:155]
    ds_read_b128 a[240:243], v30 offset:34816
    s_waitcnt lgkmcnt(3)
    v_mfma_f32_16x16x16_bf16 v[156:159], a[246:247], v[22:23], v[156:159]
    v_mfma_f32_16x16x32_bf16 v[160:163], a[248:251], v[32:35], 0
    ds_read_b128 a[244:247], v30 offset:35072
    v_mfma_f32_16x16x32_bf16 v[164:167], a[248:251], v[36:39], 0
    v_mfma_f32_16x16x32_bf16 v[172:175], a[252:255], v[36:39], 0
    ds_read_b128 a[248:251], v30 offset:36864
    v_mfma_f32_16x16x32_bf16 v[168:171], a[252:255], v[32:35], 0
    v_mfma_f32_16x16x32_bf16 v[160:163], a[224:227], v[40:43], v[160:163]
    ds_read_b128 a[252:255], v30 offset:37120
    buffer_load_dwordx4 v[32:35], v5, s[4:7], s84 offen offset:1024 sc1
    v_mfma_f32_16x16x32_bf16 v[164:167], a[224:227], v[44:47], v[164:167]
    v_pk_mul_f32 v[224:225], v[144:145], v[26:27] op_sel:[0,0] op_sel_hi:[1,0]
    v_pk_mul_f32 v[226:227], v[146:147], v[26:27] op_sel:[0,0] op_sel_hi:[1,0]
    v_pk_mul_f32 v[228:229], v[148:149], v[26:27] op_sel:[0,1] op_sel_hi:[1,1]
    v_pk_mul_f32 v[230:231], v[150:151], v[26:27] op_sel:[0,1] op_sel_hi:[1,1]
    v_pk_mul_f32 v[144:145], v[144:145], v[152:153]
    v_pk_mul_f32 v[146:147], v[146:147], v[154:155]
    v_pk_mul_f32 v[148:149], v[148:149], v[156:157]
    v_pk_mul_f32 v[150:151], v[150:151], v[158:159]
    v_mfma_f32_16x16x32_bf16 v[172:175], a[228:231], v[44:47], v[172:175]
    ds_read_b128 a[224:227], v30 offset:38912
    s_waitcnt lgkmcnt(3)
    v_mfma_f32_16x16x32_bf16 v[168:171], a[228:231], v[40:43], v[168:171]
    buffer_load_dwordx4 v[36:39], v5, s[4:7], s84 offen offset:1280 sc1
    v_mfma_f32_16x16x32_bf16 v[160:163], a[232:235], v[48:51], v[160:163]
    ds_read_b128 a[228:231], v30 offset:39168
    v_exp_f32 v224, v224
    v_mfma_f32_16x16x32_bf16 v[164:167], a[232:235], v[52:55], v[164:167]
    v_exp_f32 v225, v225
    v_mfma_f32_16x16x32_bf16 v[172:175], a[236:239], v[52:55], v[172:175]
    ds_read_b128 a[232:235], v30 offset:40960
    buffer_load_dwordx4 v[40:43], v5, s[4:7], s88 offen offset:1024 sc1
    v_mfma_f32_16x16x32_bf16 v[168:171], a[236:239], v[48:51], v[168:171]
    v_exp_f32 v226, v226
    v_mfma_f32_16x16x32_bf16 v[160:163], a[240:243], v[56:59], v[160:163]
    ds_read_b128 a[236:239], v30 offset:41216
    v_exp_f32 v227, v227
    v_mfma_f32_16x16x32_bf16 v[164:167], a[240:243], v[60:63], v[164:167]
    v_exp_f32 v228, v228
    v_mfma_f32_16x16x32_bf16 v[172:175], a[244:247], v[60:63], v[172:175]
    ds_read_b128 a[240:243], v30 offset:43008
    s_waitcnt lgkmcnt(3)
    v_mfma_f32_16x16x32_bf16 v[168:171], a[244:247], v[56:59], v[168:171]
    buffer_load_dwordx4 v[44:47], v5, s[4:7], s88 offen offset:1280 sc1
    v_mfma_f32_16x16x32_bf16 v[160:163], a[248:251], v[64:67], v[160:163]
    ds_read_b128 a[244:247], v30 offset:43264
    v_exp_f32 v229, v229
    v_mfma_f32_16x16x32_bf16 v[164:167], a[248:251], v[68:71], v[164:167]
    v_exp_f32 v230, v230
    v_exp_f32 v231, v231
    v_pk_fma_f32 v[224:225], v[224:225], v[24:25], v[24:25] op_sel:[0,1,1] op_sel_hi:[1,1,1]
    v_pk_fma_f32 v[226:227], v[226:227], v[24:25], v[24:25] op_sel:[0,1,1] op_sel_hi:[1,1,1]
    v_pk_fma_f32 v[228:229], v[228:229], v[24:25], v[24:25] op_sel:[0,0,0] op_sel_hi:[1,0,0]
    v_pk_fma_f32 v[230:231], v[230:231], v[24:25], v[24:25] op_sel:[0,0,0] op_sel_hi:[1,0,0]
    v_mfma_f32_16x16x32_bf16 v[172:175], a[252:255], v[68:71], v[172:175]
    ds_read_b128 a[248:251], v30 offset:45056
    buffer_load_dword v8, v10, s[4:7], s56 offen offset:512 sc1
    v_mfma_f32_16x16x32_bf16 v[168:171], a[252:255], v[64:67], v[168:171]
    s_add_u32 s44, s3, 11
    buffer_load_dwordx4 v[48:51], v5, s[4:7], s85 offen sc1
    v_mfma_f32_16x16x32_bf16 v[160:163], a[224:227], v[72:75], v[160:163]
    ds_read_b128 a[252:255], v30 offset:45312
    v_rcp_f32 v224, v224
    v_mfma_f32_16x16x32_bf16 v[164:167], a[224:227], v[76:79], v[164:167]
    v_rcp_f32 v225, v225
    v_mfma_f32_16x16x32_bf16 v[172:175], a[228:231], v[76:79], v[172:175]
    ds_read_b128 a[224:227], v30 offset:47104
    s_waitcnt lgkmcnt(3)
    v_mfma_f32_16x16x32_bf16 v[168:171], a[228:231], v[72:75], v[168:171]
    buffer_load_dwordx4 v[52:55], v5, s[4:7], s85 offen offset:256 sc1
    v_mfma_f32_16x16x32_bf16 v[160:163], a[232:235], v[80:83], v[160:163]
    ds_read_b128 a[228:231], v30 offset:47360
    v_rcp_f32 v226, v226
    v_mfma_f32_16x16x32_bf16 v[164:167], a[232:235], v[84:87], v[164:167]
    v_rcp_f32 v227, v227
    v_mfma_f32_16x16x32_bf16 v[172:175], a[236:239], v[84:87], v[172:175]
    ds_read_b128 a[232:235], v30 offset:49152
    buffer_load_dwordx4 v[56:59], v5, s[4:7], s89 offen sc1
    v_mfma_f32_16x16x32_bf16 v[168:171], a[236:239], v[80:83], v[168:171]
    v_rcp_f32 v228, v228
    v_mfma_f32_16x16x32_bf16 v[160:163], a[240:243], v[88:91], v[160:163]
    ds_read_b128 a[236:239], v30 offset:49408
    v_rcp_f32 v229, v229
    v_mfma_f32_16x16x32_bf16 v[164:167], a[240:243], v[92:95], v[164:167]
    v_rcp_f32 v230, v230
    v_rcp_f32 v231, v231
    v_pk_mul_f32 v[144:145], v[144:145], v[224:225]
    v_pk_mul_f32 v[146:147], v[146:147], v[226:227]
    v_pk_mul_f32 v[148:149], v[148:149], v[228:229]
    v_pk_mul_f32 v[150:151], v[150:151], v[230:231]
    v_mfma_f32_16x16x32_bf16 v[172:175], a[244:247], v[92:95], v[172:175]
    ds_read_b128 a[240:243], v30 offset:51200
    s_waitcnt lgkmcnt(3)
    v_cvt_pk_bf16_f32 v236, v144, v145
    v_mfma_f32_16x16x32_bf16 v[168:171], a[244:247], v[88:91], v[168:171]
    buffer_load_dwordx4 v[60:63], v5, s[4:7], s89 offen offset:256 sc1
    v_cvt_pk_bf16_f32 v238, v148, v149
    v_mfma_f32_16x16x32_bf16 v[160:163], a[248:251], v[96:99], v[160:163]
    ds_read_b128 a[244:247], v30 offset:51456
    v_cvt_pk_bf16_f32 v237, v146, v147
    v_cvt_pk_bf16_f32 v239, v150, v151
    v_mfma_f32_16x16x32_bf16 v[164:167], a[248:251], v[100:103], v[164:167]
    v_permlane16_swap_b32 v236, v238
    v_mfma_f32_16x16x32_bf16 v[172:175], a[252:255], v[100:103], v[172:175]
    ds_read_b128 a[248:251], v30 offset:53248
    buffer_load_dwordx4 v[64:67], v5, s[4:7], s85 offen offset:1024 sc1
    v_mfma_f32_16x16x32_bf16 v[168:171], a[252:255], v[96:99], v[168:171]
    v_permlane16_swap_b32 v237, v239
    v_mfma_f32_16x16x32_bf16 v[160:163], a[224:227], v[104:107], v[160:163]
    ds_read_b128 a[252:255], v30 offset:53504
    v_mfma_f32_16x16x32_bf16 v[164:167], a[224:227], v[108:111], v[164:167]
    buffer_store_dwordx4 v[236:239], v0, s[4:7], s57 offen offset:1024 sc1
    v_mfma_f32_16x16x32_bf16 v[172:175], a[228:231], v[108:111], v[172:175]
    ds_read_b128 a[224:227], v30 offset:55296
    s_waitcnt lgkmcnt(3)
    v_mfma_f32_16x16x32_bf16 v[168:171], a[228:231], v[104:107], v[168:171]
    v_mfma_f32_16x16x32_bf16 v[160:163], a[232:235], v[112:115], v[160:163]
    ds_read_b128 a[228:231], v30 offset:55552
    v_mfma_f32_16x16x32_bf16 v[164:167], a[232:235], v[116:119], v[164:167]
    s_waitcnt vmcnt(6)
    v_subrev_u32 v8, s44, v8
    v_cmp_le_u32 vcc, 16, v8
    s_cbranch_vccnz Lfs_312
Lc_313:
    v_mfma_f32_16x16x32_bf16 v[172:175], a[236:239], v[116:119], v[172:175]
    ds_read_b128 a[232:235], v29 offset:28672
    v_mfma_f32_16x16x32_bf16 v[168:171], a[236:239], v[112:115], v[168:171]
    v_mfma_f32_16x16x32_bf16 v[160:163], a[240:243], v[120:123], v[160:163]
    buffer_load_dwordx4 v[68:71], v5, s[4:7], s85 offen offset:1280 sc1
    v_mfma_f32_16x16x32_bf16 v[164:167], a[240:243], v[124:127], v[164:167]
    v_mfma_f32_16x16x32_bf16 v[172:175], a[244:247], v[124:127], v[172:175]
    s_waitcnt lgkmcnt(1)
    v_mfma_f32_16x16x32_bf16 v[168:171], a[244:247], v[120:123], v[168:171]
    v_mfma_f32_16x16x32_bf16 v[160:163], a[248:251], v[128:131], v[160:163]
    v_mfma_f32_16x16x32_bf16 v[164:167], a[248:251], v[132:135], v[164:167]
    v_mfma_f32_16x16x32_bf16 v[172:175], a[252:255], v[132:135], v[172:175]
    buffer_load_dwordx4 v[72:75], v5, s[4:7], s89 offen offset:1024 sc1
    v_mfma_f32_16x16x32_bf16 v[168:171], a[252:255], v[128:131], v[168:171]
    v_mfma_f32_16x16x32_bf16 v[160:163], a[224:227], v[136:139], v[160:163]
    v_or_b32_e64 v9, s3, 12
    buffer_store_dword v9, v6, s[4:7], s54 offen offset:512 sc1
    v_mfma_f32_16x16x32_bf16 v[164:167], a[224:227], v[140:143], v[164:167]
    v_mfma_f32_16x16x32_bf16 v[172:175], a[228:231], v[140:143], v[172:175]
    s_waitcnt lgkmcnt(0)
    buffer_load_dwordx4 v[76:79], v5, s[4:7], s89 offen offset:1280 sc1
    v_mfma_f32_16x16x32_bf16 v[168:171], a[228:231], v[136:139], v[168:171]
    v_mfma_f32_16x16x16_bf16 v[160:163], a[232:233], v[20:21], v[160:163]
    v_mfma_f32_16x16x16_bf16 v[164:167], a[232:233], v[22:23], v[164:167]
    v_mfma_f32_16x16x16_bf16 v[168:171], a[234:235], v[20:21], v[168:171]
    buffer_load_dwordx4 v[80:83], v5, s[4:7], s84 offen offset:2048 sc1
    v_mfma_f32_16x16x16_bf16 v[172:175], a[234:235], v[22:23], v[172:175]
LstS4_1s:
    s_cmp_ge_u32 s25, 14
    s_cbranch_scc1 Lidle_314
    v_mfma_f32_16x16x32_bf16 v[176:179], a[12:15], v[240:243], v[176:179]
    v_mfma_f32_16x16x32_bf16 v[184:187], a[40:43], v[240:243], v[184:187]
    v_mfma_f32_16x16x32_bf16 v[192:195], a[124:127], v[240:243], 0
    v_pk_mul_f32 v[224:225], v[160:161], v[26:27] op_sel:[0,0] op_sel_hi:[1,0]
    v_pk_mul_f32 v[226:227], v[162:163], v[26:27] op_sel:[0,0] op_sel_hi:[1,0]
    v_pk_mul_f32 v[228:229], v[164:165], v[26:27] op_sel:[0,1] op_sel_hi:[1,1]
    v_pk_mul_f32 v[230:231], v[166:167], v[26:27] op_sel:[0,1] op_sel_hi:[1,1]
    v_pk_mul_f32 v[160:161], v[160:161], v[168:169]
    v_pk_mul_f32 v[162:163], v[162:163], v[170:171]
    v_pk_mul_f32 v[164:165], v[164:165], v[172:173]
    v_pk_mul_f32 v[166:167], v[166:167], v[174:175]
    v_mfma_f32_16x16x32_bf16 v[200:203], a[152:155], v[240:243], 0
    v_exp_f32 v224, v224
    v_mfma_f32_16x16x32_bf16 v[204:207], a[152:155], v[244:247], 0
    buffer_load_dwordx4 v[84:87], v5, s[4:7], s84 offen offset:2304 sc1
    v_mfma_f32_16x16x32_bf16 v[196:199], a[124:127], v[244:247], 0
    v_exp_f32 v225, v225
    v_mfma_f32_16x16x32_bf16 v[188:191], a[40:43], v[244:247], v[188:191]
    v_exp_f32 v226, v226
    v_mfma_f32_16x16x32_bf16 v[180:183], a[12:15], v[244:247], v[180:183]
    v_exp_f32 v227, v227
    v_mfma_f32_16x16x32_bf16 v[176:179], a[68:71], v[248:251], v[176:179]
    buffer_load_dwordx4 v[88:91], v5, s[4:7], s88 offen offset:2048 sc1
    v_mfma_f32_16x16x32_bf16 v[184:187], a[96:99], v[248:251], v[184:187]
    v_exp_f32 v228, v228
    v_mfma_f32_16x16x32_bf16 v[192:195], a[180:183], v[248:251], v[192:195]
    v_exp_f32 v229, v229
    v_mfma_f32_16x16x32_bf16 v[200:203], a[208:211], v[248:251], v[200:203]
    v_exp_f32 v230, v230
    v_exp_f32 v231, v231
    v_pk_fma_f32 v[224:225], v[224:225], v[24:25], v[24:25] op_sel:[0,1,1] op_sel_hi:[1,1,1]
    v_pk_fma_f32 v[226:227], v[226:227], v[24:25], v[24:25] op_sel:[0,1,1] op_sel_hi:[1,1,1]
    v_pk_fma_f32 v[228:229], v[228:229], v[24:25], v[24:25] op_sel:[0,0,0] op_sel_hi:[1,0,0]
    v_pk_fma_f32 v[230:231], v[230:231], v[24:25], v[24:25] op_sel:[0,0,0] op_sel_hi:[1,0,0]
    v_mfma_f32_16x16x32_bf16 v[204:207], a[208:211], v[252:255], v[204:207]
    buffer_load_dwordx4 v[92:95], v5, s[4:7], s88 offen offset:2304 sc1
    v_mfma_f32_16x16x32_bf16 v[196:199], a[180:183], v[252:255], v[196:199]
    v_rcp_f32 v224, v224
    v_mfma_f32_16x16x32_bf16 v[188:191], a[96:99], v[252:255], v[188:191]
    v_rcp_f32 v225, v225
    v_mfma_f32_16x16x32_bf16 v[180:183], a[68:71], v[252:255], v[180:183]
    v_rcp_f32 v226, v226
    v_mfma_f32_16x16x32_bf16 v[176:179], a[16:19], v[32:35], v[176:179]
    buffer_load_dword v8, v10, s[4:7], s56 offen offset:512 sc1
    v_mfma_f32_16x16x32_bf16 v[184:187], a[44:47], v[32:35], v[184:187]
    s_add_u32 s44, s3, 12
    v_mfma_f32_16x16x32_bf16 v[192:195], a[128:131], v[32:35], v[192:195]
    buffer_load_dwordx4 v[96:99], v5, s[4:7], s85 offen offset:2048 sc1
    v_mfma_f32_16x16x32_bf16 v[200:203], a[156:159], v[32:35], v[200:203]
    v_rcp_f32 v227, v227
    v_mfma_f32_16x16x32_bf16 v[204:207], a[156:159], v[36:39], v[204:207]
    v_or_b32_e64 v9, s3, 13
    s_waitcnt vmcnt(10)
    buffer_store_dword v9, v6, s[4:7], s54 offen offset:512 sc1
    v_mfma_f32_16x16x32_bf16 v[196:199], a[128:131], v[36:39], v[196:199]
    v_rcp_f32 v228, v228
    v_mfma_f32_16x16x32_bf16 v[188:191], a[44:47], v[36:39], v[188:191]
    buffer_load_dwordx4 v[100:103], v5, s[4:7], s85 offen offset:2304 sc1
    v_mfma_f32_16x16x32_bf16 v[180:183], a[16:19], v[36:39], v[180:183]
    v_rcp_f32 v229, v229
    v_mfma_f32_16x16x32_bf16 v[176:179], a[72:75], v[40:43], v[176:179]
    v_rcp_f32 v230, v230
    v_rcp_f32 v231, v231
    v_pk_mul_f32 v[160:161], v[160:161], v[224:225]
    v_pk_mul_f32 v[162:163], v[162:163], v[226:227]
    v_pk_mul_f32 v[164:165], v[164:165], v[228:229]
    v_pk_mul_f32 v[166:167], v[166:167], v[230:231]
    v_mfma_f32_16x16x32_bf16 v[184:187], a[100:103], v[40:43], v[184:187]
    v_cvt_pk_bf16_f32 v232, v160, v161
    v_cvt_pk_bf16_f32 v234, v164, v165
    v_mfma_f32_16x16x32_bf16 v[192:195], a[184:187], v[40:43], v[192:195]
    buffer_load_dwordx4 v[104:107], v5, s[4:7], s89 offen offset:2048 sc1
    v_mfma_f32_16x16x32_bf16 v[200:203], a[212:215], v[40:43], v[200:203]
    v_cvt_pk_bf16_f32 v233, v162, v163
    v_cvt_pk_bf16_f32 v235, v166, v167
    v_mfma_f32_16x16x32_bf16 v[204:207], a[212:215], v[44:47], v[204:207]
    v_permlane16_swap_b32 v232, v234
    v_mfma_f32_16x16x32_bf16 v[196:199], a[184:187], v[44:47], v[196:199]
    v_permlane16_swap_b32 v233, v235
    v_mfma_f32_16x16x32_bf16 v[188:191], a[100:103], v[44:47], v[188:191]
    buffer_load_dwordx4 v[108:111], v5, s[4:7], s89 offen offset:2304 sc1
    v_mfma_f32_16x16x32_bf16 v[180:183], a[72:75], v[44:47], v[180:183]
    buffer_store_dwordx4 v[232:235], v0, s[4:7], s57 offen offset:2048 sc1
    v_mfma_f32_16x16x32_bf16 v[208:211], a[12:15], v[48:51], 0
    v_mfma_f32_16x16x32_bf16 v[216:219], a[40:43], v[48:51], 0
    v_mfma_f32_16x16x32_bf16 v[144:147], a[124:127], v[48:51], 0
    v_mfma_f32_16x16x32_bf16 v[152:155], a[152:155], v[48:51], 0
    v_mfma_f32_16x16x32_bf16 v[156:159], a[152:155], v[52:55], 0
    buffer_load_dwordx4 v[112:115], v5, s[4:7], s84 offen offset:3072 sc1
    v_mfma_f32_16x16x32_bf16 v[148:151], a[124:127], v[52:55], 0
    v_mfma_f32_16x16x32_bf16 v[220:223], a[40:43], v[52:55], 0
    v_mfma_f32_16x16x32_bf16 v[212:215], a[12:15], v[52:55], 0
    s_waitcnt vmcnt(7)
    v_subrev_u32 v8, s44, v8
    v_cmp_le_u32 vcc, 16, v8
    s_cbranch_vccnz Lfs_315
Lc_316:
    v_mfma_f32_16x16x32_bf16 v[208:211], a[68:71], v[56:59], v[208:211]
    buffer_load_dwordx4 v[116:119], v5, s[4:7], s84 offen offset:3328 sc1
    v_mfma_f32_16x16x32_bf16 v[216:219], a[96:99], v[56:59], v[216:219]
    v_mfma_f32_16x16x32_bf16 v[144:147], a[180:183], v[56:59], v[144:147]
    v_mfma_f32_16x16x32_bf16 v[152:155], a[208:211], v[56:59], v[152:155]
    v_mfma_f32_16x16x32_bf16 v[156:159], a[208:211], v[60:63], v[156:159]
    buffer_load_dwordx4 v[120:123], v5, s[4:7], s88 offen offset:3072 sc1
    v_mfma_f32_16x16x32_bf16 v[148:151], a[180:183], v[60:63], v[148:151]
    v_mfma_f32_16x16x32_bf16 v[220:223], a[96:99], v[60:63], v[220:223]
    v_mfma_f32_16x16x32_bf16 v[212:215], a[68:71], v[60:63], v[212:215]
    s_barrier
    v_mfma_f32_16x16x32_bf16 v[208:211], a[16:19], v[64:67], v[208:211]
    buffer_load_dword v8, v10, s[4:7], s56 offen offset:512 sc1
    v_mfma_f32_16x16x32_bf16 v[216:219], a[44:47], v[64:67], v[216:219]
    s_add_u32 s44, s3, 13
    buffer_load_dwordx4 v[124:127], v5, s[4:7], s88 offen offset:3328 sc1
    v_mfma_f32_16x16x32_bf16 v[144:147], a[128:131], v[64:67], v[144:147]
    v_or_b32_e64 v9, s3, 14
    s_waitcnt vmcnt(5)
    buffer_store_dword v9, v6, s[4:7], s54 offen offset:512 sc1
    v_mfma_f32_16x16x32_bf16 v[152:155], a[156:159], v[64:67], v[152:155]
    v_add_u32 v28, s32, v1
    v_add_u32 v29, s33, v1
    v_mfma_f32_16x16x32_bf16 v[156:159], a[156:159], v[68:71], v[156:159]
    buffer_load_dwordx4 v[128:131], v5, s[4:7], s85 offen offset:3072 sc1
    v_mfma_f32_16x16x32_bf16 v[148:151], a[128:131], v[68:71], v[148:151]
    v_add_u32 v30, s34, v1
    v_add_u32 v31, s35, v1
    v_mfma_f32_16x16x32_bf16 v[220:223], a[44:47], v[68:71], v[220:223]
    v_mfma_f32_16x16x32_bf16 v[212:215], a[16:19], v[68:71], v[212:215]
    v_mfma_f32_16x16x32_bf16 v[208:211], a[72:75], v[72:75], v[208:211]
    buffer_load_dwordx4 v[132:135], v5, s[4:7], s85 offen offset:3328 sc1
    v_mfma_f32_16x16x32_bf16 v[216:219], a[100:103], v[72:75], v[216:219]
    v_mfma_f32_16x16x32_bf16 v[144:147], a[184:187], v[72:75], v[144:147]
    v_mfma_f32_16x16x32_bf16 v[152:155], a[212:215], v[72:75], v[152:155]
    v_mfma_f32_16x16x32_bf16 v[156:159], a[212:215], v[76:79], v[156:159]
    buffer_load_dwordx4 v[136:139], v5, s[4:7], s89 offen offset:3072 sc1
    v_mfma_f32_16x16x32_bf16 v[148:151], a[184:187], v[76:79], v[148:151]
    v_mfma_f32_16x16x32_bf16 v[220:223], a[100:103], v[76:79], v[220:223]
    v_mfma_f32_16x16x32_bf16 v[212:215], a[72:75], v[76:79], v[212:215]
    v_mfma_f32_16x16x32_bf16 v[176:179], a[24:27], v[80:83], v[176:179]
    buffer_load_dwordx4 v[140:143], v5, s[4:7], s89 offen offset:3328 sc1
    v_mfma_f32_16x16x32_bf16 v[184:187], a[52:55], v[80:83], v[184:187]
    v_mfma_f32_16x16x32_bf16 v[192:195], a[136:139], v[80:83], v[192:195]
    v_mfma_f32_16x16x32_bf16 v[200:203], a[164:167], v[80:83], v[200:203]
    v_mfma_f32_16x16x32_bf16 v[204:207], a[164:167], v[84:87], v[204:207]
    buffer_load_dwordx4 v[240:243], v5, s[4:7], s86 offen sc1
    v_mfma_f32_16x16x32_bf16 v[196:199], a[136:139], v[84:87], v[196:199]
    v_mfma_f32_16x16x32_bf16 v[188:191], a[52:55], v[84:87], v[188:191]
    v_mfma_f32_16x16x32_bf16 v[180:183], a[24:27], v[84:87], v[180:183]
    s_waitcnt vmcnt(7)
    v_subrev_u32 v8, s44, v8
    v_cmp_le_u32 vcc, 16, v8
    s_cbranch_vccnz Lfs_317
Lc_318:
    v_mfma_f32_16x16x32_bf16 v[176:179], a[80:83], v[88:91], v[176:179]
    buffer_load_dwordx4 v[244:247], v5, s[4:7], s86 offen offset:256 sc1
    v_mfma_f32_16x16x32_bf16 v[184:187], a[108:111], v[88:91], v[184:187]
    v_mfma_f32_16x16x32_bf16 v[192:195], a[192:195], v[88:91], v[192:195]
    v_mfma_f32_16x16x32_bf16 v[200:203], a[220:223], v[88:91], v[200:203]
    v_mfma_f32_16x16x32_bf16 v[204:207], a[220:223], v[92:95], v[204:207]
    buffer_load_dwordx4 v[248:251], v5, s[4:7], s90 offen sc1
    v_mfma_f32_16x16x32_bf16 v[196:199], a[192:195], v[92:95], v[196:199]
    v_mfma_f32_16x16x32_bf16 v[188:191], a[108:111], v[92:95], v[188:191]
    v_mfma_f32_16x16x32_bf16 v[180:183], a[80:83], v[92:95], v[180:183]
    v_mfma_f32_16x16x32_bf16 v[208:211], a[24:27], v[96:99], v[208:211]
    buffer_load_dword v8, v10, s[4:7], s56 offen offset:512 sc1
    v_mfma_f32_16x16x32_bf16 v[216:219], a[52:55], v[96:99], v[216:219]
    s_add_u32 s44, s3, 14
    buffer_load_dwordx4 v[252:255], v5, s[4:7], s90 offen offset:256 sc1
    v_mfma_f32_16x16x32_bf16 v[144:147], a[136:139], v[96:99], v[144:147]
    v_mfma_f32_16x16x32_bf16 v[152:155], a[164:167], v[96:99], v[152:155]
    v_mfma_f32_16x16x32_bf16 v[156:159], a[164:167], v[100:103], v[156:159]
    buffer_load_dwordx4 v[32:35], v5, s[4:7], s87 offen sc1
    v_mfma_f32_16x16x32_bf16 v[148:151], a[136:139], v[100:103], v[148:151]
    v_mul_u32_u24 v164, 224, v3
    v_lshrrev_b32 v165, 5, v1
    v_mfma_f32_16x16x32_bf16 v[220:223], a[52:55], v[100:103], v[220:223]
    v_and_b32 v165, 16, v165
    v_add_u32 v164, v164, v165
    v_mfma_f32_16x16x32_bf16 v[212:215], a[24:27], v[100:103], v[212:215]
    v_mfma_f32_16x16x32_bf16 v[208:211], a[80:83], v[104:107], v[208:211]
    buffer_load_dwordx4 v[36:39], v5, s[4:7], s87 offen offset:256 sc1
    v_mfma_f32_16x16x32_bf16 v[216:219], a[108:111], v[104:107], v[216:219]
    v_mfma_f32_16x16x32_bf16 v[144:147], a[192:195], v[104:107], v[144:147]
    v_mfma_f32_16x16x32_bf16 v[152:155], a[220:223], v[104:107], v[152:155]
    v_mfma_f32_16x16x32_bf16 v[156:159], a[220:223], v[108:111], v[156:159]
    buffer_load_dwordx4 v[40:43], v5, s[4:7], s91 offen sc1
    v_mfma_f32_16x16x32_bf16 v[148:151], a[192:195], v[108:111], v[148:151]
    v_mfma_f32_16x16x32_bf16 v[220:223], a[108:111], v[108:111], v[220:223]
    v_mfma_f32_16x16x32_bf16 v[212:215], a[80:83], v[108:111], v[212:215]
    v_mfma_f32_16x16x32_bf16 v[192:195], a[132:135], v[112:115], v[192:195]
    buffer_load_dwordx4 v[44:47], v5, s[4:7], s91 offen offset:256 sc1
    v_mfma_f32_16x16x32_bf16 v[200:203], a[160:163], v[112:115], v[200:203]
    v_mfma_f32_16x16x32_bf16 v[204:207], a[160:163], v[116:119], v[204:207]
    v_mfma_f32_16x16x32_bf16 v[196:199], a[132:135], v[116:119], v[196:199]
    v_mfma_f32_16x16x32_bf16 v[192:195], a[188:191], v[120:123], v[192:195]
    buffer_load_dwordx4 v[48:51], v5, s[4:7], s86 offen offset:1024 sc1
    v_mfma_f32_16x16x32_bf16 v[200:203], a[216:219], v[120:123], v[200:203]
    s_waitcnt vmcnt(15)
    v_mfma_f32_16x16x32_bf16 v[204:207], a[216:219], v[124:127], v[204:207]
    v_mfma_f32_16x16x32_bf16 v[196:199], a[188:191], v[124:127], v[196:199]
    s_waitcnt vmcnt(6)
    v_subrev_u32 v8, s44, v8
    v_cmp_le_u32 vcc, 16, v8
    s_cbranch_vccnz Lfs_319
Lc_320:
    v_mfma_f32_16x16x32_bf16 v[208:211], a[20:23], v[128:131], v[208:211]
    buffer_load_dwordx4 v[52:55], v5, s[4:7], s86 offen offset:1280 sc1
    v_mfma_f32_16x16x32_bf16 v[216:219], a[48:51], v[128:131], v[216:219]
    v_mfma_f32_16x16x32_bf16 v[144:147], a[132:135], v[128:131], v[144:147]
    v_mfma_f32_16x16x32_bf16 v[152:155], a[160:163], v[128:131], v[152:155]
    v_mfma_f32_16x16x32_bf16 v[156:159], a[160:163], v[132:135], v[156:159]
    buffer_load_dwordx4 v[56:59], v5, s[4:7], s90 offen offset:1024 sc1
    v_mfma_f32_16x16x32_bf16 v[148:151], a[132:135], v[132:135], v[148:151]
    v_mfma_f32_16x16x32_bf16 v[220:223], a[48:51], v[132:135], v[220:223]
    v_mfma_f32_16x16x32_bf16 v[212:215], a[20:23], v[132:135], v[212:215]
    v_mfma_f32_16x16x32_bf16 v[208:211], a[76:79], v[136:139], v[208:211]
    buffer_load_dwordx4 v[60:63], v5, s[4:7], s90 offen offset:1280 sc1
    v_mfma_f32_16x16x32_bf16 v[216:219], a[104:107], v[136:139], v[216:219]
    v_mfma_f32_16x16x32_bf16 v[144:147], a[188:191], v[136:139], v[144:147]
    v_mfma_f32_16x16x32_bf16 v[152:155], a[216:219], v[136:139], v[152:155]
    v_mfma_f32_16x16x32_bf16 v[156:159], a[216:219], v[140:143], v[156:159]
    buffer_load_dwordx4 v[64:67], v5, s[4:7], s87 offen offset:1024 sc1
    v_mfma_f32_16x16x32_bf16 v[148:151], a[188:191], v[140:143], v[148:151]
    v_mfma_f32_16x16x32_bf16 v[220:223], a[104:107], v[140:143], v[220:223]
    v_mfma_f32_16x16x32_bf16 v[212:215], a[76:79], v[140:143], v[212:215]
    v_mfma_f32_16x16x32_bf16 v[192:195], a[120:123], v[240:243], v[192:195]
    buffer_load_dwordx4 v[68:71], v5, s[4:7], s87 offen offset:1280 sc1
    v_mfma_f32_16x16x32_bf16 v[200:203], a[148:151], v[240:243], v[200:203]
    v_mfma_f32_16x16x32_bf16 v[204:207], a[148:151], v[244:247], v[204:207]
    v_mfma_f32_16x16x32_bf16 v[196:199], a[120:123], v[244:247], v[196:199]
    v_mfma_f32_16x16x32_bf16 v[192:195], a[176:179], v[248:251], v[192:195]
    buffer_load_dwordx4 v[72:75], v5, s[4:7], s91 offen offset:1024 sc1
    v_mfma_f32_16x16x32_bf16 v[200:203], a[204:207], v[248:251], v[200:203]
    s_waitcnt vmcnt(11)
    v_mfma_f32_16x16x32_bf16 v[204:207], a[204:207], v[252:255], v[204:207]
    v_mfma_f32_16x16x32_bf16 v[196:199], a[176:179], v[252:255], v[196:199]
    s_waitcnt vmcnt(10)
    v_mfma_f32_16x16x32_bf16 v[208:211], a[8:11], v[32:35], v[208:211]
    buffer_load_dwordx4 v[76:79], v5, s[4:7], s91 offen offset:1280 sc1
    v_mfma_f32_16x16x32_bf16 v[216:219], a[36:39], v[32:35], v[216:219]
    v_mfma_f32_16x16x32_bf16 v[144:147], a[120:123], v[32:35], v[144:147]
    v_mfma_f32_16x16x32_bf16 v[152:155], a[148:151], v[32:35], v[152:155]
    s_waitcnt vmcnt(10)
    v_mfma_f32_16x16x32_bf16 v[156:159], a[148:151], v[36:39], v[156:159]
    buffer_load_dwordx4 v[80:83], v5, s[4:7], s86 offen offset:2048 sc1
    v_mfma_f32_16x16x32_bf16 v[148:151], a[120:123], v[36:39], v[148:151]
    v_mfma_f32_16x16x32_bf16 v[220:223], a[36:39], v[36:39], v[220:223]
    v_mfma_f32_16x16x32_bf16 v[212:215], a[8:11], v[36:39], v[212:215]
    s_waitcnt vmcnt(10)
    v_mfma_f32_16x16x32_bf16 v[208:211], a[64:67], v[40:43], v[208:211]
    buffer_load_dwordx4 v[84:87], v5, s[4:7], s86 offen offset:2304 sc1
    v_mfma_f32_16x16x32_bf16 v[216:219], a[92:95], v[40:43], v[216:219]
    v_mfma_f32_16x16x32_bf16 v[144:147], a[176:179], v[40:43], v[144:147]
    v_mfma_f32_16x16x32_bf16 v[152:155], a[204:207], v[40:43], v[152:155]
    s_waitcnt vmcnt(10)
    v_mfma_f32_16x16x32_bf16 v[156:159], a[204:207], v[44:47], v[156:159]
    buffer_load_dwordx4 v[88:91], v5, s[4:7], s90 offen offset:2048 sc1
    v_mfma_f32_16x16x32_bf16 v[148:151], a[176:179], v[44:47], v[148:151]
    v_mfma_f32_16x16x32_bf16 v[220:223], a[92:95], v[44:47], v[220:223]
    v_mfma_f32_16x16x32_bf16 v[212:215], a[64:67], v[44:47], v[212:215]
    s_waitcnt vmcnt(10)
    v_mfma_f32_16x16x32_bf16 v[192:195], a[116:119], v[48:51], v[192:195]
    buffer_load_dwordx4 v[92:95], v5, s[4:7], s90 offen offset:2304 sc1
    v_mfma_f32_16x16x32_bf16 v[200:203], a[144:147], v[48:51], v[200:203]
    s_waitcnt vmcnt(10)
    v_mfma_f32_16x16x32_bf16 v[204:207], a[144:147], v[52:55], v[204:207]
    v_mfma_f32_16x16x32_bf16 v[196:199], a[116:119], v[52:55], v[196:199]
    s_waitcnt vmcnt(9)
    v_mfma_f32_16x16x32_bf16 v[192:195], a[172:175], v[56:59], v[192:195]
    buffer_load_dwordx4 v[96:99], v5, s[4:7], s87 offen offset:2048 sc1
    v_mfma_f32_16x16x32_bf16 v[200:203], a[200:203], v[56:59], v[200:203]
    s_waitcnt vmcnt(9)
    v_mfma_f32_16x16x32_bf16 v[204:207], a[200:203], v[60:63], v[204:207]
    v_mfma_f32_16x16x32_bf16 v[196:199], a[172:175], v[60:63], v[196:199]
    s_waitcnt vmcnt(8)
    v_mfma_f32_16x16x32_bf16 v[208:211], a[4:7], v[64:67], v[208:211]
    buffer_load_dwordx4 v[100:103], v5, s[4:7], s87 offen offset:2304 sc1
    v_mfma_f32_16x16x32_bf16 v[216:219], a[32:35], v[64:67], v[216:219]
    v_mfma_f32_16x16x32_bf16 v[144:147], a[116:119], v[64:67], v[144:147]
    v_mfma_f32_16x16x32_bf16 v[152:155], a[144:147], v[64:67], v[152:155]
    s_waitcnt vmcnt(8)
    v_mfma_f32_16x16x32_bf16 v[156:159], a[144:147], v[68:71], v[156:159]
    buffer_load_dwordx4 v[104:107], v5, s[4:7], s91 offen offset:2048 sc1
    v_mfma_f32_16x16x32_bf16 v[148:151], a[116:119], v[68:71], v[148:151]
    v_mfma_f32_16x16x32_bf16 v[220:223], a[32:35], v[68:71], v[220:223]
    buffer_load_dwordx4 v[108:111], v5, s[4:7], s91 offen offset:2304 sc1
    v_mfma_f32_16x16x32_bf16 v[212:215], a[4:7], v[68:71], v[212:215]
    s_waitcnt vmcnt(9)
    v_mfma_f32_16x16x32_bf16 v[208:211], a[60:63], v[72:75], v[208:211]
    v_mfma_f32_16x16x32_bf16 v[216:219], a[88:91], v[72:75], v[216:219]
    v_mfma_f32_16x16x32_bf16 v[144:147], a[172:175], v[72:75], v[144:147]
    v_mfma_f32_16x16x32_bf16 v[152:155], a[200:203], v[72:75], v[152:155]
    s_waitcnt vmcnt(8)
    v_mfma_f32_16x16x32_bf16 v[156:159], a[200:203], v[76:79], v[156:159]
    v_mfma_f32_16x16x32_bf16 v[148:151], a[172:175], v[76:79], v[148:151]
    v_mfma_f32_16x16x32_bf16 v[220:223], a[88:91], v[76:79], v[220:223]
    v_mfma_f32_16x16x32_bf16 v[212:215], a[60:63], v[76:79], v[212:215]
    s_waitcnt vmcnt(7)
    v_mfma_f32_16x16x32_bf16 v[192:195], a[112:115], v[80:83], v[192:195]
    v_mfma_f32_16x16x32_bf16 v[200:203], a[140:143], v[80:83], v[200:203]
    s_waitcnt vmcnt(6)
    v_mfma_f32_16x16x32_bf16 v[204:207], a[140:143], v[84:87], v[204:207]
    v_mfma_f32_16x16x32_bf16 v[196:199], a[112:115], v[84:87], v[196:199]
    s_waitcnt vmcnt(5)
    v_mfma_f32_16x16x32_bf16 v[192:195], a[168:171], v[88:91], v[192:195]
    v_mfma_f32_16x16x32_bf16 v[200:203], a[196:199], v[88:91], v[200:203]
    s_waitcnt vmcnt(4)
    v_mfma_f32_16x16x32_bf16 v[204:207], a[196:199], v[92:95], v[204:207]
    v_mfma_f32_16x16x32_bf16 v[196:199], a[168:171], v[92:95], v[196:199]
    s_waitcnt vmcnt(3)
    v_mfma_f32_16x16x32_bf16 v[208:211], a[0:3], v[96:99], v[208:211]
    v_mfma_f32_16x16x32_bf16 v[216:219], a[28:31], v[96:99], v[216:219]
    s_waitcnt vmcnt(2)
    v_mfma_f32_16x16x32_bf16 v[220:223], a[28:31], v[100:103], v[220:223]
    ds_write_b128 v28, v[192:195] offset:0
    v_mfma_f32_16x16x32_bf16 v[212:215], a[0:3], v[100:103], v[212:215]
    s_nop 0
    ds_write_b128 v28, v[196:199] offset:1024
    s_waitcnt vmcnt(1)
    v_mfma_f32_16x16x32_bf16 v[208:211], a[56:59], v[104:107], v[208:211]
    ds_write_b128 v28, v[200:203] offset:2048
    v_mfma_f32_16x16x32_bf16 v[216:219], a[84:87], v[104:107], v[216:219]
    ds_write_b128 v28, v[204:207] offset:3072
    s_waitcnt vmcnt(0)
    v_mfma_f32_16x16x32_bf16 v[220:223], a[84:87], v[108:111], v[220:223]
    v_mfma_f32_16x16x32_bf16 v[212:215], a[56:59], v[108:111], v[212:215]
    v_mfma_f32_16x16x32_bf16 v[144:147], a[112:115], v[96:99], v[144:147]
    v_mfma_f32_16x16x32_bf16 v[152:155], a[140:143], v[96:99], v[152:155]
    v_mfma_f32_16x16x32_bf16 v[156:159], a[140:143], v[100:103], v[156:159]
    ds_write_b128 v29, v[208:211] offset:0
    v_mfma_f32_16x16x32_bf16 v[148:151], a[112:115], v[100:103], v[148:151]
    s_nop 2
    ds_write_b128 v29, v[212:215] offset:1024
    v_mfma_f32_16x16x32_bf16 v[144:147], a[168:171], v[104:107], v[144:147]
    ds_write_b128 v29, v[216:219] offset:2048
    v_mfma_f32_16x16x32_bf16 v[152:155], a[196:199], v[104:107], v[152:155]
    ds_write_b128 v29, v[220:223] offset:3072
    v_mfma_f32_16x16x32_bf16 v[156:159], a[196:199], v[108:111], v[156:159]
    v_mfma_f32_16x16x32_bf16 v[148:151], a[168:171], v[108:111], v[148:151]
    v_mfma_f32_16x16x32_bf16 v[176:179], a[20:23], v[112:115], v[176:179]
    v_mfma_f32_16x16x32_bf16 v[184:187], a[48:51], v[112:115], v[184:187]
    v_mfma_f32_16x16x32_bf16 v[188:191], a[48:51], v[116:119], v[188:191]
    ds_write_b128 v30, v[144:147] offset:0
    v_mfma_f32_16x16x32_bf16 v[180:183], a[20:23], v[116:119], v[180:183]
    s_nop 2
    ds_write_b128 v30, v[148:151] offset:1024
    v_mfma_f32_16x16x32_bf16 v[176:179], a[76:79], v[120:123], v[176:179]
    ds_write_b128 v30, v[152:155] offset:2048
    v_mfma_f32_16x16x32_bf16 v[184:187], a[104:107], v[120:123], v[184:187]
    ds_write_b128 v30, v[156:159] offset:3072
    v_mfma_f32_16x16x32_bf16 v[188:191], a[104:107], v[124:127], v[188:191]
    v_mfma_f32_16x16x32_bf16 v[180:183], a[76:79], v[124:127], v[180:183]
    v_mfma_f32_16x16x32_bf16 v[176:179], a[8:11], v[240:243], v[176:179]
    v_mfma_f32_16x16x32_bf16 v[184:187], a[36:39], v[240:243], v[184:187]
    s_waitcnt lgkmcnt(0)
    s_barrier
    v_mfma_f32_16x16x32_bf16 v[188:191], a[36:39], v[244:247], v[188:191]
    ds_read_b128 v[192:195], v31 offset:0
    ds_read_b128 v[208:211], v31 offset:4096
    v_mfma_f32_16x16x32_bf16 v[180:183], a[8:11], v[244:247], v[180:183]
    ds_read_b128 v[144:147], v31 offset:8192
    ds_read_b128 v[196:199], v31 offset:1024
    v_mfma_f32_16x16x32_bf16 v[176:179], a[64:67], v[248:251], v[176:179]
    ds_read_b128 v[212:215], v31 offset:5120
    ds_read_b128 v[148:151], v31 offset:9216
    v_mfma_f32_16x16x32_bf16 v[184:187], a[92:95], v[248:251], v[184:187]
    ds_read_b128 v[200:203], v31 offset:2048
    ds_read_b128 v[216:219], v31 offset:6144
    v_mfma_f32_16x16x32_bf16 v[188:191], a[92:95], v[252:255], v[188:191]
    ds_read_b128 v[152:155], v31 offset:10240
    ds_read_b128 v[204:207], v31 offset:3072
    v_mfma_f32_16x16x32_bf16 v[180:183], a[64:67], v[252:255], v[180:183]
    ds_read_b128 v[220:223], v31 offset:7168
    ds_read_b128 v[156:159], v31 offset:11264
    v_mfma_f32_16x16x32_bf16 v[176:179], a[4:7], v[48:51], v[176:179]
    s_waitcnt lgkmcnt(10)
    v_add_f32 v192, v192, v208
    v_add_f32 v193, v193, v209
    v_mfma_f32_16x16x32_bf16 v[184:187], a[32:35], v[48:51], v[184:187]
    v_add_f32 v194, v194, v210
    v_add_f32 v195, v195, v211
    v_mfma_f32_16x16x32_bf16 v[188:191], a[32:35], v[52:55], v[188:191]
    s_waitcnt lgkmcnt(9)
    v_add_f32 v192, v192, v144
    v_add_f32 v193, v193, v145
    v_mfma_f32_16x16x32_bf16 v[180:183], a[4:7], v[52:55], v[180:183]
    v_add_f32 v194, v194, v146
    v_add_f32 v195, v195, v147
    v_mfma_f32_16x16x32_bf16 v[176:179], a[60:63], v[56:59], v[176:179]
    s_waitcnt lgkmcnt(7)
    v_add_f32 v196, v196, v212
    v_add_f32 v197, v197, v213
    v_mfma_f32_16x16x32_bf16 v[184:187], a[88:91], v[56:59], v[184:187]
    v_add_f32 v198, v198, v214
    v_add_f32 v199, v199, v215
    v_mfma_f32_16x16x32_bf16 v[188:191], a[88:91], v[60:63], v[188:191]
    s_waitcnt lgkmcnt(6)
    v_add_f32 v196, v196, v148
    v_add_f32 v197, v197, v149
    v_mfma_f32_16x16x32_bf16 v[180:183], a[60:63], v[60:63], v[180:183]
    v_add_f32 v198, v198, v150
    v_add_f32 v199, v199, v151
    v_mfma_f32_16x16x32_bf16 v[176:179], a[0:3], v[80:83], v[176:179]
    s_waitcnt lgkmcnt(4)
    v_add_f32 v200, v200, v216
    v_add_f32 v201, v201, v217
    v_mfma_f32_16x16x32_bf16 v[184:187], a[28:31], v[80:83], v[184:187]
    v_add_f32 v202, v202, v218
    v_add_f32 v203, v203, v219
    v_mfma_f32_16x16x32_bf16 v[188:191], a[28:31], v[84:87], v[188:191]
    s_waitcnt lgkmcnt(3)
    v_add_f32 v200, v200, v152
    v_add_f32 v201, v201, v153
    v_mfma_f32_16x16x32_bf16 v[180:183], a[0:3], v[84:87], v[180:183]
    v_add_f32 v202, v202, v154
    v_add_f32 v203, v203, v155
    v_mfma_f32_16x16x32_bf16 v[176:179], a[56:59], v[88:91], v[176:179]
    s_waitcnt lgkmcnt(1)
    v_add_f32 v204, v204, v220
    v_add_f32 v205, v205, v221
    v_mfma_f32_16x16x32_bf16 v[184:187], a[84:87], v[88:91], v[184:187]
    v_add_f32 v206, v206, v222
    v_add_f32 v207, v207, v223
    v_mfma_f32_16x16x32_bf16 v[188:191], a[84:87], v[92:95], v[188:191]
    s_waitcnt lgkmcnt(0)
    v_add_f32 v204, v204, v156
    v_add_f32 v205, v205, v157
    v_mfma_f32_16x16x32_bf16 v[180:183], a[56:59], v[92:95], v[180:183]
    v_add_f32 v206, v206, v158
    v_add_f32 v207, v207, v159
    v_pk_add_f32 v[176:177], v[176:177], v[192:193]
    v_pk_add_f32 v[178:179], v[178:179], v[194:195]
    v_cvt_pk_bf16_f32 v12, v176, v177
    v_cvt_pk_bf16_f32 v13, v178, v179
    s_nop 1
    v_pk_add_f32 v[180:181], v[180:181], v[196:197]
    v_pk_add_f32 v[182:183], v[182:183], v[198:199]
    v_cvt_pk_bf16_f32 v14, v180, v181
    v_cvt_pk_bf16_f32 v15, v182, v183
    s_nop 0
    v_permlane16_swap_b32 v12, v14
    v_permlane16_swap_b32 v13, v15
    s_nop 0
    v_permlane32_swap_b32 v12, v14
    v_permlane32_swap_b32 v13, v15
    buffer_store_dwordx4 v[12:15], v164, s[8:11], s52 offen
    v_pk_add_f32 v[184:185], v[184:185], v[200:201]
    v_pk_add_f32 v[186:187], v[186:187], v[202:203]
    v_cvt_pk_bf16_f32 v16, v184, v185
    v_cvt_pk_bf16_f32 v17, v186, v187
    v_pk_add_f32 v[188:189], v[188:189], v[204:205]
    v_pk_add_f32 v[190:191], v[190:191], v[206:207]
    v_cvt_pk_bf16_f32 v18, v188, v189
    v_cvt_pk_bf16_f32 v19, v190, v191
    s_nop 0
    v_permlane16_swap_b32 v16, v18
    v_permlane16_swap_b32 v17, v19
    s_nop 0
    v_permlane32_swap_b32 v16, v18
    v_permlane32_swap_b32 v17, v19
    buffer_store_dwordx4 v[16:19], v164, s[8:11], s52 offen offset:32
Lfin_258:
Lend_257:
    s_endpgm
Lidle_281:
    s_waitcnt lgkmcnt(0)
    s_nop 7
    s_nop 7
    s_waitcnt vmcnt(0)
    s_barrier
    s_add_u32 m0, s55, 0xe000
    s_add_u32 s64, s39, 0xe000
    buffer_load_dwordx4 v1, s[4:7], s64 offen lds
    buffer_load_dwordx4 v1, s[4:7], s64 offen offset:1024 lds
    buffer_load_dwordx4 v1, s[4:7], s64 offen offset:2048 lds
    buffer_load_dwordx4 v1, s[4:7], s64 offen offset:3072 lds
    s_add_u32 m0, s55, 0xf000
    s_nop 0
    buffer_load_dwordx4 v0, s[4:7], s64 offen lds
    buffer_load_dwordx4 v0, s[4:7], s64 offen offset:1024 lds
    buffer_load_dwordx4 v0, s[4:7], s64 offen offset:2048 lds
    s_waitcnt vmcnt(0) lgkmcnt(0)
    s_branch LstS3_0s
Lfs_287:
    s_cmp_eq_u32 s30, 0
    s_cbranch_scc1 Lc_288
    s_sub_u32 s30, s30, 1
    buffer_load_dword v8, v10, s[4:7], s56 offen offset:512 sc1
    s_waitcnt vmcnt(0)
    v_subrev_u32 v8, s44, v8
    v_cmp_le_u32 vcc, 16, v8
    s_cbranch_vccnz Lfs_287
    s_branch Lc_288
Lfs_289:
    s_cmp_eq_u32 s30, 0
    s_cbranch_scc1 Lc_290
    s_sub_u32 s30, s30, 1
    buffer_load_dword v8, v10, s[4:7], s56 offen offset:512 sc1
    s_waitcnt vmcnt(0)
    v_subrev_u32 v8, s44, v8
    v_cmp_le_u32 vcc, 16, v8
    s_cbranch_vccnz Lfs_289
    s_branch Lc_290
Lidle_291:
    s_waitcnt lgkmcnt(0)
    s_nop 7
    s_nop 7
    v_pk_mul_f32 v[224:225], v[160:161], v[26:27] op_sel:[0,0] op_sel_hi:[1,0]
    v_pk_mul_f32 v[226:227], v[162:163], v[26:27] op_sel:[0,0] op_sel_hi:[1,0]
    v_pk_mul_f32 v[228:229], v[164:165], v[26:27] op_sel:[0,1] op_sel_hi:[1,1]
    v_pk_mul_f32 v[230:231], v[166:167], v[26:27] op_sel:[0,1] op_sel_hi:[1,1]
    v_pk_mul_f32 v[160:161], v[160:161], v[168:169]
    v_pk_mul_f32 v[162:163], v[162:163], v[170:171]
    v_pk_mul_f32 v[164:165], v[164:165], v[172:173]
    v_pk_mul_f32 v[166:167], v[166:167], v[174:175]
    v_exp_f32 v224, v224
    v_exp_f32 v225, v225
    v_exp_f32 v226, v226
    v_exp_f32 v227, v227
    v_exp_f32 v228, v228
    v_exp_f32 v229, v229
    v_exp_f32 v230, v230
    v_exp_f32 v231, v231
    v_pk_fma_f32 v[224:225], v[224:225], v[24:25], v[24:25] op_sel:[0,1,1] op_sel_hi:[1,1,1]
    v_pk_fma_f32 v[226:227], v[226:227], v[24:25], v[24:25] op_sel:[0,1,1] op_sel_hi:[1,1,1]
    v_pk_fma_f32 v[228:229], v[228:229], v[24:25], v[24:25] op_sel:[0,0,0] op_sel_hi:[1,0,0]
    v_pk_fma_f32 v[230:231], v[230:231], v[24:25], v[24:25] op_sel:[0,0,0] op_sel_hi:[1,0,0]
    v_rcp_f32 v224, v224
    v_rcp_f32 v225, v225
    v_rcp_f32 v226, v226
    v_rcp_f32 v227, v227
    v_rcp_f32 v228, v228
    v_rcp_f32 v229, v229
    v_rcp_f32 v230, v230
    v_rcp_f32 v231, v231
    v_pk_mul_f32 v[160:161], v[160:161], v[224:225]
    v_pk_mul_f32 v[162:163], v[162:163], v[226:227]
    v_pk_mul_f32 v[164:165], v[164:165], v[228:229]
    v_pk_mul_f32 v[166:167], v[166:167], v[230:231]
    v_cvt_pk_bf16_f32 v232, v160, v161
    v_cvt_pk_bf16_f32 v234, v164, v165
    v_cvt_pk_bf16_f32 v233, v162, v163
    v_cvt_pk_bf16_f32 v235, v166, v167
    v_permlane16_swap_b32 v232, v234
    s_nop 0
    v_permlane16_swap_b32 v233, v235
    buffer_store_dwordx4 v[232:235], v0, s[4:7], s57 offen offset:2048 sc1
    v_or_b32_e64 v9, s3, 6
    s_waitcnt vmcnt(0)
    buffer_store_dword v9, v6, s[4:7], s54 offen offset:512 sc1
    v_lshlrev_b32 v4, 3, v1
    v_min_u32 v4, 7040, v4
    s_barrier
    s_add_u32 m0, s55, 0x7000
    s_add_u32 s76, s96, 0x7000
    buffer_load_dwordx4 v7, s[4:7], s76 offen lds
    buffer_load_dwordx4 v7, s[4:7], s76 offen offset:1024 lds
    buffer_load_dwordx4 v7, s[4:7], s76 offen offset:2048 lds
    buffer_load_dwordx4 v7, s[4:7], s76 offen offset:3072 lds
    s_add_u32 m0, s55, 0x8000
    s_add_u32 s76, s76, 4096
    buffer_load_dwordx4 v7, s[4:7], s76 offen lds
    buffer_load_dwordx4 v7, s[4:7], s76 offen offset:1024 lds
    buffer_load_dwordx4 v7, s[4:7], s76 offen offset:2048 lds
    s_add_u32 m0, s55, 0x0
    s_add_u32 s75, s96, 0x0
    buffer_load_dwordx4 v7, s[4:7], s75 offen lds
    buffer_load_dwordx4 v7, s[4:7], s75 offen offset:1024 lds
    buffer_load_dwordx4 v7, s[4:7], s75 offen offset:2048 lds
    buffer_load_dwordx4 v7, s[4:7], s75 offen offset:3072 lds
    s_add_u32 m0, s55, 0x1000
    s_add_u32 s75, s75, 4096
    buffer_load_dwordx4 v7, s[4:7], s75 offen lds
    buffer_load_dwordx4 v7, s[4:7], s75 offen offset:1024 lds
    buffer_load_dwordx4 v7, s[4:7], s75 offen offset:2048 lds
    s_waitcnt vmcnt(0) lgkmcnt(0)
    s_branch LstS1_1s
Lfs_292:
    s_cmp_eq_u32 s30, 0
    s_cbranch_scc1 Lc_293
    s_sub_u32 s30, s30, 1
    buffer_load_dword v8, v10, s[4:7], s56 offen offset:512 sc1
    s_waitcnt vmcnt(0)
    v_subrev_u32 v8, s44, v8
    v_cmp_le_u32 vcc, 16, v8
    s_cbranch_vccnz Lfs_292
    s_branch Lc_293
Lfs_294:
    s_cmp_eq_u32 s30, 0
    s_cbranch_scc1 Lc_295
    s_sub_u32 s30, s30, 1
    buffer_load_dword v8, v10, s[4:7], s56 offen offset:512 sc1
    s_waitcnt vmcnt(0)
    v_subrev_u32 v8, s44, v8
    v_cmp_le_u32 vcc, 16, v8
    s_cbranch_vccnz Lfs_294
    s_branch Lc_295
Lfs_296:
    s_cmp_eq_u32 s30, 0
    s_cbranch_scc1 Lc_297
    s_sub_u32 s30, s30, 1
    buffer_load_dword v8, v10, s[4:7], s56 offen offset:512 sc1
    s_waitcnt vmcnt(0)
    v_subrev_u32 v8, s44, v8
    v_cmp_le_u32 vcc, 16, v8
    s_cbranch_vccnz Lfs_296
    s_branch Lc_297
Lre_301:
    s_cmp_eq_u32 s30, 0
    s_cbranch_scc1 Lc_302
    s_sub_u32 s30, s30, 1
    s_mov_b32 s97, m0
    s_add_u32 m0, s84, 2048
    s_nop 0
    buffer_load_dwordx4 v25, s[4:7], s89 offen sc1 lds
    s_sub_u32 m0, s84, 256
    s_nop 0
    buffer_load_dwordx4 v25, s[4:7], s89 offen offset:3072 sc1 lds
    buffer_load_dword v208, v2, s[4:7], s90 offen sc1
    buffer_load_dword v209, v2, s[4:7], s90 offen offset:256 sc1
    buffer_load_dword v210, v2, s[4:7], s90 offen offset:512 sc1
    buffer_load_dword v211, v2, s[4:7], s90 offen offset:640 sc1
    s_mov_b32 m0, s97
    s_waitcnt vmcnt(0)
    ds_read_b128 v[224:227], v30 offset:2048
    ds_read_b128 v[228:231], v30 offset:2304
    ds_read_b128 v[232:235], v30 offset:2560
    ds_read_b128 v[236:239], v30 offset:2816
    ds_read_b128 v[240:243], v30 offset:3072
    ds_read_b128 v[244:247], v30 offset:3328
    ds_read_b128 v[248:251], v30 offset:3584
    v_max3_u32 v27, v208, v209, v210
    s_waitcnt lgkmcnt(6)
    v_max3_u32 v27, v27, v211, v224
    s_waitcnt lgkmcnt(4)
    v_max3_u32 v27, v27, v228, v232
    s_waitcnt lgkmcnt(2)
    v_max3_u32 v27, v27, v236, v240
    s_waitcnt lgkmcnt(0)
    v_max3_u32 v27, v27, v244, v248
    v_cmp_eq_u32 vcc, -1, v27
    s_cbranch_vccnz Lre_301
    s_branch Lc_302
Lidle_304:
    s_waitcnt lgkmcnt(0)
    s_nop 7
    s_nop 7
    s_waitcnt vmcnt(0)
    s_barrier
    s_add_u32 m0, s55, 0x0
    s_add_u32 s66, s39, 0x23000
    buffer_load_dwordx4 v1, s[4:7], s66 offen lds
    buffer_load_dwordx4 v1, s[4:7], s66 offen offset:1024 lds
    buffer_load_dwordx4 v1, s[4:7], s66 offen offset:2048 lds
    buffer_load_dwordx4 v1, s[4:7], s66 offen offset:3072 lds
    s_add_u32 m0, s55, 0x1000
    s_nop 0
    buffer_load_dwordx4 v0, s[4:7], s66 offen lds
    buffer_load_dwordx4 v0, s[4:7], s66 offen offset:1024 lds
    buffer_load_dwordx4 v0, s[4:7], s66 offen offset:2048 lds
    s_waitcnt vmcnt(0) lgkmcnt(0)
    s_branch LstS3_1s
Lfs_310:
    s_cmp_eq_u32 s30, 0
    s_cbranch_scc1 Lc_311
    s_sub_u32 s30, s30, 1
    buffer_load_dword v8, v10, s[4:7], s56 offen offset:512 sc1
    s_waitcnt vmcnt(0)
    v_subrev_u32 v8, s44, v8
    v_cmp_le_u32 vcc, 16, v8
    s_cbranch_vccnz Lfs_310
    s_branch Lc_311
Lfs_312:
    s_cmp_eq_u32 s30, 0
    s_cbranch_scc1 Lc_313
    s_sub_u32 s30, s30, 1
    buffer_load_dword v8, v10, s[4:7], s56 offen offset:512 sc1
    s_waitcnt vmcnt(0)
    v_subrev_u32 v8, s44, v8
    v_cmp_le_u32 vcc, 16, v8
    s_cbranch_vccnz Lfs_312
    s_branch Lc_313
Lidle_314:
    s_waitcnt lgkmcnt(0)
    s_nop 7
    s_nop 7
    v_pk_mul_f32 v[224:225], v[160:161], v[26:27] op_sel:[0,0] op_sel_hi:[1,0]
    v_pk_mul_f32 v[226:227], v[162:163], v[26:27] op_sel:[0,0] op_sel_hi:[1,0]
    v_pk_mul_f32 v[228:229], v[164:165], v[26:27] op_sel:[0,1] op_sel_hi:[1,1]
    v_pk_mul_f32 v[230:231], v[166:167], v[26:27] op_sel:[0,1] op_sel_hi:[1,1]
    v_pk_mul_f32 v[160:161], v[160:161], v[168:169]
    v_pk_mul_f32 v[162:163], v[162:163], v[170:171]
    v_pk_mul_f32 v[164:165], v[164:165], v[172:173]
    v_pk_mul_f32 v[166:167], v[166:167], v[174:175]
    v_exp_f32 v224, v224
    v_exp_f32 v225, v225
    v_exp_f32 v226, v226
    v_exp_f32 v227, v227
    v_exp_f32 v228, v228
    v_exp_f32 v229, v229
    v_exp_f32 v230, v230
    v_exp_f32 v231, v231
    v_pk_fma_f32 v[224:225], v[224:225], v[24:25], v[24:25] op_sel:[0,1,1] op_sel_hi:[1,1,1]
    v_pk_fma_f32 v[226:227], v[226:227], v[24:25], v[24:25] op_sel:[0,1,1] op_sel_hi:[1,1,1]
    v_pk_fma_f32 v[228:229], v[228:229], v[24:25], v[24:25] op_sel:[0,0,0] op_sel_hi:[1,0,0]
    v_pk_fma_f32 v[230:231], v[230:231], v[24:25], v[24:25] op_sel:[0,0,0] op_sel_hi:[1,0,0]
    v_rcp_f32 v224, v224
    v_rcp_f32 v225, v225
    v_rcp_f32 v226, v226
    v_rcp_f32 v227, v227
    v_rcp_f32 v228, v228
    v_rcp_f32 v229, v229
    v_rcp_f32 v230, v230
    v_rcp_f32 v231, v231
    v_pk_mul_f32 v[160:161], v[160:161], v[224:225]
    v_pk_mul_f32 v[162:163], v[162:163], v[226:227]
    v_pk_mul_f32 v[164:165], v[164:165], v[228:229]
    v_pk_mul_f32 v[166:167], v[166:167], v[230:231]
    v_cvt_pk_bf16_f32 v232, v160, v161
    v_cvt_pk_bf16_f32 v234, v164, v165
    v_cvt_pk_bf16_f32 v233, v162, v163
    v_cvt_pk_bf16_f32 v235, v166, v167
    v_permlane16_swap_b32 v232, v234
    s_nop 0
    v_permlane16_swap_b32 v233, v235
    buffer_store_dwordx4 v[232:235], v0, s[4:7], s57 offen offset:2048 sc1
    v_or_b32_e64 v9, s3, 14
    s_waitcnt vmcnt(0)
    buffer_store_dword v9, v6, s[4:7], s54 offen offset:512 sc1
    s_waitcnt vmcnt(0) lgkmcnt(0)
    s_branch Lfin_258
Lfs_315:
    s_cmp_eq_u32 s30, 0
    s_cbranch_scc1 Lc_316
    s_sub_u32 s30, s30, 1
    buffer_load_dword v8, v10, s[4:7], s56 offen offset:512 sc1
    s_waitcnt vmcnt(0)
    v_subrev_u32 v8, s44, v8
    v_cmp_le_u32 vcc, 16, v8
    s_cbranch_vccnz Lfs_315
    s_branch Lc_316
Lfs_317:
    s_cmp_eq_u32 s30, 0
    s_cbranch_scc1 Lc_318
    s_sub_u32 s30, s30, 1
    buffer_load_dword v8, v10, s[4:7], s56 offen offset:512 sc1
    s_waitcnt vmcnt(0)
    v_subrev_u32 v8, s44, v8
    v_cmp_le_u32 vcc, 16, v8
    s_cbranch_vccnz Lfs_317
    s_branch Lc_318
Lfs_319:
    s_cmp_eq_u32 s30, 0
    s_cbranch_scc1 Lc_320
    s_sub_u32 s30, s30, 1
    buffer_load_dword v8, v10, s[4:7], s56 offen offset:512 sc1
    s_waitcnt vmcnt(0)
    v_subrev_u32 v8, s44, v8
    v_cmp_le_u32 vcc, 16, v8
    s_cbranch_vccnz Lfs_319
    s_branch Lc_320
Lmain_end:
.section .rodata,"a"
.p2align 6
.amdhsa_kernel interleave_layers__sliding_local_dilated__swiglu_ffn__prompt_kernel
  .amdhsa_next_free_vgpr 512
  .amdhsa_next_free_sgpr 102
  .amdhsa_accum_offset 256
  .amdhsa_group_segment_fixed_size 0
  .amdhsa_kernarg_size 80
  .amdhsa_user_sgpr_count 2
  .amdhsa_user_sgpr_kernarg_segment_ptr 1
  .amdhsa_system_sgpr_workgroup_id_x 1
.end_amdhsa_kernel
```
